```python
import torch

def _softmax(x, axis=-1):
    return torch.softmax(x, dim=axis)
def _gelu(x):
    return torch.nn.functional.gelu(x, approximate="tanh")
def _silu(x):
    return torch.nn.functional.silu(x)
def _sigmoid(x):
    return torch.sigmoid(x)
def _layernorm(x, axis=-1, eps=1e-5):
    m = x.mean(dim=axis, keepdim=True)
    v = x.var(dim=axis, keepdim=True, unbiased=False)
    return (x - m) / torch.sqrt(v + eps)
def _scatter_add(tgt, idx, src, axis=0):
    return tgt.clone().index_add_(axis, idx, src)
def _segment_sum(src, seg, n):
    out = torch.zeros((n,) + src.shape[1:], dtype=src.dtype)
    return out.index_add_(0, seg, src)
def _pad(x, pw):
    flat = tuple(v for pair in reversed(pw) for v in pair)
    return torch.nn.functional.pad(x, flat)

kernel_name = 'recurrent_scan__spectral_fnet__glu_gated_reglu__prompt'

def setup_inputs():

    _w = (lambda a: (lambda t: t.to(torch.bfloat16) if t.is_floating_point() else t)(torch.as_tensor(a)))
    def _A_setup():
        B, S, D = 1, 2048, 576
        ns = torch.arange(S)[:, None] * torch.arange(S)[None, :]
        nd = torch.arange(D)[:, None] * torch.arange(D)[None, :]
        Ws_re = torch.cos(-2.0 * torch.pi * ns / S).to(float)
        Ws_im = torch.sin(-2.0 * torch.pi * ns / S).to(float)
        Wd_re = torch.cos(-2.0 * torch.pi * nd / D).to(float)
        Wd_im = torch.sin(-2.0 * torch.pi * nd / D).to(float)
        return {
            "x": _w((lambda *s: torch.randn(*s, dtype=torch.bfloat16) * 0.05)(B, S, D)),
            "dft_seq_re": _w(Ws_re),
            "dft_seq_im": _w(Ws_im),
            "dft_hid_re": _w(Wd_re),
            "dft_hid_im": _w(Wd_im),
        }
    _A_in = _A_setup()

    def _B_setup():
        B, S, D, F = 1, 2048, 576, 4608
        return {
            "x": _w((lambda *s: torch.randn(*s, dtype=torch.bfloat16) * 0.05)(B, S, D)),
            "W_gate": _w((lambda *s: torch.randn(*s, dtype=torch.bfloat16) * 0.05)(D, F) * (2.0 / D) ** 0.5),
            "W_up": _w((lambda *s: torch.randn(*s, dtype=torch.bfloat16) * 0.05)(D, F) * (2.0 / D) ** 0.5),
            "W_down": _w((lambda *s: torch.randn(*s, dtype=torch.bfloat16) * 0.05)(F, D) * (1.0 / F) ** 0.5),
        }
    _B_in = _B_setup()

    return {
        "A_x": _A_in["x"],
        "A_dft_seq_re": _A_in["dft_seq_re"],
        "A_dft_seq_im": _A_in["dft_seq_im"],
        "A_dft_hid_re": _A_in["dft_hid_re"],
        "A_dft_hid_im": _A_in["dft_hid_im"],
        "B_x": _B_in["x"],
        "B_W_gate": _B_in["W_gate"],
        "B_W_up": _B_in["W_up"],
        "B_W_down": _B_in["W_down"],
    }

def reference(A_x, A_dft_seq_re, A_dft_seq_im, A_dft_hid_re, A_dft_hid_im, B_x, B_W_gate, B_W_up, B_W_down):
    def _A_ref(x, dft_seq_re, dft_seq_im, dft_hid_re, dft_hid_im):
        a = torch.einsum("bsd,ed->bse", x, dft_hid_re)
        b = torch.einsum("bsd,ed->bse", x, dft_hid_im)
        y = torch.einsum("ts,bse->bte", dft_seq_re, a) - torch.einsum("ts,bse->bte", dft_seq_im, b)
        return y

    def _B_ref(x, W_gate, W_up, W_down):
        gate = torch.einsum("bsd,df->bsf", x, W_gate)
        up = torch.einsum("bsd,df->bsf", x, W_up)
        gate = gate * (lambda x, dt: x.to(dt))(gate > 0, gate.dtype)
        h = gate * up
        return torch.einsum("bsf,fd->bsd", h, W_down)

    x = A_x
    xn = _layernorm(x, axis=-1)
    s = _A_ref(xn, A_dft_seq_re, A_dft_seq_im, A_dft_hid_re, A_dft_hid_im)
    g = _silu(_B_ref(xn, B_W_gate, B_W_up, B_W_down))
    return x + s * g
```

```asm
; @launch grid=(256,1,1) block=(256,1,1) lds=163840
.amdgcn_target "amdgcn-amd-amdhsa--gfx950"
.text
.globl recurrent_scan__spectral_fnet__glu_gated_reglu__prompt_kernel
.p2align 8
.type recurrent_scan__spectral_fnet__glu_gated_reglu__prompt_kernel,@function
recurrent_scan__spectral_fnet__glu_gated_reglu__prompt_kernel:
s_cmp_ge_u32 s2, 256
s_cbranch_scc1 L_end
s_load_dwordx16 s[4:19], s[0:1], 0
s_load_dwordx8 s[20:27], s[0:1], 64
s_getpc_b64 s[56:57]
s_and_b32 s56, s56, 0xffffff00
s_mov_b32 s58, L_end-recurrent_scan__spectral_fnet__glu_gated_reglu__prompt_kernel
s_mov_b32 s59, 0x20000
s_lshr_b32 s3, s2, 3
s_lshl_b32 s3, s3, 12
v_lshlrev_b32 v255, 4, v0
buffer_load_dwordx4 a[252:255], v255, s[56:59], s3 offen
v_lshrrev_b32 v2, 6, v0
v_and_b32 v1, 63, v0
s_and_b32 s73, s2, 7
v_readfirstlane_b32 s60, v2
s_lshr_b32 s74, s2, 3
s_and_b32 s61, s73, 1
s_lshl_b32 s61, s61, 3
s_and_b32 s75, s74, 7
s_add_u32 s61, s61, s75
s_lshr_b32 s62, s73, 1
s_lshl_b32 s62, s62, 2
s_lshr_b32 s75, s74, 3
s_add_u32 s62, s62, s75
s_and_b32 s73, s61, 3
s_lshl_b32 s73, s73, 2
s_cmp_gt_u32 s62, s73
s_cselect_b32 s74, 4, 0
s_sub_u32 s74, s62, s74
s_cmp_eq_u32 s62, s73
s_cselect_b32 s74, 12, s74
s_cmp_eq_u32 s75, 0
s_cselect_b32 s62, s74, s62
s_mul_i32 s64, s60, 40960
v_lshrrev_b32 v5, 2, v1
v_lshrrev_b32 v6, 5, v1
v_lshlrev_b32 v6, 1, v6
v_and_b32 v7, 3, v1
v_xor_b32 v6, v6, v7
v_lshlrev_b32 v6, 4, v6
v_mul_u32_u24 v8, 1152, v5
v_add_u32 v8, v8, v6
s_lshl_b32 s98, s61, 7
s_lshl_b32 s74, s60, 5
s_add_u32 s98, s98, s74
s_mul_i32 s98, s98, 1152
s_add_u32 s99, s98, 18432
s_and_b32 s74, s62, 3
s_mul_i32 s74, s74, 4608
s_add_u32 s74, s74, s98
s_add_u32 s75, s74, 18432
v_lshlrev_b32 v2, 7, v1
v_cmp_gt_u32 vcc, 36, v1
v_mov_b32 v3, 2147483392
s_mov_b32 s30, 2359296
s_mov_b32 s31, 0x20000
v_cndmask_b32 v2, v3, v2, vcc
s_lshl_b32 s73, s61, 2
s_waitcnt lgkmcnt(0)
s_mov_b32 s28, s4
s_mov_b32 s29, s5
s_load_dword s63, s[26:27], s73
s_load_dword s68, s[26:27], 64
v_mov_b32 v21, 2147483392
v_mov_b32 v23, 0
s_cmp_eq_u32 s62, 12
s_cbranch_scc1 L_aux
s_and_b32 s73, s62, 3
s_cbranch_scc0 L_ffn4_pre
L_ffn:
s_add_u32 m0, s64, 0
s_nop 0
buffer_load_dwordx4 v8, s[28:31], s98 offen offset:0 lds
s_add_u32 m0, s64, 960
s_nop 0
buffer_load_dwordx4 v8, s[28:31], s98 offen offset:64 lds
s_add_u32 m0, s64, 1920
v_and_b32 v2, 15, v1
buffer_load_dwordx4 v8, s[28:31], s98 offen offset:128 lds
s_add_u32 m0, s64, 2880
v_lshrrev_b32 v3, 4, v1
v_bfe_u32 v4, v1, 3, 1
buffer_load_dwordx4 v8, s[28:31], s98 offen offset:192 lds
s_add_u32 m0, s64, 3840
v_lshlrev_b32 v7, 1, v4
buffer_load_dwordx4 v8, s[28:31], s98 offen offset:256 lds
s_add_u32 m0, s64, 4800
v_xor_b32 v7, v7, v3
v_lshlrev_b32 v7, 4, v7
buffer_load_dwordx4 v8, s[28:31], s98 offen offset:320 lds
s_add_u32 m0, s64, 5760
v_lshl_add_u32 v7, v2, 6, v7
v_add_u32 v9, s64, v7
buffer_load_dwordx4 v8, s[28:31], s98 offen offset:384 lds
s_add_u32 m0, s64, 6720
v_mov_b32 v24, 0x3f803f80
buffer_load_dwordx4 v8, s[28:31], s98 offen offset:448 lds
s_add_u32 m0, s64, 7680
v_mov_b32 v25, 0x3f803f80
v_mov_b32 v26, 0x3f803f80
buffer_load_dwordx4 v8, s[28:31], s98 offen offset:512 lds
s_add_u32 m0, s64, 8640
v_mov_b32 v27, 0x3f803f80
buffer_load_dwordx4 v8, s[28:31], s98 offen offset:576 lds
s_add_u32 m0, s64, 9600
s_mov_b32 s32, s26
s_mov_b32 s33, s27
buffer_load_dwordx4 v8, s[28:31], s98 offen offset:640 lds
s_add_u32 m0, s64, 10560
s_mov_b32 s34, 36962304
s_mov_b32 s35, 0x20000
buffer_load_dwordx4 v8, s[28:31], s98 offen offset:704 lds
s_add_u32 m0, s64, 11520
s_mov_b32 s36, s16
s_mov_b32 s37, s17
buffer_load_dwordx4 v8, s[28:31], s98 offen offset:768 lds
s_waitcnt lgkmcnt(0)
s_waitcnt vmcnt(12)
ds_read_b128 v[92:95], v9 offset:0
buffer_store_dword v23, v21, s[32:35], 0 offen sc1
s_add_u32 m0, s64, 12480
s_mov_b32 s38, 5308416
s_mov_b32 s39, 0x20000
buffer_load_dwordx4 v8, s[28:31], s98 offen offset:832 lds
s_waitcnt vmcnt(13)
ds_read_b128 v[100:103], v9 offset:1024
s_add_u32 m0, s64, 13440
s_sub_u32 s40, s18, 1024
s_subb_u32 s41, s19, 0
s_mov_b32 s42, 5309440
buffer_load_dwordx4 v8, s[28:31], s98 offen offset:896 lds
s_waitcnt vmcnt(13)
ds_read_b128 v[108:111], v9 offset:2048
s_waitcnt lgkmcnt(2)
v_mfma_f32_16x16x32_bf16 v[28:31], v[24:27], v[92:95], 0
v_mfma_f32_16x16x32_bf16 v[236:239], v[92:95], v[92:95], 0
s_add_u32 m0, s64, 14400
s_mov_b32 s43, 0x20000
s_mov_b32 s52, s22
buffer_load_dwordx4 v8, s[28:31], s98 offen offset:960 lds
s_waitcnt vmcnt(13)
ds_read_b128 v[116:119], v9 offset:3072
s_waitcnt lgkmcnt(2)
v_mfma_f32_16x16x32_bf16 v[28:31], v[24:27], v[100:103], v[28:31]
v_mfma_f32_16x16x32_bf16 v[236:239], v[100:103], v[100:103], v[236:239]
s_add_u32 m0, s64, 15360
s_mov_b32 s53, s23
s_lshr_b32 s80, s62, 2
buffer_load_dwordx4 v8, s[28:31], s98 offen offset:1024 lds
s_waitcnt vmcnt(13)
ds_read_b128 v[124:127], v9 offset:4096
s_waitcnt lgkmcnt(2)
v_mfma_f32_16x16x32_bf16 v[28:31], v[24:27], v[108:111], v[28:31]
v_mfma_f32_16x16x32_bf16 v[236:239], v[108:111], v[108:111], v[236:239]
s_add_u32 m0, s64, 16320
s_and_b32 s81, s62, 3
s_sub_u32 s7, s81, 1
s_cmp_eq_u32 s81, 0
s_cselect_b32 s6, 4, s80
s_cselect_b32 s7, s80, s7
s_cselect_b32 s23, 3, 4
buffer_load_dwordx4 v8, s[28:31], s98 offen offset:1088 lds
s_waitcnt vmcnt(13)
ds_read_b128 v[132:135], v9 offset:5120
s_waitcnt lgkmcnt(2)
v_mfma_f32_16x16x32_bf16 v[28:31], v[24:27], v[116:119], v[28:31]
v_mfma_f32_16x16x32_bf16 v[236:239], v[116:119], v[116:119], v[236:239]
s_add_u32 m0, s64, 18432
s_lshl_b32 s9, s80, 3
s_lshr_b32 s9, 0x35220f00, s9
buffer_load_dwordx4 v8, s[28:31], s99 offen offset:0 lds
s_waitcnt vmcnt(13)
ds_read_b128 v[140:143], v9 offset:6144
s_waitcnt lgkmcnt(2)
v_mfma_f32_16x16x32_bf16 v[28:31], v[24:27], v[124:127], v[28:31]
v_mfma_f32_16x16x32_bf16 v[236:239], v[124:127], v[124:127], v[236:239]
s_add_u32 m0, s64, 19392
s_and_b32 s9, s9, 0xff
s_cmp_eq_u32 s6, 4
s_cselect_b32 s8, 0x1c0e00, 0
s_cselect_b32 s9, 30, s9
buffer_load_dwordx4 v8, s[28:31], s99 offen offset:64 lds
s_waitcnt vmcnt(13)
ds_read_b128 v[148:151], v9 offset:7168
s_waitcnt lgkmcnt(2)
v_mfma_f32_16x16x32_bf16 v[28:31], v[24:27], v[132:135], v[28:31]
v_mfma_f32_16x16x32_bf16 v[236:239], v[132:135], v[132:135], v[236:239]
s_add_u32 m0, s64, 20352
s_add_u32 s8, s8, 0x0a0500
s_lshl_b32 s66, s7, 3
buffer_load_dwordx4 v8, s[28:31], s99 offen offset:128 lds
s_waitcnt vmcnt(13)
ds_read_b128 v[156:159], v9 offset:8192
s_waitcnt lgkmcnt(2)
v_mfma_f32_16x16x32_bf16 v[28:31], v[24:27], v[140:143], v[28:31]
v_mfma_f32_16x16x32_bf16 v[236:239], v[140:143], v[140:143], v[236:239]
s_add_u32 m0, s64, 21312
s_lshr_b32 s66, s8, s66
s_and_b32 s66, s66, 0xff
buffer_load_dwordx4 v8, s[28:31], s99 offen offset:192 lds
s_waitcnt vmcnt(13)
ds_read_b128 v[164:167], v9 offset:9216
s_waitcnt lgkmcnt(2)
v_mfma_f32_16x16x32_bf16 v[28:31], v[24:27], v[148:151], v[28:31]
v_mfma_f32_16x16x32_bf16 v[236:239], v[148:151], v[148:151], v[236:239]
s_add_u32 m0, s64, 22272
s_add_u32 s66, s66, s9
s_mov_b32 s65, s66
buffer_load_dwordx4 v8, s[28:31], s99 offen offset:256 lds
s_waitcnt vmcnt(13)
ds_read_b128 v[172:175], v9 offset:10240
s_waitcnt lgkmcnt(2)
v_mfma_f32_16x16x32_bf16 v[28:31], v[24:27], v[156:159], v[28:31]
v_mfma_f32_16x16x32_bf16 v[236:239], v[156:159], v[156:159], v[236:239]
s_add_u32 m0, s64, 23232
s_mov_b32 s18, 128
s_lshl_b32 s65, s65, 7
s_add_u32 s19, s65, s18
buffer_load_dwordx4 v8, s[28:31], s99 offen offset:320 lds
s_waitcnt vmcnt(13)
ds_read_b128 v[180:183], v9 offset:11264
s_waitcnt lgkmcnt(2)
v_mfma_f32_16x16x32_bf16 v[28:31], v[24:27], v[164:167], v[28:31]
v_mfma_f32_16x16x32_bf16 v[236:239], v[164:167], v[164:167], v[236:239]
s_add_u32 m0, s64, 24192
s_nop 0
buffer_load_dwordx4 v8, s[28:31], s99 offen offset:384 lds
s_waitcnt vmcnt(13)
ds_read_b128 v[188:191], v9 offset:12288
s_waitcnt lgkmcnt(2)
v_mfma_f32_16x16x32_bf16 v[28:31], v[24:27], v[172:175], v[28:31]
v_mfma_f32_16x16x32_bf16 v[236:239], v[172:175], v[172:175], v[236:239]
s_add_u32 m0, s64, 25152
v_bfe_u32 v5, v1, 2, 2
v_lshrrev_b32 v3, 4, v1
v_and_b32 v6, 3, v1
v_cmp_eq_u32 vcc, v5, v3
v_mul_u32_u24 v7, 40960, v3
v_lshl_add_u32 v7, v5, 7, v7
buffer_load_dwordx4 v8, s[28:31], s99 offen offset:448 lds
s_waitcnt vmcnt(12)
ds_read_b128 v[196:199], v9 offset:13312
s_waitcnt lgkmcnt(2)
v_mfma_f32_16x16x32_bf16 v[28:31], v[24:27], v[180:183], v[28:31]
v_mfma_f32_16x16x32_bf16 v[236:239], v[180:183], v[180:183], v[236:239]
s_add_u32 m0, s64, 26112
v_lshl_add_u32 v7, v6, 3, v7
v_and_b32 v3, 1, v3
v_lshl_or_b32 v4, v3, 1, v4
v_and_b32 v3, 1, v6
v_lshlrev_b32 v3, 4, v3
v_mov_b32 v5, 0x3f80
v_lshlrev_b32 v3, v3, v5
buffer_load_dwordx4 v8, s[28:31], s99 offen offset:512 lds
s_waitcnt vmcnt(12)
ds_read_b128 v[204:207], v9 offset:14336
s_waitcnt lgkmcnt(2)
v_mfma_f32_16x16x32_bf16 v[28:31], v[24:27], v[188:191], v[28:31]
v_mfma_f32_16x16x32_bf16 v[236:239], v[188:191], v[188:191], v[236:239]
s_add_u32 m0, s64, 27072
v_cndmask_b32 v3, 0, v3, vcc
v_cmp_gt_u32 vcc, 2, v6
v_mov_b32 v244, 0
v_mov_b32 v245, 0
v_cndmask_b32 v246, 0, v3, vcc
v_cndmask_b32 v247, v3, 0, vcc
v_mov_b32 v248, 0
buffer_load_dwordx4 v8, s[28:31], s99 offen offset:576 lds
s_waitcnt vmcnt(12)
ds_read_b128 v[212:215], v9 offset:15360
s_waitcnt lgkmcnt(2)
v_mfma_f32_16x16x32_bf16 v[28:31], v[24:27], v[196:199], v[28:31]
v_mfma_f32_16x16x32_bf16 v[236:239], v[196:199], v[196:199], v[236:239]
s_add_u32 m0, s64, 28032
v_mov_b32 v249, 0
v_xor_b32 v3, 0, v4
v_lshl_add_u32 v11, v3, 5, v7
v_xor_b32 v3, 1, v4
v_lshl_add_u32 v12, v3, 5, v7
v_xor_b32 v3, 2, v4
v_lshl_add_u32 v13, v3, 5, v7
buffer_load_dwordx4 v8, s[28:31], s99 offen offset:640 lds
s_waitcnt vmcnt(12)
ds_read_b128 v[220:223], v9 offset:16384
s_waitcnt lgkmcnt(2)
v_mfma_f32_16x16x32_bf16 v[28:31], v[24:27], v[204:207], v[28:31]
v_mfma_f32_16x16x32_bf16 v[236:239], v[204:207], v[204:207], v[236:239]
s_add_u32 m0, s64, 28992
v_xor_b32 v3, 3, v4
v_lshl_add_u32 v14, v3, 5, v7
v_lshlrev_b32 v20, 4, v1
v_lshrrev_b32 v5, 3, v1
v_bfe_u32 v6, v1, 4, 1
s_and_b32 s80, s60, 1
s_lshl_b32 s80, s80, 1
buffer_load_dwordx4 v8, s[28:31], s99 offen offset:704 lds
s_waitcnt vmcnt(12)
ds_read_b128 v[228:231], v9 offset:17408
s_waitcnt lgkmcnt(2)
v_mfma_f32_16x16x32_bf16 v[28:31], v[24:27], v[212:215], v[28:31]
v_mfma_f32_16x16x32_bf16 v[236:239], v[212:215], v[212:215], v[236:239]
s_add_u32 m0, s64, 29952
v_or_b32 v6, s80, v6
v_lshlrev_b32 v6, 1, v6
v_and_b32 v4, 7, v1
v_xor_b32 v6, v6, v4
v_lshlrev_b32 v15, 4, v6
s_lshl_b32 s80, s60, 3
v_add_u32 v4, s80, v5
buffer_load_dwordx4 v8, s[28:31], s99 offen offset:768 lds
s_waitcnt vmcnt(12)
ds_read_b128 v[96:99], v9 offset:18432
s_waitcnt lgkmcnt(2)
v_mfma_f32_16x16x32_bf16 v[28:31], v[24:27], v[220:223], v[28:31]
v_mfma_f32_16x16x32_bf16 v[236:239], v[220:223], v[220:223], v[236:239]
s_add_u32 m0, s64, 30912
v_mul_u32_u24 v4, 9216, v4
v_add_u32 v10, v4, v15
s_mov_b32 s12, 0
s_lshl_b32 s4, s2, 2
s_add_u32 s4, s4, s60
s_sub_u32 s4, s4, 256
s_cselect_b32 s4, 0x10000, s4
s_mul_i32 s4, s4, 2304
buffer_load_dwordx4 v8, s[28:31], s99 offen offset:832 lds
s_waitcnt vmcnt(12)
ds_read_b128 v[104:107], v9 offset:19456
s_waitcnt lgkmcnt(2)
v_mfma_f32_16x16x32_bf16 v[28:31], v[24:27], v[228:231], v[28:31]
v_mfma_f32_16x16x32_bf16 v[236:239], v[228:231], v[228:231], v[236:239]
s_add_u32 m0, s64, 31872
s_nop 0
buffer_load_dwordx4 v8, s[28:31], s99 offen offset:896 lds
s_waitcnt vmcnt(12)
ds_read_b128 v[112:115], v9 offset:20480
s_waitcnt lgkmcnt(2)
v_mfma_f32_16x16x32_bf16 v[32:35], v[24:27], v[96:99], 0
v_mfma_f32_16x16x32_bf16 v[240:243], v[96:99], v[96:99], 0
v_mul_f32 v18, 0x3ae38e39, v28
v_cvt_pk_bf16_f32 v36, v18, v18
v_lshlrev_b32 v36, 16, v36
v_xor_b32 v36, 0x80000000, v36
v_mov_b32 v37, v36
v_mov_b32 v38, v36
v_mov_b32 v39, v36
s_add_u32 m0, s64, 32832
s_nop 0
buffer_load_dwordx4 v8, s[28:31], s99 offen offset:960 lds
s_waitcnt vmcnt(12)
ds_read_b128 v[120:123], v9 offset:21504
s_waitcnt lgkmcnt(2)
v_mfma_f32_16x16x32_bf16 v[32:35], v[24:27], v[104:107], v[32:35]
v_mfma_f32_16x16x32_bf16 v[240:243], v[104:107], v[104:107], v[240:243]
v_mfma_f32_16x16x32_bf16 v[44:47], v[246:249], v[92:95], v[36:39]
v_mfma_f32_16x16x32_bf16 v[48:51], v[244:247], v[92:95], v[36:39]
v_mfma_f32_16x16x32_bf16 v[52:55], v[246:249], v[100:103], v[36:39]
v_mfma_f32_16x16x32_bf16 v[56:59], v[244:247], v[100:103], v[36:39]
s_add_u32 m0, s64, 33792
s_nop 0
buffer_load_dwordx4 v8, s[28:31], s99 offen offset:1024 lds
s_waitcnt vmcnt(12)
ds_read_b128 v[128:131], v9 offset:22528
s_waitcnt lgkmcnt(2)
v_mfma_f32_16x16x32_bf16 v[32:35], v[24:27], v[112:115], v[32:35]
v_mfma_f32_16x16x32_bf16 v[240:243], v[112:115], v[112:115], v[240:243]
v_mfma_f32_16x16x32_bf16 v[60:63], v[246:249], v[108:111], v[36:39]
v_cvt_pk_bf16_f32 v92, v44, v45
v_cvt_pk_bf16_f32 v93, v46, v47
v_mfma_f32_16x16x32_bf16 v[64:67], v[244:247], v[108:111], v[36:39]
v_cvt_pk_bf16_f32 v94, v48, v49
v_cvt_pk_bf16_f32 v95, v50, v51
v_mfma_f32_16x16x32_bf16 v[68:71], v[246:249], v[116:119], v[36:39]
v_cvt_pk_bf16_f32 v100, v52, v53
v_cvt_pk_bf16_f32 v101, v54, v55
v_mfma_f32_16x16x32_bf16 v[72:75], v[244:247], v[116:119], v[36:39]
v_cvt_pk_bf16_f32 v102, v56, v57
v_cvt_pk_bf16_f32 v103, v58, v59
s_add_u32 m0, s64, 34752
s_nop 0
buffer_load_dwordx4 v8, s[28:31], s99 offen offset:1088 lds
s_waitcnt vmcnt(12)
ds_read_b128 v[136:139], v9 offset:23552
s_waitcnt lgkmcnt(2)
v_mfma_f32_16x16x32_bf16 v[32:35], v[24:27], v[120:123], v[32:35]
v_mfma_f32_16x16x32_bf16 v[240:243], v[120:123], v[120:123], v[240:243]
v_mfma_f32_16x16x32_bf16 v[44:47], v[246:249], v[124:127], v[36:39]
v_cvt_pk_bf16_f32 v108, v60, v61
v_cvt_pk_bf16_f32 v109, v62, v63
v_mfma_f32_16x16x32_bf16 v[48:51], v[244:247], v[124:127], v[36:39]
v_cvt_pk_bf16_f32 v110, v64, v65
v_cvt_pk_bf16_f32 v111, v66, v67
v_mfma_f32_16x16x32_bf16 v[52:55], v[246:249], v[132:135], v[36:39]
v_cvt_pk_bf16_f32 v116, v68, v69
v_cvt_pk_bf16_f32 v117, v70, v71
v_mfma_f32_16x16x32_bf16 v[56:59], v[244:247], v[132:135], v[36:39]
v_cvt_pk_bf16_f32 v118, v72, v73
v_cvt_pk_bf16_f32 v119, v74, v75
s_waitcnt vmcnt(11)
ds_read_b128 v[144:147], v9 offset:24576
s_waitcnt lgkmcnt(2)
v_mfma_f32_16x16x32_bf16 v[32:35], v[24:27], v[128:131], v[32:35]
v_mfma_f32_16x16x32_bf16 v[240:243], v[128:131], v[128:131], v[240:243]
v_mfma_f32_16x16x32_bf16 v[60:63], v[246:249], v[140:143], v[36:39]
v_cvt_pk_bf16_f32 v124, v44, v45
v_cvt_pk_bf16_f32 v125, v46, v47
v_mfma_f32_16x16x32_bf16 v[64:67], v[244:247], v[140:143], v[36:39]
v_cvt_pk_bf16_f32 v126, v48, v49
v_cvt_pk_bf16_f32 v127, v50, v51
v_mfma_f32_16x16x32_bf16 v[68:71], v[246:249], v[148:151], v[36:39]
v_cvt_pk_bf16_f32 v132, v52, v53
v_cvt_pk_bf16_f32 v133, v54, v55
v_mfma_f32_16x16x32_bf16 v[72:75], v[244:247], v[148:151], v[36:39]
v_cvt_pk_bf16_f32 v134, v56, v57
v_cvt_pk_bf16_f32 v135, v58, v59
s_add_u32 m0, s64, 0
s_add_u32 s67, s65, 0
buffer_load_dwordx4 v10, s[36:39], s67 offen lds
buffer_load_dwordx4 v10, s[40:43], s67 offen offset:1024 lds
s_waitcnt vmcnt(12)
ds_read_b128 v[152:155], v9 offset:25600
s_waitcnt lgkmcnt(2)
v_mfma_f32_16x16x32_bf16 v[32:35], v[24:27], v[136:139], v[32:35]
v_mfma_f32_16x16x32_bf16 v[240:243], v[136:139], v[136:139], v[240:243]
v_mfma_f32_16x16x32_bf16 v[44:47], v[246:249], v[156:159], v[36:39]
v_cvt_pk_bf16_f32 v140, v60, v61
v_cvt_pk_bf16_f32 v141, v62, v63
v_mfma_f32_16x16x32_bf16 v[48:51], v[244:247], v[156:159], v[36:39]
v_cvt_pk_bf16_f32 v142, v64, v65
v_cvt_pk_bf16_f32 v143, v66, v67
v_mfma_f32_16x16x32_bf16 v[52:55], v[246:249], v[164:167], v[36:39]
v_cvt_pk_bf16_f32 v148, v68, v69
v_cvt_pk_bf16_f32 v149, v70, v71
v_mfma_f32_16x16x32_bf16 v[56:59], v[244:247], v[164:167], v[36:39]
v_cvt_pk_bf16_f32 v150, v72, v73
v_cvt_pk_bf16_f32 v151, v74, v75
s_waitcnt vmcnt(11)
ds_read_b128 v[160:163], v9 offset:26624
s_waitcnt lgkmcnt(2)
v_mfma_f32_16x16x32_bf16 v[32:35], v[24:27], v[144:147], v[32:35]
v_mfma_f32_16x16x32_bf16 v[240:243], v[144:147], v[144:147], v[240:243]
v_mfma_f32_16x16x32_bf16 v[60:63], v[246:249], v[172:175], v[36:39]
v_cvt_pk_bf16_f32 v156, v44, v45
v_cvt_pk_bf16_f32 v157, v46, v47
v_mfma_f32_16x16x32_bf16 v[64:67], v[244:247], v[172:175], v[36:39]
v_cvt_pk_bf16_f32 v158, v48, v49
v_cvt_pk_bf16_f32 v159, v50, v51
v_mfma_f32_16x16x32_bf16 v[68:71], v[246:249], v[180:183], v[36:39]
v_cvt_pk_bf16_f32 v164, v52, v53
v_cvt_pk_bf16_f32 v165, v54, v55
v_mfma_f32_16x16x32_bf16 v[72:75], v[244:247], v[180:183], v[36:39]
v_cvt_pk_bf16_f32 v166, v56, v57
v_cvt_pk_bf16_f32 v167, v58, v59
s_add_u32 m0, s64, 2048
s_add_u32 s67, s65, 294912
buffer_load_dwordx4 v10, s[36:39], s67 offen lds
buffer_load_dwordx4 v10, s[40:43], s67 offen offset:1024 lds
s_waitcnt vmcnt(12)
ds_read_b128 v[168:171], v9 offset:27648
s_waitcnt lgkmcnt(2)
v_mfma_f32_16x16x32_bf16 v[32:35], v[24:27], v[152:155], v[32:35]
v_mfma_f32_16x16x32_bf16 v[240:243], v[152:155], v[152:155], v[240:243]
v_mfma_f32_16x16x32_bf16 v[44:47], v[246:249], v[188:191], v[36:39]
v_cvt_pk_bf16_f32 v172, v60, v61
v_cvt_pk_bf16_f32 v173, v62, v63
v_mfma_f32_16x16x32_bf16 v[48:51], v[244:247], v[188:191], v[36:39]
v_cvt_pk_bf16_f32 v174, v64, v65
v_cvt_pk_bf16_f32 v175, v66, v67
v_mfma_f32_16x16x32_bf16 v[52:55], v[246:249], v[196:199], v[36:39]
v_cvt_pk_bf16_f32 v180, v68, v69
v_cvt_pk_bf16_f32 v181, v70, v71
v_mfma_f32_16x16x32_bf16 v[56:59], v[244:247], v[196:199], v[36:39]
v_cvt_pk_bf16_f32 v182, v72, v73
v_cvt_pk_bf16_f32 v183, v74, v75
s_waitcnt vmcnt(11)
ds_read_b128 v[176:179], v9 offset:28672
s_waitcnt lgkmcnt(2)
v_mfma_f32_16x16x32_bf16 v[32:35], v[24:27], v[160:163], v[32:35]
v_mfma_f32_16x16x32_bf16 v[240:243], v[160:163], v[160:163], v[240:243]
v_mfma_f32_16x16x32_bf16 v[60:63], v[246:249], v[204:207], v[36:39]
v_cvt_pk_bf16_f32 v188, v44, v45
v_cvt_pk_bf16_f32 v189, v46, v47
v_mfma_f32_16x16x32_bf16 v[64:67], v[244:247], v[204:207], v[36:39]
v_cvt_pk_bf16_f32 v190, v48, v49
v_cvt_pk_bf16_f32 v191, v50, v51
v_mfma_f32_16x16x32_bf16 v[68:71], v[246:249], v[212:215], v[36:39]
v_cvt_pk_bf16_f32 v196, v52, v53
v_cvt_pk_bf16_f32 v197, v54, v55
v_mfma_f32_16x16x32_bf16 v[72:75], v[244:247], v[212:215], v[36:39]
v_cvt_pk_bf16_f32 v198, v56, v57
v_cvt_pk_bf16_f32 v199, v58, v59
s_add_u32 m0, s64, 4096
s_add_u32 s67, s65, 589824
buffer_load_dwordx4 v10, s[36:39], s67 offen lds
buffer_load_dwordx4 v10, s[40:43], s67 offen offset:1024 lds
s_waitcnt vmcnt(12)
ds_read_b128 v[184:187], v9 offset:29696
s_waitcnt lgkmcnt(2)
v_mfma_f32_16x16x32_bf16 v[32:35], v[24:27], v[168:171], v[32:35]
v_mfma_f32_16x16x32_bf16 v[240:243], v[168:171], v[168:171], v[240:243]
v_mfma_f32_16x16x32_bf16 v[44:47], v[246:249], v[220:223], v[36:39]
v_cvt_pk_bf16_f32 v204, v60, v61
v_cvt_pk_bf16_f32 v205, v62, v63
v_mfma_f32_16x16x32_bf16 v[48:51], v[244:247], v[220:223], v[36:39]
v_cvt_pk_bf16_f32 v206, v64, v65
v_cvt_pk_bf16_f32 v207, v66, v67
v_mfma_f32_16x16x32_bf16 v[52:55], v[246:249], v[228:231], v[36:39]
v_cvt_pk_bf16_f32 v212, v68, v69
v_cvt_pk_bf16_f32 v213, v70, v71
v_mfma_f32_16x16x32_bf16 v[56:59], v[244:247], v[228:231], v[36:39]
v_cvt_pk_bf16_f32 v214, v72, v73
v_cvt_pk_bf16_f32 v215, v74, v75
s_waitcnt vmcnt(11)
ds_read_b128 v[192:195], v9 offset:30720
s_waitcnt lgkmcnt(2)
v_mfma_f32_16x16x32_bf16 v[32:35], v[24:27], v[176:179], v[32:35]
v_mfma_f32_16x16x32_bf16 v[240:243], v[176:179], v[176:179], v[240:243]
s_add_u32 m0, s64, 6144
s_add_u32 s67, s65, 884736
buffer_load_dwordx4 v10, s[36:39], s67 offen lds
buffer_load_dwordx4 v10, s[40:43], s67 offen offset:1024 lds
s_waitcnt vmcnt(12)
ds_read_b128 v[200:203], v9 offset:31744
s_waitcnt lgkmcnt(2)
v_mfma_f32_16x16x32_bf16 v[32:35], v[24:27], v[184:187], v[32:35]
v_mfma_f32_16x16x32_bf16 v[240:243], v[184:187], v[184:187], v[240:243]
s_waitcnt vmcnt(11)
ds_read_b128 v[208:211], v9 offset:32768
s_waitcnt lgkmcnt(2)
v_mfma_f32_16x16x32_bf16 v[32:35], v[24:27], v[192:195], v[32:35]
v_mfma_f32_16x16x32_bf16 v[240:243], v[192:195], v[192:195], v[240:243]
s_add_u32 m0, s64, 8192
s_add_u32 s67, s65, 1179648
buffer_load_dwordx4 v10, s[36:39], s67 offen lds
buffer_load_dwordx4 v10, s[40:43], s67 offen offset:1024 lds
s_waitcnt vmcnt(12)
ds_read_b128 v[216:219], v9 offset:33792
s_waitcnt lgkmcnt(2)
v_mfma_f32_16x16x32_bf16 v[32:35], v[24:27], v[200:203], v[32:35]
v_mfma_f32_16x16x32_bf16 v[240:243], v[200:203], v[200:203], v[240:243]
s_waitcnt vmcnt(11)
ds_read_b128 v[224:227], v9 offset:34816
s_waitcnt lgkmcnt(2)
v_mfma_f32_16x16x32_bf16 v[32:35], v[24:27], v[208:211], v[32:35]
v_mfma_f32_16x16x32_bf16 v[240:243], v[208:211], v[208:211], v[240:243]
s_add_u32 m0, s64, 10240
s_add_u32 s67, s65, 1474560
buffer_load_dwordx4 v10, s[36:39], s67 offen lds
buffer_load_dwordx4 v10, s[40:43], s67 offen offset:1024 lds
s_waitcnt vmcnt(12)
ds_read_b128 v[232:235], v9 offset:35840
s_waitcnt lgkmcnt(2)
v_mfma_f32_16x16x32_bf16 v[32:35], v[24:27], v[216:219], v[32:35]
v_mfma_f32_16x16x32_bf16 v[240:243], v[216:219], v[216:219], v[240:243]
s_waitcnt lgkmcnt(1)
v_mfma_f32_16x16x32_bf16 v[32:35], v[24:27], v[224:227], v[32:35]
v_mfma_f32_16x16x32_bf16 v[240:243], v[224:227], v[224:227], v[240:243]
s_add_u32 m0, s64, 12288
s_add_u32 s67, s65, 1769472
buffer_load_dwordx4 v10, s[36:39], s67 offen lds
buffer_load_dwordx4 v10, s[40:43], s67 offen offset:1024 lds
s_waitcnt lgkmcnt(0)
v_mfma_f32_16x16x32_bf16 v[32:35], v[24:27], v[232:235], v[32:35]
v_mfma_f32_16x16x32_bf16 v[240:243], v[232:235], v[232:235], v[240:243]
s_nop 6
v_mul_f32 v19, 0x3ae38e39, v32
v_cvt_pk_bf16_f32 v40, v19, v19
v_lshlrev_b32 v40, 16, v40
v_xor_b32 v40, 0x80000000, v40
v_mov_b32 v41, v40
v_mov_b32 v42, v40
v_mov_b32 v43, v40
s_nop 1
v_mfma_f32_16x16x32_bf16 v[60:63], v[246:249], v[96:99], v[40:43]
v_cvt_pk_bf16_f32 v220, v44, v45
v_cvt_pk_bf16_f32 v221, v46, v47
s_add_u32 m0, s64, 14336
s_add_u32 s67, s65, 2064384
v_mfma_f32_16x16x32_bf16 v[64:67], v[244:247], v[96:99], v[40:43]
v_cvt_pk_bf16_f32 v222, v48, v49
v_cvt_pk_bf16_f32 v223, v50, v51
buffer_load_dwordx4 v10, s[36:39], s67 offen lds
buffer_load_dwordx4 v10, s[40:43], s67 offen offset:1024 lds
v_mfma_f32_16x16x32_bf16 v[68:71], v[246:249], v[104:107], v[40:43]
v_cvt_pk_bf16_f32 v228, v52, v53
v_cvt_pk_bf16_f32 v229, v54, v55
v_mfma_f32_16x16x32_bf16 v[72:75], v[244:247], v[104:107], v[40:43]
v_cvt_pk_bf16_f32 v230, v56, v57
v_cvt_pk_bf16_f32 v231, v58, v59
v_mfma_f32_16x16x32_bf16 v[44:47], v[246:249], v[112:115], v[40:43]
v_cvt_pk_bf16_f32 v96, v60, v61
v_cvt_pk_bf16_f32 v97, v62, v63
v_mfma_f32_16x16x32_bf16 v[48:51], v[244:247], v[112:115], v[40:43]
v_cvt_pk_bf16_f32 v98, v64, v65
v_cvt_pk_bf16_f32 v99, v66, v67
v_mfma_f32_16x16x32_bf16 v[52:55], v[246:249], v[120:123], v[40:43]
v_cvt_pk_bf16_f32 v104, v68, v69
v_cvt_pk_bf16_f32 v105, v70, v71
s_add_u32 m0, s64, 16384
s_add_u32 s67, s65, 2359296
v_mfma_f32_16x16x32_bf16 v[56:59], v[244:247], v[120:123], v[40:43]
v_cvt_pk_bf16_f32 v106, v72, v73
v_cvt_pk_bf16_f32 v107, v74, v75
buffer_load_dwordx4 v10, s[36:39], s67 offen lds
buffer_load_dwordx4 v10, s[40:43], s67 offen offset:1024 lds
v_mfma_f32_16x16x32_bf16 v[60:63], v[246:249], v[128:131], v[40:43]
v_cvt_pk_bf16_f32 v112, v44, v45
v_cvt_pk_bf16_f32 v113, v46, v47
v_mfma_f32_16x16x32_bf16 v[64:67], v[244:247], v[128:131], v[40:43]
v_cvt_pk_bf16_f32 v114, v48, v49
v_cvt_pk_bf16_f32 v115, v50, v51
v_mfma_f32_16x16x32_bf16 v[68:71], v[246:249], v[136:139], v[40:43]
v_cvt_pk_bf16_f32 v120, v52, v53
v_cvt_pk_bf16_f32 v121, v54, v55
v_mfma_f32_16x16x32_bf16 v[72:75], v[244:247], v[136:139], v[40:43]
v_cvt_pk_bf16_f32 v122, v56, v57
v_cvt_pk_bf16_f32 v123, v58, v59
v_mfma_f32_16x16x32_bf16 v[44:47], v[246:249], v[144:147], v[40:43]
v_cvt_pk_bf16_f32 v128, v60, v61
v_cvt_pk_bf16_f32 v129, v62, v63
s_add_u32 m0, s64, 18432
s_add_u32 s67, s65, 2654208
v_mfma_f32_16x16x32_bf16 v[48:51], v[244:247], v[144:147], v[40:43]
v_cvt_pk_bf16_f32 v130, v64, v65
v_cvt_pk_bf16_f32 v131, v66, v67
buffer_load_dwordx4 v10, s[36:39], s67 offen lds
buffer_load_dwordx4 v10, s[40:43], s67 offen offset:1024 lds
v_mfma_f32_16x16x32_bf16 v[52:55], v[246:249], v[152:155], v[40:43]
v_cvt_pk_bf16_f32 v136, v68, v69
v_cvt_pk_bf16_f32 v137, v70, v71
v_mfma_f32_16x16x32_bf16 v[56:59], v[244:247], v[152:155], v[40:43]
v_cvt_pk_bf16_f32 v138, v72, v73
v_cvt_pk_bf16_f32 v139, v74, v75
v_mfma_f32_16x16x32_bf16 v[60:63], v[246:249], v[160:163], v[40:43]
v_cvt_pk_bf16_f32 v144, v44, v45
v_cvt_pk_bf16_f32 v145, v46, v47
v_mfma_f32_16x16x32_bf16 v[64:67], v[244:247], v[160:163], v[40:43]
v_cvt_pk_bf16_f32 v146, v48, v49
v_cvt_pk_bf16_f32 v147, v50, v51
v_mfma_f32_16x16x32_bf16 v[68:71], v[246:249], v[168:171], v[40:43]
v_cvt_pk_bf16_f32 v152, v52, v53
v_cvt_pk_bf16_f32 v153, v54, v55
s_add_u32 m0, s64, 20480
s_add_u32 s67, s65, 2949120
v_mfma_f32_16x16x32_bf16 v[72:75], v[244:247], v[168:171], v[40:43]
v_cvt_pk_bf16_f32 v154, v56, v57
v_cvt_pk_bf16_f32 v155, v58, v59
buffer_load_dwordx4 v10, s[36:39], s67 offen lds
buffer_load_dwordx4 v10, s[40:43], s67 offen offset:1024 lds
v_mfma_f32_16x16x32_bf16 v[44:47], v[246:249], v[176:179], v[40:43]
v_cvt_pk_bf16_f32 v160, v60, v61
v_cvt_pk_bf16_f32 v161, v62, v63
v_mfma_f32_16x16x32_bf16 v[48:51], v[244:247], v[176:179], v[40:43]
v_cvt_pk_bf16_f32 v162, v64, v65
v_cvt_pk_bf16_f32 v163, v66, v67
v_mfma_f32_16x16x32_bf16 v[52:55], v[246:249], v[184:187], v[40:43]
v_cvt_pk_bf16_f32 v168, v68, v69
v_cvt_pk_bf16_f32 v169, v70, v71
v_mfma_f32_16x16x32_bf16 v[56:59], v[244:247], v[184:187], v[40:43]
v_cvt_pk_bf16_f32 v170, v72, v73
v_cvt_pk_bf16_f32 v171, v74, v75
v_mfma_f32_16x16x32_bf16 v[60:63], v[246:249], v[192:195], v[40:43]
v_cvt_pk_bf16_f32 v176, v44, v45
v_cvt_pk_bf16_f32 v177, v46, v47
s_add_u32 m0, s64, 22528
s_add_u32 s67, s65, 3244032
v_mfma_f32_16x16x32_bf16 v[64:67], v[244:247], v[192:195], v[40:43]
v_cvt_pk_bf16_f32 v178, v48, v49
v_cvt_pk_bf16_f32 v179, v50, v51
buffer_load_dwordx4 v10, s[36:39], s67 offen lds
buffer_load_dwordx4 v10, s[40:43], s67 offen offset:1024 lds
v_mfma_f32_16x16x32_bf16 v[68:71], v[246:249], v[200:203], v[40:43]
v_cvt_pk_bf16_f32 v184, v52, v53
v_cvt_pk_bf16_f32 v185, v54, v55
v_mfma_f32_16x16x32_bf16 v[72:75], v[244:247], v[200:203], v[40:43]
v_cvt_pk_bf16_f32 v186, v56, v57
v_cvt_pk_bf16_f32 v187, v58, v59
v_mfma_f32_16x16x32_bf16 v[44:47], v[246:249], v[208:211], v[40:43]
v_cvt_pk_bf16_f32 v192, v60, v61
v_cvt_pk_bf16_f32 v193, v62, v63
v_mfma_f32_16x16x32_bf16 v[48:51], v[244:247], v[208:211], v[40:43]
v_cvt_pk_bf16_f32 v194, v64, v65
v_cvt_pk_bf16_f32 v195, v66, v67
v_mfma_f32_16x16x32_bf16 v[52:55], v[246:249], v[216:219], v[40:43]
v_cvt_pk_bf16_f32 v200, v68, v69
v_cvt_pk_bf16_f32 v201, v70, v71
v_mfma_f32_16x16x32_bf16 v[56:59], v[244:247], v[216:219], v[40:43]
v_cvt_pk_bf16_f32 v202, v72, v73
v_cvt_pk_bf16_f32 v203, v74, v75
v_mfma_f32_16x16x32_bf16 v[60:63], v[246:249], v[224:227], v[40:43]
v_cvt_pk_bf16_f32 v208, v44, v45
v_cvt_pk_bf16_f32 v209, v46, v47
v_mfma_f32_16x16x32_bf16 v[64:67], v[244:247], v[224:227], v[40:43]
v_cvt_pk_bf16_f32 v210, v48, v49
v_cvt_pk_bf16_f32 v211, v50, v51
v_mfma_f32_16x16x32_bf16 v[68:71], v[246:249], v[232:235], v[40:43]
v_cvt_pk_bf16_f32 v216, v52, v53
v_cvt_pk_bf16_f32 v217, v54, v55
v_mfma_f32_16x16x32_bf16 v[72:75], v[244:247], v[232:235], v[40:43]
v_cvt_pk_bf16_f32 v218, v56, v57
v_cvt_pk_bf16_f32 v219, v58, v59
v_cvt_pk_bf16_f32 v224, v60, v61
v_cvt_pk_bf16_f32 v225, v62, v63
v_cvt_pk_bf16_f32 v226, v64, v65
v_cvt_pk_bf16_f32 v227, v66, v67
v_cvt_pk_bf16_f32 v232, v68, v69
v_cvt_pk_bf16_f32 v233, v70, v71
v_cvt_pk_bf16_f32 v234, v72, v73
v_cvt_pk_bf16_f32 v235, v74, v75
s_add_u32 s5, s4, 0
buffer_load_dwordx4 a[252:255], v20, s[36:39], s5 offen offset:0
buffer_load_dwordx4 a[252:255], v20, s[36:39], s5 offen offset:1024
buffer_load_dwordx4 a[252:255], v20, s[36:39], s5 offen offset:1280
buffer_load_dwordx4 a[252:255], v20, s[40:43], s5 offen offset:1024
buffer_load_dwordx4 a[252:255], v20, s[40:43], s5 offen offset:2048
buffer_load_dwordx4 a[252:255], v20, s[40:43], s5 offen offset:2304
L_ffn_go:
s_waitcnt vmcnt(24)
s_barrier
ds_read_b64_tr_b16 a[192:193], v11 offset:0
ds_read_b64_tr_b16 a[194:195], v11 offset:512
ds_read_b64_tr_b16 a[196:197], v12 offset:0
ds_read_b64_tr_b16 a[198:199], v12 offset:512
ds_read_b64_tr_b16 a[200:201], v13 offset:0
ds_read_b64_tr_b16 a[202:203], v13 offset:512
ds_read_b64_tr_b16 a[204:205], v14 offset:0
ds_read_b64_tr_b16 a[206:207], v14 offset:512
ds_read_b64_tr_b16 a[208:209], v11 offset:1024
ds_read_b64_tr_b16 a[210:211], v11 offset:1536
ds_read_b64_tr_b16 a[212:213], v12 offset:1024
ds_read_b64_tr_b16 a[214:215], v12 offset:1536
ds_read_b64_tr_b16 a[216:217], v13 offset:1024
ds_read_b64_tr_b16 a[218:219], v13 offset:1536
ds_read_b64_tr_b16 a[220:221], v14 offset:1024
ds_read_b64_tr_b16 a[222:223], v14 offset:1536
s_waitcnt lgkmcnt(8)
v_mfma_f32_16x16x32_bf16 v[28:31], a[192:195], v[92:95], 0
ds_read_b64_tr_b16 a[224:225], v11 offset:2048
s_add_u32 m0, s64, 24576
v_mfma_f32_16x16x32_bf16 v[32:35], a[192:195], v[96:99], 0
ds_read_b64_tr_b16 a[226:227], v11 offset:2560
s_add_u32 s67, s65, 3538944
v_mfma_f32_16x16x32_bf16 v[36:39], a[196:199], v[92:95], 0
ds_read_b64_tr_b16 a[228:229], v12 offset:2048
buffer_load_dwordx4 v10, s[36:39], s67 offen lds
v_mfma_f32_16x16x32_bf16 v[40:43], a[196:199], v[96:99], 0
ds_read_b64_tr_b16 a[230:231], v12 offset:2560
v_accvgpr_write_b32 a0, v92
v_mfma_f32_16x16x32_bf16 v[44:47], a[200:203], v[92:95], 0
ds_read_b64_tr_b16 a[232:233], v13 offset:2048
v_accvgpr_write_b32 a1, v93
v_mfma_f32_16x16x32_bf16 v[48:51], a[200:203], v[96:99], 0
ds_read_b64_tr_b16 a[234:235], v13 offset:2560
buffer_load_dwordx4 v10, s[40:43], s67 offen offset:1024 lds
v_mfma_f32_16x16x32_bf16 v[52:55], a[204:207], v[92:95], 0
ds_read_b64_tr_b16 a[236:237], v14 offset:2048
s_add_u32 m0, s64, 26624
s_add_u32 s67, s65, 3833856
v_mfma_f32_16x16x32_bf16 v[56:59], a[204:207], v[96:99], 0
ds_read_b64_tr_b16 a[238:239], v14 offset:2560
v_accvgpr_write_b32 a2, v94
s_waitcnt lgkmcnt(8)
v_mfma_f32_16x16x32_bf16 v[60:63], a[208:211], v[92:95], 0
ds_read_b64_tr_b16 a[192:193], v11 offset:3072
buffer_load_dwordx4 v10, s[36:39], s67 offen lds
v_accvgpr_write_b32 a3, v95
v_mfma_f32_16x16x32_bf16 v[64:67], a[208:211], v[96:99], 0
ds_read_b64_tr_b16 a[194:195], v11 offset:3584
v_accvgpr_write_b32 a4, v96
v_accvgpr_write_b32 a5, v97
v_mfma_f32_16x16x32_bf16 v[68:71], a[212:215], v[92:95], 0
ds_read_b64_tr_b16 a[196:197], v12 offset:3072
v_accvgpr_write_b32 a6, v98
v_mfma_f32_16x16x32_bf16 v[72:75], a[212:215], v[96:99], 0
ds_read_b64_tr_b16 a[198:199], v12 offset:3584
buffer_load_dwordx4 v10, s[40:43], s67 offen offset:1024 lds
v_mfma_f32_16x16x32_bf16 v[76:79], a[216:219], v[92:95], 0
ds_read_b64_tr_b16 a[200:201], v13 offset:3072
v_accvgpr_write_b32 a7, v99
v_mfma_f32_16x16x32_bf16 v[80:83], a[216:219], v[96:99], 0
ds_read_b64_tr_b16 a[202:203], v13 offset:3584
v_accvgpr_write_b32 a8, v100
v_mfma_f32_16x16x32_bf16 v[84:87], a[220:223], v[92:95], 0
ds_read_b64_tr_b16 a[204:205], v14 offset:3072
v_accvgpr_write_b32 a9, v101
v_mfma_f32_16x16x32_bf16 v[88:91], a[220:223], v[96:99], 0
ds_read_b64_tr_b16 a[206:207], v14 offset:3584
s_waitcnt lgkmcnt(8)
v_mfma_f32_16x16x32_bf16 v[28:31], a[224:227], v[100:103], v[28:31]
ds_read_b64_tr_b16 a[208:209], v11 offset:4096
s_add_u32 m0, s64, 28672
v_mfma_f32_16x16x32_bf16 v[32:35], a[224:227], v[104:107], v[32:35]
ds_read_b64_tr_b16 a[210:211], v11 offset:4608
s_add_u32 s67, s65, 4128768
v_mfma_f32_16x16x32_bf16 v[36:39], a[228:231], v[100:103], v[36:39]
ds_read_b64_tr_b16 a[212:213], v12 offset:4096
buffer_load_dwordx4 v10, s[36:39], s67 offen lds
v_mfma_f32_16x16x32_bf16 v[40:43], a[228:231], v[104:107], v[40:43]
ds_read_b64_tr_b16 a[214:215], v12 offset:4608
v_accvgpr_write_b32 a10, v102
v_mfma_f32_16x16x32_bf16 v[44:47], a[232:235], v[100:103], v[44:47]
ds_read_b64_tr_b16 a[216:217], v13 offset:4096
v_accvgpr_write_b32 a11, v103
v_mfma_f32_16x16x32_bf16 v[48:51], a[232:235], v[104:107], v[48:51]
ds_read_b64_tr_b16 a[218:219], v13 offset:4608
buffer_load_dwordx4 v10, s[40:43], s67 offen offset:1024 lds
v_mfma_f32_16x16x32_bf16 v[52:55], a[236:239], v[100:103], v[52:55]
ds_read_b64_tr_b16 a[220:221], v14 offset:4096
s_add_u32 m0, s64, 30720
s_add_u32 s67, s65, 4423680
v_mfma_f32_16x16x32_bf16 v[56:59], a[236:239], v[104:107], v[56:59]
ds_read_b64_tr_b16 a[222:223], v14 offset:4608
v_accvgpr_write_b32 a12, v104
s_waitcnt lgkmcnt(8)
v_mfma_f32_16x16x32_bf16 v[60:63], a[192:195], v[100:103], v[60:63]
ds_read_b64_tr_b16 a[224:225], v11 offset:5120
buffer_load_dwordx4 v10, s[36:39], s67 offen lds
v_accvgpr_write_b32 a13, v105
v_mfma_f32_16x16x32_bf16 v[64:67], a[192:195], v[104:107], v[64:67]
ds_read_b64_tr_b16 a[226:227], v11 offset:5632
v_accvgpr_write_b32 a14, v106
v_accvgpr_write_b32 a15, v107
v_mfma_f32_16x16x32_bf16 v[68:71], a[196:199], v[100:103], v[68:71]
ds_read_b64_tr_b16 a[228:229], v12 offset:5120
v_accvgpr_write_b32 a16, v108
v_mfma_f32_16x16x32_bf16 v[72:75], a[196:199], v[104:107], v[72:75]
ds_read_b64_tr_b16 a[230:231], v12 offset:5632
buffer_load_dwordx4 v10, s[40:43], s67 offen offset:1024 lds
v_mfma_f32_16x16x32_bf16 v[76:79], a[200:203], v[100:103], v[76:79]
ds_read_b64_tr_b16 a[232:233], v13 offset:5120
v_accvgpr_write_b32 a17, v109
v_mfma_f32_16x16x32_bf16 v[80:83], a[200:203], v[104:107], v[80:83]
ds_read_b64_tr_b16 a[234:235], v13 offset:5632
v_accvgpr_write_b32 a18, v110
v_mfma_f32_16x16x32_bf16 v[84:87], a[204:207], v[100:103], v[84:87]
ds_read_b64_tr_b16 a[236:237], v14 offset:5120
v_accvgpr_write_b32 a19, v111
v_mfma_f32_16x16x32_bf16 v[88:91], a[204:207], v[104:107], v[88:91]
ds_read_b64_tr_b16 a[238:239], v14 offset:5632
s_waitcnt lgkmcnt(8)
v_mfma_f32_16x16x32_bf16 v[28:31], a[208:211], v[108:111], v[28:31]
s_waitcnt vmcnt(26)
s_barrier
ds_read_b64_tr_b16 a[192:193], v11 offset:6144
v_mfma_f32_16x16x32_bf16 v[32:35], a[208:211], v[112:115], v[32:35]
ds_read_b64_tr_b16 a[194:195], v11 offset:6656
s_add_u32 m0, s64, 32768
v_mfma_f32_16x16x32_bf16 v[36:39], a[212:215], v[108:111], v[36:39]
ds_read_b64_tr_b16 a[196:197], v12 offset:6144
s_add_u32 s67, s65, 4718592
buffer_load_dwordx4 v10, s[36:39], s67 offen lds
v_mfma_f32_16x16x32_bf16 v[40:43], a[212:215], v[112:115], v[40:43]
ds_read_b64_tr_b16 a[198:199], v12 offset:6656
v_accvgpr_write_b32 a20, v112
v_mfma_f32_16x16x32_bf16 v[44:47], a[216:219], v[108:111], v[44:47]
ds_read_b64_tr_b16 a[200:201], v13 offset:6144
v_accvgpr_write_b32 a21, v113
v_mfma_f32_16x16x32_bf16 v[48:51], a[216:219], v[112:115], v[48:51]
ds_read_b64_tr_b16 a[202:203], v13 offset:6656
buffer_load_dwordx4 v10, s[40:43], s67 offen offset:1024 lds
v_mfma_f32_16x16x32_bf16 v[52:55], a[220:223], v[108:111], v[52:55]
ds_read_b64_tr_b16 a[204:205], v14 offset:6144
s_add_u32 m0, s64, 34816
s_add_u32 s67, s65, 5013504
v_mfma_f32_16x16x32_bf16 v[56:59], a[220:223], v[112:115], v[56:59]
ds_read_b64_tr_b16 a[206:207], v14 offset:6656
v_accvgpr_write_b32 a22, v114
s_waitcnt lgkmcnt(8)
v_mfma_f32_16x16x32_bf16 v[60:63], a[224:227], v[108:111], v[60:63]
ds_read_b64_tr_b16 a[208:209], v11 offset:7168
buffer_load_dwordx4 v10, s[36:39], s67 offen lds
v_accvgpr_write_b32 a23, v115
v_mfma_f32_16x16x32_bf16 v[64:67], a[224:227], v[112:115], v[64:67]
ds_read_b64_tr_b16 a[210:211], v11 offset:7680
v_accvgpr_write_b32 a24, v116
v_accvgpr_write_b32 a25, v117
v_mfma_f32_16x16x32_bf16 v[68:71], a[228:231], v[108:111], v[68:71]
ds_read_b64_tr_b16 a[212:213], v12 offset:7168
v_accvgpr_write_b32 a26, v118
v_mfma_f32_16x16x32_bf16 v[72:75], a[228:231], v[112:115], v[72:75]
ds_read_b64_tr_b16 a[214:215], v12 offset:7680
buffer_load_dwordx4 v10, s[40:43], s67 offen offset:1024 lds
v_mfma_f32_16x16x32_bf16 v[76:79], a[232:235], v[108:111], v[76:79]
ds_read_b64_tr_b16 a[216:217], v13 offset:7168
v_accvgpr_write_b32 a27, v119
v_mfma_f32_16x16x32_bf16 v[80:83], a[232:235], v[112:115], v[80:83]
ds_read_b64_tr_b16 a[218:219], v13 offset:7680
v_accvgpr_write_b32 a28, v120
v_mfma_f32_16x16x32_bf16 v[84:87], a[236:239], v[108:111], v[84:87]
ds_read_b64_tr_b16 a[220:221], v14 offset:7168
v_accvgpr_write_b32 a29, v121
v_mfma_f32_16x16x32_bf16 v[88:91], a[236:239], v[112:115], v[88:91]
ds_read_b64_tr_b16 a[222:223], v14 offset:7680
s_waitcnt lgkmcnt(8)
v_mfma_f32_16x16x32_bf16 v[28:31], a[192:195], v[116:119], v[28:31]
ds_read_b64_tr_b16 a[224:225], v11 offset:8192
s_add_u32 m0, s64, 0
v_mfma_f32_16x16x32_bf16 v[32:35], a[192:195], v[120:123], v[32:35]
ds_read_b64_tr_b16 a[226:227], v11 offset:8704
s_add_u32 s67, s19, 0
v_mfma_f32_16x16x32_bf16 v[36:39], a[196:199], v[116:119], v[36:39]
ds_read_b64_tr_b16 a[228:229], v12 offset:8192
buffer_load_dwordx4 v10, s[36:39], s67 offen lds
v_mfma_f32_16x16x32_bf16 v[40:43], a[196:199], v[120:123], v[40:43]
ds_read_b64_tr_b16 a[230:231], v12 offset:8704
v_accvgpr_write_b32 a30, v122
v_mfma_f32_16x16x32_bf16 v[44:47], a[200:203], v[116:119], v[44:47]
ds_read_b64_tr_b16 a[232:233], v13 offset:8192
v_accvgpr_write_b32 a31, v123
v_mfma_f32_16x16x32_bf16 v[48:51], a[200:203], v[120:123], v[48:51]
ds_read_b64_tr_b16 a[234:235], v13 offset:8704
buffer_load_dwordx4 v10, s[40:43], s67 offen offset:1024 lds
v_mfma_f32_16x16x32_bf16 v[52:55], a[204:207], v[116:119], v[52:55]
ds_read_b64_tr_b16 a[236:237], v14 offset:8192
v_accvgpr_write_b32 a32, v124
v_mfma_f32_16x16x32_bf16 v[56:59], a[204:207], v[120:123], v[56:59]
ds_read_b64_tr_b16 a[238:239], v14 offset:8704
s_waitcnt lgkmcnt(8)
v_mfma_f32_16x16x32_bf16 v[60:63], a[208:211], v[116:119], v[60:63]
ds_read_b64_tr_b16 a[192:193], v11 offset:9216
v_accvgpr_write_b32 a33, v125
v_mfma_f32_16x16x32_bf16 v[64:67], a[208:211], v[120:123], v[64:67]
ds_read_b64_tr_b16 a[194:195], v11 offset:9728
v_accvgpr_write_b32 a34, v126
v_mfma_f32_16x16x32_bf16 v[68:71], a[212:215], v[116:119], v[68:71]
ds_read_b64_tr_b16 a[196:197], v12 offset:9216
v_accvgpr_write_b32 a35, v127
v_mfma_f32_16x16x32_bf16 v[72:75], a[212:215], v[120:123], v[72:75]
ds_read_b64_tr_b16 a[198:199], v12 offset:9728
v_accvgpr_write_b32 a36, v128
v_mfma_f32_16x16x32_bf16 v[76:79], a[216:219], v[116:119], v[76:79]
ds_read_b64_tr_b16 a[200:201], v13 offset:9216
v_accvgpr_write_b32 a37, v129
v_mfma_f32_16x16x32_bf16 v[80:83], a[216:219], v[120:123], v[80:83]
ds_read_b64_tr_b16 a[202:203], v13 offset:9728
v_accvgpr_write_b32 a38, v130
v_mfma_f32_16x16x32_bf16 v[84:87], a[220:223], v[116:119], v[84:87]
ds_read_b64_tr_b16 a[204:205], v14 offset:9216
v_accvgpr_write_b32 a39, v131
v_mfma_f32_16x16x32_bf16 v[88:91], a[220:223], v[120:123], v[88:91]
ds_read_b64_tr_b16 a[206:207], v14 offset:9728
s_waitcnt lgkmcnt(8)
v_mfma_f32_16x16x32_bf16 v[28:31], a[224:227], v[124:127], v[28:31]
ds_read_b64_tr_b16 a[208:209], v11 offset:10240
s_add_u32 m0, s64, 2048
v_mfma_f32_16x16x32_bf16 v[32:35], a[224:227], v[128:131], v[32:35]
ds_read_b64_tr_b16 a[210:211], v11 offset:10752
s_add_u32 s67, s19, 294912
v_mfma_f32_16x16x32_bf16 v[36:39], a[228:231], v[124:127], v[36:39]
ds_read_b64_tr_b16 a[212:213], v12 offset:10240
buffer_load_dwordx4 v10, s[36:39], s67 offen lds
v_mfma_f32_16x16x32_bf16 v[40:43], a[228:231], v[128:131], v[40:43]
ds_read_b64_tr_b16 a[214:215], v12 offset:10752
v_accvgpr_write_b32 a40, v132
v_mfma_f32_16x16x32_bf16 v[44:47], a[232:235], v[124:127], v[44:47]
ds_read_b64_tr_b16 a[216:217], v13 offset:10240
v_accvgpr_write_b32 a41, v133
v_mfma_f32_16x16x32_bf16 v[48:51], a[232:235], v[128:131], v[48:51]
ds_read_b64_tr_b16 a[218:219], v13 offset:10752
buffer_load_dwordx4 v10, s[40:43], s67 offen offset:1024 lds
v_mfma_f32_16x16x32_bf16 v[52:55], a[236:239], v[124:127], v[52:55]
ds_read_b64_tr_b16 a[220:221], v14 offset:10240
v_accvgpr_write_b32 a42, v134
v_mfma_f32_16x16x32_bf16 v[56:59], a[236:239], v[128:131], v[56:59]
ds_read_b64_tr_b16 a[222:223], v14 offset:10752
s_waitcnt lgkmcnt(8)
v_mfma_f32_16x16x32_bf16 v[60:63], a[192:195], v[124:127], v[60:63]
ds_read_b64_tr_b16 a[224:225], v11 offset:11264
v_accvgpr_write_b32 a43, v135
v_mfma_f32_16x16x32_bf16 v[64:67], a[192:195], v[128:131], v[64:67]
ds_read_b64_tr_b16 a[226:227], v11 offset:11776
v_accvgpr_write_b32 a44, v136
v_mfma_f32_16x16x32_bf16 v[68:71], a[196:199], v[124:127], v[68:71]
ds_read_b64_tr_b16 a[228:229], v12 offset:11264
v_accvgpr_write_b32 a45, v137
v_mfma_f32_16x16x32_bf16 v[72:75], a[196:199], v[128:131], v[72:75]
ds_read_b64_tr_b16 a[230:231], v12 offset:11776
v_accvgpr_write_b32 a46, v138
v_mfma_f32_16x16x32_bf16 v[76:79], a[200:203], v[124:127], v[76:79]
ds_read_b64_tr_b16 a[232:233], v13 offset:11264
v_accvgpr_write_b32 a47, v139
v_mfma_f32_16x16x32_bf16 v[80:83], a[200:203], v[128:131], v[80:83]
ds_read_b64_tr_b16 a[234:235], v13 offset:11776
v_accvgpr_write_b32 a48, v140
v_mfma_f32_16x16x32_bf16 v[84:87], a[204:207], v[124:127], v[84:87]
ds_read_b64_tr_b16 a[236:237], v14 offset:11264
v_accvgpr_write_b32 a49, v141
v_mfma_f32_16x16x32_bf16 v[88:91], a[204:207], v[128:131], v[88:91]
ds_read_b64_tr_b16 a[238:239], v14 offset:11776
s_waitcnt lgkmcnt(8)
v_mfma_f32_16x16x32_bf16 v[28:31], a[208:211], v[132:135], v[28:31]
s_waitcnt vmcnt(28)
s_barrier
ds_read_b64_tr_b16 a[192:193], v11 offset:12288
v_mfma_f32_16x16x32_bf16 v[32:35], a[208:211], v[136:139], v[32:35]
ds_read_b64_tr_b16 a[194:195], v11 offset:12800
s_add_u32 m0, s64, 4096
v_mfma_f32_16x16x32_bf16 v[36:39], a[212:215], v[132:135], v[36:39]
ds_read_b64_tr_b16 a[196:197], v12 offset:12288
s_add_u32 s67, s19, 589824
buffer_load_dwordx4 v10, s[36:39], s67 offen lds
v_mfma_f32_16x16x32_bf16 v[40:43], a[212:215], v[136:139], v[40:43]
ds_read_b64_tr_b16 a[198:199], v12 offset:12800
v_accvgpr_write_b32 a50, v142
v_accvgpr_write_b32 a51, v143
v_mfma_f32_16x16x32_bf16 v[44:47], a[216:219], v[132:135], v[44:47]
ds_read_b64_tr_b16 a[200:201], v13 offset:12288
v_accvgpr_write_b32 a52, v144
v_accvgpr_write_b32 a53, v145
v_mfma_f32_16x16x32_bf16 v[48:51], a[216:219], v[136:139], v[48:51]
ds_read_b64_tr_b16 a[202:203], v13 offset:12800
buffer_load_dwordx4 v10, s[40:43], s67 offen offset:1024 lds
v_accvgpr_write_b32 a54, v146
v_mfma_f32_16x16x32_bf16 v[52:55], a[220:223], v[132:135], v[52:55]
ds_read_b64_tr_b16 a[204:205], v14 offset:12288
v_accvgpr_write_b32 a55, v147
v_accvgpr_write_b32 a56, v148
v_mfma_f32_16x16x32_bf16 v[56:59], a[220:223], v[136:139], v[56:59]
ds_read_b64_tr_b16 a[206:207], v14 offset:12800
v_accvgpr_write_b32 a57, v149
s_waitcnt lgkmcnt(8)
v_mfma_f32_16x16x32_bf16 v[60:63], a[224:227], v[132:135], v[60:63]
ds_read_b64_tr_b16 a[208:209], v11 offset:13312
s_add_u32 s5, s4, 1769472
buffer_load_dwordx4 a[252:255], v20, s[36:39], s5 offen offset:0
v_mfma_f32_16x16x32_bf16 v[64:67], a[224:227], v[136:139], v[64:67]
ds_read_b64_tr_b16 a[210:211], v11 offset:13824
buffer_load_dwordx4 a[252:255], v20, s[36:39], s5 offen offset:1024
buffer_load_dwordx4 a[252:255], v20, s[36:39], s5 offen offset:1280
v_mfma_f32_16x16x32_bf16 v[68:71], a[228:231], v[132:135], v[68:71]
ds_read_b64_tr_b16 a[212:213], v12 offset:13312
buffer_load_dwordx4 a[252:255], v20, s[40:43], s5 offen offset:1024
buffer_load_dwordx4 a[252:255], v20, s[40:43], s5 offen offset:2048
v_mfma_f32_16x16x32_bf16 v[72:75], a[228:231], v[136:139], v[72:75]
ds_read_b64_tr_b16 a[214:215], v12 offset:13824
buffer_load_dwordx4 a[252:255], v20, s[40:43], s5 offen offset:2304
v_mfma_f32_16x16x32_bf16 v[76:79], a[232:235], v[132:135], v[76:79]
ds_read_b64_tr_b16 a[216:217], v13 offset:13312
v_accvgpr_write_b32 a58, v150
v_mfma_f32_16x16x32_bf16 v[80:83], a[232:235], v[136:139], v[80:83]
ds_read_b64_tr_b16 a[218:219], v13 offset:13824
v_accvgpr_write_b32 a59, v151
v_mfma_f32_16x16x32_bf16 v[84:87], a[236:239], v[132:135], v[84:87]
ds_read_b64_tr_b16 a[220:221], v14 offset:13312
v_accvgpr_write_b32 a60, v152
v_mfma_f32_16x16x32_bf16 v[88:91], a[236:239], v[136:139], v[88:91]
ds_read_b64_tr_b16 a[222:223], v14 offset:13824
s_waitcnt lgkmcnt(8)
v_mfma_f32_16x16x32_bf16 v[28:31], a[192:195], v[140:143], v[28:31]
ds_read_b64_tr_b16 a[224:225], v11 offset:14336
s_add_u32 m0, s64, 6144
v_mfma_f32_16x16x32_bf16 v[32:35], a[192:195], v[144:147], v[32:35]
ds_read_b64_tr_b16 a[226:227], v11 offset:14848
s_add_u32 s67, s19, 884736
v_mfma_f32_16x16x32_bf16 v[36:39], a[196:199], v[140:143], v[36:39]
ds_read_b64_tr_b16 a[228:229], v12 offset:14336
buffer_load_dwordx4 v10, s[36:39], s67 offen lds
v_mfma_f32_16x16x32_bf16 v[40:43], a[196:199], v[144:147], v[40:43]
ds_read_b64_tr_b16 a[230:231], v12 offset:14848
v_accvgpr_write_b32 a61, v153
v_mfma_f32_16x16x32_bf16 v[44:47], a[200:203], v[140:143], v[44:47]
ds_read_b64_tr_b16 a[232:233], v13 offset:14336
v_accvgpr_write_b32 a62, v154
v_mfma_f32_16x16x32_bf16 v[48:51], a[200:203], v[144:147], v[48:51]
ds_read_b64_tr_b16 a[234:235], v13 offset:14848
buffer_load_dwordx4 v10, s[40:43], s67 offen offset:1024 lds
v_mfma_f32_16x16x32_bf16 v[52:55], a[204:207], v[140:143], v[52:55]
ds_read_b64_tr_b16 a[236:237], v14 offset:14336
v_accvgpr_write_b32 a63, v155
v_mfma_f32_16x16x32_bf16 v[56:59], a[204:207], v[144:147], v[56:59]
ds_read_b64_tr_b16 a[238:239], v14 offset:14848
s_waitcnt lgkmcnt(8)
v_mfma_f32_16x16x32_bf16 v[60:63], a[208:211], v[140:143], v[60:63]
ds_read_b64_tr_b16 a[192:193], v11 offset:15360
s_mov_b32 s44, s20
v_mfma_f32_16x16x32_bf16 v[64:67], a[208:211], v[144:147], v[64:67]
ds_read_b64_tr_b16 a[194:195], v11 offset:15872
s_mov_b32 s45, s21
v_mfma_f32_16x16x32_bf16 v[68:71], a[212:215], v[140:143], v[68:71]
ds_read_b64_tr_b16 a[196:197], v12 offset:15360
s_mov_b32 s46, 5308416
v_mfma_f32_16x16x32_bf16 v[72:75], a[212:215], v[144:147], v[72:75]
ds_read_b64_tr_b16 a[198:199], v12 offset:15872
s_mov_b32 s47, 0x20000
v_mfma_f32_16x16x32_bf16 v[76:79], a[216:219], v[140:143], v[76:79]
ds_read_b64_tr_b16 a[200:201], v13 offset:15360
s_add_u32 s48, s20, 35840
s_addc_u32 s49, s21, 0
v_mfma_f32_16x16x32_bf16 v[80:83], a[216:219], v[144:147], v[80:83]
ds_read_b64_tr_b16 a[202:203], v13 offset:15872
s_mov_b32 s50, 5272576
v_mfma_f32_16x16x32_bf16 v[84:87], a[220:223], v[140:143], v[84:87]
ds_read_b64_tr_b16 a[204:205], v14 offset:15360
s_mov_b32 s51, 0x20000
v_mfma_f32_16x16x32_bf16 v[88:91], a[220:223], v[144:147], v[88:91]
ds_read_b64_tr_b16 a[206:207], v14 offset:15872
s_waitcnt lgkmcnt(8)
v_mfma_f32_16x16x32_bf16 v[28:31], a[224:227], v[148:151], v[28:31]
ds_read_b64_tr_b16 a[208:209], v11 offset:16384
s_add_u32 m0, s64, 8192
v_mfma_f32_16x16x32_bf16 v[32:35], a[224:227], v[152:155], v[32:35]
ds_read_b64_tr_b16 a[210:211], v11 offset:16896
s_add_u32 s67, s19, 1179648
v_mfma_f32_16x16x32_bf16 v[36:39], a[228:231], v[148:151], v[36:39]
ds_read_b64_tr_b16 a[212:213], v12 offset:16384
buffer_load_dwordx4 v10, s[36:39], s67 offen lds
v_mfma_f32_16x16x32_bf16 v[40:43], a[228:231], v[152:155], v[40:43]
ds_read_b64_tr_b16 a[214:215], v12 offset:16896
s_mov_b32 s54, 2359296
v_mfma_f32_16x16x32_bf16 v[44:47], a[232:235], v[148:151], v[44:47]
ds_read_b64_tr_b16 a[216:217], v13 offset:16384
s_mov_b32 s55, 0x20000
v_mfma_f32_16x16x32_bf16 v[48:51], a[232:235], v[152:155], v[48:51]
ds_read_b64_tr_b16 a[218:219], v13 offset:16896
buffer_load_dwordx4 v10, s[40:43], s67 offen offset:1024 lds
v_mfma_f32_16x16x32_bf16 v[52:55], a[236:239], v[148:151], v[52:55]
ds_read_b64_tr_b16 a[220:221], v14 offset:16384
v_lshrrev_b32 v2, 3, v1
v_mfma_f32_16x16x32_bf16 v[56:59], a[236:239], v[152:155], v[56:59]
ds_read_b64_tr_b16 a[222:223], v14 offset:16896
s_waitcnt lgkmcnt(8)
v_mfma_f32_16x16x32_bf16 v[60:63], a[192:195], v[148:151], v[60:63]
ds_read_b64_tr_b16 a[224:225], v11 offset:17408
v_lshrrev_b32 v3, 2, v2
v_mfma_f32_16x16x32_bf16 v[64:67], a[192:195], v[152:155], v[64:67]
ds_read_b64_tr_b16 a[226:227], v11 offset:17920
v_lshlrev_b32 v3, 4, v3
v_mfma_f32_16x16x32_bf16 v[68:71], a[196:199], v[148:151], v[68:71]
ds_read_b64_tr_b16 a[228:229], v12 offset:17408
v_and_b32 v2, 3, v2
v_mfma_f32_16x16x32_bf16 v[72:75], a[196:199], v[152:155], v[72:75]
ds_read_b64_tr_b16 a[230:231], v12 offset:17920
s_lshl_b32 s80, s60, 2
v_mfma_f32_16x16x32_bf16 v[76:79], a[200:203], v[148:151], v[76:79]
ds_read_b64_tr_b16 a[232:233], v13 offset:17408
v_add3_u32 v2, v2, v3, s80
v_mfma_f32_16x16x32_bf16 v[80:83], a[200:203], v[152:155], v[80:83]
ds_read_b64_tr_b16 a[234:235], v13 offset:17920
v_mul_u32_u24 v2, 1152, v2
v_mfma_f32_16x16x32_bf16 v[84:87], a[204:207], v[148:151], v[84:87]
ds_read_b64_tr_b16 a[236:237], v14 offset:17408
v_add_u32 v15, v2, v15
v_mfma_f32_16x16x32_bf16 v[88:91], a[204:207], v[152:155], v[88:91]
ds_read_b64_tr_b16 a[238:239], v14 offset:17920
s_waitcnt lgkmcnt(8)
v_mfma_f32_16x16x32_bf16 v[28:31], a[208:211], v[156:159], v[28:31]
s_waitcnt vmcnt(34)
s_barrier
ds_read_b64_tr_b16 a[192:193], v11 offset:18432
v_mfma_f32_16x16x32_bf16 v[32:35], a[208:211], v[160:163], v[32:35]
ds_read_b64_tr_b16 a[194:195], v11 offset:18944
s_add_u32 m0, s64, 10240
v_mfma_f32_16x16x32_bf16 v[36:39], a[212:215], v[156:159], v[36:39]
ds_read_b64_tr_b16 a[196:197], v12 offset:18432
s_add_u32 s67, s19, 1474560
buffer_load_dwordx4 v10, s[36:39], s67 offen lds
v_mfma_f32_16x16x32_bf16 v[40:43], a[212:215], v[160:163], v[40:43]
ds_read_b64_tr_b16 a[198:199], v12 offset:18944
s_lshl_b32 s15, s61, 15
v_mfma_f32_16x16x32_bf16 v[44:47], a[216:219], v[156:159], v[44:47]
ds_read_b64_tr_b16 a[200:201], v13 offset:18432
s_add_u32 s15, s15, 3145728
v_mfma_f32_16x16x32_bf16 v[48:51], a[216:219], v[160:163], v[48:51]
ds_read_b64_tr_b16 a[202:203], v13 offset:18944
buffer_load_dwordx4 v10, s[40:43], s67 offen offset:1024 lds
v_mfma_f32_16x16x32_bf16 v[52:55], a[220:223], v[156:159], v[52:55]
ds_read_b64_tr_b16 a[204:205], v14 offset:18432
s_mul_i32 s24, s66, 73728
v_mfma_f32_16x16x32_bf16 v[56:59], a[220:223], v[160:163], v[56:59]
ds_read_b64_tr_b16 a[206:207], v14 offset:18944
s_waitcnt lgkmcnt(8)
v_mfma_f32_16x16x32_bf16 v[60:63], a[224:227], v[156:159], v[60:63]
ds_read_b64_tr_b16 a[208:209], v11 offset:19456
s_mul_i32 s80, s61, 23040
v_mfma_f32_16x16x32_bf16 v[64:67], a[224:227], v[160:163], v[64:67]
ds_read_b64_tr_b16 a[210:211], v11 offset:19968
s_add_u32 s24, s24, s80
v_mfma_f32_16x16x32_bf16 v[68:71], a[228:231], v[156:159], v[68:71]
ds_read_b64_tr_b16 a[212:213], v12 offset:19456
s_mul_i32 s80, s60, 6144
v_mfma_f32_16x16x32_bf16 v[72:75], a[228:231], v[160:163], v[72:75]
ds_read_b64_tr_b16 a[214:215], v12 offset:19968
s_add_u32 s24, s24, s80
v_mfma_f32_16x16x32_bf16 v[76:79], a[232:235], v[156:159], v[76:79]
ds_read_b64_tr_b16 a[216:217], v13 offset:19456
s_mov_b32 s70, 73728
v_mfma_f32_16x16x32_bf16 v[80:83], a[232:235], v[160:163], v[80:83]
ds_read_b64_tr_b16 a[218:219], v13 offset:19968
s_mul_i32 s66, s66, 73728
v_mfma_f32_16x16x32_bf16 v[84:87], a[236:239], v[156:159], v[84:87]
ds_read_b64_tr_b16 a[220:221], v14 offset:19456
s_mul_i32 s80, s7, 384
v_mfma_f32_16x16x32_bf16 v[88:91], a[236:239], v[160:163], v[88:91]
ds_read_b64_tr_b16 a[222:223], v14 offset:19968
s_waitcnt lgkmcnt(8)
v_mfma_f32_16x16x32_bf16 v[28:31], a[192:195], v[164:167], v[28:31]
ds_read_b64_tr_b16 a[224:225], v11 offset:20480
s_add_u32 m0, s64, 12288
v_mfma_f32_16x16x32_bf16 v[32:35], a[192:195], v[168:171], v[32:35]
ds_read_b64_tr_b16 a[226:227], v11 offset:20992
s_add_u32 s67, s19, 1769472
v_mfma_f32_16x16x32_bf16 v[36:39], a[196:199], v[164:167], v[36:39]
ds_read_b64_tr_b16 a[228:229], v12 offset:20480
buffer_load_dwordx4 v10, s[36:39], s67 offen lds
v_mfma_f32_16x16x32_bf16 v[40:43], a[196:199], v[168:171], v[40:43]
ds_read_b64_tr_b16 a[230:231], v12 offset:20992
s_add_u32 s66, s66, s80
v_mfma_f32_16x16x32_bf16 v[44:47], a[200:203], v[164:167], v[44:47]
ds_read_b64_tr_b16 a[232:233], v13 offset:20480
s_lshl_b32 s21, s61, 4
v_mfma_f32_16x16x32_bf16 v[48:51], a[200:203], v[168:171], v[48:51]
ds_read_b64_tr_b16 a[234:235], v13 offset:20992
buffer_load_dwordx4 v10, s[40:43], s67 offen offset:1024 lds
v_mfma_f32_16x16x32_bf16 v[52:55], a[204:207], v[164:167], v[52:55]
ds_read_b64_tr_b16 a[236:237], v14 offset:20480
s_add_u32 s21, s21, s62
v_mfma_f32_16x16x32_bf16 v[56:59], a[204:207], v[168:171], v[56:59]
ds_read_b64_tr_b16 a[238:239], v14 offset:20992
s_waitcnt lgkmcnt(8)
v_mfma_f32_16x16x32_bf16 v[60:63], a[208:211], v[164:167], v[60:63]
ds_read_b64_tr_b16 a[192:193], v11 offset:21504
s_mul_i32 s21, s21, 81920
v_mfma_f32_16x16x32_bf16 v[64:67], a[208:211], v[168:171], v[64:67]
ds_read_b64_tr_b16 a[194:195], v11 offset:22016
s_lshl_b32 s80, s60, 12
v_mfma_f32_16x16x32_bf16 v[68:71], a[212:215], v[164:167], v[68:71]
ds_read_b64_tr_b16 a[196:197], v12 offset:21504
s_add_u32 s21, s21, s80
v_mfma_f32_16x16x32_bf16 v[72:75], a[212:215], v[168:171], v[72:75]
ds_read_b64_tr_b16 a[198:199], v12 offset:22016
s_add_u32 s21, s21, 15990784
v_mfma_f32_16x16x32_bf16 v[76:79], a[216:219], v[164:167], v[76:79]
ds_read_b64_tr_b16 a[200:201], v13 offset:21504
s_lshl_b32 s80, s62, 7
v_mfma_f32_16x16x32_bf16 v[80:83], a[216:219], v[168:171], v[80:83]
ds_read_b64_tr_b16 a[202:203], v13 offset:22016
v_mov_b32 v21, 2147483392
v_mfma_f32_16x16x32_bf16 v[84:87], a[220:223], v[164:167], v[84:87]
ds_read_b64_tr_b16 a[204:205], v14 offset:21504
v_mov_b32 v2, s80
v_mfma_f32_16x16x32_bf16 v[88:91], a[220:223], v[168:171], v[88:91]
ds_read_b64_tr_b16 a[206:207], v14 offset:22016
s_waitcnt lgkmcnt(8)
v_mfma_f32_16x16x32_bf16 v[28:31], a[224:227], v[172:175], v[28:31]
ds_read_b64_tr_b16 a[208:209], v11 offset:22528
s_add_u32 m0, s64, 14336
v_mfma_f32_16x16x32_bf16 v[32:35], a[224:227], v[176:179], v[32:35]
ds_read_b64_tr_b16 a[210:211], v11 offset:23040
s_add_u32 s67, s19, 2064384
v_mfma_f32_16x16x32_bf16 v[36:39], a[228:231], v[172:175], v[36:39]
ds_read_b64_tr_b16 a[212:213], v12 offset:22528
buffer_load_dwordx4 v10, s[36:39], s67 offen lds
v_mfma_f32_16x16x32_bf16 v[40:43], a[228:231], v[176:179], v[40:43]
ds_read_b64_tr_b16 a[214:215], v12 offset:23040
v_cmp_eq_u32 vcc, 192, v0
v_mfma_f32_16x16x32_bf16 v[44:47], a[232:235], v[172:175], v[44:47]
ds_read_b64_tr_b16 a[216:217], v13 offset:22528
v_cndmask_b32 v21, v21, v2, vcc
v_mfma_f32_16x16x32_bf16 v[48:51], a[232:235], v[176:179], v[48:51]
ds_read_b64_tr_b16 a[218:219], v13 offset:23040
buffer_load_dwordx4 v10, s[40:43], s67 offen offset:1024 lds
v_mfma_f32_16x16x32_bf16 v[52:55], a[236:239], v[172:175], v[52:55]
ds_read_b64_tr_b16 a[220:221], v14 offset:22528
s_mul_i32 s63, s63, 2654435761
v_mfma_f32_16x16x32_bf16 v[56:59], a[236:239], v[176:179], v[56:59]
ds_read_b64_tr_b16 a[222:223], v14 offset:23040
s_waitcnt lgkmcnt(8)
v_mfma_f32_16x16x32_bf16 v[60:63], a[192:195], v[172:175], v[60:63]
ds_read_b64_tr_b16 a[224:225], v11 offset:23552
s_add_u32 s63, s63, 2135587861
v_mfma_f32_16x16x32_bf16 v[64:67], a[192:195], v[176:179], v[64:67]
ds_read_b64_tr_b16 a[226:227], v11 offset:24064
v_mov_b32 v22, s63
v_mfma_f32_16x16x32_bf16 v[68:71], a[196:199], v[172:175], v[68:71]
ds_read_b64_tr_b16 a[228:229], v12 offset:23552
v_add_u32 v6, 1, v22
v_mfma_f32_16x16x32_bf16 v[72:75], a[196:199], v[176:179], v[72:75]
ds_read_b64_tr_b16 a[230:231], v12 offset:24064
s_add_u32 s68, s63, s23
v_mfma_f32_16x16x32_bf16 v[76:79], a[200:203], v[172:175], v[76:79]
ds_read_b64_tr_b16 a[232:233], v13 offset:23552
s_sub_u32 s68, s68, 1
v_mfma_f32_16x16x32_bf16 v[80:83], a[200:203], v[176:179], v[80:83]
ds_read_b64_tr_b16 a[234:235], v13 offset:24064
v_accvgpr_write_b32 a64, v156
v_mfma_f32_16x16x32_bf16 v[84:87], a[204:207], v[172:175], v[84:87]
ds_read_b64_tr_b16 a[236:237], v14 offset:23552
v_accvgpr_write_b32 a65, v157
v_mfma_f32_16x16x32_bf16 v[88:91], a[204:207], v[176:179], v[88:91]
ds_read_b64_tr_b16 a[238:239], v14 offset:24064
s_waitcnt lgkmcnt(8)
v_mfma_f32_16x16x32_bf16 v[28:31], a[208:211], v[180:183], v[28:31]
s_waitcnt vmcnt(28)
s_barrier
ds_read_b64_tr_b16 a[192:193], v11 offset:24576
v_mfma_f32_16x16x32_bf16 v[32:35], a[208:211], v[184:187], v[32:35]
ds_read_b64_tr_b16 a[194:195], v11 offset:25088
s_add_u32 m0, s64, 16384
v_mfma_f32_16x16x32_bf16 v[36:39], a[212:215], v[180:183], v[36:39]
ds_read_b64_tr_b16 a[196:197], v12 offset:24576
s_add_u32 s67, s19, 2359296
buffer_load_dwordx4 v10, s[36:39], s67 offen lds
v_mfma_f32_16x16x32_bf16 v[40:43], a[212:215], v[184:187], v[40:43]
ds_read_b64_tr_b16 a[198:199], v12 offset:25088
v_accvgpr_write_b32 a66, v158
v_accvgpr_write_b32 a67, v159
v_mfma_f32_16x16x32_bf16 v[44:47], a[216:219], v[180:183], v[44:47]
ds_read_b64_tr_b16 a[200:201], v13 offset:24576
v_accvgpr_write_b32 a68, v160
v_accvgpr_write_b32 a69, v161
v_mfma_f32_16x16x32_bf16 v[48:51], a[216:219], v[184:187], v[48:51]
ds_read_b64_tr_b16 a[202:203], v13 offset:25088
buffer_load_dwordx4 v10, s[40:43], s67 offen offset:1024 lds
v_accvgpr_write_b32 a70, v162
v_mfma_f32_16x16x32_bf16 v[52:55], a[220:223], v[180:183], v[52:55]
ds_read_b64_tr_b16 a[204:205], v14 offset:24576
v_accvgpr_write_b32 a71, v163
v_accvgpr_write_b32 a72, v164
v_mfma_f32_16x16x32_bf16 v[56:59], a[220:223], v[184:187], v[56:59]
ds_read_b64_tr_b16 a[206:207], v14 offset:25088
v_accvgpr_write_b32 a73, v165
s_waitcnt lgkmcnt(8)
v_mfma_f32_16x16x32_bf16 v[60:63], a[224:227], v[180:183], v[60:63]
ds_read_b64_tr_b16 a[208:209], v11 offset:25600
s_add_u32 s5, s4, 3538944
buffer_load_dwordx4 a[252:255], v20, s[36:39], s5 offen offset:0
v_mfma_f32_16x16x32_bf16 v[64:67], a[224:227], v[184:187], v[64:67]
ds_read_b64_tr_b16 a[210:211], v11 offset:26112
buffer_load_dwordx4 a[252:255], v20, s[36:39], s5 offen offset:1024
buffer_load_dwordx4 a[252:255], v20, s[36:39], s5 offen offset:1280
v_mfma_f32_16x16x32_bf16 v[68:71], a[228:231], v[180:183], v[68:71]
ds_read_b64_tr_b16 a[212:213], v12 offset:25600
buffer_load_dwordx4 a[252:255], v20, s[40:43], s5 offen offset:1024
buffer_load_dwordx4 a[252:255], v20, s[40:43], s5 offen offset:2048
v_mfma_f32_16x16x32_bf16 v[72:75], a[228:231], v[184:187], v[72:75]
ds_read_b64_tr_b16 a[214:215], v12 offset:26112
buffer_load_dwordx4 a[252:255], v20, s[40:43], s5 offen offset:2304
v_mfma_f32_16x16x32_bf16 v[76:79], a[232:235], v[180:183], v[76:79]
ds_read_b64_tr_b16 a[216:217], v13 offset:25600
v_accvgpr_write_b32 a74, v166
v_mfma_f32_16x16x32_bf16 v[80:83], a[232:235], v[184:187], v[80:83]
ds_read_b64_tr_b16 a[218:219], v13 offset:26112
v_accvgpr_write_b32 a75, v167
v_mfma_f32_16x16x32_bf16 v[84:87], a[236:239], v[180:183], v[84:87]
ds_read_b64_tr_b16 a[220:221], v14 offset:25600
v_accvgpr_write_b32 a76, v168
v_mfma_f32_16x16x32_bf16 v[88:91], a[236:239], v[184:187], v[88:91]
ds_read_b64_tr_b16 a[222:223], v14 offset:26112
s_waitcnt lgkmcnt(8)
v_mfma_f32_16x16x32_bf16 v[28:31], a[192:195], v[188:191], v[28:31]
ds_read_b64_tr_b16 a[224:225], v11 offset:26624
s_add_u32 m0, s64, 18432
v_mfma_f32_16x16x32_bf16 v[32:35], a[192:195], v[192:195], v[32:35]
ds_read_b64_tr_b16 a[226:227], v11 offset:27136
s_add_u32 s67, s19, 2654208
v_mfma_f32_16x16x32_bf16 v[36:39], a[196:199], v[188:191], v[36:39]
ds_read_b64_tr_b16 a[228:229], v12 offset:26624
buffer_load_dwordx4 v10, s[36:39], s67 offen lds
v_mfma_f32_16x16x32_bf16 v[40:43], a[196:199], v[192:195], v[40:43]
ds_read_b64_tr_b16 a[230:231], v12 offset:27136
v_accvgpr_write_b32 a77, v169
v_mfma_f32_16x16x32_bf16 v[44:47], a[200:203], v[188:191], v[44:47]
ds_read_b64_tr_b16 a[232:233], v13 offset:26624
v_accvgpr_write_b32 a78, v170
v_mfma_f32_16x16x32_bf16 v[48:51], a[200:203], v[192:195], v[48:51]
ds_read_b64_tr_b16 a[234:235], v13 offset:27136
buffer_load_dwordx4 v10, s[40:43], s67 offen offset:1024 lds
v_mfma_f32_16x16x32_bf16 v[52:55], a[204:207], v[188:191], v[52:55]
ds_read_b64_tr_b16 a[236:237], v14 offset:26624
v_accvgpr_write_b32 a79, v171
v_mfma_f32_16x16x32_bf16 v[56:59], a[204:207], v[192:195], v[56:59]
ds_read_b64_tr_b16 a[238:239], v14 offset:27136
s_waitcnt lgkmcnt(8)
v_mfma_f32_16x16x32_bf16 v[60:63], a[208:211], v[188:191], v[60:63]
ds_read_b64_tr_b16 a[192:193], v11 offset:27648
v_accvgpr_write_b32 a80, v172
v_mfma_f32_16x16x32_bf16 v[64:67], a[208:211], v[192:195], v[64:67]
ds_read_b64_tr_b16 a[194:195], v11 offset:28160
v_accvgpr_write_b32 a81, v173
v_mfma_f32_16x16x32_bf16 v[68:71], a[212:215], v[188:191], v[68:71]
ds_read_b64_tr_b16 a[196:197], v12 offset:27648
v_accvgpr_write_b32 a82, v174
v_mfma_f32_16x16x32_bf16 v[72:75], a[212:215], v[192:195], v[72:75]
ds_read_b64_tr_b16 a[198:199], v12 offset:28160
v_accvgpr_write_b32 a83, v175
v_mfma_f32_16x16x32_bf16 v[76:79], a[216:219], v[188:191], v[76:79]
ds_read_b64_tr_b16 a[200:201], v13 offset:27648
v_accvgpr_write_b32 a84, v176
v_mfma_f32_16x16x32_bf16 v[80:83], a[216:219], v[192:195], v[80:83]
ds_read_b64_tr_b16 a[202:203], v13 offset:28160
v_accvgpr_write_b32 a85, v177
v_mfma_f32_16x16x32_bf16 v[84:87], a[220:223], v[188:191], v[84:87]
ds_read_b64_tr_b16 a[204:205], v14 offset:27648
v_accvgpr_write_b32 a86, v178
v_mfma_f32_16x16x32_bf16 v[88:91], a[220:223], v[192:195], v[88:91]
ds_read_b64_tr_b16 a[206:207], v14 offset:28160
s_waitcnt lgkmcnt(8)
v_mfma_f32_16x16x32_bf16 v[28:31], a[224:227], v[196:199], v[28:31]
ds_read_b64_tr_b16 a[208:209], v11 offset:28672
s_add_u32 m0, s64, 20480
v_mfma_f32_16x16x32_bf16 v[32:35], a[224:227], v[200:203], v[32:35]
ds_read_b64_tr_b16 a[210:211], v11 offset:29184
s_add_u32 s67, s19, 2949120
v_mfma_f32_16x16x32_bf16 v[36:39], a[228:231], v[196:199], v[36:39]
ds_read_b64_tr_b16 a[212:213], v12 offset:28672
buffer_load_dwordx4 v10, s[36:39], s67 offen lds
v_mfma_f32_16x16x32_bf16 v[40:43], a[228:231], v[200:203], v[40:43]
ds_read_b64_tr_b16 a[214:215], v12 offset:29184
v_accvgpr_write_b32 a87, v179
v_mfma_f32_16x16x32_bf16 v[44:47], a[232:235], v[196:199], v[44:47]
ds_read_b64_tr_b16 a[216:217], v13 offset:28672
v_accvgpr_write_b32 a88, v180
v_mfma_f32_16x16x32_bf16 v[48:51], a[232:235], v[200:203], v[48:51]
ds_read_b64_tr_b16 a[218:219], v13 offset:29184
buffer_load_dwordx4 v10, s[40:43], s67 offen offset:1024 lds
v_mfma_f32_16x16x32_bf16 v[52:55], a[236:239], v[196:199], v[52:55]
ds_read_b64_tr_b16 a[220:221], v14 offset:28672
v_accvgpr_write_b32 a89, v181
v_mfma_f32_16x16x32_bf16 v[56:59], a[236:239], v[200:203], v[56:59]
ds_read_b64_tr_b16 a[222:223], v14 offset:29184
s_waitcnt lgkmcnt(8)
v_mfma_f32_16x16x32_bf16 v[60:63], a[192:195], v[196:199], v[60:63]
ds_read_b64_tr_b16 a[224:225], v11 offset:29696
v_accvgpr_write_b32 a90, v182
v_mfma_f32_16x16x32_bf16 v[64:67], a[192:195], v[200:203], v[64:67]
ds_read_b64_tr_b16 a[226:227], v11 offset:30208
v_accvgpr_write_b32 a91, v183
v_mfma_f32_16x16x32_bf16 v[68:71], a[196:199], v[196:199], v[68:71]
ds_read_b64_tr_b16 a[228:229], v12 offset:29696
v_accvgpr_write_b32 a92, v184
v_mfma_f32_16x16x32_bf16 v[72:75], a[196:199], v[200:203], v[72:75]
ds_read_b64_tr_b16 a[230:231], v12 offset:30208
v_accvgpr_write_b32 a93, v185
v_mfma_f32_16x16x32_bf16 v[76:79], a[200:203], v[196:199], v[76:79]
ds_read_b64_tr_b16 a[232:233], v13 offset:29696
v_accvgpr_write_b32 a94, v186
v_mfma_f32_16x16x32_bf16 v[80:83], a[200:203], v[200:203], v[80:83]
ds_read_b64_tr_b16 a[234:235], v13 offset:30208
v_accvgpr_write_b32 a95, v187
v_mfma_f32_16x16x32_bf16 v[84:87], a[204:207], v[196:199], v[84:87]
ds_read_b64_tr_b16 a[236:237], v14 offset:29696
v_accvgpr_write_b32 a96, v188
v_mfma_f32_16x16x32_bf16 v[88:91], a[204:207], v[200:203], v[88:91]
ds_read_b64_tr_b16 a[238:239], v14 offset:30208
s_waitcnt lgkmcnt(8)
v_mfma_f32_16x16x32_bf16 v[28:31], a[208:211], v[204:207], v[28:31]
s_waitcnt vmcnt(34)
s_barrier
ds_read_b64_tr_b16 a[192:193], v11 offset:30720
v_mfma_f32_16x16x32_bf16 v[32:35], a[208:211], v[208:211], v[32:35]
ds_read_b64_tr_b16 a[194:195], v11 offset:31232
s_add_u32 m0, s64, 22528
v_mfma_f32_16x16x32_bf16 v[36:39], a[212:215], v[204:207], v[36:39]
ds_read_b64_tr_b16 a[196:197], v12 offset:30720
s_add_u32 s67, s19, 3244032
buffer_load_dwordx4 v10, s[36:39], s67 offen lds
v_mfma_f32_16x16x32_bf16 v[40:43], a[212:215], v[208:211], v[40:43]
ds_read_b64_tr_b16 a[198:199], v12 offset:31232
v_accvgpr_write_b32 a97, v189
v_mfma_f32_16x16x32_bf16 v[44:47], a[216:219], v[204:207], v[44:47]
ds_read_b64_tr_b16 a[200:201], v13 offset:30720
v_accvgpr_write_b32 a98, v190
v_mfma_f32_16x16x32_bf16 v[48:51], a[216:219], v[208:211], v[48:51]
ds_read_b64_tr_b16 a[202:203], v13 offset:31232
buffer_load_dwordx4 v10, s[40:43], s67 offen offset:1024 lds
v_mfma_f32_16x16x32_bf16 v[52:55], a[220:223], v[204:207], v[52:55]
ds_read_b64_tr_b16 a[204:205], v14 offset:30720
v_accvgpr_write_b32 a99, v191
v_mfma_f32_16x16x32_bf16 v[56:59], a[220:223], v[208:211], v[56:59]
ds_read_b64_tr_b16 a[206:207], v14 offset:31232
s_waitcnt lgkmcnt(8)
v_mfma_f32_16x16x32_bf16 v[60:63], a[224:227], v[204:207], v[60:63]
ds_read_b64_tr_b16 a[208:209], v11 offset:31744
v_accvgpr_write_b32 a100, v192
v_mfma_f32_16x16x32_bf16 v[64:67], a[224:227], v[208:211], v[64:67]
ds_read_b64_tr_b16 a[210:211], v11 offset:32256
v_accvgpr_write_b32 a101, v193
v_mfma_f32_16x16x32_bf16 v[68:71], a[228:231], v[204:207], v[68:71]
ds_read_b64_tr_b16 a[212:213], v12 offset:31744
v_accvgpr_write_b32 a102, v194
v_mfma_f32_16x16x32_bf16 v[72:75], a[228:231], v[208:211], v[72:75]
ds_read_b64_tr_b16 a[214:215], v12 offset:32256
v_accvgpr_write_b32 a103, v195
v_mfma_f32_16x16x32_bf16 v[76:79], a[232:235], v[204:207], v[76:79]
ds_read_b64_tr_b16 a[216:217], v13 offset:31744
v_accvgpr_write_b32 a104, v196
v_mfma_f32_16x16x32_bf16 v[80:83], a[232:235], v[208:211], v[80:83]
ds_read_b64_tr_b16 a[218:219], v13 offset:32256
v_accvgpr_write_b32 a105, v197
v_mfma_f32_16x16x32_bf16 v[84:87], a[236:239], v[204:207], v[84:87]
ds_read_b64_tr_b16 a[220:221], v14 offset:31744
v_accvgpr_write_b32 a106, v198
v_mfma_f32_16x16x32_bf16 v[88:91], a[236:239], v[208:211], v[88:91]
ds_read_b64_tr_b16 a[222:223], v14 offset:32256
s_waitcnt lgkmcnt(8)
v_mfma_f32_16x16x32_bf16 v[28:31], a[192:195], v[212:215], v[28:31]
ds_read_b64_tr_b16 a[224:225], v11 offset:32768
s_add_u32 m0, s64, 24576
v_mfma_f32_16x16x32_bf16 v[32:35], a[192:195], v[216:219], v[32:35]
ds_read_b64_tr_b16 a[226:227], v11 offset:33280
s_add_u32 s67, s19, 3538944
v_mfma_f32_16x16x32_bf16 v[36:39], a[196:199], v[212:215], v[36:39]
ds_read_b64_tr_b16 a[228:229], v12 offset:32768
buffer_load_dwordx4 v10, s[36:39], s67 offen lds
v_mfma_f32_16x16x32_bf16 v[40:43], a[196:199], v[216:219], v[40:43]
ds_read_b64_tr_b16 a[230:231], v12 offset:33280
v_accvgpr_write_b32 a107, v199
v_mfma_f32_16x16x32_bf16 v[44:47], a[200:203], v[212:215], v[44:47]
ds_read_b64_tr_b16 a[232:233], v13 offset:32768
v_accvgpr_write_b32 a108, v200
v_mfma_f32_16x16x32_bf16 v[48:51], a[200:203], v[216:219], v[48:51]
ds_read_b64_tr_b16 a[234:235], v13 offset:33280
buffer_load_dwordx4 v10, s[40:43], s67 offen offset:1024 lds
v_mfma_f32_16x16x32_bf16 v[52:55], a[204:207], v[212:215], v[52:55]
ds_read_b64_tr_b16 a[236:237], v14 offset:32768
v_accvgpr_write_b32 a109, v201
v_mfma_f32_16x16x32_bf16 v[56:59], a[204:207], v[216:219], v[56:59]
ds_read_b64_tr_b16 a[238:239], v14 offset:33280
s_waitcnt lgkmcnt(8)
v_mfma_f32_16x16x32_bf16 v[60:63], a[208:211], v[212:215], v[60:63]
ds_read_b64_tr_b16 a[192:193], v11 offset:33792
v_accvgpr_write_b32 a110, v202
v_mfma_f32_16x16x32_bf16 v[64:67], a[208:211], v[216:219], v[64:67]
ds_read_b64_tr_b16 a[194:195], v11 offset:34304
v_accvgpr_write_b32 a111, v203
v_mfma_f32_16x16x32_bf16 v[68:71], a[212:215], v[212:215], v[68:71]
ds_read_b64_tr_b16 a[196:197], v12 offset:33792
v_accvgpr_write_b32 a112, v204
v_mfma_f32_16x16x32_bf16 v[72:75], a[212:215], v[216:219], v[72:75]
ds_read_b64_tr_b16 a[198:199], v12 offset:34304
v_accvgpr_write_b32 a113, v205
v_mfma_f32_16x16x32_bf16 v[76:79], a[216:219], v[212:215], v[76:79]
ds_read_b64_tr_b16 a[200:201], v13 offset:33792
v_accvgpr_write_b32 a114, v206
v_mfma_f32_16x16x32_bf16 v[80:83], a[216:219], v[216:219], v[80:83]
ds_read_b64_tr_b16 a[202:203], v13 offset:34304
v_accvgpr_write_b32 a115, v207
v_mfma_f32_16x16x32_bf16 v[84:87], a[220:223], v[212:215], v[84:87]
ds_read_b64_tr_b16 a[204:205], v14 offset:33792
v_accvgpr_write_b32 a116, v208
v_mfma_f32_16x16x32_bf16 v[88:91], a[220:223], v[216:219], v[88:91]
ds_read_b64_tr_b16 a[206:207], v14 offset:34304
s_waitcnt lgkmcnt(8)
v_mfma_f32_16x16x32_bf16 v[28:31], a[224:227], v[220:223], v[28:31]
ds_read_b64_tr_b16 a[208:209], v11 offset:34816
s_add_u32 m0, s64, 26624
v_mfma_f32_16x16x32_bf16 v[32:35], a[224:227], v[224:227], v[32:35]
ds_read_b64_tr_b16 a[210:211], v11 offset:35328
s_add_u32 s67, s19, 3833856
v_mfma_f32_16x16x32_bf16 v[36:39], a[228:231], v[220:223], v[36:39]
ds_read_b64_tr_b16 a[212:213], v12 offset:34816
buffer_load_dwordx4 v10, s[36:39], s67 offen lds
v_accvgpr_write_b32 a117, v209
v_mfma_f32_16x16x32_bf16 v[40:43], a[228:231], v[224:227], v[40:43]
ds_read_b64_tr_b16 a[214:215], v12 offset:35328
v_accvgpr_write_b32 a118, v210
v_mfma_f32_16x16x32_bf16 v[44:47], a[232:235], v[220:223], v[44:47]
ds_read_b64_tr_b16 a[216:217], v13 offset:34816
v_accvgpr_write_b32 a119, v211
v_mfma_f32_16x16x32_bf16 v[48:51], a[232:235], v[224:227], v[48:51]
ds_read_b64_tr_b16 a[218:219], v13 offset:35328
buffer_load_dwordx4 v10, s[40:43], s67 offen offset:1024 lds
v_mfma_f32_16x16x32_bf16 v[52:55], a[236:239], v[220:223], v[52:55]
ds_read_b64_tr_b16 a[220:221], v14 offset:34816
v_accvgpr_write_b32 a120, v212
v_mfma_f32_16x16x32_bf16 v[56:59], a[236:239], v[224:227], v[56:59]
ds_read_b64_tr_b16 a[222:223], v14 offset:35328
s_waitcnt lgkmcnt(8)
v_mfma_f32_16x16x32_bf16 v[60:63], a[192:195], v[220:223], v[60:63]
ds_read_b64_tr_b16 a[224:225], v11 offset:35840
v_accvgpr_write_b32 a121, v213
v_mfma_f32_16x16x32_bf16 v[64:67], a[192:195], v[224:227], v[64:67]
ds_read_b64_tr_b16 a[226:227], v11 offset:36352
v_accvgpr_write_b32 a122, v214
v_mfma_f32_16x16x32_bf16 v[68:71], a[196:199], v[220:223], v[68:71]
ds_read_b64_tr_b16 a[228:229], v12 offset:35840
v_accvgpr_write_b32 a123, v215
v_mfma_f32_16x16x32_bf16 v[72:75], a[196:199], v[224:227], v[72:75]
ds_read_b64_tr_b16 a[230:231], v12 offset:36352
v_accvgpr_write_b32 a124, v216
v_mfma_f32_16x16x32_bf16 v[76:79], a[200:203], v[220:223], v[76:79]
ds_read_b64_tr_b16 a[232:233], v13 offset:35840
v_accvgpr_write_b32 a125, v217
v_mfma_f32_16x16x32_bf16 v[80:83], a[200:203], v[224:227], v[80:83]
ds_read_b64_tr_b16 a[234:235], v13 offset:36352
v_accvgpr_write_b32 a126, v218
v_mfma_f32_16x16x32_bf16 v[84:87], a[204:207], v[220:223], v[84:87]
ds_read_b64_tr_b16 a[236:237], v14 offset:35840
v_accvgpr_write_b32 a127, v219
v_mfma_f32_16x16x32_bf16 v[88:91], a[204:207], v[224:227], v[88:91]
ds_read_b64_tr_b16 a[238:239], v14 offset:36352
s_waitcnt lgkmcnt(8)
v_mfma_f32_16x16x32_bf16 v[92:95], a[208:211], v[228:231], v[28:31]
s_waitcnt vmcnt(34)
s_barrier
ds_read_b64_tr_b16 a[192:193], v11 offset:0
v_mfma_f32_16x16x32_bf16 v[96:99], a[208:211], v[232:235], v[32:35]
ds_read_b64_tr_b16 a[194:195], v11 offset:512
s_add_u32 m0, s64, 28672
v_mfma_f32_16x16x32_bf16 v[100:103], a[212:215], v[228:231], v[36:39]
ds_read_b64_tr_b16 a[196:197], v12 offset:0
s_add_u32 s67, s19, 4128768
v_mfma_f32_16x16x32_bf16 v[104:107], a[212:215], v[232:235], v[40:43]
ds_read_b64_tr_b16 a[198:199], v12 offset:512
buffer_load_dwordx4 v10, s[36:39], s67 offen lds
v_mfma_f32_16x16x32_bf16 v[108:111], a[216:219], v[228:231], v[44:47]
ds_read_b64_tr_b16 a[200:201], v13 offset:0
v_mfma_f32_16x16x32_bf16 v[112:115], a[216:219], v[232:235], v[48:51]
ds_read_b64_tr_b16 a[202:203], v13 offset:512
v_mfma_f32_16x16x32_bf16 v[116:119], a[220:223], v[228:231], v[52:55]
ds_read_b64_tr_b16 a[204:205], v14 offset:0
buffer_load_dwordx4 v10, s[40:43], s67 offen offset:1024 lds
v_mfma_f32_16x16x32_bf16 v[120:123], a[220:223], v[232:235], v[56:59]
ds_read_b64_tr_b16 a[206:207], v14 offset:512
s_waitcnt lgkmcnt(8)
v_mfma_f32_16x16x32_bf16 v[124:127], a[224:227], v[228:231], v[60:63]
ds_read_b64_tr_b16 a[208:209], v11 offset:1024
buffer_load_dwordx4 a[252:255], v255, s[56:59], s3 offen
v_mfma_f32_16x16x32_bf16 v[128:131], a[224:227], v[232:235], v[64:67]
ds_read_b64_tr_b16 a[210:211], v11 offset:1536
buffer_load_dwordx4 a[252:255], v255, s[56:59], s3 offen
v_mfma_f32_16x16x32_bf16 v[132:135], a[228:231], v[228:231], v[68:71]
ds_read_b64_tr_b16 a[212:213], v12 offset:1024
buffer_load_dwordx4 a[252:255], v255, s[56:59], s3 offen
v_mfma_f32_16x16x32_bf16 v[136:139], a[228:231], v[232:235], v[72:75]
ds_read_b64_tr_b16 a[214:215], v12 offset:1536
v_mfma_f32_16x16x32_bf16 v[140:143], a[232:235], v[228:231], v[76:79]
ds_read_b64_tr_b16 a[216:217], v13 offset:1024
v_mfma_f32_16x16x32_bf16 v[144:147], a[232:235], v[232:235], v[80:83]
ds_read_b64_tr_b16 a[218:219], v13 offset:1536
v_mfma_f32_16x16x32_bf16 v[148:151], a[236:239], v[228:231], v[84:87]
ds_read_b64_tr_b16 a[220:221], v14 offset:1024
v_mfma_f32_16x16x32_bf16 v[152:155], a[236:239], v[232:235], v[88:91]
ds_read_b64_tr_b16 a[222:223], v14 offset:1536
s_mov_b32 s65, s19
s_add_u32 s19, s65, s18
s_add_u32 s12, s12, 1
L_loopA:
s_waitcnt lgkmcnt(8)
v_mfma_f32_16x16x32_bf16 v[28:31], a[192:195], a[0:3], 0
ds_read_b64_tr_b16 a[224:225], v11 offset:2048
s_add_u32 m0, s64, 30720
v_mfma_f32_16x16x32_bf16 v[32:35], a[192:195], a[4:7], 0
ds_read_b64_tr_b16 a[226:227], v11 offset:2560
s_add_u32 s67, s65, 4423680
v_mfma_f32_16x16x32_bf16 v[36:39], a[196:199], a[0:3], 0
ds_read_b64_tr_b16 a[228:229], v12 offset:2048
buffer_load_dwordx4 v10, s[36:39], s67 offen lds
v_mfma_f32_16x16x32_bf16 v[40:43], a[196:199], a[4:7], 0
ds_read_b64_tr_b16 a[230:231], v12 offset:2560
v_max_f32 v92, 0, v92
v_mfma_f32_16x16x32_bf16 v[44:47], a[200:203], a[0:3], 0
ds_read_b64_tr_b16 a[232:233], v13 offset:2048
s_mul_i32 s14, s61, 9
v_mfma_f32_16x16x32_bf16 v[48:51], a[200:203], a[4:7], 0
ds_read_b64_tr_b16 a[234:235], v13 offset:2560
buffer_load_dwordx4 v10, s[40:43], s67 offen offset:1024 lds
v_mfma_f32_16x16x32_bf16 v[52:55], a[204:207], a[0:3], 0
ds_read_b64_tr_b16 a[236:237], v14 offset:2048
v_max_f32 v93, 0, v93
v_mfma_f32_16x16x32_bf16 v[56:59], a[204:207], a[4:7], 0
ds_read_b64_tr_b16 a[238:239], v14 offset:2560
s_waitcnt lgkmcnt(8)
v_mfma_f32_16x16x32_bf16 v[60:63], a[208:211], a[0:3], 0
ds_read_b64_tr_b16 a[192:193], v11 offset:3072
s_mul_i32 s10, s7, 3
v_mfma_f32_16x16x32_bf16 v[64:67], a[208:211], a[4:7], 0
ds_read_b64_tr_b16 a[194:195], v11 offset:3584
v_max_f32 v94, 0, v94
v_mfma_f32_16x16x32_bf16 v[68:71], a[212:215], a[0:3], 0
ds_read_b64_tr_b16 a[196:197], v12 offset:3072
s_add_u32 s14, s14, s10
v_mfma_f32_16x16x32_bf16 v[72:75], a[212:215], a[4:7], 0
ds_read_b64_tr_b16 a[198:199], v12 offset:3584
v_max_f32 v95, 0, v95
v_mfma_f32_16x16x32_bf16 v[76:79], a[216:219], a[0:3], 0
ds_read_b64_tr_b16 a[200:201], v13 offset:3072
s_lshl_b32 s14, s14, 2
v_mfma_f32_16x16x32_bf16 v[80:83], a[216:219], a[4:7], 0
ds_read_b64_tr_b16 a[202:203], v13 offset:3584
v_mov_b32 v172, v188
v_mfma_f32_16x16x32_bf16 v[84:87], a[220:223], a[0:3], 0
ds_read_b64_tr_b16 a[204:205], v14 offset:3072
v_mfma_f32_16x16x32_bf16 v[88:91], a[220:223], a[4:7], 0
ds_read_b64_tr_b16 a[206:207], v14 offset:3584
s_waitcnt lgkmcnt(8)
v_mfma_f32_16x16x32_bf16 v[28:31], a[224:227], a[8:11], v[28:31]
ds_read_b64_tr_b16 a[208:209], v11 offset:4096
s_add_u32 m0, s64, 32768
v_mfma_f32_16x16x32_bf16 v[32:35], a[224:227], a[12:15], v[32:35]
ds_read_b64_tr_b16 a[210:211], v11 offset:4608
s_add_u32 s67, s65, 4718592
v_mfma_f32_16x16x32_bf16 v[36:39], a[228:231], a[8:11], v[36:39]
ds_read_b64_tr_b16 a[212:213], v12 offset:4096
buffer_load_dwordx4 v10, s[36:39], s67 offen lds
v_mfma_f32_16x16x32_bf16 v[40:43], a[228:231], a[12:15], v[40:43]
ds_read_b64_tr_b16 a[214:215], v12 offset:4608
s_add_u32 s14, s14, s60
v_mfma_f32_16x16x32_bf16 v[44:47], a[232:235], a[8:11], v[44:47]
ds_read_b64_tr_b16 a[216:217], v13 offset:4096
v_mov_b32 v188, v204
v_mfma_f32_16x16x32_bf16 v[48:51], a[232:235], a[12:15], v[48:51]
ds_read_b64_tr_b16 a[218:219], v13 offset:4608
buffer_load_dwordx4 v10, s[40:43], s67 offen offset:1024 lds
v_mfma_f32_16x16x32_bf16 v[52:55], a[236:239], a[8:11], v[52:55]
ds_read_b64_tr_b16 a[220:221], v14 offset:4096
s_mul_i32 s14, s14, 5
v_mfma_f32_16x16x32_bf16 v[56:59], a[236:239], a[12:15], v[56:59]
ds_read_b64_tr_b16 a[222:223], v14 offset:4608
s_waitcnt lgkmcnt(8)
v_mfma_f32_16x16x32_bf16 v[60:63], a[192:195], a[8:11], v[60:63]
ds_read_b64_tr_b16 a[224:225], v11 offset:5120
v_mov_b32 v173, v189
v_mfma_f32_16x16x32_bf16 v[64:67], a[192:195], a[12:15], v[64:67]
ds_read_b64_tr_b16 a[226:227], v11 offset:5632
s_add_u32 s14, s14, s6
v_mfma_f32_16x16x32_bf16 v[68:71], a[196:199], a[8:11], v[68:71]
ds_read_b64_tr_b16 a[228:229], v12 offset:5120
v_mov_b32 v189, v205
v_mfma_f32_16x16x32_bf16 v[72:75], a[196:199], a[12:15], v[72:75]
ds_read_b64_tr_b16 a[230:231], v12 offset:5632
s_lshl_b32 s14, s14, 12
v_mfma_f32_16x16x32_bf16 v[76:79], a[200:203], a[8:11], v[76:79]
ds_read_b64_tr_b16 a[232:233], v13 offset:5120
v_mul_f32 v92, v92, v124
v_mfma_f32_16x16x32_bf16 v[80:83], a[200:203], a[12:15], v[80:83]
ds_read_b64_tr_b16 a[234:235], v13 offset:5632
s_add_u32 s14, s14, 4194304
v_mfma_f32_16x16x32_bf16 v[84:87], a[204:207], a[8:11], v[84:87]
ds_read_b64_tr_b16 a[236:237], v14 offset:5120
v_mul_f32 v93, v93, v125
v_mfma_f32_16x16x32_bf16 v[88:91], a[204:207], a[12:15], v[88:91]
ds_read_b64_tr_b16 a[238:239], v14 offset:5632
s_waitcnt lgkmcnt(8)
v_mfma_f32_16x16x32_bf16 v[28:31], a[208:211], a[16:19], v[28:31]
s_waitcnt vmcnt(28)
s_barrier
ds_read_b64_tr_b16 a[192:193], v11 offset:6144
v_mfma_f32_16x16x32_bf16 v[32:35], a[208:211], a[20:23], v[32:35]
ds_read_b64_tr_b16 a[194:195], v11 offset:6656
s_add_u32 m0, s64, 34816
v_mfma_f32_16x16x32_bf16 v[36:39], a[212:215], a[16:19], v[36:39]
ds_read_b64_tr_b16 a[196:197], v12 offset:6144
s_add_u32 s67, s65, 5013504
buffer_load_dwordx4 v10, s[36:39], s67 offen lds
v_mfma_f32_16x16x32_bf16 v[40:43], a[212:215], a[20:23], v[40:43]
ds_read_b64_tr_b16 a[198:199], v12 offset:6656
s_cmp_eq_u32 s6, 4
s_cselect_b32 s13, 4, 1
v_mfma_f32_16x16x32_bf16 v[44:47], a[216:219], a[16:19], v[44:47]
ds_read_b64_tr_b16 a[200:201], v13 offset:6144
v_mul_f32 v94, v94, v126
v_mfma_f32_16x16x32_bf16 v[48:51], a[216:219], a[20:23], v[48:51]
ds_read_b64_tr_b16 a[202:203], v13 offset:6656
buffer_load_dwordx4 v10, s[40:43], s67 offen offset:1024 lds
v_mfma_f32_16x16x32_bf16 v[52:55], a[220:223], a[16:19], v[52:55]
ds_read_b64_tr_b16 a[204:205], v14 offset:6144
s_lshl_b32 s16, s60, 12
v_mfma_f32_16x16x32_bf16 v[56:59], a[220:223], a[20:23], v[56:59]
ds_read_b64_tr_b16 a[206:207], v14 offset:6656
s_waitcnt lgkmcnt(8)
v_mfma_f32_16x16x32_bf16 v[60:63], a[224:227], a[16:19], v[60:63]
ds_read_b64_tr_b16 a[208:209], v11 offset:7168
v_mul_f32 v95, v95, v127
v_mfma_f32_16x16x32_bf16 v[64:67], a[224:227], a[20:23], v[64:67]
ds_read_b64_tr_b16 a[210:211], v11 offset:7680
s_add_u32 s16, s16, 15990784
v_mfma_f32_16x16x32_bf16 v[68:71], a[228:231], a[16:19], v[68:71]
ds_read_b64_tr_b16 a[212:213], v12 offset:7168
v_cvt_pk_bf16_f32 v204, v92, v93
v_mfma_f32_16x16x32_bf16 v[72:75], a[228:231], a[20:23], v[72:75]
ds_read_b64_tr_b16 a[214:215], v12 offset:7680
v_mov_b32 v7, 2147483392
v_mfma_f32_16x16x32_bf16 v[76:79], a[232:235], a[16:19], v[76:79]
ds_read_b64_tr_b16 a[216:217], v13 offset:7168
v_cvt_pk_bf16_f32 v205, v94, v95
v_mfma_f32_16x16x32_bf16 v[80:83], a[232:235], a[20:23], v[80:83]
ds_read_b64_tr_b16 a[218:219], v13 offset:7680
s_lshl_b32 s10, s7, 1
v_mfma_f32_16x16x32_bf16 v[84:87], a[236:239], a[16:19], v[84:87]
ds_read_b64_tr_b16 a[220:221], v14 offset:7168
v_max_f32 v96, 0, v96
v_mfma_f32_16x16x32_bf16 v[88:91], a[236:239], a[20:23], v[88:91]
ds_read_b64_tr_b16 a[222:223], v14 offset:7680
s_waitcnt lgkmcnt(8)
v_mfma_f32_16x16x32_bf16 v[28:31], a[192:195], a[24:27], v[28:31]
ds_read_b64_tr_b16 a[224:225], v11 offset:8192
s_add_u32 m0, s64, 0
v_mfma_f32_16x16x32_bf16 v[32:35], a[192:195], a[28:31], v[32:35]
ds_read_b64_tr_b16 a[226:227], v11 offset:8704
s_add_u32 s67, s19, 0
v_mfma_f32_16x16x32_bf16 v[36:39], a[196:199], a[24:27], v[36:39]
ds_read_b64_tr_b16 a[228:229], v12 offset:8192
buffer_load_dwordx4 v10, s[36:39], s67 offen lds
v_mfma_f32_16x16x32_bf16 v[40:43], a[196:199], a[28:31], v[40:43]
ds_read_b64_tr_b16 a[230:231], v12 offset:8704
s_lshr_b32 s10, 9, s10
v_mfma_f32_16x16x32_bf16 v[44:47], a[200:203], a[24:27], v[44:47]
ds_read_b64_tr_b16 a[232:233], v13 offset:8192
v_max_f32 v97, 0, v97
v_mfma_f32_16x16x32_bf16 v[48:51], a[200:203], a[28:31], v[48:51]
ds_read_b64_tr_b16 a[234:235], v13 offset:8704
buffer_load_dwordx4 v10, s[40:43], s67 offen offset:1024 lds
v_mfma_f32_16x16x32_bf16 v[52:55], a[204:207], a[24:27], v[52:55]
ds_read_b64_tr_b16 a[236:237], v14 offset:8192
s_and_b32 s10, s10, 3
v_mfma_f32_16x16x32_bf16 v[56:59], a[204:207], a[28:31], v[56:59]
ds_read_b64_tr_b16 a[238:239], v14 offset:8704
s_waitcnt lgkmcnt(8)
v_mfma_f32_16x16x32_bf16 v[60:63], a[208:211], a[24:27], v[60:63]
ds_read_b64_tr_b16 a[192:193], v11 offset:9216
v_max_f32 v98, 0, v98
v_mfma_f32_16x16x32_bf16 v[64:67], a[208:211], a[28:31], v[64:67]
ds_read_b64_tr_b16 a[194:195], v11 offset:9728
s_lshl_b32 s11, s10, 3
v_mfma_f32_16x16x32_bf16 v[68:71], a[212:215], a[24:27], v[68:71]
ds_read_b64_tr_b16 a[196:197], v12 offset:9216
v_max_f32 v99, 0, v99
v_mfma_f32_16x16x32_bf16 v[72:75], a[212:215], a[28:31], v[72:75]
ds_read_b64_tr_b16 a[198:199], v12 offset:9728
s_lshr_b32 s11, s8, s11
v_mfma_f32_16x16x32_bf16 v[76:79], a[216:219], a[24:27], v[76:79]
ds_read_b64_tr_b16 a[200:201], v13 offset:9216
v_mov_b32 v176, v192
v_mfma_f32_16x16x32_bf16 v[80:83], a[216:219], a[28:31], v[80:83]
ds_read_b64_tr_b16 a[202:203], v13 offset:9728
s_and_b32 s11, s11, 0xff
v_mfma_f32_16x16x32_bf16 v[84:87], a[220:223], a[24:27], v[84:87]
ds_read_b64_tr_b16 a[204:205], v14 offset:9216
v_mov_b32 v192, v208
v_mfma_f32_16x16x32_bf16 v[88:91], a[220:223], a[28:31], v[88:91]
ds_read_b64_tr_b16 a[206:207], v14 offset:9728
s_waitcnt lgkmcnt(8)
v_mfma_f32_16x16x32_bf16 v[28:31], a[224:227], a[32:35], v[28:31]
ds_read_b64_tr_b16 a[208:209], v11 offset:10240
s_add_u32 m0, s64, 2048
v_mfma_f32_16x16x32_bf16 v[32:35], a[224:227], a[36:39], v[32:35]
ds_read_b64_tr_b16 a[210:211], v11 offset:10752
s_add_u32 s67, s19, 294912
v_mfma_f32_16x16x32_bf16 v[36:39], a[228:231], a[32:35], v[36:39]
ds_read_b64_tr_b16 a[212:213], v12 offset:10240
buffer_load_dwordx4 v10, s[36:39], s67 offen lds
v_mfma_f32_16x16x32_bf16 v[40:43], a[228:231], a[36:39], v[40:43]
ds_read_b64_tr_b16 a[214:215], v12 offset:10752
s_add_u32 s11, s11, s9
v_mfma_f32_16x16x32_bf16 v[44:47], a[232:235], a[32:35], v[44:47]
ds_read_b64_tr_b16 a[216:217], v13 offset:10240
v_mov_b32 v177, v193
v_mfma_f32_16x16x32_bf16 v[48:51], a[232:235], a[36:39], v[48:51]
ds_read_b64_tr_b16 a[218:219], v13 offset:10752
buffer_load_dwordx4 v10, s[40:43], s67 offen offset:1024 lds
v_mfma_f32_16x16x32_bf16 v[52:55], a[236:239], a[32:35], v[52:55]
ds_read_b64_tr_b16 a[220:221], v14 offset:10240
s_mov_b32 s71, 73728
v_mfma_f32_16x16x32_bf16 v[56:59], a[236:239], a[36:39], v[56:59]
ds_read_b64_tr_b16 a[222:223], v14 offset:10752
s_waitcnt lgkmcnt(8)
v_mfma_f32_16x16x32_bf16 v[60:63], a[192:195], a[32:35], v[60:63]
ds_read_b64_tr_b16 a[224:225], v11 offset:11264
v_mov_b32 v193, v209
v_mfma_f32_16x16x32_bf16 v[64:67], a[192:195], a[36:39], v[64:67]
ds_read_b64_tr_b16 a[226:227], v11 offset:11776
s_mul_i32 s92, s11, 73728
v_mfma_f32_16x16x32_bf16 v[68:71], a[196:199], a[32:35], v[68:71]
ds_read_b64_tr_b16 a[228:229], v12 offset:11264
v_mul_f32 v96, v96, v128
v_mfma_f32_16x16x32_bf16 v[72:75], a[196:199], a[36:39], v[72:75]
ds_read_b64_tr_b16 a[230:231], v12 offset:11776
s_mul_i32 s11, s7, 384
v_mfma_f32_16x16x32_bf16 v[76:79], a[200:203], a[32:35], v[76:79]
ds_read_b64_tr_b16 a[232:233], v13 offset:11264
v_mul_f32 v97, v97, v129
v_mfma_f32_16x16x32_bf16 v[80:83], a[200:203], a[36:39], v[80:83]
ds_read_b64_tr_b16 a[234:235], v13 offset:11776
s_add_u32 s92, s92, s11
v_mfma_f32_16x16x32_bf16 v[84:87], a[204:207], a[32:35], v[84:87]
ds_read_b64_tr_b16 a[236:237], v14 offset:11264
v_mul_f32 v98, v98, v130
v_mfma_f32_16x16x32_bf16 v[88:91], a[204:207], a[36:39], v[88:91]
ds_read_b64_tr_b16 a[238:239], v14 offset:11776
s_waitcnt lgkmcnt(8)
v_mfma_f32_16x16x32_bf16 v[28:31], a[208:211], a[40:43], v[28:31]
s_waitcnt vmcnt(27)
s_barrier
ds_read_b64_tr_b16 a[192:193], v11 offset:12288
v_mfma_f32_16x16x32_bf16 v[32:35], a[208:211], a[44:47], v[32:35]
ds_read_b64_tr_b16 a[194:195], v11 offset:12800
s_add_u32 m0, s64, 4096
v_mfma_f32_16x16x32_bf16 v[36:39], a[212:215], a[40:43], v[36:39]
ds_read_b64_tr_b16 a[196:197], v12 offset:12288
s_add_u32 s67, s19, 589824
buffer_load_dwordx4 v10, s[36:39], s67 offen lds
v_mfma_f32_16x16x32_bf16 v[40:43], a[212:215], a[44:47], v[40:43]
ds_read_b64_tr_b16 a[198:199], v12 offset:12800
s_sub_u32 s10, s10, s7
v_mul_f32 v99, v99, v131
v_mfma_f32_16x16x32_bf16 v[44:47], a[216:219], a[40:43], v[44:47]
ds_read_b64_tr_b16 a[200:201], v13 offset:12288
s_mul_i32 s10, s10, s13
v_cvt_pk_bf16_f32 v208, v96, v97
v_mfma_f32_16x16x32_bf16 v[48:51], a[216:219], a[44:47], v[48:51]
ds_read_b64_tr_b16 a[202:203], v13 offset:12800
buffer_load_dwordx4 v10, s[40:43], s67 offen offset:1024 lds
s_add_u32 s10, s10, s62
v_mfma_f32_16x16x32_bf16 v[52:55], a[220:223], a[40:43], v[52:55]
ds_read_b64_tr_b16 a[204:205], v14 offset:12288
v_cvt_pk_bf16_f32 v209, v98, v99
v_mfma_f32_16x16x32_bf16 v[56:59], a[220:223], a[44:47], v[56:59]
ds_read_b64_tr_b16 a[206:207], v14 offset:12800
s_waitcnt lgkmcnt(8)
v_mfma_f32_16x16x32_bf16 v[60:63], a[224:227], a[40:43], v[60:63]
ds_read_b64_tr_b16 a[208:209], v11 offset:13312
buffer_load_dwordx4 a[252:255], v20, s[44:47], s24 offen offset:0
v_mfma_f32_16x16x32_bf16 v[64:67], a[224:227], a[44:47], v[64:67]
ds_read_b64_tr_b16 a[210:211], v11 offset:13824
buffer_load_dwordx4 a[252:255], v20, s[44:47], s24 offen offset:1024
v_mfma_f32_16x16x32_bf16 v[68:71], a[228:231], a[40:43], v[68:71]
ds_read_b64_tr_b16 a[212:213], v12 offset:13312
s_add_u32 s24, s24, 2048
v_mfma_f32_16x16x32_bf16 v[72:75], a[228:231], a[44:47], v[72:75]
ds_read_b64_tr_b16 a[214:215], v12 offset:13824
s_lshl_b32 s11, s10, 7
v_mfma_f32_16x16x32_bf16 v[76:79], a[232:235], a[40:43], v[76:79]
ds_read_b64_tr_b16 a[216:217], v13 offset:13312
v_max_f32 v100, 0, v100
v_mfma_f32_16x16x32_bf16 v[80:83], a[232:235], a[44:47], v[80:83]
ds_read_b64_tr_b16 a[218:219], v13 offset:13824
v_mov_b32 v2, s11
v_mfma_f32_16x16x32_bf16 v[84:87], a[236:239], a[40:43], v[84:87]
ds_read_b64_tr_b16 a[220:221], v14 offset:13312
v_max_f32 v101, 0, v101
v_mfma_f32_16x16x32_bf16 v[88:91], a[236:239], a[44:47], v[88:91]
ds_read_b64_tr_b16 a[222:223], v14 offset:13824
s_waitcnt lgkmcnt(8)
v_mfma_f32_16x16x32_bf16 v[28:31], a[192:195], a[48:51], v[28:31]
ds_read_b64_tr_b16 a[224:225], v11 offset:14336
s_add_u32 m0, s64, 6144
v_mfma_f32_16x16x32_bf16 v[32:35], a[192:195], a[52:55], v[32:35]
ds_read_b64_tr_b16 a[226:227], v11 offset:14848
s_add_u32 s67, s19, 884736
v_mfma_f32_16x16x32_bf16 v[36:39], a[196:199], a[48:51], v[36:39]
ds_read_b64_tr_b16 a[228:229], v12 offset:14336
buffer_load_dwordx4 v10, s[36:39], s67 offen lds
v_mfma_f32_16x16x32_bf16 v[40:43], a[196:199], a[52:55], v[40:43]
ds_read_b64_tr_b16 a[230:231], v12 offset:14848
v_cmp_eq_u32 vcc, 0, v1
v_mfma_f32_16x16x32_bf16 v[44:47], a[200:203], a[48:51], v[44:47]
ds_read_b64_tr_b16 a[232:233], v13 offset:14336
v_max_f32 v102, 0, v102
v_mfma_f32_16x16x32_bf16 v[48:51], a[200:203], a[52:55], v[48:51]
ds_read_b64_tr_b16 a[234:235], v13 offset:14848
buffer_load_dwordx4 v10, s[40:43], s67 offen offset:1024 lds
v_mfma_f32_16x16x32_bf16 v[52:55], a[204:207], a[48:51], v[52:55]
ds_read_b64_tr_b16 a[236:237], v14 offset:14336
s_lshl_b32 s11, s61, 4
v_mfma_f32_16x16x32_bf16 v[56:59], a[204:207], a[52:55], v[56:59]
ds_read_b64_tr_b16 a[238:239], v14 offset:14848
s_waitcnt lgkmcnt(8)
v_mfma_f32_16x16x32_bf16 v[60:63], a[208:211], a[48:51], v[60:63]
ds_read_b64_tr_b16 a[192:193], v11 offset:15360
v_max_f32 v103, 0, v103
v_mfma_f32_16x16x32_bf16 v[64:67], a[208:211], a[52:55], v[64:67]
ds_read_b64_tr_b16 a[194:195], v11 offset:15872
s_add_u32 s10, s10, s11
v_mfma_f32_16x16x32_bf16 v[68:71], a[212:215], a[48:51], v[68:71]
ds_read_b64_tr_b16 a[196:197], v12 offset:15360
v_mov_b32 v174, v190
v_mfma_f32_16x16x32_bf16 v[72:75], a[212:215], a[52:55], v[72:75]
ds_read_b64_tr_b16 a[198:199], v12 offset:15872
v_cndmask_b32 v7, v7, v2, vcc
v_mfma_f32_16x16x32_bf16 v[76:79], a[216:219], a[48:51], v[76:79]
ds_read_b64_tr_b16 a[200:201], v13 offset:15360
v_mov_b32 v190, v206
v_mfma_f32_16x16x32_bf16 v[80:83], a[216:219], a[52:55], v[80:83]
ds_read_b64_tr_b16 a[202:203], v13 offset:15872
s_mul_i32 s94, s10, 81920
v_mfma_f32_16x16x32_bf16 v[84:87], a[220:223], a[48:51], v[84:87]
ds_read_b64_tr_b16 a[204:205], v14 offset:15360
v_mov_b32 v175, v191
v_mfma_f32_16x16x32_bf16 v[88:91], a[220:223], a[52:55], v[88:91]
ds_read_b64_tr_b16 a[206:207], v14 offset:15872
s_waitcnt lgkmcnt(8)
v_mfma_f32_16x16x32_bf16 v[28:31], a[224:227], a[56:59], v[28:31]
ds_read_b64_tr_b16 a[208:209], v11 offset:16384
s_add_u32 m0, s64, 8192
v_mfma_f32_16x16x32_bf16 v[32:35], a[224:227], a[60:63], v[32:35]
ds_read_b64_tr_b16 a[210:211], v11 offset:16896
s_add_u32 s67, s19, 1179648
v_mfma_f32_16x16x32_bf16 v[36:39], a[228:231], a[56:59], v[36:39]
ds_read_b64_tr_b16 a[212:213], v12 offset:16384
buffer_load_dwordx4 v10, s[36:39], s67 offen lds
v_mfma_f32_16x16x32_bf16 v[40:43], a[228:231], a[60:63], v[40:43]
ds_read_b64_tr_b16 a[214:215], v12 offset:16896
s_add_u32 s94, s94, s16
v_mfma_f32_16x16x32_bf16 v[44:47], a[232:235], a[56:59], v[44:47]
ds_read_b64_tr_b16 a[216:217], v13 offset:16384
v_mov_b32 v191, v207
v_mfma_f32_16x16x32_bf16 v[48:51], a[232:235], a[60:63], v[48:51]
ds_read_b64_tr_b16 a[218:219], v13 offset:16896
buffer_load_dwordx4 v10, s[40:43], s67 offen offset:1024 lds
v_mfma_f32_16x16x32_bf16 v[52:55], a[236:239], a[56:59], v[52:55]
ds_read_b64_tr_b16 a[220:221], v14 offset:16384
s_lshl_b32 s10, s7, 1
v_mfma_f32_16x16x32_bf16 v[56:59], a[236:239], a[60:63], v[56:59]
ds_read_b64_tr_b16 a[222:223], v14 offset:16896
s_waitcnt lgkmcnt(8)
v_mfma_f32_16x16x32_bf16 v[60:63], a[192:195], a[56:59], v[60:63]
ds_read_b64_tr_b16 a[224:225], v11 offset:17408
v_mul_f32 v100, v100, v132
v_mfma_f32_16x16x32_bf16 v[64:67], a[192:195], a[60:63], v[64:67]
ds_read_b64_tr_b16 a[226:227], v11 offset:17920
s_lshr_b32 s10, 18, s10
v_mfma_f32_16x16x32_bf16 v[68:71], a[196:199], a[56:59], v[68:71]
ds_read_b64_tr_b16 a[228:229], v12 offset:17408
v_mul_f32 v101, v101, v133
v_mfma_f32_16x16x32_bf16 v[72:75], a[196:199], a[60:63], v[72:75]
ds_read_b64_tr_b16 a[230:231], v12 offset:17920
s_and_b32 s10, s10, 3
v_mfma_f32_16x16x32_bf16 v[76:79], a[200:203], a[56:59], v[76:79]
ds_read_b64_tr_b16 a[232:233], v13 offset:17408
v_mul_f32 v102, v102, v134
v_mfma_f32_16x16x32_bf16 v[80:83], a[200:203], a[60:63], v[80:83]
ds_read_b64_tr_b16 a[234:235], v13 offset:17920
s_lshl_b32 s11, s10, 3
v_mfma_f32_16x16x32_bf16 v[84:87], a[204:207], a[56:59], v[84:87]
ds_read_b64_tr_b16 a[236:237], v14 offset:17408
v_mul_f32 v103, v103, v135
v_mfma_f32_16x16x32_bf16 v[88:91], a[204:207], a[60:63], v[88:91]
ds_read_b64_tr_b16 a[238:239], v14 offset:17920
s_waitcnt lgkmcnt(8)
v_mfma_f32_16x16x32_bf16 v[28:31], a[208:211], a[64:67], v[28:31]
s_waitcnt vmcnt(27)
s_barrier
ds_read_b64_tr_b16 a[192:193], v11 offset:18432
v_mfma_f32_16x16x32_bf16 v[32:35], a[208:211], a[68:71], v[32:35]
ds_read_b64_tr_b16 a[194:195], v11 offset:18944
s_add_u32 m0, s64, 10240
v_mfma_f32_16x16x32_bf16 v[36:39], a[212:215], a[64:67], v[36:39]
ds_read_b64_tr_b16 a[196:197], v12 offset:18432
s_add_u32 s67, s19, 1474560
buffer_load_dwordx4 v10, s[36:39], s67 offen lds
v_mfma_f32_16x16x32_bf16 v[40:43], a[212:215], a[68:71], v[40:43]
ds_read_b64_tr_b16 a[198:199], v12 offset:18944
s_lshr_b32 s11, s8, s11
v_mfma_f32_16x16x32_bf16 v[44:47], a[216:219], a[64:67], v[44:47]
ds_read_b64_tr_b16 a[200:201], v13 offset:18432
v_cvt_pk_bf16_f32 v206, v100, v101
v_mfma_f32_16x16x32_bf16 v[48:51], a[216:219], a[68:71], v[48:51]
ds_read_b64_tr_b16 a[202:203], v13 offset:18944
buffer_load_dwordx4 v10, s[40:43], s67 offen offset:1024 lds
v_mfma_f32_16x16x32_bf16 v[52:55], a[220:223], a[64:67], v[52:55]
ds_read_b64_tr_b16 a[204:205], v14 offset:18432
s_and_b32 s11, s11, 0xff
v_mfma_f32_16x16x32_bf16 v[56:59], a[220:223], a[68:71], v[56:59]
ds_read_b64_tr_b16 a[206:207], v14 offset:18944
s_waitcnt lgkmcnt(8)
v_mfma_f32_16x16x32_bf16 v[60:63], a[224:227], a[64:67], v[60:63]
ds_read_b64_tr_b16 a[208:209], v11 offset:19456
v_cvt_pk_bf16_f32 v207, v102, v103
v_mfma_f32_16x16x32_bf16 v[64:67], a[224:227], a[68:71], v[64:67]
ds_read_b64_tr_b16 a[210:211], v11 offset:19968
s_add_u32 s11, s11, s9
v_mfma_f32_16x16x32_bf16 v[68:71], a[228:231], a[64:67], v[68:71]
ds_read_b64_tr_b16 a[212:213], v12 offset:19456
v_max_f32 v104, 0, v104
v_mfma_f32_16x16x32_bf16 v[72:75], a[228:231], a[68:71], v[72:75]
ds_read_b64_tr_b16 a[214:215], v12 offset:19968
s_mov_b32 s72, 73728
v_mfma_f32_16x16x32_bf16 v[76:79], a[232:235], a[64:67], v[76:79]
ds_read_b64_tr_b16 a[216:217], v13 offset:19456
v_max_f32 v105, 0, v105
v_mfma_f32_16x16x32_bf16 v[80:83], a[232:235], a[68:71], v[80:83]
ds_read_b64_tr_b16 a[218:219], v13 offset:19968
s_mul_i32 s93, s11, 73728
v_mfma_f32_16x16x32_bf16 v[84:87], a[236:239], a[64:67], v[84:87]
ds_read_b64_tr_b16 a[220:221], v14 offset:19456
v_max_f32 v106, 0, v106
v_mfma_f32_16x16x32_bf16 v[88:91], a[236:239], a[68:71], v[88:91]
ds_read_b64_tr_b16 a[222:223], v14 offset:19968
s_waitcnt lgkmcnt(8)
v_mfma_f32_16x16x32_bf16 v[28:31], a[192:195], a[72:75], v[28:31]
ds_read_b64_tr_b16 a[224:225], v11 offset:20480
s_add_u32 m0, s64, 12288
v_mfma_f32_16x16x32_bf16 v[32:35], a[192:195], a[76:79], v[32:35]
ds_read_b64_tr_b16 a[226:227], v11 offset:20992
s_add_u32 s67, s19, 1769472
v_mfma_f32_16x16x32_bf16 v[36:39], a[196:199], a[72:75], v[36:39]
ds_read_b64_tr_b16 a[228:229], v12 offset:20480
buffer_load_dwordx4 v10, s[36:39], s67 offen lds
v_mfma_f32_16x16x32_bf16 v[40:43], a[196:199], a[76:79], v[40:43]
ds_read_b64_tr_b16 a[230:231], v12 offset:20992
s_mul_i32 s11, s7, 384
v_mfma_f32_16x16x32_bf16 v[44:47], a[200:203], a[72:75], v[44:47]
ds_read_b64_tr_b16 a[232:233], v13 offset:20480
v_max_f32 v107, 0, v107
v_mfma_f32_16x16x32_bf16 v[48:51], a[200:203], a[76:79], v[48:51]
ds_read_b64_tr_b16 a[234:235], v13 offset:20992
buffer_load_dwordx4 v10, s[40:43], s67 offen offset:1024 lds
v_mfma_f32_16x16x32_bf16 v[52:55], a[204:207], a[72:75], v[52:55]
ds_read_b64_tr_b16 a[236:237], v14 offset:20480
s_add_u32 s93, s93, s11
v_mfma_f32_16x16x32_bf16 v[56:59], a[204:207], a[76:79], v[56:59]
ds_read_b64_tr_b16 a[238:239], v14 offset:20992
s_waitcnt lgkmcnt(8)
v_mfma_f32_16x16x32_bf16 v[60:63], a[208:211], a[72:75], v[60:63]
ds_read_b64_tr_b16 a[192:193], v11 offset:21504
v_mov_b32 v178, v194
v_mfma_f32_16x16x32_bf16 v[64:67], a[208:211], a[76:79], v[64:67]
ds_read_b64_tr_b16 a[194:195], v11 offset:22016
s_sub_u32 s10, s10, s7
v_mfma_f32_16x16x32_bf16 v[68:71], a[212:215], a[72:75], v[68:71]
ds_read_b64_tr_b16 a[196:197], v12 offset:21504
v_mov_b32 v194, v210
v_mfma_f32_16x16x32_bf16 v[72:75], a[212:215], a[76:79], v[72:75]
ds_read_b64_tr_b16 a[198:199], v12 offset:22016
s_mul_i32 s10, s10, s13
v_mfma_f32_16x16x32_bf16 v[76:79], a[216:219], a[72:75], v[76:79]
ds_read_b64_tr_b16 a[200:201], v13 offset:21504
v_mov_b32 v179, v195
v_mfma_f32_16x16x32_bf16 v[80:83], a[216:219], a[76:79], v[80:83]
ds_read_b64_tr_b16 a[202:203], v13 offset:22016
s_add_u32 s10, s10, s62
v_mfma_f32_16x16x32_bf16 v[84:87], a[220:223], a[72:75], v[84:87]
ds_read_b64_tr_b16 a[204:205], v14 offset:21504
v_mov_b32 v195, v211
v_mfma_f32_16x16x32_bf16 v[88:91], a[220:223], a[76:79], v[88:91]
ds_read_b64_tr_b16 a[206:207], v14 offset:22016
s_waitcnt lgkmcnt(8)
v_mfma_f32_16x16x32_bf16 v[28:31], a[224:227], a[80:83], v[28:31]
ds_read_b64_tr_b16 a[208:209], v11 offset:22528
s_add_u32 m0, s64, 14336
v_mfma_f32_16x16x32_bf16 v[32:35], a[224:227], a[84:87], v[32:35]
ds_read_b64_tr_b16 a[210:211], v11 offset:23040
s_add_u32 s67, s19, 2064384
v_mfma_f32_16x16x32_bf16 v[36:39], a[228:231], a[80:83], v[36:39]
ds_read_b64_tr_b16 a[212:213], v12 offset:22528
buffer_load_dwordx4 v10, s[36:39], s67 offen lds
v_mfma_f32_16x16x32_bf16 v[40:43], a[228:231], a[84:87], v[40:43]
ds_read_b64_tr_b16 a[214:215], v12 offset:23040
s_lshl_b32 s11, s10, 7
v_mfma_f32_16x16x32_bf16 v[44:47], a[232:235], a[80:83], v[44:47]
ds_read_b64_tr_b16 a[216:217], v13 offset:22528
v_mul_f32 v104, v104, v136
v_mfma_f32_16x16x32_bf16 v[48:51], a[232:235], a[84:87], v[48:51]
ds_read_b64_tr_b16 a[218:219], v13 offset:23040
buffer_load_dwordx4 v10, s[40:43], s67 offen offset:1024 lds
v_mfma_f32_16x16x32_bf16 v[52:55], a[236:239], a[80:83], v[52:55]
ds_read_b64_tr_b16 a[220:221], v14 offset:22528
v_mov_b32 v2, s11
v_mfma_f32_16x16x32_bf16 v[56:59], a[236:239], a[84:87], v[56:59]
ds_read_b64_tr_b16 a[222:223], v14 offset:23040
s_waitcnt lgkmcnt(8)
v_mfma_f32_16x16x32_bf16 v[60:63], a[192:195], a[80:83], v[60:63]
ds_read_b64_tr_b16 a[224:225], v11 offset:23552
v_mul_f32 v105, v105, v137
v_mfma_f32_16x16x32_bf16 v[64:67], a[192:195], a[84:87], v[64:67]
ds_read_b64_tr_b16 a[226:227], v11 offset:24064
v_cmp_eq_u32 vcc, 1, v1
v_mfma_f32_16x16x32_bf16 v[68:71], a[196:199], a[80:83], v[68:71]
ds_read_b64_tr_b16 a[228:229], v12 offset:23552
v_mul_f32 v106, v106, v138
v_mfma_f32_16x16x32_bf16 v[72:75], a[196:199], a[84:87], v[72:75]
ds_read_b64_tr_b16 a[230:231], v12 offset:24064
s_lshl_b32 s11, s61, 4
v_mfma_f32_16x16x32_bf16 v[76:79], a[200:203], a[80:83], v[76:79]
ds_read_b64_tr_b16 a[232:233], v13 offset:23552
v_mul_f32 v107, v107, v139
v_mfma_f32_16x16x32_bf16 v[80:83], a[200:203], a[84:87], v[80:83]
ds_read_b64_tr_b16 a[234:235], v13 offset:24064
s_add_u32 s10, s10, s11
v_mfma_f32_16x16x32_bf16 v[84:87], a[204:207], a[80:83], v[84:87]
ds_read_b64_tr_b16 a[236:237], v14 offset:23552
v_cvt_pk_bf16_f32 v210, v104, v105
v_mfma_f32_16x16x32_bf16 v[88:91], a[204:207], a[84:87], v[88:91]
ds_read_b64_tr_b16 a[238:239], v14 offset:24064
s_waitcnt lgkmcnt(8)
v_mfma_f32_16x16x32_bf16 v[28:31], a[208:211], a[88:91], v[28:31]
s_waitcnt vmcnt(25)
s_barrier
ds_read_b64_tr_b16 a[192:193], v11 offset:24576
v_mfma_f32_16x16x32_bf16 v[32:35], a[208:211], a[92:95], v[32:35]
ds_read_b64_tr_b16 a[194:195], v11 offset:25088
buffer_store_dword v6, v21, s[32:35], s15 offen sc1
v_mfma_f32_16x16x32_bf16 v[36:39], a[212:215], a[88:91], v[36:39]
ds_read_b64_tr_b16 a[196:197], v12 offset:24576
v_add_u32 v6, 1, v6
s_add_u32 m0, s64, 16384
v_mfma_f32_16x16x32_bf16 v[40:43], a[212:215], a[92:95], v[40:43]
ds_read_b64_tr_b16 a[198:199], v12 offset:25088
s_add_u32 s67, s19, 2359296
buffer_load_dwordx4 v10, s[36:39], s67 offen lds
v_mfma_f32_16x16x32_bf16 v[44:47], a[216:219], a[88:91], v[44:47]
ds_read_b64_tr_b16 a[200:201], v13 offset:24576
v_cndmask_b32 v7, v7, v2, vcc
v_cvt_pk_bf16_f32 v211, v106, v107
v_mfma_f32_16x16x32_bf16 v[48:51], a[216:219], a[92:95], v[48:51]
ds_read_b64_tr_b16 a[202:203], v13 offset:25088
s_mul_i32 s95, s10, 81920
v_max_f32 v108, 0, v108
v_mfma_f32_16x16x32_bf16 v[52:55], a[220:223], a[88:91], v[52:55]
ds_read_b64_tr_b16 a[204:205], v14 offset:24576
buffer_load_dwordx4 v10, s[40:43], s67 offen offset:1024 lds
s_add_u32 s95, s95, s16
v_mfma_f32_16x16x32_bf16 v[56:59], a[220:223], a[92:95], v[56:59]
ds_read_b64_tr_b16 a[206:207], v14 offset:25088
s_waitcnt lgkmcnt(8)
v_mfma_f32_16x16x32_bf16 v[60:63], a[224:227], a[88:91], v[60:63]
ds_read_b64_tr_b16 a[208:209], v11 offset:25600
buffer_store_dwordx4 v[204:207], v20, s[32:35], s21 offen offset:0 sc1
v_mfma_f32_16x16x32_bf16 v[64:67], a[224:227], a[92:95], v[64:67]
ds_read_b64_tr_b16 a[210:211], v11 offset:26112
buffer_store_dwordx4 v[208:211], v20, s[32:35], s21 offen offset:1024 sc1
v_mfma_f32_16x16x32_bf16 v[68:71], a[228:231], a[88:91], v[68:71]
ds_read_b64_tr_b16 a[212:213], v12 offset:25600
v_max_f32 v109, 0, v109
v_mfma_f32_16x16x32_bf16 v[72:75], a[228:231], a[92:95], v[72:75]
ds_read_b64_tr_b16 a[214:215], v12 offset:26112
v_max_f32 v110, 0, v110
v_mfma_f32_16x16x32_bf16 v[76:79], a[232:235], a[88:91], v[76:79]
ds_read_b64_tr_b16 a[216:217], v13 offset:25600
v_max_f32 v111, 0, v111
v_mfma_f32_16x16x32_bf16 v[80:83], a[232:235], a[92:95], v[80:83]
ds_read_b64_tr_b16 a[218:219], v13 offset:26112
v_mov_b32 v180, v196
v_mfma_f32_16x16x32_bf16 v[84:87], a[236:239], a[88:91], v[84:87]
ds_read_b64_tr_b16 a[220:221], v14 offset:25600
v_mov_b32 v196, v212
v_mfma_f32_16x16x32_bf16 v[88:91], a[236:239], a[92:95], v[88:91]
ds_read_b64_tr_b16 a[222:223], v14 offset:26112
s_waitcnt lgkmcnt(8)
v_mfma_f32_16x16x32_bf16 v[28:31], a[192:195], a[96:99], v[28:31]
ds_read_b64_tr_b16 a[224:225], v11 offset:26624
s_add_u32 m0, s64, 18432
v_mfma_f32_16x16x32_bf16 v[32:35], a[192:195], a[100:103], v[32:35]
ds_read_b64_tr_b16 a[226:227], v11 offset:27136
s_add_u32 s67, s19, 2654208
v_mfma_f32_16x16x32_bf16 v[36:39], a[196:199], a[96:99], v[36:39]
ds_read_b64_tr_b16 a[228:229], v12 offset:26624
buffer_load_dwordx4 v10, s[36:39], s67 offen lds
v_mfma_f32_16x16x32_bf16 v[40:43], a[196:199], a[100:103], v[40:43]
ds_read_b64_tr_b16 a[230:231], v12 offset:27136
v_mov_b32 v181, v197
v_mfma_f32_16x16x32_bf16 v[44:47], a[200:203], a[96:99], v[44:47]
ds_read_b64_tr_b16 a[232:233], v13 offset:26624
v_mov_b32 v197, v213
v_mfma_f32_16x16x32_bf16 v[48:51], a[200:203], a[100:103], v[48:51]
ds_read_b64_tr_b16 a[234:235], v13 offset:27136
buffer_load_dwordx4 v10, s[40:43], s67 offen offset:1024 lds
v_mfma_f32_16x16x32_bf16 v[52:55], a[204:207], a[96:99], v[52:55]
ds_read_b64_tr_b16 a[236:237], v14 offset:26624
v_mul_f32 v108, v108, v140
v_mfma_f32_16x16x32_bf16 v[56:59], a[204:207], a[100:103], v[56:59]
ds_read_b64_tr_b16 a[238:239], v14 offset:27136
s_waitcnt lgkmcnt(8)
v_mfma_f32_16x16x32_bf16 v[60:63], a[208:211], a[96:99], v[60:63]
ds_read_b64_tr_b16 a[192:193], v11 offset:27648
v_mul_f32 v109, v109, v141
v_mfma_f32_16x16x32_bf16 v[64:67], a[208:211], a[100:103], v[64:67]
ds_read_b64_tr_b16 a[194:195], v11 offset:28160
v_mul_f32 v110, v110, v142
v_mfma_f32_16x16x32_bf16 v[68:71], a[212:215], a[96:99], v[68:71]
ds_read_b64_tr_b16 a[196:197], v12 offset:27648
v_mul_f32 v111, v111, v143
v_mfma_f32_16x16x32_bf16 v[72:75], a[212:215], a[100:103], v[72:75]
ds_read_b64_tr_b16 a[198:199], v12 offset:28160
v_cvt_pk_bf16_f32 v212, v108, v109
v_mfma_f32_16x16x32_bf16 v[76:79], a[216:219], a[96:99], v[76:79]
ds_read_b64_tr_b16 a[200:201], v13 offset:27648
v_cvt_pk_bf16_f32 v213, v110, v111
v_mfma_f32_16x16x32_bf16 v[80:83], a[216:219], a[100:103], v[80:83]
ds_read_b64_tr_b16 a[202:203], v13 offset:28160
v_max_f32 v112, 0, v112
v_mfma_f32_16x16x32_bf16 v[84:87], a[220:223], a[96:99], v[84:87]
ds_read_b64_tr_b16 a[204:205], v14 offset:27648
v_max_f32 v113, 0, v113
v_mfma_f32_16x16x32_bf16 v[88:91], a[220:223], a[100:103], v[88:91]
ds_read_b64_tr_b16 a[206:207], v14 offset:28160
s_waitcnt lgkmcnt(8)
v_mfma_f32_16x16x32_bf16 v[28:31], a[224:227], a[104:107], v[28:31]
ds_read_b64_tr_b16 a[208:209], v11 offset:28672
s_add_u32 m0, s64, 20480
v_mfma_f32_16x16x32_bf16 v[32:35], a[224:227], a[108:111], v[32:35]
ds_read_b64_tr_b16 a[210:211], v11 offset:29184
s_add_u32 s67, s19, 2949120
v_mfma_f32_16x16x32_bf16 v[36:39], a[228:231], a[104:107], v[36:39]
ds_read_b64_tr_b16 a[212:213], v12 offset:28672
buffer_load_dwordx4 v10, s[36:39], s67 offen lds
v_mfma_f32_16x16x32_bf16 v[40:43], a[228:231], a[108:111], v[40:43]
ds_read_b64_tr_b16 a[214:215], v12 offset:29184
v_max_f32 v114, 0, v114
v_mfma_f32_16x16x32_bf16 v[44:47], a[232:235], a[104:107], v[44:47]
ds_read_b64_tr_b16 a[216:217], v13 offset:28672
v_max_f32 v115, 0, v115
v_mfma_f32_16x16x32_bf16 v[48:51], a[232:235], a[108:111], v[48:51]
ds_read_b64_tr_b16 a[218:219], v13 offset:29184
buffer_load_dwordx4 v10, s[40:43], s67 offen offset:1024 lds
v_mfma_f32_16x16x32_bf16 v[52:55], a[236:239], a[104:107], v[52:55]
ds_read_b64_tr_b16 a[220:221], v14 offset:28672
v_mov_b32 v184, v200
v_mfma_f32_16x16x32_bf16 v[56:59], a[236:239], a[108:111], v[56:59]
ds_read_b64_tr_b16 a[222:223], v14 offset:29184
s_waitcnt lgkmcnt(8)
v_mfma_f32_16x16x32_bf16 v[60:63], a[192:195], a[104:107], v[60:63]
ds_read_b64_tr_b16 a[224:225], v11 offset:29696
v_mov_b32 v200, v216
v_mfma_f32_16x16x32_bf16 v[64:67], a[192:195], a[108:111], v[64:67]
ds_read_b64_tr_b16 a[226:227], v11 offset:30208
v_mov_b32 v185, v201
v_mfma_f32_16x16x32_bf16 v[68:71], a[196:199], a[104:107], v[68:71]
ds_read_b64_tr_b16 a[228:229], v12 offset:29696
v_mov_b32 v201, v217
v_mfma_f32_16x16x32_bf16 v[72:75], a[196:199], a[108:111], v[72:75]
ds_read_b64_tr_b16 a[230:231], v12 offset:30208
v_mul_f32 v112, v112, v144
v_mfma_f32_16x16x32_bf16 v[76:79], a[200:203], a[104:107], v[76:79]
ds_read_b64_tr_b16 a[232:233], v13 offset:29696
v_mul_f32 v113, v113, v145
v_mfma_f32_16x16x32_bf16 v[80:83], a[200:203], a[108:111], v[80:83]
ds_read_b64_tr_b16 a[234:235], v13 offset:30208
v_mul_f32 v114, v114, v146
v_mfma_f32_16x16x32_bf16 v[84:87], a[204:207], a[104:107], v[84:87]
ds_read_b64_tr_b16 a[236:237], v14 offset:29696
v_mul_f32 v115, v115, v147
v_mfma_f32_16x16x32_bf16 v[88:91], a[204:207], a[108:111], v[88:91]
ds_read_b64_tr_b16 a[238:239], v14 offset:30208
s_waitcnt lgkmcnt(8)
v_mfma_f32_16x16x32_bf16 v[28:31], a[208:211], a[112:115], v[28:31]
s_waitcnt vmcnt(27)
s_barrier
ds_read_b64_tr_b16 a[192:193], v11 offset:30720
v_mfma_f32_16x16x32_bf16 v[32:35], a[208:211], a[116:119], v[32:35]
ds_read_b64_tr_b16 a[194:195], v11 offset:31232
s_add_u32 m0, s64, 22528
v_mfma_f32_16x16x32_bf16 v[36:39], a[212:215], a[112:115], v[36:39]
ds_read_b64_tr_b16 a[196:197], v12 offset:30720
s_add_u32 s67, s19, 3244032
buffer_load_dwordx4 v10, s[36:39], s67 offen lds
v_mfma_f32_16x16x32_bf16 v[40:43], a[212:215], a[116:119], v[40:43]
ds_read_b64_tr_b16 a[198:199], v12 offset:31232
v_cvt_pk_bf16_f32 v216, v112, v113
v_mfma_f32_16x16x32_bf16 v[44:47], a[216:219], a[112:115], v[44:47]
ds_read_b64_tr_b16 a[200:201], v13 offset:30720
v_cvt_pk_bf16_f32 v217, v114, v115
v_mfma_f32_16x16x32_bf16 v[48:51], a[216:219], a[116:119], v[48:51]
ds_read_b64_tr_b16 a[202:203], v13 offset:31232
buffer_load_dwordx4 v10, s[40:43], s67 offen offset:1024 lds
v_mfma_f32_16x16x32_bf16 v[52:55], a[220:223], a[112:115], v[52:55]
ds_read_b64_tr_b16 a[204:205], v14 offset:30720
v_max_f32 v116, 0, v116
v_mfma_f32_16x16x32_bf16 v[56:59], a[220:223], a[116:119], v[56:59]
ds_read_b64_tr_b16 a[206:207], v14 offset:31232
s_waitcnt lgkmcnt(8)
v_mfma_f32_16x16x32_bf16 v[60:63], a[224:227], a[112:115], v[60:63]
ds_read_b64_tr_b16 a[208:209], v11 offset:31744
v_max_f32 v117, 0, v117
v_mfma_f32_16x16x32_bf16 v[64:67], a[224:227], a[116:119], v[64:67]
ds_read_b64_tr_b16 a[210:211], v11 offset:32256
v_max_f32 v118, 0, v118
v_mfma_f32_16x16x32_bf16 v[68:71], a[228:231], a[112:115], v[68:71]
ds_read_b64_tr_b16 a[212:213], v12 offset:31744
v_max_f32 v119, 0, v119
v_mfma_f32_16x16x32_bf16 v[72:75], a[228:231], a[116:119], v[72:75]
ds_read_b64_tr_b16 a[214:215], v12 offset:32256
v_mov_b32 v182, v198
v_mfma_f32_16x16x32_bf16 v[76:79], a[232:235], a[112:115], v[76:79]
ds_read_b64_tr_b16 a[216:217], v13 offset:31744
v_mov_b32 v198, v214
v_mfma_f32_16x16x32_bf16 v[80:83], a[232:235], a[116:119], v[80:83]
ds_read_b64_tr_b16 a[218:219], v13 offset:32256
v_mov_b32 v183, v199
v_mfma_f32_16x16x32_bf16 v[84:87], a[236:239], a[112:115], v[84:87]
ds_read_b64_tr_b16 a[220:221], v14 offset:31744
v_mov_b32 v199, v215
v_mfma_f32_16x16x32_bf16 v[88:91], a[236:239], a[116:119], v[88:91]
ds_read_b64_tr_b16 a[222:223], v14 offset:32256
s_waitcnt lgkmcnt(8)
v_mfma_f32_16x16x32_bf16 v[28:31], a[192:195], a[120:123], v[28:31]
ds_read_b64_tr_b16 a[224:225], v11 offset:32768
s_add_u32 m0, s64, 24576
v_mfma_f32_16x16x32_bf16 v[32:35], a[192:195], a[124:127], v[32:35]
ds_read_b64_tr_b16 a[226:227], v11 offset:33280
s_add_u32 s67, s19, 3538944
v_mfma_f32_16x16x32_bf16 v[36:39], a[196:199], a[120:123], v[36:39]
ds_read_b64_tr_b16 a[228:229], v12 offset:32768
buffer_load_dwordx4 v10, s[36:39], s67 offen lds
v_mfma_f32_16x16x32_bf16 v[40:43], a[196:199], a[124:127], v[40:43]
ds_read_b64_tr_b16 a[230:231], v12 offset:33280
v_mul_f32 v116, v116, v148
v_mfma_f32_16x16x32_bf16 v[44:47], a[200:203], a[120:123], v[44:47]
ds_read_b64_tr_b16 a[232:233], v13 offset:32768
v_mul_f32 v117, v117, v149
v_mfma_f32_16x16x32_bf16 v[48:51], a[200:203], a[124:127], v[48:51]
ds_read_b64_tr_b16 a[234:235], v13 offset:33280
buffer_load_dwordx4 v10, s[40:43], s67 offen offset:1024 lds
v_mfma_f32_16x16x32_bf16 v[52:55], a[204:207], a[120:123], v[52:55]
ds_read_b64_tr_b16 a[236:237], v14 offset:32768
v_mul_f32 v118, v118, v150
v_mfma_f32_16x16x32_bf16 v[56:59], a[204:207], a[124:127], v[56:59]
ds_read_b64_tr_b16 a[238:239], v14 offset:33280
s_waitcnt lgkmcnt(8)
v_mfma_f32_16x16x32_bf16 v[60:63], a[208:211], a[120:123], v[60:63]
ds_read_b64_tr_b16 a[192:193], v11 offset:33792
v_mul_f32 v119, v119, v151
v_mfma_f32_16x16x32_bf16 v[64:67], a[208:211], a[124:127], v[64:67]
ds_read_b64_tr_b16 a[194:195], v11 offset:34304
v_cvt_pk_bf16_f32 v214, v116, v117
v_mfma_f32_16x16x32_bf16 v[68:71], a[212:215], a[120:123], v[68:71]
ds_read_b64_tr_b16 a[196:197], v12 offset:33792
v_cvt_pk_bf16_f32 v215, v118, v119
v_mfma_f32_16x16x32_bf16 v[72:75], a[212:215], a[124:127], v[72:75]
ds_read_b64_tr_b16 a[198:199], v12 offset:34304
v_max_f32 v120, 0, v120
v_mfma_f32_16x16x32_bf16 v[76:79], a[216:219], a[120:123], v[76:79]
ds_read_b64_tr_b16 a[200:201], v13 offset:33792
v_max_f32 v121, 0, v121
v_mfma_f32_16x16x32_bf16 v[80:83], a[216:219], a[124:127], v[80:83]
ds_read_b64_tr_b16 a[202:203], v13 offset:34304
v_max_f32 v122, 0, v122
v_mfma_f32_16x16x32_bf16 v[84:87], a[220:223], a[120:123], v[84:87]
ds_read_b64_tr_b16 a[204:205], v14 offset:33792
v_max_f32 v123, 0, v123
v_mfma_f32_16x16x32_bf16 v[88:91], a[220:223], a[124:127], v[88:91]
ds_read_b64_tr_b16 a[206:207], v14 offset:34304
s_waitcnt lgkmcnt(8)
v_mfma_f32_16x16x32_bf16 v[28:31], a[224:227], v[220:223], v[28:31]
ds_read_b64_tr_b16 a[208:209], v11 offset:34816
s_add_u32 m0, s64, 26624
v_mfma_f32_16x16x32_bf16 v[32:35], a[224:227], v[224:227], v[32:35]
ds_read_b64_tr_b16 a[210:211], v11 offset:35328
s_add_u32 s67, s19, 3833856
v_mfma_f32_16x16x32_bf16 v[36:39], a[228:231], v[220:223], v[36:39]
ds_read_b64_tr_b16 a[212:213], v12 offset:34816
buffer_load_dwordx4 v10, s[36:39], s67 offen lds
v_mfma_f32_16x16x32_bf16 v[40:43], a[228:231], v[224:227], v[40:43]
ds_read_b64_tr_b16 a[214:215], v12 offset:35328
v_mov_b32 v186, v202
v_mfma_f32_16x16x32_bf16 v[44:47], a[232:235], v[220:223], v[44:47]
ds_read_b64_tr_b16 a[216:217], v13 offset:34816
v_mov_b32 v202, v218
v_mfma_f32_16x16x32_bf16 v[48:51], a[232:235], v[224:227], v[48:51]
ds_read_b64_tr_b16 a[218:219], v13 offset:35328
buffer_load_dwordx4 v10, s[40:43], s67 offen offset:1024 lds
v_mfma_f32_16x16x32_bf16 v[52:55], a[236:239], v[220:223], v[52:55]
ds_read_b64_tr_b16 a[220:221], v14 offset:34816
v_mov_b32 v187, v203
v_mfma_f32_16x16x32_bf16 v[56:59], a[236:239], v[224:227], v[56:59]
ds_read_b64_tr_b16 a[222:223], v14 offset:35328
s_waitcnt lgkmcnt(8)
v_mfma_f32_16x16x32_bf16 v[60:63], a[192:195], v[220:223], v[60:63]
ds_read_b64_tr_b16 a[224:225], v11 offset:35840
v_mov_b32 v203, v219
v_mfma_f32_16x16x32_bf16 v[64:67], a[192:195], v[224:227], v[64:67]
ds_read_b64_tr_b16 a[226:227], v11 offset:36352
v_mul_f32 v120, v120, v152
v_mfma_f32_16x16x32_bf16 v[68:71], a[196:199], v[220:223], v[68:71]
ds_read_b64_tr_b16 a[228:229], v12 offset:35840
v_mul_f32 v121, v121, v153
v_mfma_f32_16x16x32_bf16 v[72:75], a[196:199], v[224:227], v[72:75]
ds_read_b64_tr_b16 a[230:231], v12 offset:36352
v_mul_f32 v122, v122, v154
v_mfma_f32_16x16x32_bf16 v[76:79], a[200:203], v[220:223], v[76:79]
ds_read_b64_tr_b16 a[232:233], v13 offset:35840
v_mul_f32 v123, v123, v155
v_mfma_f32_16x16x32_bf16 v[80:83], a[200:203], v[224:227], v[80:83]
ds_read_b64_tr_b16 a[234:235], v13 offset:36352
v_cvt_pk_bf16_f32 v218, v120, v121
v_mfma_f32_16x16x32_bf16 v[84:87], a[204:207], v[220:223], v[84:87]
ds_read_b64_tr_b16 a[236:237], v14 offset:35840
v_cvt_pk_bf16_f32 v219, v122, v123
v_mfma_f32_16x16x32_bf16 v[88:91], a[204:207], v[224:227], v[88:91]
ds_read_b64_tr_b16 a[238:239], v14 offset:36352
s_waitcnt lgkmcnt(8)
v_mfma_f32_16x16x32_bf16 v[92:95], a[208:211], v[228:231], v[28:31]
s_waitcnt vmcnt(27)
s_barrier
ds_read_b64_tr_b16 a[192:193], v11 offset:0
v_mfma_f32_16x16x32_bf16 v[96:99], a[208:211], v[232:235], v[32:35]
ds_read_b64_tr_b16 a[194:195], v11 offset:512
s_add_u32 m0, s64, 28672
v_mfma_f32_16x16x32_bf16 v[100:103], a[212:215], v[228:231], v[36:39]
ds_read_b64_tr_b16 a[196:197], v12 offset:0
s_add_u32 s67, s19, 4128768
v_mfma_f32_16x16x32_bf16 v[104:107], a[212:215], v[232:235], v[40:43]
ds_read_b64_tr_b16 a[198:199], v12 offset:512
buffer_load_dwordx4 v10, s[36:39], s67 offen lds
v_mfma_f32_16x16x32_bf16 v[108:111], a[216:219], v[228:231], v[44:47]
ds_read_b64_tr_b16 a[200:201], v13 offset:0
v_mfma_f32_16x16x32_bf16 v[112:115], a[216:219], v[232:235], v[48:51]
ds_read_b64_tr_b16 a[202:203], v13 offset:512
v_mfma_f32_16x16x32_bf16 v[116:119], a[220:223], v[228:231], v[52:55]
ds_read_b64_tr_b16 a[204:205], v14 offset:0
buffer_load_dwordx4 v10, s[40:43], s67 offen offset:1024 lds
v_mfma_f32_16x16x32_bf16 v[120:123], a[220:223], v[232:235], v[56:59]
ds_read_b64_tr_b16 a[206:207], v14 offset:512
s_waitcnt lgkmcnt(8)
v_mfma_f32_16x16x32_bf16 v[124:127], a[224:227], v[228:231], v[60:63]
ds_read_b64_tr_b16 a[208:209], v11 offset:1024
buffer_store_dwordx4 v[212:215], v20, s[32:35], s21 offen offset:2048 sc1
v_mfma_f32_16x16x32_bf16 v[128:131], a[224:227], v[232:235], v[64:67]
ds_read_b64_tr_b16 a[210:211], v11 offset:1536
buffer_store_dwordx4 v[216:219], v20, s[32:35], s21 offen offset:3072 sc1
v_mfma_f32_16x16x32_bf16 v[132:135], a[228:231], v[228:231], v[68:71]
ds_read_b64_tr_b16 a[212:213], v12 offset:1024
s_add_u32 s21, s21, 16384
v_mfma_f32_16x16x32_bf16 v[136:139], a[228:231], v[232:235], v[72:75]
ds_read_b64_tr_b16 a[214:215], v12 offset:1536
buffer_load_dwordx4 a[252:255], v255, s[56:59], s3 offen
v_mfma_f32_16x16x32_bf16 v[140:143], a[232:235], v[228:231], v[76:79]
ds_read_b64_tr_b16 a[216:217], v13 offset:1024
v_mfma_f32_16x16x32_bf16 v[144:147], a[232:235], v[232:235], v[80:83]
ds_read_b64_tr_b16 a[218:219], v13 offset:1536
v_mfma_f32_16x16x32_bf16 v[148:151], a[236:239], v[228:231], v[84:87]
ds_read_b64_tr_b16 a[220:221], v14 offset:1024
v_mfma_f32_16x16x32_bf16 v[152:155], a[236:239], v[232:235], v[88:91]
ds_read_b64_tr_b16 a[222:223], v14 offset:1536
s_mov_b32 s65, s19
s_add_u32 s19, s65, s18
s_add_u32 s12, s12, 1
s_cmp_lt_u32 s12, s23
s_cbranch_scc1 L_loopA
s_cmp_eq_u32 s23, 3
s_cbranch_scc1 L_ffn4_tail
s_waitcnt lgkmcnt(8)
v_mfma_f32_16x16x32_bf16 v[28:31], a[192:195], a[0:3], 0
ds_read_b64_tr_b16 a[224:225], v11 offset:2048
s_add_u32 m0, s64, 30720
v_mfma_f32_16x16x32_bf16 v[32:35], a[192:195], a[4:7], 0
ds_read_b64_tr_b16 a[226:227], v11 offset:2560
s_add_u32 s67, s65, 4423680
v_mfma_f32_16x16x32_bf16 v[36:39], a[196:199], a[0:3], 0
ds_read_b64_tr_b16 a[228:229], v12 offset:2048
buffer_load_dwordx4 v10, s[36:39], s67 offen lds
v_mfma_f32_16x16x32_bf16 v[40:43], a[196:199], a[4:7], 0
ds_read_b64_tr_b16 a[230:231], v12 offset:2560
s_add_u32 s22, s15, 0
v_mfma_f32_16x16x32_bf16 v[44:47], a[200:203], a[0:3], 0
ds_read_b64_tr_b16 a[232:233], v13 offset:2048
buffer_load_dword v23, v7, s[32:35], s22 offen sc1
v_mfma_f32_16x16x32_bf16 v[48:51], a[200:203], a[4:7], 0
ds_read_b64_tr_b16 a[234:235], v13 offset:2560
buffer_load_dwordx4 v10, s[40:43], s67 offen offset:1024 lds
v_mfma_f32_16x16x32_bf16 v[52:55], a[204:207], a[0:3], 0
ds_read_b64_tr_b16 a[236:237], v14 offset:2048
v_max_f32 v92, 0, v92
v_mfma_f32_16x16x32_bf16 v[56:59], a[204:207], a[4:7], 0
ds_read_b64_tr_b16 a[238:239], v14 offset:2560
s_waitcnt lgkmcnt(8)
v_mfma_f32_16x16x32_bf16 v[60:63], a[208:211], a[0:3], 0
ds_read_b64_tr_b16 a[192:193], v11 offset:3072
v_max_f32 v93, 0, v93
v_mfma_f32_16x16x32_bf16 v[64:67], a[208:211], a[4:7], 0
ds_read_b64_tr_b16 a[194:195], v11 offset:3584
v_max_f32 v94, 0, v94
v_mfma_f32_16x16x32_bf16 v[68:71], a[212:215], a[0:3], 0
ds_read_b64_tr_b16 a[196:197], v12 offset:3072
v_max_f32 v95, 0, v95
v_mfma_f32_16x16x32_bf16 v[72:75], a[212:215], a[4:7], 0
ds_read_b64_tr_b16 a[198:199], v12 offset:3584
s_lshr_b32 s19, s6, 1
v_mfma_f32_16x16x32_bf16 v[76:79], a[216:219], a[0:3], 0
ds_read_b64_tr_b16 a[200:201], v13 offset:3072
s_lshl_b32 s98, s19, 1
v_mfma_f32_16x16x32_bf16 v[80:83], a[216:219], a[4:7], 0
ds_read_b64_tr_b16 a[202:203], v13 offset:3584
s_lshr_b32 s17, 0x09, s98
v_mfma_f32_16x16x32_bf16 v[84:87], a[220:223], a[0:3], 0
ds_read_b64_tr_b16 a[204:205], v14 offset:3072
s_and_b32 s17, s17, 3
v_mfma_f32_16x16x32_bf16 v[88:91], a[220:223], a[4:7], 0
ds_read_b64_tr_b16 a[206:207], v14 offset:3584
s_waitcnt lgkmcnt(8)
v_mfma_f32_16x16x32_bf16 v[28:31], a[224:227], a[8:11], v[28:31]
ds_read_b64_tr_b16 a[208:209], v11 offset:4096
s_add_u32 m0, s64, 32768
v_mfma_f32_16x16x32_bf16 v[32:35], a[224:227], a[12:15], v[32:35]
ds_read_b64_tr_b16 a[210:211], v11 offset:4608
s_add_u32 s67, s65, 4718592
v_mfma_f32_16x16x32_bf16 v[36:39], a[228:231], a[8:11], v[36:39]
ds_read_b64_tr_b16 a[212:213], v12 offset:4096
buffer_load_dwordx4 v10, s[36:39], s67 offen lds
v_mfma_f32_16x16x32_bf16 v[40:43], a[228:231], a[12:15], v[40:43]
ds_read_b64_tr_b16 a[214:215], v12 offset:4608
v_mul_f32 v92, v92, v124
v_mfma_f32_16x16x32_bf16 v[44:47], a[232:235], a[8:11], v[44:47]
ds_read_b64_tr_b16 a[216:217], v13 offset:4096
v_mul_f32 v93, v93, v125
v_mfma_f32_16x16x32_bf16 v[48:51], a[232:235], a[12:15], v[48:51]
ds_read_b64_tr_b16 a[218:219], v13 offset:4608
buffer_load_dwordx4 v10, s[40:43], s67 offen offset:1024 lds
v_mfma_f32_16x16x32_bf16 v[52:55], a[236:239], a[8:11], v[52:55]
ds_read_b64_tr_b16 a[220:221], v14 offset:4096
v_mul_f32 v94, v94, v126
v_mfma_f32_16x16x32_bf16 v[56:59], a[236:239], a[12:15], v[56:59]
ds_read_b64_tr_b16 a[222:223], v14 offset:4608
s_waitcnt lgkmcnt(8)
v_mfma_f32_16x16x32_bf16 v[60:63], a[192:195], a[8:11], v[60:63]
ds_read_b64_tr_b16 a[224:225], v11 offset:5120
v_mul_f32 v95, v95, v127
v_mfma_f32_16x16x32_bf16 v[64:67], a[192:195], a[12:15], v[64:67]
ds_read_b64_tr_b16 a[226:227], v11 offset:5632
v_cvt_pk_bf16_f32 v156, v92, v93
v_mfma_f32_16x16x32_bf16 v[68:71], a[196:199], a[8:11], v[68:71]
ds_read_b64_tr_b16 a[228:229], v12 offset:5120
s_lshr_b32 s18, 0x12, s98
v_mfma_f32_16x16x32_bf16 v[72:75], a[196:199], a[12:15], v[72:75]
ds_read_b64_tr_b16 a[230:231], v12 offset:5632
s_and_b32 s18, s18, 3
v_mfma_f32_16x16x32_bf16 v[76:79], a[200:203], a[8:11], v[76:79]
ds_read_b64_tr_b16 a[232:233], v13 offset:5120
s_lshl_b32 s8, s17, 7
v_mfma_f32_16x16x32_bf16 v[80:83], a[200:203], a[12:15], v[80:83]
ds_read_b64_tr_b16 a[234:235], v13 offset:5632
s_add_u32 s11, s92, s8
v_mfma_f32_16x16x32_bf16 v[84:87], a[204:207], a[8:11], v[84:87]
ds_read_b64_tr_b16 a[236:237], v14 offset:5120
s_add_u32 s96, s93, s8
v_mfma_f32_16x16x32_bf16 v[88:91], a[204:207], a[12:15], v[88:91]
ds_read_b64_tr_b16 a[238:239], v14 offset:5632
s_waitcnt lgkmcnt(8)
v_mfma_f32_16x16x32_bf16 v[28:31], a[208:211], a[16:19], v[28:31]
s_waitcnt vmcnt(29)
s_barrier
ds_read_b64_tr_b16 a[192:193], v11 offset:6144
v_mfma_f32_16x16x32_bf16 v[32:35], a[208:211], a[20:23], v[32:35]
ds_read_b64_tr_b16 a[194:195], v11 offset:6656
s_add_u32 m0, s64, 34816
v_mfma_f32_16x16x32_bf16 v[36:39], a[212:215], a[16:19], v[36:39]
ds_read_b64_tr_b16 a[196:197], v12 offset:6144
s_add_u32 s67, s65, 5013504
buffer_load_dwordx4 v10, s[36:39], s67 offen lds
v_mfma_f32_16x16x32_bf16 v[40:43], a[212:215], a[20:23], v[40:43]
ds_read_b64_tr_b16 a[198:199], v12 offset:6656
v_cvt_pk_bf16_f32 v157, v94, v95
v_mfma_f32_16x16x32_bf16 v[44:47], a[216:219], a[16:19], v[44:47]
ds_read_b64_tr_b16 a[200:201], v13 offset:6144
v_max_f32 v96, 0, v96
v_mfma_f32_16x16x32_bf16 v[48:51], a[216:219], a[20:23], v[48:51]
ds_read_b64_tr_b16 a[202:203], v13 offset:6656
buffer_load_dwordx4 v10, s[40:43], s67 offen offset:1024 lds
v_mfma_f32_16x16x32_bf16 v[52:55], a[220:223], a[16:19], v[52:55]
ds_read_b64_tr_b16 a[204:205], v14 offset:6144
v_max_f32 v97, 0, v97
v_mfma_f32_16x16x32_bf16 v[56:59], a[220:223], a[20:23], v[56:59]
ds_read_b64_tr_b16 a[206:207], v14 offset:6656
s_waitcnt lgkmcnt(8)
v_mfma_f32_16x16x32_bf16 v[60:63], a[224:227], a[16:19], v[60:63]
ds_read_b64_tr_b16 a[208:209], v11 offset:7168
v_max_f32 v98, 0, v98
v_mfma_f32_16x16x32_bf16 v[64:67], a[224:227], a[20:23], v[64:67]
ds_read_b64_tr_b16 a[210:211], v11 offset:7680
v_max_f32 v99, 0, v99
v_mfma_f32_16x16x32_bf16 v[68:71], a[228:231], a[16:19], v[68:71]
ds_read_b64_tr_b16 a[212:213], v12 offset:7168
s_add_u32 s8, s66, s8
v_mfma_f32_16x16x32_bf16 v[72:75], a[228:231], a[20:23], v[72:75]
ds_read_b64_tr_b16 a[214:215], v12 offset:7680
s_mul_i32 s17, s17, 81920
v_mfma_f32_16x16x32_bf16 v[76:79], a[232:235], a[16:19], v[76:79]
ds_read_b64_tr_b16 a[216:217], v13 offset:7168
s_add_u32 s17, s17, s14
v_mfma_f32_16x16x32_bf16 v[80:83], a[232:235], a[20:23], v[80:83]
ds_read_b64_tr_b16 a[218:219], v13 offset:7680
s_lshl_b32 s9, s18, 7
v_mfma_f32_16x16x32_bf16 v[84:87], a[236:239], a[16:19], v[84:87]
ds_read_b64_tr_b16 a[220:221], v14 offset:7168
s_add_u32 s13, s92, s9
v_mfma_f32_16x16x32_bf16 v[88:91], a[236:239], a[20:23], v[88:91]
ds_read_b64_tr_b16 a[222:223], v14 offset:7680
s_waitcnt vmcnt(5)
v_cmp_ne_u32 vcc, s68, v23
s_nop 1
s_and_b32 vcc_lo, vcc_lo, 3
s_cbranch_scc0 L_ok_1
s_mov_b32 s74, 200000
s_add_u32 s73, s15, 0
L_sp_2:
buffer_load_dword v4, v7, s[32:35], s73 offen sc1
s_sub_u32 s74, s74, 1
s_waitcnt vmcnt(0)
v_cmp_ne_u32 vcc, s68, v4
s_cmp_eq_u32 s74, 0
s_cbranch_scc1 L_spd_3
s_and_b32 vcc_lo, vcc_lo, 3
s_cbranch_scc1 L_sp_2
L_spd_3:
L_ok_1:
s_waitcnt lgkmcnt(8)
v_mfma_f32_16x16x32_bf16 v[28:31], a[192:195], a[24:27], v[28:31]
ds_read_b64_tr_b16 a[224:225], v11 offset:8192
s_add_u32 m0, s64, 0
v_mfma_f32_16x16x32_bf16 v[32:35], a[192:195], a[28:31], v[32:35]
ds_read_b64_tr_b16 a[226:227], v11 offset:8704
s_add_u32 s67, s8, 0
v_mfma_f32_16x16x32_bf16 v[36:39], a[196:199], a[24:27], v[36:39]
ds_read_b64_tr_b16 a[228:229], v12 offset:8192
buffer_load_dwordx4 v15, s[44:47], s67 offen lds
v_mfma_f32_16x16x32_bf16 v[40:43], a[196:199], a[28:31], v[40:43]
ds_read_b64_tr_b16 a[230:231], v12 offset:8704
v_mul_f32 v96, v96, v128
v_mfma_f32_16x16x32_bf16 v[44:47], a[200:203], a[24:27], v[44:47]
ds_read_b64_tr_b16 a[232:233], v13 offset:8192
v_mul_f32 v97, v97, v129
v_mfma_f32_16x16x32_bf16 v[48:51], a[200:203], a[28:31], v[48:51]
ds_read_b64_tr_b16 a[234:235], v13 offset:8704
buffer_load_dwordx4 v15, s[48:51], s67 offen offset:1024 lds
v_mfma_f32_16x16x32_bf16 v[52:55], a[204:207], a[24:27], v[52:55]
ds_read_b64_tr_b16 a[236:237], v14 offset:8192
v_mul_f32 v98, v98, v130
v_mfma_f32_16x16x32_bf16 v[56:59], a[204:207], a[28:31], v[56:59]
ds_read_b64_tr_b16 a[238:239], v14 offset:8704
s_waitcnt lgkmcnt(8)
v_mfma_f32_16x16x32_bf16 v[60:63], a[208:211], a[24:27], v[60:63]
ds_read_b64_tr_b16 a[192:193], v11 offset:9216
v_mul_f32 v99, v99, v131
v_mfma_f32_16x16x32_bf16 v[64:67], a[208:211], a[28:31], v[64:67]
ds_read_b64_tr_b16 a[194:195], v11 offset:9728
s_add_u32 s97, s93, s9
v_mfma_f32_16x16x32_bf16 v[68:71], a[212:215], a[24:27], v[68:71]
ds_read_b64_tr_b16 a[196:197], v12 offset:9216
s_add_u32 s9, s66, s9
v_mfma_f32_16x16x32_bf16 v[72:75], a[212:215], a[28:31], v[72:75]
ds_read_b64_tr_b16 a[198:199], v12 offset:9728
s_mul_i32 s18, s18, 81920
v_mfma_f32_16x16x32_bf16 v[76:79], a[216:219], a[24:27], v[76:79]
ds_read_b64_tr_b16 a[200:201], v13 offset:9216
s_add_u32 s18, s18, s14
v_mfma_f32_16x16x32_bf16 v[80:83], a[216:219], a[28:31], v[80:83]
ds_read_b64_tr_b16 a[202:203], v13 offset:9728
s_lshl_b32 s10, s19, 7
v_mfma_f32_16x16x32_bf16 v[84:87], a[220:223], a[24:27], v[84:87]
ds_read_b64_tr_b16 a[204:205], v14 offset:9216
s_add_u32 s80, s94, 0
v_mfma_f32_16x16x32_bf16 v[88:91], a[220:223], a[28:31], v[88:91]
ds_read_b64_tr_b16 a[206:207], v14 offset:9728
s_waitcnt lgkmcnt(8)
v_mfma_f32_16x16x32_bf16 v[28:31], a[224:227], a[32:35], v[28:31]
ds_read_b64_tr_b16 a[208:209], v11 offset:10240
s_add_u32 m0, s64, 2048
v_mfma_f32_16x16x32_bf16 v[32:35], a[224:227], a[36:39], v[32:35]
ds_read_b64_tr_b16 a[210:211], v11 offset:10752
s_add_u32 s67, s8, 73728
v_mfma_f32_16x16x32_bf16 v[36:39], a[228:231], a[32:35], v[36:39]
ds_read_b64_tr_b16 a[212:213], v12 offset:10240
buffer_load_dwordx4 v15, s[44:47], s67 offen lds
v_cvt_pk_bf16_f32 v160, v96, v97
v_mfma_f32_16x16x32_bf16 v[40:43], a[228:231], a[36:39], v[40:43]
ds_read_b64_tr_b16 a[214:215], v12 offset:10752
v_cvt_pk_bf16_f32 v161, v98, v99
v_max_f32 v100, 0, v100
v_mfma_f32_16x16x32_bf16 v[44:47], a[232:235], a[32:35], v[44:47]
ds_read_b64_tr_b16 a[216:217], v13 offset:10240
v_max_f32 v101, 0, v101
v_mfma_f32_16x16x32_bf16 v[48:51], a[232:235], a[36:39], v[48:51]
ds_read_b64_tr_b16 a[218:219], v13 offset:10752
buffer_load_dwordx4 v15, s[48:51], s67 offen offset:1024 lds
v_mfma_f32_16x16x32_bf16 v[52:55], a[236:239], a[32:35], v[52:55]
ds_read_b64_tr_b16 a[220:221], v14 offset:10240
v_max_f32 v102, 0, v102
v_mfma_f32_16x16x32_bf16 v[56:59], a[236:239], a[36:39], v[56:59]
ds_read_b64_tr_b16 a[222:223], v14 offset:10752
s_waitcnt lgkmcnt(8)
v_mfma_f32_16x16x32_bf16 v[60:63], a[192:195], a[32:35], v[60:63]
ds_read_b64_tr_b16 a[224:225], v11 offset:11264
s_add_u32 s16, s92, s10
v_mfma_f32_16x16x32_bf16 v[64:67], a[192:195], a[36:39], v[64:67]
ds_read_b64_tr_b16 a[226:227], v11 offset:11776
s_add_u32 s98, s93, s10
v_mfma_f32_16x16x32_bf16 v[68:71], a[196:199], a[32:35], v[68:71]
ds_read_b64_tr_b16 a[228:229], v12 offset:11264
s_add_u32 s10, s66, s10
v_mfma_f32_16x16x32_bf16 v[72:75], a[196:199], a[36:39], v[72:75]
ds_read_b64_tr_b16 a[230:231], v12 offset:11776
s_mul_i32 s19, s19, 81920
v_mfma_f32_16x16x32_bf16 v[76:79], a[200:203], a[32:35], v[76:79]
ds_read_b64_tr_b16 a[232:233], v13 offset:11264
s_add_u32 s19, s19, s14
v_mfma_f32_16x16x32_bf16 v[80:83], a[200:203], a[36:39], v[80:83]
ds_read_b64_tr_b16 a[234:235], v13 offset:11776
buffer_load_dwordx4 a[128:131], v20, s[32:35], s80 offen offset:0 sc1
v_mfma_f32_16x16x32_bf16 v[84:87], a[204:207], a[32:35], v[84:87]
ds_read_b64_tr_b16 a[236:237], v14 offset:11264
buffer_load_dwordx4 a[132:135], v20, s[32:35], s80 offen offset:1024 sc1
v_mfma_f32_16x16x32_bf16 v[88:91], a[204:207], a[36:39], v[88:91]
ds_read_b64_tr_b16 a[238:239], v14 offset:11776
s_waitcnt lgkmcnt(8)
v_mfma_f32_16x16x32_bf16 v[28:31], a[208:211], a[40:43], v[28:31]
s_barrier
ds_read_b64_tr_b16 a[192:193], v11 offset:12288
v_mfma_f32_16x16x32_bf16 v[32:35], a[208:211], a[44:47], v[32:35]
ds_read_b64_tr_b16 a[194:195], v11 offset:12800
s_add_u32 m0, s64, 4096
v_mfma_f32_16x16x32_bf16 v[36:39], a[212:215], a[40:43], v[36:39]
ds_read_b64_tr_b16 a[196:197], v12 offset:12288
s_add_u32 s67, s8, 147456
v_mfma_f32_16x16x32_bf16 v[40:43], a[212:215], a[44:47], v[40:43]
ds_read_b64_tr_b16 a[198:199], v12 offset:12800
buffer_load_dwordx4 v15, s[44:47], s67 offen lds
v_mfma_f32_16x16x32_bf16 v[44:47], a[216:219], a[40:43], v[44:47]
ds_read_b64_tr_b16 a[200:201], v13 offset:12288
v_max_f32 v103, 0, v103
v_mfma_f32_16x16x32_bf16 v[48:51], a[216:219], a[44:47], v[48:51]
ds_read_b64_tr_b16 a[202:203], v13 offset:12800
v_mul_f32 v100, v100, v132
v_mfma_f32_16x16x32_bf16 v[52:55], a[220:223], a[40:43], v[52:55]
ds_read_b64_tr_b16 a[204:205], v14 offset:12288
buffer_load_dwordx4 v15, s[48:51], s67 offen offset:1024 lds
v_mfma_f32_16x16x32_bf16 v[56:59], a[220:223], a[44:47], v[56:59]
ds_read_b64_tr_b16 a[206:207], v14 offset:12800
s_waitcnt lgkmcnt(8)
v_mfma_f32_16x16x32_bf16 v[60:63], a[224:227], a[40:43], v[60:63]
ds_read_b64_tr_b16 a[208:209], v11 offset:13312
v_mul_f32 v101, v101, v133
v_mfma_f32_16x16x32_bf16 v[64:67], a[224:227], a[44:47], v[64:67]
ds_read_b64_tr_b16 a[210:211], v11 offset:13824
v_mul_f32 v102, v102, v134
v_mfma_f32_16x16x32_bf16 v[68:71], a[228:231], a[40:43], v[68:71]
ds_read_b64_tr_b16 a[212:213], v12 offset:13312
v_mul_f32 v103, v103, v135
v_mfma_f32_16x16x32_bf16 v[72:75], a[228:231], a[44:47], v[72:75]
ds_read_b64_tr_b16 a[214:215], v12 offset:13824
buffer_load_dwordx4 a[136:139], v20, s[32:35], s80 offen offset:2048 sc1
v_mfma_f32_16x16x32_bf16 v[76:79], a[232:235], a[40:43], v[76:79]
ds_read_b64_tr_b16 a[216:217], v13 offset:13312
v_mfma_f32_16x16x32_bf16 v[80:83], a[232:235], a[44:47], v[80:83]
ds_read_b64_tr_b16 a[218:219], v13 offset:13824
v_mfma_f32_16x16x32_bf16 v[84:87], a[236:239], a[40:43], v[84:87]
ds_read_b64_tr_b16 a[220:221], v14 offset:13312
v_mfma_f32_16x16x32_bf16 v[88:91], a[236:239], a[44:47], v[88:91]
ds_read_b64_tr_b16 a[222:223], v14 offset:13824
s_waitcnt lgkmcnt(8)
v_mfma_f32_16x16x32_bf16 v[28:31], a[192:195], a[48:51], v[28:31]
ds_read_b64_tr_b16 a[224:225], v11 offset:14336
s_add_u32 m0, s64, 6144
v_mfma_f32_16x16x32_bf16 v[32:35], a[192:195], a[52:55], v[32:35]
ds_read_b64_tr_b16 a[226:227], v11 offset:14848
s_add_u32 s67, s8, 221184
v_mfma_f32_16x16x32_bf16 v[36:39], a[196:199], a[48:51], v[36:39]
ds_read_b64_tr_b16 a[228:229], v12 offset:14336
buffer_load_dwordx4 v15, s[44:47], s67 offen lds
v_mfma_f32_16x16x32_bf16 v[40:43], a[196:199], a[52:55], v[40:43]
ds_read_b64_tr_b16 a[230:231], v12 offset:14848
v_cvt_pk_bf16_f32 v158, v100, v101
v_mfma_f32_16x16x32_bf16 v[44:47], a[200:203], a[48:51], v[44:47]
ds_read_b64_tr_b16 a[232:233], v13 offset:14336
v_cvt_pk_bf16_f32 v159, v102, v103
v_mfma_f32_16x16x32_bf16 v[48:51], a[200:203], a[52:55], v[48:51]
ds_read_b64_tr_b16 a[234:235], v13 offset:14848
buffer_load_dwordx4 v15, s[48:51], s67 offen offset:1024 lds
v_mfma_f32_16x16x32_bf16 v[52:55], a[204:207], a[48:51], v[52:55]
ds_read_b64_tr_b16 a[236:237], v14 offset:14336
v_max_f32 v104, 0, v104
v_mfma_f32_16x16x32_bf16 v[56:59], a[204:207], a[52:55], v[56:59]
ds_read_b64_tr_b16 a[238:239], v14 offset:14848
s_waitcnt lgkmcnt(8)
v_mfma_f32_16x16x32_bf16 v[60:63], a[208:211], a[48:51], v[60:63]
ds_read_b64_tr_b16 a[192:193], v11 offset:15360
v_max_f32 v105, 0, v105
v_mfma_f32_16x16x32_bf16 v[64:67], a[208:211], a[52:55], v[64:67]
ds_read_b64_tr_b16 a[194:195], v11 offset:15872
buffer_load_dwordx4 a[140:143], v20, s[32:35], s80 offen offset:3072 sc1
v_mfma_f32_16x16x32_bf16 v[68:71], a[212:215], a[48:51], v[68:71]
ds_read_b64_tr_b16 a[196:197], v12 offset:15360
s_add_u32 s80, s95, 0
v_mfma_f32_16x16x32_bf16 v[72:75], a[212:215], a[52:55], v[72:75]
ds_read_b64_tr_b16 a[198:199], v12 offset:15872
v_mfma_f32_16x16x32_bf16 v[76:79], a[216:219], a[48:51], v[76:79]
ds_read_b64_tr_b16 a[200:201], v13 offset:15360
v_mfma_f32_16x16x32_bf16 v[80:83], a[216:219], a[52:55], v[80:83]
ds_read_b64_tr_b16 a[202:203], v13 offset:15872
v_mfma_f32_16x16x32_bf16 v[84:87], a[220:223], a[48:51], v[84:87]
ds_read_b64_tr_b16 a[204:205], v14 offset:15360
v_mfma_f32_16x16x32_bf16 v[88:91], a[220:223], a[52:55], v[88:91]
ds_read_b64_tr_b16 a[206:207], v14 offset:15872
s_waitcnt lgkmcnt(8)
v_mfma_f32_16x16x32_bf16 v[28:31], a[224:227], a[56:59], v[28:31]
ds_read_b64_tr_b16 a[208:209], v11 offset:16384
s_add_u32 m0, s64, 8192
v_mfma_f32_16x16x32_bf16 v[32:35], a[224:227], a[60:63], v[32:35]
ds_read_b64_tr_b16 a[210:211], v11 offset:16896
s_add_u32 s67, s9, 0
v_mfma_f32_16x16x32_bf16 v[36:39], a[228:231], a[56:59], v[36:39]
ds_read_b64_tr_b16 a[212:213], v12 offset:16384
buffer_load_dwordx4 v15, s[44:47], s67 offen lds
v_mfma_f32_16x16x32_bf16 v[40:43], a[228:231], a[60:63], v[40:43]
ds_read_b64_tr_b16 a[214:215], v12 offset:16896
v_max_f32 v106, 0, v106
v_mfma_f32_16x16x32_bf16 v[44:47], a[232:235], a[56:59], v[44:47]
ds_read_b64_tr_b16 a[216:217], v13 offset:16384
v_max_f32 v107, 0, v107
v_mfma_f32_16x16x32_bf16 v[48:51], a[232:235], a[60:63], v[48:51]
ds_read_b64_tr_b16 a[218:219], v13 offset:16896
buffer_load_dwordx4 v15, s[48:51], s67 offen offset:1024 lds
v_mfma_f32_16x16x32_bf16 v[52:55], a[236:239], a[56:59], v[52:55]
ds_read_b64_tr_b16 a[220:221], v14 offset:16384
v_mul_f32 v104, v104, v136
v_mfma_f32_16x16x32_bf16 v[56:59], a[236:239], a[60:63], v[56:59]
ds_read_b64_tr_b16 a[222:223], v14 offset:16896
s_waitcnt lgkmcnt(8)
v_mfma_f32_16x16x32_bf16 v[60:63], a[192:195], a[56:59], v[60:63]
ds_read_b64_tr_b16 a[224:225], v11 offset:17408
v_mul_f32 v105, v105, v137
v_mfma_f32_16x16x32_bf16 v[64:67], a[192:195], a[60:63], v[64:67]
ds_read_b64_tr_b16 a[226:227], v11 offset:17920
v_mul_f32 v106, v106, v138
v_mfma_f32_16x16x32_bf16 v[68:71], a[196:199], a[56:59], v[68:71]
ds_read_b64_tr_b16 a[228:229], v12 offset:17408
buffer_load_dwordx4 a[144:147], v20, s[32:35], s80 offen offset:0 sc1
v_mfma_f32_16x16x32_bf16 v[72:75], a[196:199], a[60:63], v[72:75]
ds_read_b64_tr_b16 a[230:231], v12 offset:17920
v_mfma_f32_16x16x32_bf16 v[76:79], a[200:203], a[56:59], v[76:79]
ds_read_b64_tr_b16 a[232:233], v13 offset:17408
v_mfma_f32_16x16x32_bf16 v[80:83], a[200:203], a[60:63], v[80:83]
ds_read_b64_tr_b16 a[234:235], v13 offset:17920
v_mfma_f32_16x16x32_bf16 v[84:87], a[204:207], a[56:59], v[84:87]
ds_read_b64_tr_b16 a[236:237], v14 offset:17408
v_mfma_f32_16x16x32_bf16 v[88:91], a[204:207], a[60:63], v[88:91]
ds_read_b64_tr_b16 a[238:239], v14 offset:17920
s_waitcnt lgkmcnt(8)
v_mfma_f32_16x16x32_bf16 v[28:31], a[208:211], a[64:67], v[28:31]
s_barrier
ds_read_b64_tr_b16 a[192:193], v11 offset:18432
v_mfma_f32_16x16x32_bf16 v[32:35], a[208:211], a[68:71], v[32:35]
ds_read_b64_tr_b16 a[194:195], v11 offset:18944
s_add_u32 m0, s64, 10240
v_mfma_f32_16x16x32_bf16 v[36:39], a[212:215], a[64:67], v[36:39]
ds_read_b64_tr_b16 a[196:197], v12 offset:18432
s_add_u32 s67, s9, 73728
v_mfma_f32_16x16x32_bf16 v[40:43], a[212:215], a[68:71], v[40:43]
ds_read_b64_tr_b16 a[198:199], v12 offset:18944
buffer_load_dwordx4 v15, s[44:47], s67 offen lds
v_mfma_f32_16x16x32_bf16 v[44:47], a[216:219], a[64:67], v[44:47]
ds_read_b64_tr_b16 a[200:201], v13 offset:18432
v_mul_f32 v107, v107, v139
v_mfma_f32_16x16x32_bf16 v[48:51], a[216:219], a[68:71], v[48:51]
ds_read_b64_tr_b16 a[202:203], v13 offset:18944
v_cvt_pk_bf16_f32 v162, v104, v105
v_mfma_f32_16x16x32_bf16 v[52:55], a[220:223], a[64:67], v[52:55]
ds_read_b64_tr_b16 a[204:205], v14 offset:18432
buffer_load_dwordx4 v15, s[48:51], s67 offen offset:1024 lds
v_mfma_f32_16x16x32_bf16 v[56:59], a[220:223], a[68:71], v[56:59]
ds_read_b64_tr_b16 a[206:207], v14 offset:18944
s_waitcnt lgkmcnt(8)
v_mfma_f32_16x16x32_bf16 v[60:63], a[224:227], a[64:67], v[60:63]
ds_read_b64_tr_b16 a[208:209], v11 offset:19456
v_cvt_pk_bf16_f32 v163, v106, v107
v_mfma_f32_16x16x32_bf16 v[64:67], a[224:227], a[68:71], v[64:67]
ds_read_b64_tr_b16 a[210:211], v11 offset:19968
v_max_f32 v108, 0, v108
v_mfma_f32_16x16x32_bf16 v[68:71], a[228:231], a[64:67], v[68:71]
ds_read_b64_tr_b16 a[212:213], v12 offset:19456
v_max_f32 v109, 0, v109
v_mfma_f32_16x16x32_bf16 v[72:75], a[228:231], a[68:71], v[72:75]
ds_read_b64_tr_b16 a[214:215], v12 offset:19968
buffer_load_dwordx4 a[148:151], v20, s[32:35], s80 offen offset:1024 sc1
v_mfma_f32_16x16x32_bf16 v[76:79], a[232:235], a[64:67], v[76:79]
ds_read_b64_tr_b16 a[216:217], v13 offset:19456
buffer_load_dwordx4 a[152:155], v20, s[32:35], s80 offen offset:2048 sc1
v_mfma_f32_16x16x32_bf16 v[80:83], a[232:235], a[68:71], v[80:83]
ds_read_b64_tr_b16 a[218:219], v13 offset:19968
v_mfma_f32_16x16x32_bf16 v[84:87], a[236:239], a[64:67], v[84:87]
ds_read_b64_tr_b16 a[220:221], v14 offset:19456
v_mfma_f32_16x16x32_bf16 v[88:91], a[236:239], a[68:71], v[88:91]
ds_read_b64_tr_b16 a[222:223], v14 offset:19968
s_waitcnt lgkmcnt(8)
v_mfma_f32_16x16x32_bf16 v[28:31], a[192:195], a[72:75], v[28:31]
ds_read_b64_tr_b16 a[224:225], v11 offset:20480
s_add_u32 m0, s64, 12288
v_mfma_f32_16x16x32_bf16 v[32:35], a[192:195], a[76:79], v[32:35]
ds_read_b64_tr_b16 a[226:227], v11 offset:20992
s_add_u32 s67, s9, 147456
v_mfma_f32_16x16x32_bf16 v[36:39], a[196:199], a[72:75], v[36:39]
ds_read_b64_tr_b16 a[228:229], v12 offset:20480
buffer_load_dwordx4 v15, s[44:47], s67 offen lds
v_mfma_f32_16x16x32_bf16 v[40:43], a[196:199], a[76:79], v[40:43]
ds_read_b64_tr_b16 a[230:231], v12 offset:20992
v_max_f32 v110, 0, v110
v_mfma_f32_16x16x32_bf16 v[44:47], a[200:203], a[72:75], v[44:47]
ds_read_b64_tr_b16 a[232:233], v13 offset:20480
v_max_f32 v111, 0, v111
v_mfma_f32_16x16x32_bf16 v[48:51], a[200:203], a[76:79], v[48:51]
ds_read_b64_tr_b16 a[234:235], v13 offset:20992
buffer_load_dwordx4 v15, s[48:51], s67 offen offset:1024 lds
v_mfma_f32_16x16x32_bf16 v[52:55], a[204:207], a[72:75], v[52:55]
ds_read_b64_tr_b16 a[236:237], v14 offset:20480
v_mul_f32 v108, v108, v140
v_mfma_f32_16x16x32_bf16 v[56:59], a[204:207], a[76:79], v[56:59]
ds_read_b64_tr_b16 a[238:239], v14 offset:20992
s_waitcnt lgkmcnt(8)
v_mfma_f32_16x16x32_bf16 v[60:63], a[208:211], a[72:75], v[60:63]
ds_read_b64_tr_b16 a[192:193], v11 offset:21504
v_mul_f32 v109, v109, v141
v_mfma_f32_16x16x32_bf16 v[64:67], a[208:211], a[76:79], v[64:67]
ds_read_b64_tr_b16 a[194:195], v11 offset:22016
v_mul_f32 v110, v110, v142
v_mfma_f32_16x16x32_bf16 v[68:71], a[212:215], a[72:75], v[68:71]
ds_read_b64_tr_b16 a[196:197], v12 offset:21504
buffer_load_dwordx4 a[156:159], v20, s[32:35], s80 offen offset:3072 sc1
v_mfma_f32_16x16x32_bf16 v[72:75], a[212:215], a[76:79], v[72:75]
ds_read_b64_tr_b16 a[198:199], v12 offset:22016
v_mfma_f32_16x16x32_bf16 v[76:79], a[216:219], a[72:75], v[76:79]
ds_read_b64_tr_b16 a[200:201], v13 offset:21504
v_mfma_f32_16x16x32_bf16 v[80:83], a[216:219], a[76:79], v[80:83]
ds_read_b64_tr_b16 a[202:203], v13 offset:22016
v_mfma_f32_16x16x32_bf16 v[84:87], a[220:223], a[72:75], v[84:87]
ds_read_b64_tr_b16 a[204:205], v14 offset:21504
v_mfma_f32_16x16x32_bf16 v[88:91], a[220:223], a[76:79], v[88:91]
ds_read_b64_tr_b16 a[206:207], v14 offset:22016
s_waitcnt lgkmcnt(8)
v_mfma_f32_16x16x32_bf16 v[28:31], a[224:227], a[80:83], v[28:31]
ds_read_b64_tr_b16 a[208:209], v11 offset:22528
s_add_u32 m0, s64, 14336
v_mfma_f32_16x16x32_bf16 v[32:35], a[224:227], a[84:87], v[32:35]
ds_read_b64_tr_b16 a[210:211], v11 offset:23040
s_add_u32 s67, s9, 221184
v_mfma_f32_16x16x32_bf16 v[36:39], a[228:231], a[80:83], v[36:39]
ds_read_b64_tr_b16 a[212:213], v12 offset:22528
buffer_load_dwordx4 v15, s[44:47], s67 offen lds
v_mfma_f32_16x16x32_bf16 v[40:43], a[228:231], a[84:87], v[40:43]
ds_read_b64_tr_b16 a[214:215], v12 offset:23040
v_mul_f32 v111, v111, v143
v_mfma_f32_16x16x32_bf16 v[44:47], a[232:235], a[80:83], v[44:47]
ds_read_b64_tr_b16 a[216:217], v13 offset:22528
v_cvt_pk_bf16_f32 v164, v108, v109
v_mfma_f32_16x16x32_bf16 v[48:51], a[232:235], a[84:87], v[48:51]
ds_read_b64_tr_b16 a[218:219], v13 offset:23040
buffer_load_dwordx4 v15, s[48:51], s67 offen offset:1024 lds
v_mfma_f32_16x16x32_bf16 v[52:55], a[236:239], a[80:83], v[52:55]
ds_read_b64_tr_b16 a[220:221], v14 offset:22528
v_cvt_pk_bf16_f32 v165, v110, v111
v_mfma_f32_16x16x32_bf16 v[56:59], a[236:239], a[84:87], v[56:59]
ds_read_b64_tr_b16 a[222:223], v14 offset:23040
s_waitcnt lgkmcnt(8)
v_mfma_f32_16x16x32_bf16 v[60:63], a[192:195], a[80:83], v[60:63]
ds_read_b64_tr_b16 a[224:225], v11 offset:23552
v_max_f32 v112, 0, v112
v_mfma_f32_16x16x32_bf16 v[64:67], a[192:195], a[84:87], v[64:67]
ds_read_b64_tr_b16 a[226:227], v11 offset:24064
s_add_u32 s80, s94, 16384
v_mfma_f32_16x16x32_bf16 v[68:71], a[196:199], a[80:83], v[68:71]
ds_read_b64_tr_b16 a[228:229], v12 offset:23552
buffer_load_dwordx4 a[160:163], v20, s[32:35], s80 offen offset:0 sc1
v_mfma_f32_16x16x32_bf16 v[72:75], a[196:199], a[84:87], v[72:75]
ds_read_b64_tr_b16 a[230:231], v12 offset:24064
v_mfma_f32_16x16x32_bf16 v[76:79], a[200:203], a[80:83], v[76:79]
ds_read_b64_tr_b16 a[232:233], v13 offset:23552
v_mfma_f32_16x16x32_bf16 v[80:83], a[200:203], a[84:87], v[80:83]
ds_read_b64_tr_b16 a[234:235], v13 offset:24064
v_mfma_f32_16x16x32_bf16 v[84:87], a[204:207], a[80:83], v[84:87]
ds_read_b64_tr_b16 a[236:237], v14 offset:23552
v_mfma_f32_16x16x32_bf16 v[88:91], a[204:207], a[84:87], v[88:91]
ds_read_b64_tr_b16 a[238:239], v14 offset:24064
s_waitcnt lgkmcnt(8)
v_mfma_f32_16x16x32_bf16 v[28:31], a[208:211], a[88:91], v[28:31]
s_barrier
ds_read_b64_tr_b16 a[192:193], v11 offset:24576
v_mfma_f32_16x16x32_bf16 v[32:35], a[208:211], a[92:95], v[32:35]
ds_read_b64_tr_b16 a[194:195], v11 offset:25088
s_add_u32 s22, s15, 2048
buffer_store_dword v22, v21, s[32:35], s22 offen sc1
v_mfma_f32_16x16x32_bf16 v[36:39], a[212:215], a[88:91], v[36:39]
ds_read_b64_tr_b16 a[196:197], v12 offset:24576
s_add_u32 m0, s64, 16384
v_mfma_f32_16x16x32_bf16 v[40:43], a[212:215], a[92:95], v[40:43]
ds_read_b64_tr_b16 a[198:199], v12 offset:25088
s_add_u32 s67, s8, 294912
v_mfma_f32_16x16x32_bf16 v[44:47], a[216:219], a[88:91], v[44:47]
ds_read_b64_tr_b16 a[200:201], v13 offset:24576
buffer_load_dwordx4 v15, s[44:47], s67 offen lds
v_mfma_f32_16x16x32_bf16 v[48:51], a[216:219], a[92:95], v[48:51]
ds_read_b64_tr_b16 a[202:203], v13 offset:25088
v_max_f32 v113, 0, v113
v_mfma_f32_16x16x32_bf16 v[52:55], a[220:223], a[88:91], v[52:55]
ds_read_b64_tr_b16 a[204:205], v14 offset:24576
v_max_f32 v114, 0, v114
v_mfma_f32_16x16x32_bf16 v[56:59], a[220:223], a[92:95], v[56:59]
ds_read_b64_tr_b16 a[206:207], v14 offset:25088
s_waitcnt lgkmcnt(8)
v_mfma_f32_16x16x32_bf16 v[60:63], a[224:227], a[88:91], v[60:63]
ds_read_b64_tr_b16 a[208:209], v11 offset:25600
buffer_load_dwordx4 v15, s[48:51], s67 offen offset:1024 lds
v_mfma_f32_16x16x32_bf16 v[64:67], a[224:227], a[92:95], v[64:67]
ds_read_b64_tr_b16 a[210:211], v11 offset:26112
buffer_store_dwordx4 v[156:159], v20, s[32:35], s21 offen offset:0 sc1
v_mfma_f32_16x16x32_bf16 v[68:71], a[228:231], a[88:91], v[68:71]
ds_read_b64_tr_b16 a[212:213], v12 offset:25600
buffer_store_dwordx4 v[160:163], v20, s[32:35], s21 offen offset:1024 sc1
v_mfma_f32_16x16x32_bf16 v[72:75], a[228:231], a[92:95], v[72:75]
ds_read_b64_tr_b16 a[214:215], v12 offset:26112
v_max_f32 v115, 0, v115
v_mfma_f32_16x16x32_bf16 v[76:79], a[232:235], a[88:91], v[76:79]
ds_read_b64_tr_b16 a[216:217], v13 offset:25600
v_mul_f32 v112, v112, v144
v_mfma_f32_16x16x32_bf16 v[80:83], a[232:235], a[92:95], v[80:83]
ds_read_b64_tr_b16 a[218:219], v13 offset:26112
v_mul_f32 v113, v113, v145
v_mfma_f32_16x16x32_bf16 v[84:87], a[236:239], a[88:91], v[84:87]
ds_read_b64_tr_b16 a[220:221], v14 offset:25600
buffer_load_dwordx4 a[164:167], v20, s[32:35], s80 offen offset:1024 sc1
v_mfma_f32_16x16x32_bf16 v[88:91], a[236:239], a[92:95], v[88:91]
ds_read_b64_tr_b16 a[222:223], v14 offset:26112
s_waitcnt lgkmcnt(8)
v_mfma_f32_16x16x32_bf16 v[28:31], a[192:195], a[96:99], v[28:31]
ds_read_b64_tr_b16 a[224:225], v11 offset:26624
s_add_u32 m0, s64, 18432
v_mfma_f32_16x16x32_bf16 v[32:35], a[192:195], a[100:103], v[32:35]
ds_read_b64_tr_b16 a[226:227], v11 offset:27136
s_add_u32 s67, s9, 294912
v_mfma_f32_16x16x32_bf16 v[36:39], a[196:199], a[96:99], v[36:39]
ds_read_b64_tr_b16 a[228:229], v12 offset:26624
buffer_load_dwordx4 v15, s[44:47], s67 offen lds
v_mfma_f32_16x16x32_bf16 v[40:43], a[196:199], a[100:103], v[40:43]
ds_read_b64_tr_b16 a[230:231], v12 offset:27136
v_mul_f32 v114, v114, v146
v_mfma_f32_16x16x32_bf16 v[44:47], a[200:203], a[96:99], v[44:47]
ds_read_b64_tr_b16 a[232:233], v13 offset:26624
v_mul_f32 v115, v115, v147
v_mfma_f32_16x16x32_bf16 v[48:51], a[200:203], a[100:103], v[48:51]
ds_read_b64_tr_b16 a[234:235], v13 offset:27136
buffer_load_dwordx4 v15, s[48:51], s67 offen offset:1024 lds
v_mfma_f32_16x16x32_bf16 v[52:55], a[204:207], a[96:99], v[52:55]
ds_read_b64_tr_b16 a[236:237], v14 offset:26624
v_cvt_pk_bf16_f32 v168, v112, v113
v_mfma_f32_16x16x32_bf16 v[56:59], a[204:207], a[100:103], v[56:59]
ds_read_b64_tr_b16 a[238:239], v14 offset:27136
s_waitcnt lgkmcnt(8)
v_mfma_f32_16x16x32_bf16 v[60:63], a[208:211], a[96:99], v[60:63]
ds_read_b64_tr_b16 a[192:193], v11 offset:27648
v_cvt_pk_bf16_f32 v169, v114, v115
v_mfma_f32_16x16x32_bf16 v[64:67], a[208:211], a[100:103], v[64:67]
ds_read_b64_tr_b16 a[194:195], v11 offset:28160
v_max_f32 v116, 0, v116
v_mfma_f32_16x16x32_bf16 v[68:71], a[212:215], a[96:99], v[68:71]
ds_read_b64_tr_b16 a[196:197], v12 offset:27648
buffer_load_dwordx4 a[168:171], v20, s[32:35], s80 offen offset:2048 sc1
v_mfma_f32_16x16x32_bf16 v[72:75], a[212:215], a[100:103], v[72:75]
ds_read_b64_tr_b16 a[198:199], v12 offset:28160
buffer_load_dwordx4 a[172:175], v20, s[32:35], s80 offen offset:3072 sc1
v_mfma_f32_16x16x32_bf16 v[76:79], a[216:219], a[96:99], v[76:79]
ds_read_b64_tr_b16 a[200:201], v13 offset:27648
v_mfma_f32_16x16x32_bf16 v[80:83], a[216:219], a[100:103], v[80:83]
ds_read_b64_tr_b16 a[202:203], v13 offset:28160
v_mfma_f32_16x16x32_bf16 v[84:87], a[220:223], a[96:99], v[84:87]
ds_read_b64_tr_b16 a[204:205], v14 offset:27648
v_mfma_f32_16x16x32_bf16 v[88:91], a[220:223], a[100:103], v[88:91]
ds_read_b64_tr_b16 a[206:207], v14 offset:28160
s_waitcnt lgkmcnt(8)
v_mfma_f32_16x16x32_bf16 v[28:31], a[224:227], a[104:107], v[28:31]
ds_read_b64_tr_b16 a[208:209], v11 offset:28672
s_add_u32 m0, s64, 20480
v_mfma_f32_16x16x32_bf16 v[32:35], a[224:227], a[108:111], v[32:35]
ds_read_b64_tr_b16 a[210:211], v11 offset:29184
s_add_u32 s67, s11, 0
v_mfma_f32_16x16x32_bf16 v[36:39], a[228:231], a[104:107], v[36:39]
ds_read_b64_tr_b16 a[212:213], v12 offset:28672
buffer_load_dwordx4 v15, s[44:47], s67 offen lds
v_mfma_f32_16x16x32_bf16 v[40:43], a[228:231], a[108:111], v[40:43]
ds_read_b64_tr_b16 a[214:215], v12 offset:29184
v_max_f32 v117, 0, v117
v_mfma_f32_16x16x32_bf16 v[44:47], a[232:235], a[104:107], v[44:47]
ds_read_b64_tr_b16 a[216:217], v13 offset:28672
v_max_f32 v118, 0, v118
v_mfma_f32_16x16x32_bf16 v[48:51], a[232:235], a[108:111], v[48:51]
ds_read_b64_tr_b16 a[218:219], v13 offset:29184
buffer_load_dwordx4 v15, s[48:51], s67 offen offset:1024 lds
v_mfma_f32_16x16x32_bf16 v[52:55], a[236:239], a[104:107], v[52:55]
ds_read_b64_tr_b16 a[220:221], v14 offset:28672
v_max_f32 v119, 0, v119
v_mfma_f32_16x16x32_bf16 v[56:59], a[236:239], a[108:111], v[56:59]
ds_read_b64_tr_b16 a[222:223], v14 offset:29184
s_waitcnt lgkmcnt(8)
v_mfma_f32_16x16x32_bf16 v[60:63], a[192:195], a[104:107], v[60:63]
ds_read_b64_tr_b16 a[224:225], v11 offset:29696
v_mul_f32 v116, v116, v148
v_mfma_f32_16x16x32_bf16 v[64:67], a[192:195], a[108:111], v[64:67]
ds_read_b64_tr_b16 a[226:227], v11 offset:30208
s_add_u32 s80, s95, 16384
v_mfma_f32_16x16x32_bf16 v[68:71], a[196:199], a[104:107], v[68:71]
ds_read_b64_tr_b16 a[228:229], v12 offset:29696
v_mfma_f32_16x16x32_bf16 v[72:75], a[196:199], a[108:111], v[72:75]
ds_read_b64_tr_b16 a[230:231], v12 offset:30208
v_mfma_f32_16x16x32_bf16 v[76:79], a[200:203], a[104:107], v[76:79]
ds_read_b64_tr_b16 a[232:233], v13 offset:29696
v_mfma_f32_16x16x32_bf16 v[80:83], a[200:203], a[108:111], v[80:83]
ds_read_b64_tr_b16 a[234:235], v13 offset:30208
v_mfma_f32_16x16x32_bf16 v[84:87], a[204:207], a[104:107], v[84:87]
ds_read_b64_tr_b16 a[236:237], v14 offset:29696
v_mfma_f32_16x16x32_bf16 v[88:91], a[204:207], a[108:111], v[88:91]
ds_read_b64_tr_b16 a[238:239], v14 offset:30208
s_waitcnt lgkmcnt(8)
v_mfma_f32_16x16x32_bf16 v[28:31], a[208:211], a[112:115], v[28:31]
s_waitcnt vmcnt(37)
s_barrier
ds_read_b64_tr_b16 a[192:193], v11 offset:30720
v_mfma_f32_16x16x32_bf16 v[32:35], a[208:211], a[116:119], v[32:35]
ds_read_b64_tr_b16 a[194:195], v11 offset:31232
s_add_u32 m0, s64, 22528
v_mfma_f32_16x16x32_bf16 v[36:39], a[212:215], a[112:115], v[36:39]
ds_read_b64_tr_b16 a[196:197], v12 offset:30720
s_add_u32 s67, s96, 0
v_mfma_f32_16x16x32_bf16 v[40:43], a[212:215], a[116:119], v[40:43]
ds_read_b64_tr_b16 a[198:199], v12 offset:31232
buffer_load_dwordx4 v15, s[44:47], s67 offen lds
v_mfma_f32_16x16x32_bf16 v[44:47], a[216:219], a[112:115], v[44:47]
ds_read_b64_tr_b16 a[200:201], v13 offset:30720
v_mul_f32 v117, v117, v149
v_mfma_f32_16x16x32_bf16 v[48:51], a[216:219], a[116:119], v[48:51]
ds_read_b64_tr_b16 a[202:203], v13 offset:31232
v_mul_f32 v118, v118, v150
v_mfma_f32_16x16x32_bf16 v[52:55], a[220:223], a[112:115], v[52:55]
ds_read_b64_tr_b16 a[204:205], v14 offset:30720
buffer_load_dwordx4 v15, s[48:51], s67 offen offset:1024 lds
v_mfma_f32_16x16x32_bf16 v[56:59], a[220:223], a[116:119], v[56:59]
ds_read_b64_tr_b16 a[206:207], v14 offset:31232
s_waitcnt lgkmcnt(8)
v_mfma_f32_16x16x32_bf16 v[60:63], a[224:227], a[112:115], v[60:63]
ds_read_b64_tr_b16 a[208:209], v11 offset:31744
v_mul_f32 v119, v119, v151
v_mfma_f32_16x16x32_bf16 v[64:67], a[224:227], a[116:119], v[64:67]
ds_read_b64_tr_b16 a[210:211], v11 offset:32256
v_cvt_pk_bf16_f32 v166, v116, v117
v_mfma_f32_16x16x32_bf16 v[68:71], a[228:231], a[112:115], v[68:71]
ds_read_b64_tr_b16 a[212:213], v12 offset:31744
v_cvt_pk_bf16_f32 v167, v118, v119
v_mfma_f32_16x16x32_bf16 v[72:75], a[228:231], a[116:119], v[72:75]
ds_read_b64_tr_b16 a[214:215], v12 offset:32256
buffer_load_dwordx4 a[176:179], v20, s[32:35], s80 offen offset:0 sc1
v_mfma_f32_16x16x32_bf16 v[76:79], a[232:235], a[112:115], v[76:79]
ds_read_b64_tr_b16 a[216:217], v13 offset:31744
buffer_load_dwordx4 a[180:183], v20, s[32:35], s80 offen offset:1024 sc1
v_mfma_f32_16x16x32_bf16 v[80:83], a[232:235], a[116:119], v[80:83]
ds_read_b64_tr_b16 a[218:219], v13 offset:32256
v_mfma_f32_16x16x32_bf16 v[84:87], a[236:239], a[112:115], v[84:87]
ds_read_b64_tr_b16 a[220:221], v14 offset:31744
v_mfma_f32_16x16x32_bf16 v[88:91], a[236:239], a[116:119], v[88:91]
ds_read_b64_tr_b16 a[222:223], v14 offset:32256
s_waitcnt lgkmcnt(8)
v_mfma_f32_16x16x32_bf16 v[28:31], a[192:195], a[120:123], v[28:31]
ds_read_b64_tr_b16 a[224:225], v11 offset:32768
s_add_u32 m0, s64, 24576
v_mfma_f32_16x16x32_bf16 v[32:35], a[192:195], a[124:127], v[32:35]
ds_read_b64_tr_b16 a[226:227], v11 offset:33280
s_add_u32 s67, s11, 73728
v_mfma_f32_16x16x32_bf16 v[36:39], a[196:199], a[120:123], v[36:39]
ds_read_b64_tr_b16 a[228:229], v12 offset:32768
buffer_load_dwordx4 v15, s[44:47], s67 offen lds
v_mfma_f32_16x16x32_bf16 v[40:43], a[196:199], a[124:127], v[40:43]
ds_read_b64_tr_b16 a[230:231], v12 offset:33280
v_max_f32 v120, 0, v120
v_mfma_f32_16x16x32_bf16 v[44:47], a[200:203], a[120:123], v[44:47]
ds_read_b64_tr_b16 a[232:233], v13 offset:32768
v_max_f32 v121, 0, v121
v_mfma_f32_16x16x32_bf16 v[48:51], a[200:203], a[124:127], v[48:51]
ds_read_b64_tr_b16 a[234:235], v13 offset:33280
buffer_load_dwordx4 v15, s[48:51], s67 offen offset:1024 lds
v_mfma_f32_16x16x32_bf16 v[52:55], a[204:207], a[120:123], v[52:55]
ds_read_b64_tr_b16 a[236:237], v14 offset:32768
v_max_f32 v122, 0, v122
v_mfma_f32_16x16x32_bf16 v[56:59], a[204:207], a[124:127], v[56:59]
ds_read_b64_tr_b16 a[238:239], v14 offset:33280
s_waitcnt lgkmcnt(8)
v_mfma_f32_16x16x32_bf16 v[60:63], a[208:211], a[120:123], v[60:63]
ds_read_b64_tr_b16 a[192:193], v11 offset:33792
v_max_f32 v123, 0, v123
v_mfma_f32_16x16x32_bf16 v[64:67], a[208:211], a[124:127], v[64:67]
ds_read_b64_tr_b16 a[194:195], v11 offset:34304
v_mul_f32 v120, v120, v152
v_mfma_f32_16x16x32_bf16 v[68:71], a[212:215], a[120:123], v[68:71]
ds_read_b64_tr_b16 a[196:197], v12 offset:33792
buffer_load_dwordx4 a[184:187], v20, s[32:35], s80 offen offset:2048 sc1
v_mfma_f32_16x16x32_bf16 v[72:75], a[212:215], a[124:127], v[72:75]
ds_read_b64_tr_b16 a[198:199], v12 offset:34304
buffer_load_dwordx4 a[188:191], v20, s[32:35], s80 offen offset:3072 sc1
v_mfma_f32_16x16x32_bf16 v[76:79], a[216:219], a[120:123], v[76:79]
ds_read_b64_tr_b16 a[200:201], v13 offset:33792
v_mfma_f32_16x16x32_bf16 v[80:83], a[216:219], a[124:127], v[80:83]
ds_read_b64_tr_b16 a[202:203], v13 offset:34304
v_mfma_f32_16x16x32_bf16 v[84:87], a[220:223], a[120:123], v[84:87]
ds_read_b64_tr_b16 a[204:205], v14 offset:33792
v_mfma_f32_16x16x32_bf16 v[88:91], a[220:223], a[124:127], v[88:91]
ds_read_b64_tr_b16 a[206:207], v14 offset:34304
s_waitcnt lgkmcnt(8)
v_mfma_f32_16x16x32_bf16 v[28:31], a[224:227], v[220:223], v[28:31]
ds_read_b64_tr_b16 a[208:209], v11 offset:34816
s_add_u32 m0, s64, 26624
v_mfma_f32_16x16x32_bf16 v[32:35], a[224:227], v[224:227], v[32:35]
ds_read_b64_tr_b16 a[210:211], v11 offset:35328
s_add_u32 s67, s96, 73728
v_mfma_f32_16x16x32_bf16 v[36:39], a[228:231], v[220:223], v[36:39]
ds_read_b64_tr_b16 a[212:213], v12 offset:34816
buffer_load_dwordx4 v15, s[44:47], s67 offen lds
v_mfma_f32_16x16x32_bf16 v[40:43], a[228:231], v[224:227], v[40:43]
ds_read_b64_tr_b16 a[214:215], v12 offset:35328
v_mul_f32 v121, v121, v153
v_mfma_f32_16x16x32_bf16 v[44:47], a[232:235], v[220:223], v[44:47]
ds_read_b64_tr_b16 a[216:217], v13 offset:34816
v_mul_f32 v122, v122, v154
v_mfma_f32_16x16x32_bf16 v[48:51], a[232:235], v[224:227], v[48:51]
ds_read_b64_tr_b16 a[218:219], v13 offset:35328
buffer_load_dwordx4 v15, s[48:51], s67 offen offset:1024 lds
v_mfma_f32_16x16x32_bf16 v[52:55], a[236:239], v[220:223], v[52:55]
ds_read_b64_tr_b16 a[220:221], v14 offset:34816
v_mul_f32 v123, v123, v155
v_mfma_f32_16x16x32_bf16 v[56:59], a[236:239], v[224:227], v[56:59]
ds_read_b64_tr_b16 a[222:223], v14 offset:35328
s_waitcnt lgkmcnt(8)
v_mfma_f32_16x16x32_bf16 v[60:63], a[192:195], v[220:223], v[60:63]
ds_read_b64_tr_b16 a[224:225], v11 offset:35840
v_cvt_pk_bf16_f32 v170, v120, v121
v_mfma_f32_16x16x32_bf16 v[64:67], a[192:195], v[224:227], v[64:67]
ds_read_b64_tr_b16 a[226:227], v11 offset:36352
v_cvt_pk_bf16_f32 v171, v122, v123
v_mfma_f32_16x16x32_bf16 v[68:71], a[196:199], v[220:223], v[68:71]
ds_read_b64_tr_b16 a[228:229], v12 offset:35840
v_mfma_f32_16x16x32_bf16 v[72:75], a[196:199], v[224:227], v[72:75]
ds_read_b64_tr_b16 a[230:231], v12 offset:36352
v_mfma_f32_16x16x32_bf16 v[76:79], a[200:203], v[220:223], v[76:79]
ds_read_b64_tr_b16 a[232:233], v13 offset:35840
v_mfma_f32_16x16x32_bf16 v[80:83], a[200:203], v[224:227], v[80:83]
ds_read_b64_tr_b16 a[234:235], v13 offset:36352
v_mfma_f32_16x16x32_bf16 v[84:87], a[204:207], v[220:223], v[84:87]
ds_read_b64_tr_b16 a[236:237], v14 offset:35840
v_mfma_f32_16x16x32_bf16 v[88:91], a[204:207], v[224:227], v[88:91]
ds_read_b64_tr_b16 a[238:239], v14 offset:36352
s_waitcnt lgkmcnt(8)
v_mfma_f32_16x16x32_bf16 v[92:95], a[208:211], v[228:231], v[28:31]
s_waitcnt vmcnt(43)
s_barrier
ds_read_b64_tr_b16 a[192:193], v11 offset:0
v_mfma_f32_16x16x32_bf16 v[96:99], a[208:211], v[232:235], v[32:35]
ds_read_b64_tr_b16 a[194:195], v11 offset:512
s_add_u32 m0, s64, 28672
v_mfma_f32_16x16x32_bf16 v[100:103], a[212:215], v[228:231], v[36:39]
ds_read_b64_tr_b16 a[196:197], v12 offset:0
s_add_u32 s67, s11, 147456
v_mfma_f32_16x16x32_bf16 v[104:107], a[212:215], v[232:235], v[40:43]
ds_read_b64_tr_b16 a[198:199], v12 offset:512
buffer_load_dwordx4 v15, s[44:47], s67 offen lds
v_mfma_f32_16x16x32_bf16 v[108:111], a[216:219], v[228:231], v[44:47]
ds_read_b64_tr_b16 a[200:201], v13 offset:0
v_mfma_f32_16x16x32_bf16 v[112:115], a[216:219], v[232:235], v[48:51]
ds_read_b64_tr_b16 a[202:203], v13 offset:512
v_mfma_f32_16x16x32_bf16 v[116:119], a[220:223], v[228:231], v[52:55]
ds_read_b64_tr_b16 a[204:205], v14 offset:0
buffer_load_dwordx4 v15, s[48:51], s67 offen offset:1024 lds
v_mfma_f32_16x16x32_bf16 v[120:123], a[220:223], v[232:235], v[56:59]
ds_read_b64_tr_b16 a[206:207], v14 offset:512
s_waitcnt lgkmcnt(8)
v_mfma_f32_16x16x32_bf16 v[124:127], a[224:227], v[228:231], v[60:63]
ds_read_b64_tr_b16 a[208:209], v11 offset:1024
buffer_store_dwordx4 v[164:167], v20, s[32:35], s21 offen offset:2048 sc1
v_mfma_f32_16x16x32_bf16 v[128:131], a[224:227], v[232:235], v[64:67]
ds_read_b64_tr_b16 a[210:211], v11 offset:1536
buffer_store_dwordx4 v[168:171], v20, s[32:35], s21 offen offset:3072 sc1
v_mfma_f32_16x16x32_bf16 v[132:135], a[228:231], v[228:231], v[68:71]
ds_read_b64_tr_b16 a[212:213], v12 offset:1024
s_add_u32 s21, s21, 16384
v_mfma_f32_16x16x32_bf16 v[136:139], a[228:231], v[232:235], v[72:75]
ds_read_b64_tr_b16 a[214:215], v12 offset:1536
buffer_load_dwordx4 a[252:255], v255, s[56:59], s3 offen
v_mfma_f32_16x16x32_bf16 v[140:143], a[232:235], v[228:231], v[76:79]
ds_read_b64_tr_b16 a[216:217], v13 offset:1024
v_mfma_f32_16x16x32_bf16 v[144:147], a[232:235], v[232:235], v[80:83]
ds_read_b64_tr_b16 a[218:219], v13 offset:1536
v_mfma_f32_16x16x32_bf16 v[148:151], a[236:239], v[228:231], v[84:87]
ds_read_b64_tr_b16 a[220:221], v14 offset:1024
v_mfma_f32_16x16x32_bf16 v[152:155], a[236:239], v[232:235], v[88:91]
ds_read_b64_tr_b16 a[222:223], v14 offset:1536
s_waitcnt lgkmcnt(8)
v_mfma_f32_16x16x32_bf16 v[28:31], a[192:195], v[172:175], 0
ds_read_b64_tr_b16 a[224:225], v11 offset:2048
s_add_u32 m0, s64, 30720
v_mfma_f32_16x16x32_bf16 v[32:35], a[192:195], v[176:179], 0
ds_read_b64_tr_b16 a[226:227], v11 offset:2560
s_add_u32 s67, s96, 147456
v_mfma_f32_16x16x32_bf16 v[36:39], a[196:199], v[172:175], 0
ds_read_b64_tr_b16 a[228:229], v12 offset:2048
buffer_load_dwordx4 v15, s[44:47], s67 offen lds
s_add_u32 s22, s15, 2048
v_mfma_f32_16x16x32_bf16 v[40:43], a[196:199], v[176:179], 0
ds_read_b64_tr_b16 a[230:231], v12 offset:2560
buffer_load_dword v23, v7, s[32:35], s22 offen sc1
v_max_f32 v92, 0, v92
v_mfma_f32_16x16x32_bf16 v[44:47], a[200:203], v[172:175], 0
ds_read_b64_tr_b16 a[232:233], v13 offset:2048
v_max_f32 v93, 0, v93
v_mfma_f32_16x16x32_bf16 v[48:51], a[200:203], v[176:179], 0
ds_read_b64_tr_b16 a[234:235], v13 offset:2560
buffer_load_dwordx4 v15, s[48:51], s67 offen offset:1024 lds
v_mfma_f32_16x16x32_bf16 v[52:55], a[204:207], v[172:175], 0
ds_read_b64_tr_b16 a[236:237], v14 offset:2048
s_add_u32 m0, s64, 32768
s_add_u32 s67, s13, 0
v_mfma_f32_16x16x32_bf16 v[56:59], a[204:207], v[176:179], 0
ds_read_b64_tr_b16 a[238:239], v14 offset:2560
v_max_f32 v94, 0, v94
s_waitcnt lgkmcnt(8)
v_mfma_f32_16x16x32_bf16 v[28:31], a[208:211], v[180:183], v[28:31]
ds_read_b64_tr_b16 a[192:193], v11 offset:3072
buffer_load_dwordx4 v15, s[44:47], s67 offen lds
v_max_f32 v95, 0, v95
v_mfma_f32_16x16x32_bf16 v[32:35], a[208:211], v[184:187], v[32:35]
ds_read_b64_tr_b16 a[194:195], v11 offset:3584
v_mul_f32 v92, v92, v124
v_mul_f32 v93, v93, v125
v_mfma_f32_16x16x32_bf16 v[36:39], a[212:215], v[180:183], v[36:39]
ds_read_b64_tr_b16 a[196:197], v12 offset:3072
v_mul_f32 v94, v94, v126
v_mfma_f32_16x16x32_bf16 v[40:43], a[212:215], v[184:187], v[40:43]
ds_read_b64_tr_b16 a[198:199], v12 offset:3584
buffer_load_dwordx4 v15, s[48:51], s67 offen offset:1024 lds
v_mfma_f32_16x16x32_bf16 v[44:47], a[216:219], v[180:183], v[44:47]
ds_read_b64_tr_b16 a[200:201], v13 offset:3072
v_mul_f32 v95, v95, v127
v_mfma_f32_16x16x32_bf16 v[48:51], a[216:219], v[184:187], v[48:51]
ds_read_b64_tr_b16 a[202:203], v13 offset:3584
v_cvt_pk_bf16_f32 v220, v92, v93
v_mfma_f32_16x16x32_bf16 v[52:55], a[220:223], v[180:183], v[52:55]
ds_read_b64_tr_b16 a[204:205], v14 offset:3072
v_cvt_pk_bf16_f32 v221, v94, v95
v_mfma_f32_16x16x32_bf16 v[56:59], a[220:223], v[184:187], v[56:59]
ds_read_b64_tr_b16 a[206:207], v14 offset:3584
s_waitcnt lgkmcnt(8)
v_mfma_f32_16x16x32_bf16 v[28:31], a[224:227], v[188:191], v[28:31]
s_waitcnt vmcnt(43)
s_barrier
ds_read_b64_tr_b16 a[208:209], v11 offset:4096
v_mfma_f32_16x16x32_bf16 v[32:35], a[224:227], v[192:195], v[32:35]
ds_read_b64_tr_b16 a[210:211], v11 offset:4608
s_add_u32 m0, s64, 34816
v_mfma_f32_16x16x32_bf16 v[36:39], a[228:231], v[188:191], v[36:39]
ds_read_b64_tr_b16 a[212:213], v12 offset:4096
s_add_u32 s67, s97, 0
buffer_load_dwordx4 v15, s[44:47], s67 offen lds
v_mfma_f32_16x16x32_bf16 v[40:43], a[228:231], v[192:195], v[40:43]
ds_read_b64_tr_b16 a[214:215], v12 offset:4608
v_max_f32 v96, 0, v96
v_max_f32 v97, 0, v97
v_mfma_f32_16x16x32_bf16 v[44:47], a[232:235], v[188:191], v[44:47]
ds_read_b64_tr_b16 a[216:217], v13 offset:4096
v_max_f32 v98, 0, v98
v_mfma_f32_16x16x32_bf16 v[48:51], a[232:235], v[192:195], v[48:51]
ds_read_b64_tr_b16 a[218:219], v13 offset:4608
buffer_load_dwordx4 v15, s[48:51], s67 offen offset:1024 lds
v_mfma_f32_16x16x32_bf16 v[52:55], a[236:239], v[188:191], v[52:55]
ds_read_b64_tr_b16 a[220:221], v14 offset:4096
s_add_u32 m0, s64, 36864
s_add_u32 s67, s13, 73728
v_mfma_f32_16x16x32_bf16 v[56:59], a[236:239], v[192:195], v[56:59]
ds_read_b64_tr_b16 a[222:223], v14 offset:4608
v_max_f32 v99, 0, v99
s_waitcnt lgkmcnt(8)
v_mfma_f32_16x16x32_bf16 v[28:31], a[192:195], v[196:199], v[28:31]
ds_read_b64_tr_b16 a[224:225], v11 offset:5120
buffer_load_dwordx4 v15, s[44:47], s67 offen lds
v_mul_f32 v96, v96, v128
v_mfma_f32_16x16x32_bf16 v[32:35], a[192:195], v[200:203], v[32:35]
ds_read_b64_tr_b16 a[226:227], v11 offset:5632
v_mul_f32 v97, v97, v129
v_mul_f32 v98, v98, v130
v_mfma_f32_16x16x32_bf16 v[36:39], a[196:199], v[196:199], v[36:39]
ds_read_b64_tr_b16 a[228:229], v12 offset:5120
v_mul_f32 v99, v99, v131
v_mfma_f32_16x16x32_bf16 v[40:43], a[196:199], v[200:203], v[40:43]
ds_read_b64_tr_b16 a[230:231], v12 offset:5632
buffer_load_dwordx4 v15, s[48:51], s67 offen offset:1024 lds
v_mfma_f32_16x16x32_bf16 v[44:47], a[200:203], v[196:199], v[44:47]
ds_read_b64_tr_b16 a[232:233], v13 offset:5120
v_cvt_pk_bf16_f32 v224, v96, v97
v_mfma_f32_16x16x32_bf16 v[48:51], a[200:203], v[200:203], v[48:51]
ds_read_b64_tr_b16 a[234:235], v13 offset:5632
v_cvt_pk_bf16_f32 v225, v98, v99
v_mfma_f32_16x16x32_bf16 v[52:55], a[204:207], v[196:199], v[52:55]
ds_read_b64_tr_b16 a[236:237], v14 offset:5120
v_max_f32 v100, 0, v100
v_mfma_f32_16x16x32_bf16 v[56:59], a[204:207], v[200:203], v[56:59]
ds_read_b64_tr_b16 a[238:239], v14 offset:5632
s_waitcnt lgkmcnt(8)
v_mfma_f32_16x16x32_bf16 v[28:31], a[208:211], v[204:207], v[28:31]
ds_read_b64_tr_b16 a[192:193], v11 offset:6144
s_add_u32 m0, s64, 38912
v_mfma_f32_16x16x32_bf16 v[32:35], a[208:211], v[208:211], v[32:35]
ds_read_b64_tr_b16 a[194:195], v11 offset:6656
s_add_u32 s67, s97, 73728
v_mfma_f32_16x16x32_bf16 v[36:39], a[212:215], v[204:207], v[36:39]
ds_read_b64_tr_b16 a[196:197], v12 offset:6144
buffer_load_dwordx4 v15, s[44:47], s67 offen lds
v_mfma_f32_16x16x32_bf16 v[40:43], a[212:215], v[208:211], v[40:43]
ds_read_b64_tr_b16 a[198:199], v12 offset:6656
v_max_f32 v101, 0, v101
v_mfma_f32_16x16x32_bf16 v[44:47], a[216:219], v[204:207], v[44:47]
ds_read_b64_tr_b16 a[200:201], v13 offset:6144
v_max_f32 v102, 0, v102
v_mfma_f32_16x16x32_bf16 v[48:51], a[216:219], v[208:211], v[48:51]
ds_read_b64_tr_b16 a[202:203], v13 offset:6656
buffer_load_dwordx4 v15, s[48:51], s67 offen offset:1024 lds
v_mfma_f32_16x16x32_bf16 v[52:55], a[220:223], v[204:207], v[52:55]
ds_read_b64_tr_b16 a[204:205], v14 offset:6144
v_max_f32 v103, 0, v103
v_mfma_f32_16x16x32_bf16 v[56:59], a[220:223], v[208:211], v[56:59]
ds_read_b64_tr_b16 a[206:207], v14 offset:6656
s_waitcnt lgkmcnt(8)
v_mfma_f32_16x16x32_bf16 v[28:31], a[224:227], v[212:215], v[28:31]
ds_read_b64_tr_b16 a[208:209], v11 offset:7168
v_mul_f32 v100, v100, v132
v_mfma_f32_16x16x32_bf16 v[32:35], a[224:227], v[216:219], v[32:35]
ds_read_b64_tr_b16 a[210:211], v11 offset:7680
v_mul_f32 v101, v101, v133
v_mfma_f32_16x16x32_bf16 v[36:39], a[228:231], v[212:215], v[36:39]
ds_read_b64_tr_b16 a[212:213], v12 offset:7168
v_mul_f32 v102, v102, v134
v_mfma_f32_16x16x32_bf16 v[40:43], a[228:231], v[216:219], v[40:43]
ds_read_b64_tr_b16 a[214:215], v12 offset:7680
v_mul_f32 v103, v103, v135
v_mfma_f32_16x16x32_bf16 v[44:47], a[232:235], v[212:215], v[44:47]
ds_read_b64_tr_b16 a[216:217], v13 offset:7168
v_cvt_pk_bf16_f32 v222, v100, v101
v_mfma_f32_16x16x32_bf16 v[48:51], a[232:235], v[216:219], v[48:51]
ds_read_b64_tr_b16 a[218:219], v13 offset:7680
v_cvt_pk_bf16_f32 v223, v102, v103
v_mfma_f32_16x16x32_bf16 v[52:55], a[236:239], v[212:215], v[52:55]
ds_read_b64_tr_b16 a[220:221], v14 offset:7168
buffer_store_dwordx4 v[220:223], v20, s[32:35], s21 offen offset:0 sc1
v_mfma_f32_16x16x32_bf16 v[56:59], a[236:239], v[216:219], v[56:59]
ds_read_b64_tr_b16 a[222:223], v14 offset:7680
s_waitcnt lgkmcnt(8)
v_mfma_f32_16x16x32_bf16 v[28:31], a[192:195], v[156:159], v[28:31]
ds_read_b64_tr_b16 a[224:225], v11 offset:8192
s_add_u32 m0, s64, 0
v_mfma_f32_16x16x32_bf16 v[32:35], a[192:195], v[160:163], v[32:35]
ds_read_b64_tr_b16 a[226:227], v11 offset:8704
s_add_u32 s67, s13, 147456
v_mfma_f32_16x16x32_bf16 v[36:39], a[196:199], v[156:159], v[36:39]
ds_read_b64_tr_b16 a[228:229], v12 offset:8192
buffer_load_dwordx4 v15, s[44:47], s67 offen lds
v_max_f32 v104, 0, v104
v_mfma_f32_16x16x32_bf16 v[40:43], a[196:199], v[160:163], v[40:43]
ds_read_b64_tr_b16 a[230:231], v12 offset:8704
v_max_f32 v105, 0, v105
v_mfma_f32_16x16x32_bf16 v[44:47], a[200:203], v[156:159], v[44:47]
ds_read_b64_tr_b16 a[232:233], v13 offset:8192
v_max_f32 v106, 0, v106
v_mfma_f32_16x16x32_bf16 v[48:51], a[200:203], v[160:163], v[48:51]
ds_read_b64_tr_b16 a[234:235], v13 offset:8704
buffer_load_dwordx4 v15, s[48:51], s67 offen offset:1024 lds
v_mfma_f32_16x16x32_bf16 v[52:55], a[204:207], v[156:159], v[52:55]
ds_read_b64_tr_b16 a[236:237], v14 offset:8192
v_max_f32 v107, 0, v107
v_mfma_f32_16x16x32_bf16 v[56:59], a[204:207], v[160:163], v[56:59]
ds_read_b64_tr_b16 a[238:239], v14 offset:8704
s_waitcnt lgkmcnt(8)
v_mfma_f32_16x16x32_bf16 v[28:31], a[208:211], v[164:167], v[28:31]
ds_read_b64_tr_b16 a[192:193], v11 offset:9216
v_mul_f32 v104, v104, v136
v_mfma_f32_16x16x32_bf16 v[32:35], a[208:211], v[168:171], v[32:35]
ds_read_b64_tr_b16 a[194:195], v11 offset:9728
v_mul_f32 v105, v105, v137
v_mfma_f32_16x16x32_bf16 v[36:39], a[212:215], v[164:167], v[36:39]
ds_read_b64_tr_b16 a[196:197], v12 offset:9216
v_mul_f32 v106, v106, v138
v_mfma_f32_16x16x32_bf16 v[40:43], a[212:215], v[168:171], v[40:43]
ds_read_b64_tr_b16 a[198:199], v12 offset:9728
v_mul_f32 v107, v107, v139
v_mfma_f32_16x16x32_bf16 v[44:47], a[216:219], v[164:167], v[44:47]
ds_read_b64_tr_b16 a[200:201], v13 offset:9216
v_cvt_pk_bf16_f32 v226, v104, v105
v_mfma_f32_16x16x32_bf16 v[48:51], a[216:219], v[168:171], v[48:51]
ds_read_b64_tr_b16 a[202:203], v13 offset:9728
v_cvt_pk_bf16_f32 v227, v106, v107
v_mfma_f32_16x16x32_bf16 v[52:55], a[220:223], v[164:167], v[52:55]
ds_read_b64_tr_b16 a[204:205], v14 offset:9216
buffer_store_dwordx4 v[224:227], v20, s[32:35], s21 offen offset:1024 sc1
v_mfma_f32_16x16x32_bf16 v[56:59], a[220:223], v[168:171], v[56:59]
ds_read_b64_tr_b16 a[206:207], v14 offset:9728
s_waitcnt lgkmcnt(8)
v_mfma_f32_16x16x32_bf16 v[60:63], a[224:227], v[172:175], 0
s_waitcnt vmcnt(46)
s_barrier
ds_read_b64_tr_b16 a[208:209], v11 offset:10240
v_mfma_f32_16x16x32_bf16 v[64:67], a[224:227], v[176:179], 0
ds_read_b64_tr_b16 a[210:211], v11 offset:10752
s_add_u32 m0, s64, 2048
v_mfma_f32_16x16x32_bf16 v[68:71], a[228:231], v[172:175], 0
ds_read_b64_tr_b16 a[212:213], v12 offset:10240
s_add_u32 s67, s97, 147456
buffer_load_dwordx4 v15, s[44:47], s67 offen lds
v_mfma_f32_16x16x32_bf16 v[72:75], a[228:231], v[176:179], 0
ds_read_b64_tr_b16 a[214:215], v12 offset:10752
v_max_f32 v108, 0, v108
v_max_f32 v109, 0, v109
v_mfma_f32_16x16x32_bf16 v[76:79], a[232:235], v[172:175], 0
ds_read_b64_tr_b16 a[216:217], v13 offset:10240
v_max_f32 v110, 0, v110
v_mfma_f32_16x16x32_bf16 v[80:83], a[232:235], v[176:179], 0
ds_read_b64_tr_b16 a[218:219], v13 offset:10752
buffer_load_dwordx4 v15, s[48:51], s67 offen offset:1024 lds
v_mfma_f32_16x16x32_bf16 v[84:87], a[236:239], v[172:175], 0
ds_read_b64_tr_b16 a[220:221], v14 offset:10240
v_max_f32 v111, 0, v111
v_mfma_f32_16x16x32_bf16 v[88:91], a[236:239], v[176:179], 0
ds_read_b64_tr_b16 a[222:223], v14 offset:10752
s_waitcnt lgkmcnt(8)
v_mfma_f32_16x16x32_bf16 v[60:63], a[192:195], v[180:183], v[60:63]
ds_read_b64_tr_b16 a[224:225], v11 offset:11264
v_mul_f32 v108, v108, v140
v_mfma_f32_16x16x32_bf16 v[64:67], a[192:195], v[184:187], v[64:67]
ds_read_b64_tr_b16 a[226:227], v11 offset:11776
v_mul_f32 v109, v109, v141
v_mfma_f32_16x16x32_bf16 v[68:71], a[196:199], v[180:183], v[68:71]
ds_read_b64_tr_b16 a[228:229], v12 offset:11264
v_mul_f32 v110, v110, v142
v_mfma_f32_16x16x32_bf16 v[72:75], a[196:199], v[184:187], v[72:75]
ds_read_b64_tr_b16 a[230:231], v12 offset:11776
v_mul_f32 v111, v111, v143
v_mfma_f32_16x16x32_bf16 v[76:79], a[200:203], v[180:183], v[76:79]
ds_read_b64_tr_b16 a[232:233], v13 offset:11264
v_cvt_pk_bf16_f32 v228, v108, v109
v_mfma_f32_16x16x32_bf16 v[80:83], a[200:203], v[184:187], v[80:83]
ds_read_b64_tr_b16 a[234:235], v13 offset:11776
v_cvt_pk_bf16_f32 v229, v110, v111
v_mfma_f32_16x16x32_bf16 v[84:87], a[204:207], v[180:183], v[84:87]
ds_read_b64_tr_b16 a[236:237], v14 offset:11264
v_max_f32 v112, 0, v112
v_mfma_f32_16x16x32_bf16 v[88:91], a[204:207], v[184:187], v[88:91]
ds_read_b64_tr_b16 a[238:239], v14 offset:11776
s_waitcnt lgkmcnt(8)
v_mfma_f32_16x16x32_bf16 v[60:63], a[208:211], v[188:191], v[60:63]
ds_read_b64_tr_b16 a[192:193], v11 offset:12288
s_add_u32 m0, s64, 4096
v_mfma_f32_16x16x32_bf16 v[64:67], a[208:211], v[192:195], v[64:67]
ds_read_b64_tr_b16 a[194:195], v11 offset:12800
s_add_u32 s67, s11, 221184
v_mfma_f32_16x16x32_bf16 v[68:71], a[212:215], v[188:191], v[68:71]
ds_read_b64_tr_b16 a[196:197], v12 offset:12288
buffer_load_dwordx4 v15, s[44:47], s67 offen lds
v_mfma_f32_16x16x32_bf16 v[72:75], a[212:215], v[192:195], v[72:75]
ds_read_b64_tr_b16 a[198:199], v12 offset:12800
v_max_f32 v113, 0, v113
v_mfma_f32_16x16x32_bf16 v[76:79], a[216:219], v[188:191], v[76:79]
ds_read_b64_tr_b16 a[200:201], v13 offset:12288
v_max_f32 v114, 0, v114
v_mfma_f32_16x16x32_bf16 v[80:83], a[216:219], v[192:195], v[80:83]
ds_read_b64_tr_b16 a[202:203], v13 offset:12800
buffer_load_dwordx4 v15, s[48:51], s67 offen offset:1024 lds
v_mfma_f32_16x16x32_bf16 v[84:87], a[220:223], v[188:191], v[84:87]
ds_read_b64_tr_b16 a[204:205], v14 offset:12288
v_max_f32 v115, 0, v115
v_mfma_f32_16x16x32_bf16 v[88:91], a[220:223], v[192:195], v[88:91]
ds_read_b64_tr_b16 a[206:207], v14 offset:12800
s_waitcnt lgkmcnt(8)
v_mfma_f32_16x16x32_bf16 v[60:63], a[224:227], v[196:199], v[60:63]
ds_read_b64_tr_b16 a[208:209], v11 offset:13312
v_mul_f32 v112, v112, v144
v_mfma_f32_16x16x32_bf16 v[64:67], a[224:227], v[200:203], v[64:67]
ds_read_b64_tr_b16 a[210:211], v11 offset:13824
v_mul_f32 v113, v113, v145
v_mfma_f32_16x16x32_bf16 v[68:71], a[228:231], v[196:199], v[68:71]
ds_read_b64_tr_b16 a[212:213], v12 offset:13312
v_mul_f32 v114, v114, v146
v_mfma_f32_16x16x32_bf16 v[72:75], a[228:231], v[200:203], v[72:75]
ds_read_b64_tr_b16 a[214:215], v12 offset:13824
v_mul_f32 v115, v115, v147
v_mfma_f32_16x16x32_bf16 v[76:79], a[232:235], v[196:199], v[76:79]
ds_read_b64_tr_b16 a[216:217], v13 offset:13312
v_cvt_pk_bf16_f32 v232, v112, v113
v_mfma_f32_16x16x32_bf16 v[80:83], a[232:235], v[200:203], v[80:83]
ds_read_b64_tr_b16 a[218:219], v13 offset:13824
v_cvt_pk_bf16_f32 v233, v114, v115
v_mfma_f32_16x16x32_bf16 v[84:87], a[236:239], v[196:199], v[84:87]
ds_read_b64_tr_b16 a[220:221], v14 offset:13312
v_max_f32 v116, 0, v116
v_mfma_f32_16x16x32_bf16 v[88:91], a[236:239], v[200:203], v[88:91]
ds_read_b64_tr_b16 a[222:223], v14 offset:13824
s_waitcnt vmcnt(17)
v_cmp_ne_u32 vcc, s63, v23
s_nop 1
s_and_b32 vcc_lo, vcc_lo, 3
s_cbranch_scc0 L_ok_4
s_mov_b32 s74, 200000
s_add_u32 s73, s15, 2048
L_sp_5:
buffer_load_dword v4, v7, s[32:35], s73 offen sc1
s_sub_u32 s74, s74, 1
s_waitcnt vmcnt(0)
v_cmp_ne_u32 vcc, s63, v4
s_cmp_eq_u32 s74, 0
s_cbranch_scc1 L_spd_6
s_and_b32 vcc_lo, vcc_lo, 3
s_cbranch_scc1 L_sp_5
L_spd_6:
L_ok_4:
s_waitcnt lgkmcnt(8)
v_mfma_f32_16x16x32_bf16 v[60:63], a[192:195], v[204:207], v[60:63]
s_barrier
ds_read_b64_tr_b16 a[224:225], v11 offset:14336
v_mfma_f32_16x16x32_bf16 v[64:67], a[192:195], v[208:211], v[64:67]
ds_read_b64_tr_b16 a[226:227], v11 offset:14848
s_add_u32 m0, s64, 6144
v_mfma_f32_16x16x32_bf16 v[68:71], a[196:199], v[204:207], v[68:71]
ds_read_b64_tr_b16 a[228:229], v12 offset:14336
s_add_u32 s67, s96, 221184
buffer_load_dwordx4 v15, s[44:47], s67 offen lds
v_mfma_f32_16x16x32_bf16 v[72:75], a[196:199], v[208:211], v[72:75]
ds_read_b64_tr_b16 a[230:231], v12 offset:14848
v_max_f32 v117, 0, v117
v_max_f32 v118, 0, v118
v_mfma_f32_16x16x32_bf16 v[76:79], a[200:203], v[204:207], v[76:79]
ds_read_b64_tr_b16 a[232:233], v13 offset:14336
v_max_f32 v119, 0, v119
v_mul_f32 v116, v116, v148
v_mfma_f32_16x16x32_bf16 v[80:83], a[200:203], v[208:211], v[80:83]
ds_read_b64_tr_b16 a[234:235], v13 offset:14848
buffer_load_dwordx4 v15, s[48:51], s67 offen offset:1024 lds
v_mul_f32 v117, v117, v149
v_mfma_f32_16x16x32_bf16 v[84:87], a[204:207], v[204:207], v[84:87]
ds_read_b64_tr_b16 a[236:237], v14 offset:14336
v_mul_f32 v118, v118, v150
v_mfma_f32_16x16x32_bf16 v[88:91], a[204:207], v[208:211], v[88:91]
ds_read_b64_tr_b16 a[238:239], v14 offset:14848
s_waitcnt lgkmcnt(8)
v_mfma_f32_16x16x32_bf16 v[60:63], a[208:211], v[212:215], v[60:63]
ds_read_b64_tr_b16 a[192:193], v11 offset:15360
v_mul_f32 v119, v119, v151
v_mfma_f32_16x16x32_bf16 v[64:67], a[208:211], v[216:219], v[64:67]
ds_read_b64_tr_b16 a[194:195], v11 offset:15872
v_cvt_pk_bf16_f32 v230, v116, v117
v_mfma_f32_16x16x32_bf16 v[68:71], a[212:215], v[212:215], v[68:71]
ds_read_b64_tr_b16 a[196:197], v12 offset:15360
v_cvt_pk_bf16_f32 v231, v118, v119
v_mfma_f32_16x16x32_bf16 v[72:75], a[212:215], v[216:219], v[72:75]
ds_read_b64_tr_b16 a[198:199], v12 offset:15872
buffer_store_dwordx4 v[228:231], v20, s[32:35], s21 offen offset:2048 sc1
v_mfma_f32_16x16x32_bf16 v[76:79], a[216:219], v[212:215], v[76:79]
ds_read_b64_tr_b16 a[200:201], v13 offset:15360
v_max_f32 v120, 0, v120
v_mfma_f32_16x16x32_bf16 v[80:83], a[216:219], v[216:219], v[80:83]
ds_read_b64_tr_b16 a[202:203], v13 offset:15872
s_add_u32 s80, s94, 32768
v_mfma_f32_16x16x32_bf16 v[84:87], a[220:223], v[212:215], v[84:87]
ds_read_b64_tr_b16 a[204:205], v14 offset:15360
buffer_load_dwordx4 a[0:3], v20, s[32:35], s80 offen offset:0 sc1
v_mfma_f32_16x16x32_bf16 v[88:91], a[220:223], v[216:219], v[88:91]
ds_read_b64_tr_b16 a[206:207], v14 offset:15872
s_waitcnt lgkmcnt(8)
v_mfma_f32_16x16x32_bf16 v[60:63], a[224:227], v[156:159], v[60:63]
ds_read_b64_tr_b16 a[208:209], v11 offset:16384
s_add_u32 m0, s64, 8192
v_mfma_f32_16x16x32_bf16 v[64:67], a[224:227], v[160:163], v[64:67]
ds_read_b64_tr_b16 a[210:211], v11 offset:16896
s_add_u32 s67, s11, 294912
v_mfma_f32_16x16x32_bf16 v[68:71], a[228:231], v[156:159], v[68:71]
ds_read_b64_tr_b16 a[212:213], v12 offset:16384
buffer_load_dwordx4 v15, s[44:47], s67 offen lds
v_max_f32 v121, 0, v121
v_mfma_f32_16x16x32_bf16 v[72:75], a[228:231], v[160:163], v[72:75]
ds_read_b64_tr_b16 a[214:215], v12 offset:16896
v_max_f32 v122, 0, v122
v_max_f32 v123, 0, v123
v_mfma_f32_16x16x32_bf16 v[76:79], a[232:235], v[156:159], v[76:79]
ds_read_b64_tr_b16 a[216:217], v13 offset:16384
v_mul_f32 v120, v120, v152
v_mul_f32 v121, v121, v153
v_mfma_f32_16x16x32_bf16 v[80:83], a[232:235], v[160:163], v[80:83]
ds_read_b64_tr_b16 a[218:219], v13 offset:16896
buffer_load_dwordx4 v15, s[48:51], s67 offen offset:1024 lds
v_mfma_f32_16x16x32_bf16 v[84:87], a[236:239], v[156:159], v[84:87]
ds_read_b64_tr_b16 a[220:221], v14 offset:16384
v_mul_f32 v122, v122, v154
v_mfma_f32_16x16x32_bf16 v[88:91], a[236:239], v[160:163], v[88:91]
ds_read_b64_tr_b16 a[222:223], v14 offset:16896
s_waitcnt lgkmcnt(8)
v_mfma_f32_16x16x32_bf16 v[60:63], a[192:195], v[164:167], v[60:63]
ds_read_b64_tr_b16 a[224:225], v11 offset:17408
v_mul_f32 v123, v123, v155
v_mfma_f32_16x16x32_bf16 v[64:67], a[192:195], v[168:171], v[64:67]
ds_read_b64_tr_b16 a[226:227], v11 offset:17920
v_cvt_pk_bf16_f32 v234, v120, v121
v_mfma_f32_16x16x32_bf16 v[68:71], a[196:199], v[164:167], v[68:71]
ds_read_b64_tr_b16 a[228:229], v12 offset:17408
v_cvt_pk_bf16_f32 v235, v122, v123
v_mfma_f32_16x16x32_bf16 v[72:75], a[196:199], v[168:171], v[72:75]
ds_read_b64_tr_b16 a[230:231], v12 offset:17920
buffer_store_dwordx4 v[232:235], v20, s[32:35], s21 offen offset:3072 sc1
v_mfma_f32_16x16x32_bf16 v[76:79], a[200:203], v[164:167], v[76:79]
ds_read_b64_tr_b16 a[232:233], v13 offset:17408
s_add_u32 s21, s21, 16384
v_mfma_f32_16x16x32_bf16 v[80:83], a[200:203], v[168:171], v[80:83]
ds_read_b64_tr_b16 a[234:235], v13 offset:17920
buffer_load_dwordx4 a[4:7], v20, s[32:35], s80 offen offset:1024 sc1
v_mfma_f32_16x16x32_bf16 v[84:87], a[204:207], v[164:167], v[84:87]
ds_read_b64_tr_b16 a[236:237], v14 offset:17408
buffer_load_dwordx4 a[8:11], v20, s[32:35], s80 offen offset:2048 sc1
v_mfma_f32_16x16x32_bf16 v[88:91], a[204:207], v[168:171], v[88:91]
ds_read_b64_tr_b16 a[238:239], v14 offset:17920
s_waitcnt lgkmcnt(8)
v_mfma_f32_16x16x32_bf16 v[28:31], a[208:211], v[220:223], v[28:31]
ds_read_b64_tr_b16 a[192:193], v11 offset:18432
s_add_u32 m0, s64, 10240
v_mfma_f32_16x16x32_bf16 v[32:35], a[208:211], v[224:227], v[32:35]
ds_read_b64_tr_b16 a[194:195], v11 offset:18944
s_add_u32 s67, s96, 294912
v_mfma_f32_16x16x32_bf16 v[36:39], a[212:215], v[220:223], v[36:39]
ds_read_b64_tr_b16 a[196:197], v12 offset:18432
buffer_load_dwordx4 v15, s[44:47], s67 offen lds
v_mfma_f32_16x16x32_bf16 v[40:43], a[212:215], v[224:227], v[40:43]
ds_read_b64_tr_b16 a[198:199], v12 offset:18944
buffer_load_dwordx4 a[12:15], v20, s[32:35], s80 offen offset:3072 sc1
v_mfma_f32_16x16x32_bf16 v[44:47], a[216:219], v[220:223], v[44:47]
ds_read_b64_tr_b16 a[200:201], v13 offset:18432
s_add_u32 s80, s95, 32768
v_mfma_f32_16x16x32_bf16 v[48:51], a[216:219], v[224:227], v[48:51]
ds_read_b64_tr_b16 a[202:203], v13 offset:18944
buffer_load_dwordx4 v15, s[48:51], s67 offen offset:1024 lds
v_mfma_f32_16x16x32_bf16 v[52:55], a[220:223], v[220:223], v[52:55]
ds_read_b64_tr_b16 a[204:205], v14 offset:18432
buffer_load_dwordx4 a[252:255], v255, s[56:59], s3 offen
v_mfma_f32_16x16x32_bf16 v[56:59], a[220:223], v[224:227], v[56:59]
ds_read_b64_tr_b16 a[206:207], v14 offset:18944
s_waitcnt lgkmcnt(8)
v_mfma_f32_16x16x32_bf16 v[28:31], a[224:227], v[228:231], v[28:31]
ds_read_b64_tr_b16 a[208:209], v11 offset:19456
v_mfma_f32_16x16x32_bf16 v[32:35], a[224:227], v[232:235], v[32:35]
ds_read_b64_tr_b16 a[210:211], v11 offset:19968
v_mfma_f32_16x16x32_bf16 v[36:39], a[228:231], v[228:231], v[36:39]
ds_read_b64_tr_b16 a[212:213], v12 offset:19456
v_mfma_f32_16x16x32_bf16 v[40:43], a[228:231], v[232:235], v[40:43]
ds_read_b64_tr_b16 a[214:215], v12 offset:19968
v_mfma_f32_16x16x32_bf16 v[44:47], a[232:235], v[228:231], v[44:47]
ds_read_b64_tr_b16 a[216:217], v13 offset:19456
v_mfma_f32_16x16x32_bf16 v[48:51], a[232:235], v[232:235], v[48:51]
ds_read_b64_tr_b16 a[218:219], v13 offset:19968
v_mfma_f32_16x16x32_bf16 v[52:55], a[236:239], v[228:231], v[52:55]
ds_read_b64_tr_b16 a[220:221], v14 offset:19456
v_mfma_f32_16x16x32_bf16 v[56:59], a[236:239], v[232:235], v[56:59]
ds_read_b64_tr_b16 a[222:223], v14 offset:19968
s_waitcnt lgkmcnt(8)
v_mfma_f32_16x16x32_bf16 v[60:63], a[192:195], v[220:223], v[60:63]
s_barrier
ds_read_b64_tr_b16 a[224:225], v11 offset:20480
v_mfma_f32_16x16x32_bf16 v[64:67], a[192:195], v[224:227], v[64:67]
ds_read_b64_tr_b16 a[226:227], v11 offset:20992
s_add_u32 s22, s15, 4096
buffer_store_dword v22, v21, s[32:35], s22 offen sc1
v_mfma_f32_16x16x32_bf16 v[68:71], a[196:199], v[220:223], v[68:71]
ds_read_b64_tr_b16 a[228:229], v12 offset:20480
s_add_u32 m0, s64, 12288
v_mfma_f32_16x16x32_bf16 v[72:75], a[196:199], v[224:227], v[72:75]
ds_read_b64_tr_b16 a[230:231], v12 offset:20992
s_add_u32 s67, s13, 221184
v_mfma_f32_16x16x32_bf16 v[76:79], a[200:203], v[220:223], v[76:79]
ds_read_b64_tr_b16 a[232:233], v13 offset:20480
buffer_load_dwordx4 v15, s[44:47], s67 offen lds
v_mfma_f32_16x16x32_bf16 v[80:83], a[200:203], v[224:227], v[80:83]
ds_read_b64_tr_b16 a[234:235], v13 offset:20992
buffer_load_dwordx4 a[16:19], v20, s[32:35], s80 offen offset:0 sc1
v_mfma_f32_16x16x32_bf16 v[84:87], a[204:207], v[220:223], v[84:87]
ds_read_b64_tr_b16 a[236:237], v14 offset:20480
buffer_load_dwordx4 a[20:23], v20, s[32:35], s80 offen offset:1024 sc1
v_mfma_f32_16x16x32_bf16 v[88:91], a[204:207], v[224:227], v[88:91]
ds_read_b64_tr_b16 a[238:239], v14 offset:20992
s_waitcnt lgkmcnt(8)
v_mfma_f32_16x16x32_bf16 v[60:63], a[208:211], v[228:231], v[60:63]
ds_read_b64_tr_b16 a[192:193], v11 offset:21504
buffer_load_dwordx4 v15, s[48:51], s67 offen offset:1024 lds
v_mfma_f32_16x16x32_bf16 v[64:67], a[208:211], v[232:235], v[64:67]
ds_read_b64_tr_b16 a[194:195], v11 offset:22016
v_mfma_f32_16x16x32_bf16 v[68:71], a[212:215], v[228:231], v[68:71]
ds_read_b64_tr_b16 a[196:197], v12 offset:21504
v_mfma_f32_16x16x32_bf16 v[72:75], a[212:215], v[232:235], v[72:75]
ds_read_b64_tr_b16 a[198:199], v12 offset:22016
v_mfma_f32_16x16x32_bf16 v[76:79], a[216:219], v[228:231], v[76:79]
ds_read_b64_tr_b16 a[200:201], v13 offset:21504
v_mfma_f32_16x16x32_bf16 v[80:83], a[216:219], v[232:235], v[80:83]
ds_read_b64_tr_b16 a[202:203], v13 offset:22016
v_mfma_f32_16x16x32_bf16 v[84:87], a[220:223], v[228:231], v[84:87]
ds_read_b64_tr_b16 a[204:205], v14 offset:21504
v_mfma_f32_16x16x32_bf16 v[88:91], a[220:223], v[232:235], v[88:91]
ds_read_b64_tr_b16 a[206:207], v14 offset:22016
s_waitcnt lgkmcnt(8)
v_mfma_f32_16x16x32_bf16 v[28:31], a[224:227], a[128:131], v[28:31]
ds_read_b64_tr_b16 a[208:209], v11 offset:22528
s_add_u32 m0, s64, 14336
v_mfma_f32_16x16x32_bf16 v[32:35], a[224:227], a[132:135], v[32:35]
ds_read_b64_tr_b16 a[210:211], v11 offset:23040
s_add_u32 s67, s97, 221184
v_mfma_f32_16x16x32_bf16 v[36:39], a[228:231], a[128:131], v[36:39]
ds_read_b64_tr_b16 a[212:213], v12 offset:22528
buffer_load_dwordx4 v15, s[44:47], s67 offen lds
buffer_load_dwordx4 a[24:27], v20, s[32:35], s80 offen offset:2048 sc1
v_mfma_f32_16x16x32_bf16 v[40:43], a[228:231], a[132:135], v[40:43]
ds_read_b64_tr_b16 a[214:215], v12 offset:23040
buffer_load_dwordx4 a[28:31], v20, s[32:35], s80 offen offset:3072 sc1
v_and_b32 v250, 3, v1
v_mfma_f32_16x16x32_bf16 v[44:47], a[232:235], a[128:131], v[44:47]
ds_read_b64_tr_b16 a[216:217], v13 offset:22528
v_cmp_eq_u32 vcc, 0, v250
v_cmp_eq_u32 s[74:75], 2, v250
v_mfma_f32_16x16x32_bf16 v[48:51], a[232:235], a[132:135], v[48:51]
ds_read_b64_tr_b16 a[218:219], v13 offset:23040
buffer_load_dwordx4 v15, s[48:51], s67 offen offset:1024 lds
v_mfma_f32_16x16x32_bf16 v[52:55], a[236:239], a[128:131], v[52:55]
ds_read_b64_tr_b16 a[220:221], v14 offset:22528
v_bfe_u32 v251, v1, 2, 2
v_mfma_f32_16x16x32_bf16 v[56:59], a[236:239], a[132:135], v[56:59]
ds_read_b64_tr_b16 a[222:223], v14 offset:23040
s_waitcnt lgkmcnt(8)
v_mfma_f32_16x16x32_bf16 v[28:31], a[192:195], a[136:139], v[28:31]
ds_read_b64_tr_b16 a[224:225], v11 offset:23552
v_lshrrev_b32 v252, 4, v1
v_mfma_f32_16x16x32_bf16 v[32:35], a[192:195], a[140:143], v[32:35]
ds_read_b64_tr_b16 a[226:227], v11 offset:24064
v_cndmask_b32 v236, v237, v236, vcc
v_mfma_f32_16x16x32_bf16 v[36:39], a[196:199], a[136:139], v[36:39]
ds_read_b64_tr_b16 a[228:229], v12 offset:23552
v_cndmask_b32 v238, v239, v238, s[74:75]
v_mfma_f32_16x16x32_bf16 v[40:43], a[196:199], a[140:143], v[40:43]
ds_read_b64_tr_b16 a[230:231], v12 offset:24064
v_cndmask_b32 v240, v241, v240, vcc
v_mfma_f32_16x16x32_bf16 v[44:47], a[200:203], a[136:139], v[44:47]
ds_read_b64_tr_b16 a[232:233], v13 offset:23552
v_cndmask_b32 v242, v243, v242, s[74:75]
v_mfma_f32_16x16x32_bf16 v[48:51], a[200:203], a[140:143], v[48:51]
ds_read_b64_tr_b16 a[234:235], v13 offset:24064
v_cmp_gt_u32 vcc, 2, v250
v_mfma_f32_16x16x32_bf16 v[52:55], a[204:207], a[136:139], v[52:55]
ds_read_b64_tr_b16 a[236:237], v14 offset:23552
v_cmp_eq_u32 s[74:75], v251, v252
v_mfma_f32_16x16x32_bf16 v[56:59], a[204:207], a[140:143], v[56:59]
ds_read_b64_tr_b16 a[238:239], v14 offset:24064
s_waitcnt lgkmcnt(8)
v_mfma_f32_16x16x32_bf16 v[28:31], a[208:211], a[144:147], v[28:31]
s_barrier
ds_read_b64_tr_b16 a[192:193], v11 offset:24576
v_mfma_f32_16x16x32_bf16 v[32:35], a[208:211], a[148:151], v[32:35]
ds_read_b64_tr_b16 a[194:195], v11 offset:25088
s_add_u32 m0, s64, 16384
v_mfma_f32_16x16x32_bf16 v[36:39], a[212:215], a[144:147], v[36:39]
ds_read_b64_tr_b16 a[196:197], v12 offset:24576
s_add_u32 s67, s13, 294912
buffer_load_dwordx4 v15, s[44:47], s67 offen lds
v_mfma_f32_16x16x32_bf16 v[40:43], a[212:215], a[148:151], v[40:43]
ds_read_b64_tr_b16 a[198:199], v12 offset:25088
v_cndmask_b32 v236, v238, v236, vcc
v_cndmask_b32 v240, v242, v240, vcc
v_mfma_f32_16x16x32_bf16 v[44:47], a[216:219], a[144:147], v[44:47]
ds_read_b64_tr_b16 a[200:201], v13 offset:24576
v_cndmask_b32 v236, 0, v236, s[74:75]
v_mfma_f32_16x16x32_bf16 v[48:51], a[216:219], a[148:151], v[48:51]
ds_read_b64_tr_b16 a[202:203], v13 offset:25088
buffer_load_dwordx4 v15, s[48:51], s67 offen offset:1024 lds
v_mfma_f32_16x16x32_bf16 v[52:55], a[220:223], a[144:147], v[52:55]
ds_read_b64_tr_b16 a[204:205], v14 offset:24576
v_cndmask_b32 v240, 0, v240, s[74:75]
v_mfma_f32_16x16x32_bf16 v[56:59], a[220:223], a[148:151], v[56:59]
ds_read_b64_tr_b16 a[206:207], v14 offset:25088
s_waitcnt lgkmcnt(8)
v_mfma_f32_16x16x32_bf16 v[28:31], a[224:227], a[152:155], v[28:31]
ds_read_b64_tr_b16 a[208:209], v11 offset:25600
v_mov_b32 v237, v236
v_mfma_f32_16x16x32_bf16 v[32:35], a[224:227], a[156:159], v[32:35]
ds_read_b64_tr_b16 a[210:211], v11 offset:26112
v_mov_b32 v241, v240
v_mfma_f32_16x16x32_bf16 v[36:39], a[228:231], a[152:155], v[36:39]
ds_read_b64_tr_b16 a[212:213], v12 offset:25600
v_permlane32_swap_b32 v237, v236
v_mfma_f32_16x16x32_bf16 v[40:43], a[228:231], a[156:159], v[40:43]
ds_read_b64_tr_b16 a[214:215], v12 offset:26112
v_permlane32_swap_b32 v241, v240
v_mfma_f32_16x16x32_bf16 v[44:47], a[232:235], a[152:155], v[44:47]
ds_read_b64_tr_b16 a[216:217], v13 offset:25600
v_add_f32 v236, v236, v237
v_mfma_f32_16x16x32_bf16 v[48:51], a[232:235], a[156:159], v[48:51]
ds_read_b64_tr_b16 a[218:219], v13 offset:26112
v_add_f32 v240, v240, v241
v_mfma_f32_16x16x32_bf16 v[52:55], a[236:239], a[152:155], v[52:55]
ds_read_b64_tr_b16 a[220:221], v14 offset:25600
v_mov_b32 v237, v236
v_mfma_f32_16x16x32_bf16 v[56:59], a[236:239], a[156:159], v[56:59]
ds_read_b64_tr_b16 a[222:223], v14 offset:26112
s_waitcnt lgkmcnt(8)
v_mfma_f32_16x16x32_bf16 v[28:31], a[192:195], a[160:163], v[28:31]
ds_read_b64_tr_b16 a[224:225], v11 offset:26624
s_add_u32 m0, s64, 18432
v_mfma_f32_16x16x32_bf16 v[32:35], a[192:195], a[164:167], v[32:35]
ds_read_b64_tr_b16 a[226:227], v11 offset:27136
s_add_u32 s67, s97, 294912
v_mfma_f32_16x16x32_bf16 v[36:39], a[196:199], a[160:163], v[36:39]
ds_read_b64_tr_b16 a[228:229], v12 offset:26624
buffer_load_dwordx4 v15, s[44:47], s67 offen lds
s_add_u32 s22, s15, 4096
v_mfma_f32_16x16x32_bf16 v[40:43], a[196:199], a[164:167], v[40:43]
ds_read_b64_tr_b16 a[230:231], v12 offset:27136
buffer_load_dword v23, v7, s[32:35], s22 offen sc1
v_mov_b32 v241, v240
v_mfma_f32_16x16x32_bf16 v[44:47], a[200:203], a[160:163], v[44:47]
ds_read_b64_tr_b16 a[232:233], v13 offset:26624
v_permlane16_swap_b32 v237, v236
v_permlane16_swap_b32 v241, v240
v_mfma_f32_16x16x32_bf16 v[48:51], a[200:203], a[164:167], v[48:51]
ds_read_b64_tr_b16 a[234:235], v13 offset:27136
buffer_load_dwordx4 v15, s[48:51], s67 offen offset:1024 lds
v_add_f32 v236, v236, v237
v_mfma_f32_16x16x32_bf16 v[52:55], a[204:207], a[160:163], v[52:55]
ds_read_b64_tr_b16 a[236:237], v14 offset:26624
v_add_f32 v240, v240, v241
v_mfma_f32_16x16x32_bf16 v[56:59], a[204:207], a[164:167], v[56:59]
ds_read_b64_tr_b16 a[238:239], v14 offset:27136
s_waitcnt lgkmcnt(8)
v_mfma_f32_16x16x32_bf16 v[28:31], a[208:211], a[168:171], v[28:31]
ds_read_b64_tr_b16 a[192:193], v11 offset:27648
v_mul_f32 v237, v18, v18
v_mfma_f32_16x16x32_bf16 v[32:35], a[208:211], a[172:175], v[32:35]
ds_read_b64_tr_b16 a[194:195], v11 offset:28160
v_mul_f32 v241, v19, v19
v_mfma_f32_16x16x32_bf16 v[36:39], a[212:215], a[168:171], v[36:39]
ds_read_b64_tr_b16 a[196:197], v12 offset:27648
v_mov_b32 v238, 0x3ae38e39
v_mfma_f32_16x16x32_bf16 v[40:43], a[212:215], a[172:175], v[40:43]
ds_read_b64_tr_b16 a[198:199], v12 offset:28160
v_mov_b32 v239, 0x3ae38e39
v_mfma_f32_16x16x32_bf16 v[44:47], a[216:219], a[168:171], v[44:47]
ds_read_b64_tr_b16 a[200:201], v13 offset:27648
v_fma_f32 v236, v236, v238, -v237
v_mfma_f32_16x16x32_bf16 v[48:51], a[216:219], a[172:175], v[48:51]
ds_read_b64_tr_b16 a[202:203], v13 offset:28160
v_fma_f32 v240, v240, v239, -v241
v_mfma_f32_16x16x32_bf16 v[52:55], a[220:223], a[168:171], v[52:55]
ds_read_b64_tr_b16 a[204:205], v14 offset:27648
v_max_f32 v236, 0, v236
v_mfma_f32_16x16x32_bf16 v[56:59], a[220:223], a[172:175], v[56:59]
ds_read_b64_tr_b16 a[206:207], v14 offset:28160
s_waitcnt lgkmcnt(8)
v_mfma_f32_16x16x32_bf16 v[28:31], a[224:227], a[176:179], v[28:31]
ds_read_b64_tr_b16 a[208:209], v11 offset:28672
s_add_u32 m0, s64, 20480
v_mfma_f32_16x16x32_bf16 v[32:35], a[224:227], a[180:183], v[32:35]
ds_read_b64_tr_b16 a[210:211], v11 offset:29184
s_add_u32 s67, s10, 0
v_mfma_f32_16x16x32_bf16 v[36:39], a[228:231], a[176:179], v[36:39]
ds_read_b64_tr_b16 a[212:213], v12 offset:28672
buffer_load_dwordx4 v15, s[44:47], s67 offen lds
v_max_f32 v240, 0, v240
v_mfma_f32_16x16x32_bf16 v[40:43], a[228:231], a[180:183], v[40:43]
ds_read_b64_tr_b16 a[214:215], v12 offset:29184
v_cvt_pk_bf16_f32 v236, v236, v236
v_mfma_f32_16x16x32_bf16 v[44:47], a[232:235], a[176:179], v[44:47]
ds_read_b64_tr_b16 a[216:217], v13 offset:28672
v_cvt_pk_bf16_f32 v240, v240, v240
v_mfma_f32_16x16x32_bf16 v[48:51], a[232:235], a[180:183], v[48:51]
ds_read_b64_tr_b16 a[218:219], v13 offset:29184
buffer_load_dwordx4 v15, s[48:51], s67 offen offset:1024 lds
v_mfma_f32_16x16x32_bf16 v[52:55], a[236:239], a[176:179], v[52:55]
ds_read_b64_tr_b16 a[220:221], v14 offset:28672
v_lshlrev_b32 v236, 16, v236
v_mfma_f32_16x16x32_bf16 v[56:59], a[236:239], a[180:183], v[56:59]
ds_read_b64_tr_b16 a[222:223], v14 offset:29184
s_waitcnt lgkmcnt(8)
v_mfma_f32_16x16x32_bf16 v[28:31], a[192:195], a[184:187], v[28:31]
ds_read_b64_tr_b16 a[224:225], v11 offset:29696
v_lshlrev_b32 v240, 16, v240
v_mfma_f32_16x16x32_bf16 v[32:35], a[192:195], a[188:191], v[32:35]
ds_read_b64_tr_b16 a[226:227], v11 offset:30208
v_add_f32 v236, 0x3727c5ac, v236
v_mfma_f32_16x16x32_bf16 v[36:39], a[196:199], a[184:187], v[36:39]
ds_read_b64_tr_b16 a[228:229], v12 offset:29696
v_add_f32 v240, 0x3727c5ac, v240
v_mfma_f32_16x16x32_bf16 v[40:43], a[196:199], a[188:191], v[40:43]
ds_read_b64_tr_b16 a[230:231], v12 offset:30208
v_cvt_pk_bf16_f32 v236, v236, v236
v_mfma_f32_16x16x32_bf16 v[44:47], a[200:203], a[184:187], v[44:47]
ds_read_b64_tr_b16 a[232:233], v13 offset:29696
v_cvt_pk_bf16_f32 v240, v240, v240
v_mfma_f32_16x16x32_bf16 v[48:51], a[200:203], a[188:191], v[48:51]
ds_read_b64_tr_b16 a[234:235], v13 offset:30208
v_lshlrev_b32 v236, 16, v236
v_mfma_f32_16x16x32_bf16 v[52:55], a[204:207], a[184:187], v[52:55]
ds_read_b64_tr_b16 a[236:237], v14 offset:29696
v_lshlrev_b32 v240, 16, v240
v_mfma_f32_16x16x32_bf16 v[56:59], a[204:207], a[188:191], v[56:59]
ds_read_b64_tr_b16 a[238:239], v14 offset:30208
s_waitcnt vmcnt(18)
s_waitcnt lgkmcnt(8)
v_mfma_f32_16x16x32_bf16 v[28:31], a[208:211], a[0:3], v[28:31]
s_barrier
ds_read_b64_tr_b16 a[192:193], v11 offset:30720
v_mfma_f32_16x16x32_bf16 v[32:35], a[208:211], a[4:7], v[32:35]
ds_read_b64_tr_b16 a[194:195], v11 offset:31232
s_add_u32 s22, s15, 6144
buffer_store_dword v22, v21, s[32:35], s22 offen sc1
v_mfma_f32_16x16x32_bf16 v[36:39], a[212:215], a[0:3], v[36:39]
ds_read_b64_tr_b16 a[196:197], v12 offset:30720
s_add_u32 m0, s64, 22528
s_add_u32 s67, s10, 73728
v_mfma_f32_16x16x32_bf16 v[40:43], a[212:215], a[4:7], v[40:43]
ds_read_b64_tr_b16 a[198:199], v12 offset:31232
buffer_load_dwordx4 v15, s[44:47], s67 offen lds
v_sqrt_f32 v236, v236
v_mfma_f32_16x16x32_bf16 v[44:47], a[216:219], a[0:3], v[44:47]
ds_read_b64_tr_b16 a[200:201], v13 offset:30720
v_sqrt_f32 v240, v240
v_cvt_pk_bf16_f32 v236, v236, v236
v_mfma_f32_16x16x32_bf16 v[48:51], a[216:219], a[4:7], v[48:51]
ds_read_b64_tr_b16 a[202:203], v13 offset:31232
v_cvt_pk_bf16_f32 v240, v240, v240
v_lshlrev_b32 v236, 16, v236
v_mfma_f32_16x16x32_bf16 v[52:55], a[220:223], a[0:3], v[52:55]
ds_read_b64_tr_b16 a[204:205], v14 offset:30720
buffer_load_dwordx4 v15, s[48:51], s67 offen offset:1024 lds
v_mfma_f32_16x16x32_bf16 v[56:59], a[220:223], a[4:7], v[56:59]
ds_read_b64_tr_b16 a[206:207], v14 offset:31232
s_waitcnt lgkmcnt(8)
v_mfma_f32_16x16x32_bf16 v[28:31], a[224:227], a[8:11], v[28:31]
ds_read_b64_tr_b16 a[208:209], v11 offset:31744
v_lshlrev_b32 v240, 16, v240
v_mfma_f32_16x16x32_bf16 v[32:35], a[224:227], a[12:15], v[32:35]
ds_read_b64_tr_b16 a[210:211], v11 offset:32256
v_mul_f32 v236, v236, v236
v_mfma_f32_16x16x32_bf16 v[36:39], a[228:231], a[8:11], v[36:39]
ds_read_b64_tr_b16 a[212:213], v12 offset:31744
v_mul_f32 v240, v240, v240
v_mfma_f32_16x16x32_bf16 v[40:43], a[228:231], a[12:15], v[40:43]
ds_read_b64_tr_b16 a[214:215], v12 offset:32256
v_rcp_f32 v238, v236
v_mfma_f32_16x16x32_bf16 v[44:47], a[232:235], a[8:11], v[44:47]
ds_read_b64_tr_b16 a[216:217], v13 offset:31744
v_rcp_f32 v239, v240
v_mfma_f32_16x16x32_bf16 v[48:51], a[232:235], a[12:15], v[48:51]
ds_read_b64_tr_b16 a[218:219], v13 offset:32256
v_mul_f32 v240, 0xbfb8aa3b, v238
v_mfma_f32_16x16x32_bf16 v[52:55], a[236:239], a[8:11], v[52:55]
ds_read_b64_tr_b16 a[220:221], v14 offset:31744
v_mul_f32 v241, 0xbfb8aa3b, v239
v_mfma_f32_16x16x32_bf16 v[56:59], a[236:239], a[12:15], v[56:59]
ds_read_b64_tr_b16 a[222:223], v14 offset:32256
s_waitcnt vmcnt(6)
v_cmp_ne_u32 vcc, s63, v23
s_nop 1
s_and_b32 vcc_lo, vcc_lo, 3
s_cbranch_scc0 L_ok_7
s_mov_b32 s74, 200000
s_add_u32 s73, s15, 4096
L_sp_8:
buffer_load_dword v4, v7, s[32:35], s73 offen sc1
s_sub_u32 s74, s74, 1
s_waitcnt vmcnt(0)
v_cmp_ne_u32 vcc, s63, v4
s_cmp_eq_u32 s74, 0
s_cbranch_scc1 L_spd_9
s_and_b32 vcc_lo, vcc_lo, 3
s_cbranch_scc1 L_sp_8
L_spd_9:
L_ok_7:
s_waitcnt lgkmcnt(8)
v_mfma_f32_16x16x32_bf16 v[28:31], a[192:195], a[16:19], v[28:31]
ds_read_b64_tr_b16 a[224:225], v11 offset:32768
s_add_u32 m0, s64, 24576
v_mfma_f32_16x16x32_bf16 v[32:35], a[192:195], a[20:23], v[32:35]
ds_read_b64_tr_b16 a[226:227], v11 offset:33280
s_add_u32 s67, s10, 147456
v_mfma_f32_16x16x32_bf16 v[36:39], a[196:199], a[16:19], v[36:39]
ds_read_b64_tr_b16 a[228:229], v12 offset:32768
buffer_load_dwordx4 v15, s[44:47], s67 offen lds
v_mfma_f32_16x16x32_bf16 v[40:43], a[196:199], a[20:23], v[40:43]
ds_read_b64_tr_b16 a[230:231], v12 offset:33280
s_add_u32 s80, s94, 49152
v_mfma_f32_16x16x32_bf16 v[44:47], a[200:203], a[16:19], v[44:47]
ds_read_b64_tr_b16 a[232:233], v13 offset:32768
buffer_load_dwordx4 a[32:35], v20, s[32:35], s80 offen offset:0 sc1
v_mfma_f32_16x16x32_bf16 v[48:51], a[200:203], a[20:23], v[48:51]
ds_read_b64_tr_b16 a[234:235], v13 offset:33280
buffer_load_dwordx4 v15, s[48:51], s67 offen offset:1024 lds
v_mfma_f32_16x16x32_bf16 v[52:55], a[204:207], a[16:19], v[52:55]
ds_read_b64_tr_b16 a[236:237], v14 offset:32768
v_mfma_f32_16x16x32_bf16 v[56:59], a[204:207], a[20:23], v[56:59]
ds_read_b64_tr_b16 a[238:239], v14 offset:33280
s_waitcnt lgkmcnt(8)
v_mfma_f32_16x16x32_bf16 v[28:31], a[208:211], a[24:27], v[28:31]
ds_read_b64_tr_b16 a[192:193], v11 offset:33792
v_mfma_f32_16x16x32_bf16 v[32:35], a[208:211], a[28:31], v[32:35]
ds_read_b64_tr_b16 a[194:195], v11 offset:34304
v_mfma_f32_16x16x32_bf16 v[36:39], a[212:215], a[24:27], v[36:39]
ds_read_b64_tr_b16 a[196:197], v12 offset:33792
v_mfma_f32_16x16x32_bf16 v[40:43], a[212:215], a[28:31], v[40:43]
ds_read_b64_tr_b16 a[198:199], v12 offset:34304
v_mfma_f32_16x16x32_bf16 v[44:47], a[216:219], a[24:27], v[44:47]
ds_read_b64_tr_b16 a[200:201], v13 offset:33792
v_mfma_f32_16x16x32_bf16 v[48:51], a[216:219], a[28:31], v[48:51]
ds_read_b64_tr_b16 a[202:203], v13 offset:34304
v_mfma_f32_16x16x32_bf16 v[52:55], a[220:223], a[24:27], v[52:55]
ds_read_b64_tr_b16 a[204:205], v14 offset:33792
v_mfma_f32_16x16x32_bf16 v[56:59], a[220:223], a[28:31], v[56:59]
ds_read_b64_tr_b16 a[206:207], v14 offset:34304
s_waitcnt lgkmcnt(8)
v_mfma_f32_16x16x32_bf16 v[60:63], a[224:227], a[128:131], v[60:63]
s_barrier
ds_read_b64_tr_b16 a[208:209], v11 offset:34816
v_mfma_f32_16x16x32_bf16 v[64:67], a[224:227], a[132:135], v[64:67]
ds_read_b64_tr_b16 a[210:211], v11 offset:35328
s_add_u32 m0, s64, 26624
v_mfma_f32_16x16x32_bf16 v[68:71], a[228:231], a[128:131], v[68:71]
ds_read_b64_tr_b16 a[212:213], v12 offset:34816
s_add_u32 s67, s10, 221184
v_mfma_f32_16x16x32_bf16 v[72:75], a[228:231], a[132:135], v[72:75]
ds_read_b64_tr_b16 a[214:215], v12 offset:35328
buffer_load_dwordx4 v15, s[44:47], s67 offen lds
v_mfma_f32_16x16x32_bf16 v[76:79], a[232:235], a[128:131], v[76:79]
ds_read_b64_tr_b16 a[216:217], v13 offset:34816
buffer_load_dwordx4 a[36:39], v20, s[32:35], s80 offen offset:1024 sc1
v_mfma_f32_16x16x32_bf16 v[80:83], a[232:235], a[132:135], v[80:83]
ds_read_b64_tr_b16 a[218:219], v13 offset:35328
buffer_load_dwordx4 a[40:43], v20, s[32:35], s80 offen offset:2048 sc1
v_mfma_f32_16x16x32_bf16 v[84:87], a[236:239], a[128:131], v[84:87]
ds_read_b64_tr_b16 a[220:221], v14 offset:34816
buffer_load_dwordx4 v15, s[48:51], s67 offen offset:1024 lds
v_mfma_f32_16x16x32_bf16 v[88:91], a[236:239], a[132:135], v[88:91]
ds_read_b64_tr_b16 a[222:223], v14 offset:35328
s_waitcnt lgkmcnt(8)
v_mfma_f32_16x16x32_bf16 v[60:63], a[192:195], a[136:139], v[60:63]
ds_read_b64_tr_b16 a[224:225], v11 offset:35840
v_mfma_f32_16x16x32_bf16 v[64:67], a[192:195], a[140:143], v[64:67]
ds_read_b64_tr_b16 a[226:227], v11 offset:36352
v_mfma_f32_16x16x32_bf16 v[68:71], a[196:199], a[136:139], v[68:71]
ds_read_b64_tr_b16 a[228:229], v12 offset:35840
v_mfma_f32_16x16x32_bf16 v[72:75], a[196:199], a[140:143], v[72:75]
ds_read_b64_tr_b16 a[230:231], v12 offset:36352
v_mfma_f32_16x16x32_bf16 v[76:79], a[200:203], a[136:139], v[76:79]
ds_read_b64_tr_b16 a[232:233], v13 offset:35840
v_mfma_f32_16x16x32_bf16 v[80:83], a[200:203], a[140:143], v[80:83]
ds_read_b64_tr_b16 a[234:235], v13 offset:36352
v_mfma_f32_16x16x32_bf16 v[84:87], a[204:207], a[136:139], v[84:87]
ds_read_b64_tr_b16 a[236:237], v14 offset:35840
v_mfma_f32_16x16x32_bf16 v[88:91], a[204:207], a[140:143], v[88:91]
ds_read_b64_tr_b16 a[238:239], v14 offset:36352
s_waitcnt lgkmcnt(8)
v_mfma_f32_16x16x32_bf16 v[60:63], a[208:211], a[144:147], v[60:63]
ds_read_b64_tr_b16 a[192:193], v11 offset:36864
s_add_u32 m0, s64, 28672
v_mfma_f32_16x16x32_bf16 v[64:67], a[208:211], a[148:151], v[64:67]
ds_read_b64_tr_b16 a[194:195], v11 offset:37376
s_add_u32 s67, s10, 294912
v_mfma_f32_16x16x32_bf16 v[68:71], a[212:215], a[144:147], v[68:71]
ds_read_b64_tr_b16 a[196:197], v12 offset:36864
buffer_load_dwordx4 v15, s[44:47], s67 offen lds
v_mfma_f32_16x16x32_bf16 v[72:75], a[212:215], a[148:151], v[72:75]
ds_read_b64_tr_b16 a[198:199], v12 offset:37376
buffer_load_dwordx4 a[44:47], v20, s[32:35], s80 offen offset:3072 sc1
v_mfma_f32_16x16x32_bf16 v[76:79], a[216:219], a[144:147], v[76:79]
ds_read_b64_tr_b16 a[200:201], v13 offset:36864
s_add_u32 s80, s95, 49152
v_mfma_f32_16x16x32_bf16 v[80:83], a[216:219], a[148:151], v[80:83]
ds_read_b64_tr_b16 a[202:203], v13 offset:37376
buffer_load_dwordx4 v15, s[48:51], s67 offen offset:1024 lds
v_mfma_f32_16x16x32_bf16 v[84:87], a[220:223], a[144:147], v[84:87]
ds_read_b64_tr_b16 a[204:205], v14 offset:36864
s_add_u32 s22, s15, 6144
v_mfma_f32_16x16x32_bf16 v[88:91], a[220:223], a[148:151], v[88:91]
ds_read_b64_tr_b16 a[206:207], v14 offset:37376
s_waitcnt lgkmcnt(8)
v_mfma_f32_16x16x32_bf16 v[60:63], a[224:227], a[152:155], v[60:63]
ds_read_b64_tr_b16 a[208:209], v11 offset:37888
buffer_load_dword v23, v7, s[32:35], s22 offen sc1
v_mfma_f32_16x16x32_bf16 v[64:67], a[224:227], a[156:159], v[64:67]
ds_read_b64_tr_b16 a[210:211], v11 offset:38400
v_mfma_f32_16x16x32_bf16 v[68:71], a[228:231], a[152:155], v[68:71]
ds_read_b64_tr_b16 a[212:213], v12 offset:37888
v_mfma_f32_16x16x32_bf16 v[72:75], a[228:231], a[156:159], v[72:75]
ds_read_b64_tr_b16 a[214:215], v12 offset:38400
v_mfma_f32_16x16x32_bf16 v[76:79], a[232:235], a[152:155], v[76:79]
ds_read_b64_tr_b16 a[216:217], v13 offset:37888
v_mfma_f32_16x16x32_bf16 v[80:83], a[232:235], a[156:159], v[80:83]
ds_read_b64_tr_b16 a[218:219], v13 offset:38400
v_mfma_f32_16x16x32_bf16 v[84:87], a[236:239], a[152:155], v[84:87]
ds_read_b64_tr_b16 a[220:221], v14 offset:37888
v_mfma_f32_16x16x32_bf16 v[88:91], a[236:239], a[156:159], v[88:91]
ds_read_b64_tr_b16 a[222:223], v14 offset:38400
s_waitcnt lgkmcnt(8)
v_mfma_f32_16x16x32_bf16 v[60:63], a[192:195], a[160:163], v[60:63]
ds_read_b64_tr_b16 a[224:225], v11 offset:38912
s_add_u32 m0, s64, 30720
v_mfma_f32_16x16x32_bf16 v[64:67], a[192:195], a[164:167], v[64:67]
ds_read_b64_tr_b16 a[226:227], v11 offset:39424
s_add_u32 s67, s16, 0
v_mfma_f32_16x16x32_bf16 v[68:71], a[196:199], a[160:163], v[68:71]
ds_read_b64_tr_b16 a[228:229], v12 offset:38912
buffer_load_dwordx4 v15, s[44:47], s67 offen lds
v_mfma_f32_16x16x32_bf16 v[72:75], a[196:199], a[164:167], v[72:75]
ds_read_b64_tr_b16 a[230:231], v12 offset:39424
buffer_load_dwordx4 a[48:51], v20, s[32:35], s80 offen offset:0 sc1
v_mfma_f32_16x16x32_bf16 v[76:79], a[200:203], a[160:163], v[76:79]
ds_read_b64_tr_b16 a[232:233], v13 offset:38912
buffer_load_dwordx4 a[52:55], v20, s[32:35], s80 offen offset:1024 sc1
v_mfma_f32_16x16x32_bf16 v[80:83], a[200:203], a[164:167], v[80:83]
ds_read_b64_tr_b16 a[234:235], v13 offset:39424
buffer_load_dwordx4 v15, s[48:51], s67 offen offset:1024 lds
v_mfma_f32_16x16x32_bf16 v[84:87], a[204:207], a[160:163], v[84:87]
ds_read_b64_tr_b16 a[236:237], v14 offset:38912
v_mfma_f32_16x16x32_bf16 v[88:91], a[204:207], a[164:167], v[88:91]
ds_read_b64_tr_b16 a[238:239], v14 offset:39424
s_waitcnt lgkmcnt(8)
v_mfma_f32_16x16x32_bf16 v[60:63], a[208:211], a[168:171], v[60:63]
ds_read_b64_tr_b16 a[192:193], v11 offset:39936
v_mfma_f32_16x16x32_bf16 v[64:67], a[208:211], a[172:175], v[64:67]
ds_read_b64_tr_b16 a[194:195], v11 offset:40448
v_mfma_f32_16x16x32_bf16 v[68:71], a[212:215], a[168:171], v[68:71]
ds_read_b64_tr_b16 a[196:197], v12 offset:39936
v_mfma_f32_16x16x32_bf16 v[72:75], a[212:215], a[172:175], v[72:75]
ds_read_b64_tr_b16 a[198:199], v12 offset:40448
v_mfma_f32_16x16x32_bf16 v[76:79], a[216:219], a[168:171], v[76:79]
ds_read_b64_tr_b16 a[200:201], v13 offset:39936
v_mfma_f32_16x16x32_bf16 v[80:83], a[216:219], a[172:175], v[80:83]
ds_read_b64_tr_b16 a[202:203], v13 offset:40448
v_mfma_f32_16x16x32_bf16 v[84:87], a[220:223], a[168:171], v[84:87]
ds_read_b64_tr_b16 a[204:205], v14 offset:39936
v_mfma_f32_16x16x32_bf16 v[88:91], a[220:223], a[172:175], v[88:91]
ds_read_b64_tr_b16 a[206:207], v14 offset:40448
s_waitcnt lgkmcnt(8)
v_mfma_f32_16x16x32_bf16 v[60:63], a[224:227], a[176:179], v[60:63]
s_barrier
ds_read_b64_tr_b16 a[208:209], v11 offset:0
v_mfma_f32_16x16x32_bf16 v[64:67], a[224:227], a[180:183], v[64:67]
ds_read_b64_tr_b16 a[210:211], v11 offset:512
s_add_u32 m0, s64, 32768
v_mfma_f32_16x16x32_bf16 v[68:71], a[228:231], a[176:179], v[68:71]
ds_read_b64_tr_b16 a[212:213], v12 offset:0
s_add_u32 s67, s98, 0
v_mfma_f32_16x16x32_bf16 v[72:75], a[228:231], a[180:183], v[72:75]
ds_read_b64_tr_b16 a[214:215], v12 offset:512
buffer_load_dwordx4 v15, s[44:47], s67 offen lds
v_mfma_f32_16x16x32_bf16 v[76:79], a[232:235], a[176:179], v[76:79]
ds_read_b64_tr_b16 a[216:217], v13 offset:0
buffer_load_dwordx4 a[56:59], v20, s[32:35], s80 offen offset:2048 sc1
v_mfma_f32_16x16x32_bf16 v[80:83], a[232:235], a[180:183], v[80:83]
ds_read_b64_tr_b16 a[218:219], v13 offset:512
buffer_load_dwordx4 a[60:63], v20, s[32:35], s80 offen offset:3072 sc1
v_mfma_f32_16x16x32_bf16 v[84:87], a[236:239], a[176:179], v[84:87]
ds_read_b64_tr_b16 a[220:221], v14 offset:0
buffer_load_dwordx4 v15, s[48:51], s67 offen offset:1024 lds
v_mfma_f32_16x16x32_bf16 v[88:91], a[236:239], a[180:183], v[88:91]
ds_read_b64_tr_b16 a[222:223], v14 offset:512
s_waitcnt lgkmcnt(8)
v_mfma_f32_16x16x32_bf16 v[60:63], a[192:195], a[184:187], v[60:63]
ds_read_b64_tr_b16 a[224:225], v11 offset:1024
v_mfma_f32_16x16x32_bf16 v[64:67], a[192:195], a[188:191], v[64:67]
ds_read_b64_tr_b16 a[226:227], v11 offset:1536
v_mfma_f32_16x16x32_bf16 v[68:71], a[196:199], a[184:187], v[68:71]
ds_read_b64_tr_b16 a[228:229], v12 offset:1024
v_mfma_f32_16x16x32_bf16 v[72:75], a[196:199], a[188:191], v[72:75]
ds_read_b64_tr_b16 a[230:231], v12 offset:1536
v_mfma_f32_16x16x32_bf16 v[76:79], a[200:203], a[184:187], v[76:79]
ds_read_b64_tr_b16 a[232:233], v13 offset:1024
v_mfma_f32_16x16x32_bf16 v[80:83], a[200:203], a[188:191], v[80:83]
ds_read_b64_tr_b16 a[234:235], v13 offset:1536
v_mfma_f32_16x16x32_bf16 v[84:87], a[204:207], a[184:187], v[84:87]
ds_read_b64_tr_b16 a[236:237], v14 offset:1024
v_mfma_f32_16x16x32_bf16 v[88:91], a[204:207], a[188:191], v[88:91]
ds_read_b64_tr_b16 a[238:239], v14 offset:1536
s_waitcnt vmcnt(8)
v_cmp_ne_u32 vcc, s63, v23
s_nop 1
s_and_b32 vcc_lo, vcc_lo, 3
s_cbranch_scc0 L_ok_10
s_mov_b32 s74, 200000
s_add_u32 s73, s15, 6144
L_sp_11:
buffer_load_dword v4, v7, s[32:35], s73 offen sc1
s_sub_u32 s74, s74, 1
s_waitcnt vmcnt(0)
v_cmp_ne_u32 vcc, s63, v4
s_cmp_eq_u32 s74, 0
s_cbranch_scc1 L_spd_12
s_and_b32 vcc_lo, vcc_lo, 3
s_cbranch_scc1 L_sp_11
L_spd_12:
L_ok_10:
s_waitcnt lgkmcnt(8)
v_mfma_f32_16x16x32_bf16 v[60:63], a[208:211], a[0:3], v[60:63]
ds_read_b64_tr_b16 a[192:193], v11 offset:2048
s_add_u32 m0, s64, 34816
v_mfma_f32_16x16x32_bf16 v[64:67], a[208:211], a[4:7], v[64:67]
ds_read_b64_tr_b16 a[194:195], v11 offset:2560
s_add_u32 s67, s16, 73728
v_mfma_f32_16x16x32_bf16 v[68:71], a[212:215], a[0:3], v[68:71]
ds_read_b64_tr_b16 a[196:197], v12 offset:2048
buffer_load_dwordx4 v15, s[44:47], s67 offen lds
v_mfma_f32_16x16x32_bf16 v[72:75], a[212:215], a[4:7], v[72:75]
ds_read_b64_tr_b16 a[198:199], v12 offset:2560
s_add_u32 s80, s94, 65536
v_mfma_f32_16x16x32_bf16 v[76:79], a[216:219], a[0:3], v[76:79]
ds_read_b64_tr_b16 a[200:201], v13 offset:2048
buffer_load_dwordx4 a[64:67], v20, s[32:35], s80 offen offset:0 sc1
v_mfma_f32_16x16x32_bf16 v[80:83], a[216:219], a[4:7], v[80:83]
ds_read_b64_tr_b16 a[202:203], v13 offset:2560
buffer_load_dwordx4 v15, s[48:51], s67 offen offset:1024 lds
v_mfma_f32_16x16x32_bf16 v[84:87], a[220:223], a[0:3], v[84:87]
ds_read_b64_tr_b16 a[204:205], v14 offset:2048
buffer_load_dwordx4 a[68:71], v20, s[32:35], s80 offen offset:1024 sc1
v_mfma_f32_16x16x32_bf16 v[88:91], a[220:223], a[4:7], v[88:91]
ds_read_b64_tr_b16 a[206:207], v14 offset:2560
s_waitcnt lgkmcnt(8)
v_mfma_f32_16x16x32_bf16 v[60:63], a[224:227], a[8:11], v[60:63]
ds_read_b64_tr_b16 a[208:209], v11 offset:3072
buffer_load_dwordx4 a[72:75], v20, s[32:35], s80 offen offset:2048 sc1
v_mfma_f32_16x16x32_bf16 v[64:67], a[224:227], a[12:15], v[64:67]
ds_read_b64_tr_b16 a[210:211], v11 offset:3584
buffer_load_dwordx4 a[76:79], v20, s[32:35], s80 offen offset:3072 sc1
v_mfma_f32_16x16x32_bf16 v[68:71], a[228:231], a[8:11], v[68:71]
ds_read_b64_tr_b16 a[212:213], v12 offset:3072
v_mfma_f32_16x16x32_bf16 v[72:75], a[228:231], a[12:15], v[72:75]
ds_read_b64_tr_b16 a[214:215], v12 offset:3584
v_mfma_f32_16x16x32_bf16 v[76:79], a[232:235], a[8:11], v[76:79]
ds_read_b64_tr_b16 a[216:217], v13 offset:3072
v_mfma_f32_16x16x32_bf16 v[80:83], a[232:235], a[12:15], v[80:83]
ds_read_b64_tr_b16 a[218:219], v13 offset:3584
v_mfma_f32_16x16x32_bf16 v[84:87], a[236:239], a[8:11], v[84:87]
ds_read_b64_tr_b16 a[220:221], v14 offset:3072
v_mfma_f32_16x16x32_bf16 v[88:91], a[236:239], a[12:15], v[88:91]
ds_read_b64_tr_b16 a[222:223], v14 offset:3584
s_waitcnt lgkmcnt(8)
v_mfma_f32_16x16x32_bf16 v[60:63], a[192:195], a[16:19], v[60:63]
s_barrier
ds_read_b64_tr_b16 a[224:225], v11 offset:4096
v_mfma_f32_16x16x32_bf16 v[64:67], a[192:195], a[20:23], v[64:67]
ds_read_b64_tr_b16 a[226:227], v11 offset:4608
s_add_u32 m0, s64, 36864
v_mfma_f32_16x16x32_bf16 v[68:71], a[196:199], a[16:19], v[68:71]
ds_read_b64_tr_b16 a[228:229], v12 offset:4096
s_add_u32 s67, s98, 73728
v_mfma_f32_16x16x32_bf16 v[72:75], a[196:199], a[20:23], v[72:75]
ds_read_b64_tr_b16 a[230:231], v12 offset:4608
buffer_load_dwordx4 v15, s[44:47], s67 offen lds
v_mfma_f32_16x16x32_bf16 v[76:79], a[200:203], a[16:19], v[76:79]
ds_read_b64_tr_b16 a[232:233], v13 offset:4096
s_add_u32 s80, s95, 65536
v_mfma_f32_16x16x32_bf16 v[80:83], a[200:203], a[20:23], v[80:83]
ds_read_b64_tr_b16 a[234:235], v13 offset:4608
buffer_load_dwordx4 a[80:83], v20, s[32:35], s80 offen offset:0 sc1
v_mfma_f32_16x16x32_bf16 v[84:87], a[204:207], a[16:19], v[84:87]
ds_read_b64_tr_b16 a[236:237], v14 offset:4096
buffer_load_dwordx4 v15, s[48:51], s67 offen offset:1024 lds
v_mfma_f32_16x16x32_bf16 v[88:91], a[204:207], a[20:23], v[88:91]
ds_read_b64_tr_b16 a[238:239], v14 offset:4608
s_waitcnt lgkmcnt(8)
v_mfma_f32_16x16x32_bf16 v[60:63], a[208:211], a[24:27], v[60:63]
ds_read_b64_tr_b16 a[192:193], v11 offset:5120
buffer_load_dwordx4 a[84:87], v20, s[32:35], s80 offen offset:1024 sc1
v_mfma_f32_16x16x32_bf16 v[64:67], a[208:211], a[28:31], v[64:67]
ds_read_b64_tr_b16 a[194:195], v11 offset:5632
buffer_load_dwordx4 a[88:91], v20, s[32:35], s80 offen offset:2048 sc1
v_mfma_f32_16x16x32_bf16 v[68:71], a[212:215], a[24:27], v[68:71]
ds_read_b64_tr_b16 a[196:197], v12 offset:5120
buffer_load_dwordx4 a[92:95], v20, s[32:35], s80 offen offset:3072 sc1
v_mfma_f32_16x16x32_bf16 v[72:75], a[212:215], a[28:31], v[72:75]
ds_read_b64_tr_b16 a[198:199], v12 offset:5632
v_mfma_f32_16x16x32_bf16 v[76:79], a[216:219], a[24:27], v[76:79]
ds_read_b64_tr_b16 a[200:201], v13 offset:5120
v_mfma_f32_16x16x32_bf16 v[80:83], a[216:219], a[28:31], v[80:83]
ds_read_b64_tr_b16 a[202:203], v13 offset:5632
v_mfma_f32_16x16x32_bf16 v[84:87], a[220:223], a[24:27], v[84:87]
ds_read_b64_tr_b16 a[204:205], v14 offset:5120
v_mfma_f32_16x16x32_bf16 v[88:91], a[220:223], a[28:31], v[88:91]
ds_read_b64_tr_b16 a[206:207], v14 offset:5632
s_waitcnt lgkmcnt(8)
v_mfma_f32_16x16x32_bf16 v[28:31], a[224:227], a[32:35], v[28:31]
ds_read_b64_tr_b16 a[208:209], v11 offset:6144
s_add_u32 m0, s64, 38912
v_mfma_f32_16x16x32_bf16 v[32:35], a[224:227], a[36:39], v[32:35]
ds_read_b64_tr_b16 a[210:211], v11 offset:6656
s_add_u32 s67, s16, 147456
v_mfma_f32_16x16x32_bf16 v[36:39], a[228:231], a[32:35], v[36:39]
ds_read_b64_tr_b16 a[212:213], v12 offset:6144
buffer_load_dwordx4 v15, s[44:47], s67 offen lds
s_add_u32 s79, s64, 10240
v_mfma_f32_16x16x32_bf16 v[40:43], a[228:231], a[36:39], v[40:43]
ds_read_b64_tr_b16 a[214:215], v12 offset:6656
s_lshl_b32 s73, s60, 5
s_lshl_b32 s74, s61, 7
v_mfma_f32_16x16x32_bf16 v[44:47], a[232:235], a[32:35], v[44:47]
ds_read_b64_tr_b16 a[216:217], v13 offset:6144
s_add_u32 s73, s73, s74
v_mfma_f32_16x16x32_bf16 v[48:51], a[232:235], a[36:39], v[48:51]
ds_read_b64_tr_b16 a[218:219], v13 offset:6656
buffer_load_dwordx4 v15, s[48:51], s67 offen offset:1024 lds
v_mfma_f32_16x16x32_bf16 v[52:55], a[236:239], a[32:35], v[52:55]
ds_read_b64_tr_b16 a[220:221], v14 offset:6144
s_lshl_b32 s78, s60, 11
v_mfma_f32_16x16x32_bf16 v[56:59], a[236:239], a[36:39], v[56:59]
ds_read_b64_tr_b16 a[222:223], v14 offset:6656
s_waitcnt lgkmcnt(8)
v_mfma_f32_16x16x32_bf16 v[28:31], a[192:195], a[40:43], v[28:31]
ds_read_b64_tr_b16 a[224:225], v11 offset:7168
s_add_u32 s78, s78, s15
v_mfma_f32_16x16x32_bf16 v[32:35], a[192:195], a[44:47], v[32:35]
ds_read_b64_tr_b16 a[226:227], v11 offset:7680
s_cmp_lt_u32 s61, 8
s_cselect_b32 s77, 256, 0
v_mfma_f32_16x16x32_bf16 v[36:39], a[196:199], a[40:43], v[36:39]
ds_read_b64_tr_b16 a[228:229], v12 offset:7168
s_sub_u32 s77, s77, 128
v_mfma_f32_16x16x32_bf16 v[40:43], a[196:199], a[44:47], v[40:43]
ds_read_b64_tr_b16 a[230:231], v12 offset:7680
v_lshrrev_b32 v2, 2, v1
v_mfma_f32_16x16x32_bf16 v[44:47], a[200:203], a[40:43], v[44:47]
ds_read_b64_tr_b16 a[232:233], v13 offset:7168
v_mul_u32_u24 v8, 144, v2
v_mfma_f32_16x16x32_bf16 v[48:51], a[200:203], a[44:47], v[48:51]
ds_read_b64_tr_b16 a[234:235], v13 offset:7680
v_add_u32 v2, s73, v2
v_mfma_f32_16x16x32_bf16 v[52:55], a[204:207], a[40:43], v[52:55]
ds_read_b64_tr_b16 a[236:237], v14 offset:7168
v_mul_u32_u24 v2, 1152, v2
v_mfma_f32_16x16x32_bf16 v[56:59], a[204:207], a[44:47], v[56:59]
ds_read_b64_tr_b16 a[238:239], v14 offset:7680
s_waitcnt vmcnt(15)
s_waitcnt lgkmcnt(8)
v_mfma_f32_16x16x32_bf16 v[28:31], a[208:211], a[48:51], v[28:31]
ds_read_b64_tr_b16 a[192:193], v11 offset:8192
s_add_u32 m0, s64, 0
v_mfma_f32_16x16x32_bf16 v[32:35], a[208:211], a[52:55], v[32:35]
ds_read_b64_tr_b16 a[194:195], v11 offset:8704
s_add_u32 s67, s98, 147456
v_mfma_f32_16x16x32_bf16 v[36:39], a[212:215], a[48:51], v[36:39]
ds_read_b64_tr_b16 a[196:197], v12 offset:8192
buffer_load_dwordx4 v15, s[44:47], s67 offen lds
v_and_b32 v3, 3, v1
v_mfma_f32_16x16x32_bf16 v[40:43], a[212:215], a[52:55], v[40:43]
ds_read_b64_tr_b16 a[198:199], v12 offset:8704
v_lshl_add_u32 v16, v3, 4, v2
v_lshl_add_u32 v8, v3, 5, v8
v_mfma_f32_16x16x32_bf16 v[44:47], a[216:219], a[48:51], v[44:47]
ds_read_b64_tr_b16 a[200:201], v13 offset:8192
v_add_u32 v27, s79, v8
v_and_b32 v9, 15, v1
v_mfma_f32_16x16x32_bf16 v[48:51], a[216:219], a[52:55], v[48:51]
ds_read_b64_tr_b16 a[202:203], v13 offset:8704
buffer_load_dwordx4 v15, s[48:51], s67 offen offset:1024 lds
v_mfma_f32_16x16x32_bf16 v[52:55], a[220:223], a[48:51], v[52:55]
ds_read_b64_tr_b16 a[204:205], v14 offset:8192
v_add_u32 v2, s73, v9
v_mfma_f32_16x16x32_bf16 v[56:59], a[220:223], a[52:55], v[56:59]
ds_read_b64_tr_b16 a[206:207], v14 offset:8704
s_waitcnt lgkmcnt(8)
v_mfma_f32_16x16x32_bf16 v[28:31], a[224:227], a[56:59], v[28:31]
ds_read_b64_tr_b16 a[208:209], v11 offset:9216
v_lshrrev_b32 v3, 4, v1
v_mfma_f32_16x16x32_bf16 v[32:35], a[224:227], a[60:63], v[32:35]
ds_read_b64_tr_b16 a[210:211], v11 offset:9728
v_sub_u32 v4, 2048, v2
v_mfma_f32_16x16x32_bf16 v[36:39], a[228:231], a[56:59], v[36:39]
ds_read_b64_tr_b16 a[212:213], v12 offset:9216
v_min_u32 v4, v4, v2
v_mfma_f32_16x16x32_bf16 v[40:43], a[228:231], a[60:63], v[40:43]
ds_read_b64_tr_b16 a[214:215], v12 offset:9728
v_cmp_gt_u32 vcc, 1024, v2
v_mfma_f32_16x16x32_bf16 v[44:47], a[232:235], a[56:59], v[44:47]
ds_read_b64_tr_b16 a[216:217], v13 offset:9216
v_and_b32 v8, 1, v4
v_mfma_f32_16x16x32_bf16 v[48:51], a[232:235], a[60:63], v[48:51]
ds_read_b64_tr_b16 a[218:219], v13 offset:9728
v_mul_u32_u24 v8, 377856, v8
v_mfma_f32_16x16x32_bf16 v[52:55], a[236:239], a[56:59], v[52:55]
ds_read_b64_tr_b16 a[220:221], v14 offset:9216
v_lshrrev_b32 v4, 1, v4
v_mfma_f32_16x16x32_bf16 v[56:59], a[236:239], a[60:63], v[56:59]
ds_read_b64_tr_b16 a[222:223], v14 offset:9728
s_waitcnt vmcnt(10)
s_waitcnt lgkmcnt(8)
v_mfma_f32_16x16x32_bf16 v[28:31], a[192:195], a[64:67], v[28:31]
s_barrier
ds_read_b64_tr_b16 a[224:225], v11 offset:10240
v_mfma_f32_16x16x32_bf16 v[32:35], a[192:195], a[68:71], v[32:35]
ds_read_b64_tr_b16 a[226:227], v11 offset:10752
s_add_u32 m0, s64, 2048
v_mfma_f32_16x16x32_bf16 v[36:39], a[196:199], a[64:67], v[36:39]
ds_read_b64_tr_b16 a[228:229], v12 offset:10240
s_add_u32 s67, s16, 221184
buffer_load_dwordx4 v15, s[44:47], s67 offen lds
v_mfma_f32_16x16x32_bf16 v[40:43], a[196:199], a[68:71], v[40:43]
ds_read_b64_tr_b16 a[230:231], v12 offset:10752
v_cndmask_b32 v19, 1.0, -1.0, vcc
v_lshl_add_u32 v4, v4, 4, v8
v_mfma_f32_16x16x32_bf16 v[44:47], a[200:203], a[64:67], v[44:47]
ds_read_b64_tr_b16 a[232:233], v13 offset:10240
v_mul_u32_u24 v8, 9216, v3
v_cmp_eq_u32 vcc, 0, v3
v_mfma_f32_16x16x32_bf16 v[48:51], a[200:203], a[68:71], v[48:51]
ds_read_b64_tr_b16 a[234:235], v13 offset:10752
buffer_load_dwordx4 v15, s[48:51], s67 offen offset:1024 lds
v_add_u32 v17, v4, v8
v_mfma_f32_16x16x32_bf16 v[52:55], a[204:207], a[64:67], v[52:55]
ds_read_b64_tr_b16 a[236:237], v14 offset:10240
v_sub_u32 v8, v4, v8
v_add_u32 v18, 27648, v8
v_mfma_f32_16x16x32_bf16 v[56:59], a[204:207], a[68:71], v[56:59]
ds_read_b64_tr_b16 a[238:239], v14 offset:10752
s_waitcnt lgkmcnt(8)
v_mfma_f32_16x16x32_bf16 v[28:31], a[208:211], a[72:75], v[28:31]
ds_read_b64_tr_b16 a[192:193], v11 offset:11264
v_add_u32 v8, 36864, v8
v_mfma_f32_16x16x32_bf16 v[32:35], a[208:211], a[76:79], v[32:35]
ds_read_b64_tr_b16 a[194:195], v11 offset:11776
v_mov_b32 v2, 2147483392
v_mfma_f32_16x16x32_bf16 v[36:39], a[212:215], a[72:75], v[36:39]
ds_read_b64_tr_b16 a[196:197], v12 offset:11264
v_subrev_u32 v4, 16, v1
v_mfma_f32_16x16x32_bf16 v[40:43], a[212:215], a[76:79], v[40:43]
ds_read_b64_tr_b16 a[198:199], v12 offset:11776
v_cndmask_b32 v24, v2, v8, vcc
v_mfma_f32_16x16x32_bf16 v[44:47], a[216:219], a[72:75], v[44:47]
ds_read_b64_tr_b16 a[200:201], v13 offset:11264
v_and_b32 v4, 63, v4
v_mfma_f32_16x16x32_bf16 v[48:51], a[216:219], a[76:79], v[48:51]
ds_read_b64_tr_b16 a[202:203], v13 offset:11776
v_lshlrev_b32 v25, 2, v4
v_mfma_f32_16x16x32_bf16 v[52:55], a[220:223], a[72:75], v[52:55]
ds_read_b64_tr_b16 a[204:205], v14 offset:11264
buffer_load_dwordx4 a[252:255], v255, s[56:59], s3 offen
v_mfma_f32_16x16x32_bf16 v[56:59], a[220:223], a[76:79], v[56:59]
ds_read_b64_tr_b16 a[206:207], v14 offset:11776
s_waitcnt vmcnt(7)
s_waitcnt lgkmcnt(8)
v_mfma_f32_16x16x32_bf16 v[28:31], a[224:227], a[80:83], v[28:31]
ds_read_b64_tr_b16 a[208:209], v11 offset:12288
s_add_u32 m0, s64, 4096
v_mfma_f32_16x16x32_bf16 v[32:35], a[224:227], a[84:87], v[32:35]
ds_read_b64_tr_b16 a[210:211], v11 offset:12800
s_add_u32 s67, s98, 221184
v_mfma_f32_16x16x32_bf16 v[36:39], a[228:231], a[80:83], v[36:39]
ds_read_b64_tr_b16 a[212:213], v12 offset:12288
buffer_load_dwordx4 v15, s[44:47], s67 offen lds
v_mul_u32_u24 v9, 144, v9
v_mfma_f32_16x16x32_bf16 v[40:43], a[228:231], a[84:87], v[40:43]
ds_read_b64_tr_b16 a[214:215], v12 offset:12800
v_lshl_add_u32 v9, v3, 4, v9
v_add_u32 v26, s79, v9
v_mfma_f32_16x16x32_bf16 v[44:47], a[232:235], a[80:83], v[44:47]
ds_read_b64_tr_b16 a[216:217], v13 offset:12288
s_and_b32 s73, s6, 1
v_mfma_f32_16x16x32_bf16 v[48:51], a[232:235], a[84:87], v[48:51]
ds_read_b64_tr_b16 a[218:219], v13 offset:12800
buffer_load_dwordx4 v15, s[48:51], s67 offen offset:1024 lds
v_mfma_f32_16x16x32_bf16 v[52:55], a[236:239], a[80:83], v[52:55]
ds_read_b64_tr_b16 a[220:221], v14 offset:12288
s_lshl_b32 s74, s73, 11
v_mfma_f32_16x16x32_bf16 v[56:59], a[236:239], a[84:87], v[56:59]
ds_read_b64_tr_b16 a[222:223], v14 offset:12800
s_waitcnt lgkmcnt(8)
v_mfma_f32_16x16x32_bf16 v[28:31], a[192:195], a[88:91], v[28:31]
ds_read_b64_tr_b16 a[224:225], v11 offset:13312
s_lshl_b32 s75, s6, 12
v_mfma_f32_16x16x32_bf16 v[32:35], a[192:195], a[92:95], v[32:35]
ds_read_b64_tr_b16 a[226:227], v11 offset:13824
s_sub_u32 s20, s19, s75
v_mfma_f32_16x16x32_bf16 v[36:39], a[196:199], a[88:91], v[36:39]
ds_read_b64_tr_b16 a[228:229], v12 offset:13312
s_add_u32 s20, s20, s74
v_mfma_f32_16x16x32_bf16 v[40:43], a[196:199], a[92:95], v[40:43]
ds_read_b64_tr_b16 a[230:231], v12 offset:13824
s_xor_b32 s74, s74, 2048
v_mfma_f32_16x16x32_bf16 v[44:47], a[200:203], a[88:91], v[44:47]
ds_read_b64_tr_b16 a[232:233], v13 offset:13312
s_add_u32 s19, s19, s74
v_mfma_f32_16x16x32_bf16 v[48:51], a[200:203], a[92:95], v[48:51]
ds_read_b64_tr_b16 a[234:235], v13 offset:13824
s_cmp_eq_u32 s73, 0
s_cselect_b64 vcc, -1, 0
v_mfma_f32_16x16x32_bf16 v[52:55], a[204:207], a[88:91], v[52:55]
ds_read_b64_tr_b16 a[236:237], v14 offset:13312
v_cndmask_b32 v250, v11, v13, vcc
v_mfma_f32_16x16x32_bf16 v[56:59], a[204:207], a[92:95], v[56:59]
ds_read_b64_tr_b16 a[238:239], v14 offset:13824
s_waitcnt lgkmcnt(8)
v_mfma_f32_16x16x32_bf16 v[60:63], a[208:211], a[32:35], v[60:63]
s_barrier
ds_read_b64_tr_b16 a[192:193], v11 offset:14336
v_mfma_f32_16x16x32_bf16 v[64:67], a[208:211], a[36:39], v[64:67]
ds_read_b64_tr_b16 a[194:195], v11 offset:14848
s_add_u32 m0, s64, 6144
v_mfma_f32_16x16x32_bf16 v[68:71], a[212:215], a[32:35], v[68:71]
ds_read_b64_tr_b16 a[196:197], v12 offset:14336
s_add_u32 s67, s16, 294912
buffer_load_dwordx4 v15, s[44:47], s67 offen lds
v_mfma_f32_16x16x32_bf16 v[72:75], a[212:215], a[36:39], v[72:75]
ds_read_b64_tr_b16 a[198:199], v12 offset:14848
v_cvt_pk_bf16_f32 v92, v28, v29
v_cvt_pk_bf16_f32 v93, v30, v31
v_mfma_f32_16x16x32_bf16 v[76:79], a[216:219], a[32:35], v[76:79]
ds_read_b64_tr_b16 a[200:201], v13 offset:14336
v_cvt_pk_bf16_f32 v94, v36, v37
v_cvt_pk_bf16_f32 v95, v38, v39
v_mfma_f32_16x16x32_bf16 v[80:83], a[216:219], a[36:39], v[80:83]
ds_read_b64_tr_b16 a[202:203], v13 offset:14848
buffer_load_dwordx4 v15, s[48:51], s67 offen offset:1024 lds
buffer_store_dwordx4 v[92:95], v20, s[32:35], s17 offen offset:0 sc1
v_mfma_f32_16x16x32_bf16 v[84:87], a[220:223], a[32:35], v[84:87]
ds_read_b64_tr_b16 a[204:205], v14 offset:14336
v_cvt_pk_bf16_f32 v96, v32, v33
v_cndmask_b32 v251, v12, v14, vcc
v_mfma_f32_16x16x32_bf16 v[88:91], a[220:223], a[36:39], v[88:91]
ds_read_b64_tr_b16 a[206:207], v14 offset:14848
v_cndmask_b32 v252, v13, v11, vcc
s_waitcnt lgkmcnt(8)
v_mfma_f32_16x16x32_bf16 v[60:63], a[224:227], a[40:43], v[60:63]
ds_read_b64_tr_b16 a[208:209], v11 offset:15360
v_cndmask_b32 v253, v14, v12, vcc
s_mul_i32 s76, s7, 6
v_mfma_f32_16x16x32_bf16 v[64:67], a[224:227], a[44:47], v[64:67]
ds_read_b64_tr_b16 a[210:211], v11 offset:15872
s_add_u32 s76, s76, s6
s_xor_b32 s73, s6, 2
v_mfma_f32_16x16x32_bf16 v[68:71], a[228:231], a[40:43], v[68:71]
ds_read_b64_tr_b16 a[212:213], v12 offset:15360
s_andn2_b32 s73, s73, 1
s_xor_b32 s74, s6, 1
v_mfma_f32_16x16x32_bf16 v[72:75], a[228:231], a[44:47], v[72:75]
ds_read_b64_tr_b16 a[214:215], v12 offset:15872
s_xor_b32 s75, s62, 4
s_lshl_b32 s93, 1, s75
v_mfma_f32_16x16x32_bf16 v[76:79], a[232:235], a[40:43], v[76:79]
ds_read_b64_tr_b16 a[216:217], v13 offset:15360
s_cmp_eq_u32 s6, 4
s_cselect_b32 s73, 0, s73
s_cselect_b32 s74, 3, s74
s_cselect_b32 s75, 2, 4
s_cselect_b32 s93, 0, s93
v_mfma_f32_16x16x32_bf16 v[80:83], a[232:235], a[44:47], v[80:83]
ds_read_b64_tr_b16 a[218:219], v13 offset:15872
s_lshl_b32 s73, s73, 12
v_mfma_f32_16x16x32_bf16 v[84:87], a[236:239], a[40:43], v[84:87]
ds_read_b64_tr_b16 a[220:221], v14 offset:15360
s_add_u32 s4, s20, s73
v_mfma_f32_16x16x32_bf16 v[88:91], a[236:239], a[44:47], v[88:91]
ds_read_b64_tr_b16 a[222:223], v14 offset:15872
s_waitcnt lgkmcnt(8)
v_mfma_f32_16x16x32_bf16 v[60:63], a[192:195], a[48:51], v[60:63]
ds_read_b64_tr_b16 a[224:225], v11 offset:16384
s_add_u32 m0, s64, 8192
v_mfma_f32_16x16x32_bf16 v[64:67], a[192:195], a[52:55], v[64:67]
ds_read_b64_tr_b16 a[226:227], v11 offset:16896
s_add_u32 s67, s98, 294912
v_mfma_f32_16x16x32_bf16 v[68:71], a[196:199], a[48:51], v[68:71]
ds_read_b64_tr_b16 a[228:229], v12 offset:16384
buffer_load_dwordx4 v15, s[44:47], s67 offen lds
v_cvt_pk_bf16_f32 v97, v34, v35
v_mfma_f32_16x16x32_bf16 v[72:75], a[196:199], a[52:55], v[72:75]
ds_read_b64_tr_b16 a[230:231], v12 offset:16896
v_cvt_pk_bf16_f32 v98, v40, v41
v_cvt_pk_bf16_f32 v99, v42, v43
v_mfma_f32_16x16x32_bf16 v[76:79], a[200:203], a[48:51], v[76:79]
ds_read_b64_tr_b16 a[232:233], v13 offset:16384
buffer_store_dwordx4 v[96:99], v20, s[32:35], s17 offen offset:1024 sc1
v_cvt_pk_bf16_f32 v100, v44, v45
v_mfma_f32_16x16x32_bf16 v[80:83], a[200:203], a[52:55], v[80:83]
ds_read_b64_tr_b16 a[234:235], v13 offset:16896
buffer_load_dwordx4 v15, s[48:51], s67 offen offset:1024 lds
v_cvt_pk_bf16_f32 v101, v46, v47
v_mfma_f32_16x16x32_bf16 v[84:87], a[204:207], a[48:51], v[84:87]
ds_read_b64_tr_b16 a[236:237], v14 offset:16384
v_cvt_pk_bf16_f32 v102, v52, v53
s_add_u32 s5, s4, 4096
v_mfma_f32_16x16x32_bf16 v[88:91], a[204:207], a[52:55], v[88:91]
ds_read_b64_tr_b16 a[238:239], v14 offset:16896
s_lshl_b32 s75, s75, 12
s_waitcnt lgkmcnt(8)
v_mfma_f32_16x16x32_bf16 v[60:63], a[208:211], a[56:59], v[60:63]
ds_read_b64_tr_b16 a[192:193], v11 offset:17408
s_add_u32 s12, s20, s75
s_lshl_b32 s74, s74, 12
v_mfma_f32_16x16x32_bf16 v[64:67], a[208:211], a[60:63], v[64:67]
ds_read_b64_tr_b16 a[194:195], v11 offset:17920
s_add_u32 s25, s20, s74
s_lshl_b32 s92, 0x2222, s7
v_mfma_f32_16x16x32_bf16 v[68:71], a[212:215], a[56:59], v[68:71]
ds_read_b64_tr_b16 a[196:197], v12 offset:17408
s_lshl_b32 s73, s7, 2
s_lshl_b32 s73, 1, s73
v_mfma_f32_16x16x32_bf16 v[72:75], a[212:215], a[60:63], v[72:75]
ds_read_b64_tr_b16 a[198:199], v12 offset:17920
s_or_b32 s92, s92, s73
s_lshl_b32 s73, 1, s62
v_mfma_f32_16x16x32_bf16 v[76:79], a[216:219], a[56:59], v[76:79]
ds_read_b64_tr_b16 a[200:201], v13 offset:17408
s_or_b32 s73, s73, s93
v_mfma_f32_16x16x32_bf16 v[80:83], a[216:219], a[60:63], v[80:83]
ds_read_b64_tr_b16 a[202:203], v13 offset:17920
s_andn2_b32 s92, s92, s73
v_mfma_f32_16x16x32_bf16 v[84:87], a[220:223], a[56:59], v[84:87]
ds_read_b64_tr_b16 a[204:205], v14 offset:17408
s_lshl_b32 s73, s62, 7
v_mfma_f32_16x16x32_bf16 v[88:91], a[220:223], a[60:63], v[88:91]
ds_read_b64_tr_b16 a[206:207], v14 offset:17920
s_waitcnt lgkmcnt(8)
v_mfma_f32_16x16x32_bf16 v[60:63], a[224:227], a[64:67], v[60:63]
ds_read_b64_tr_b16 a[208:209], v11 offset:18432
v_mfma_f32_16x16x32_bf16 v[64:67], a[224:227], a[68:71], v[64:67]
ds_read_b64_tr_b16 a[210:211], v11 offset:18944
v_mfma_f32_16x16x32_bf16 v[68:71], a[228:231], a[64:67], v[68:71]
ds_read_b64_tr_b16 a[212:213], v12 offset:18432
v_cvt_pk_bf16_f32 v103, v54, v55
buffer_store_dwordx4 v[100:103], v20, s[32:35], s17 offen offset:2048 sc1
v_mfma_f32_16x16x32_bf16 v[72:75], a[228:231], a[68:71], v[72:75]
ds_read_b64_tr_b16 a[214:215], v12 offset:18944
v_cvt_pk_bf16_f32 v104, v48, v49
v_cvt_pk_bf16_f32 v105, v50, v51
v_mfma_f32_16x16x32_bf16 v[76:79], a[232:235], a[64:67], v[76:79]
ds_read_b64_tr_b16 a[216:217], v13 offset:18432
v_cvt_pk_bf16_f32 v106, v56, v57
v_cvt_pk_bf16_f32 v107, v58, v59
v_mfma_f32_16x16x32_bf16 v[80:83], a[232:235], a[68:71], v[80:83]
ds_read_b64_tr_b16 a[218:219], v13 offset:18944
buffer_store_dwordx4 v[104:107], v20, s[32:35], s17 offen offset:3072 sc1
v_mov_b32 v5, 2147483392
v_mfma_f32_16x16x32_bf16 v[84:87], a[236:239], a[64:67], v[84:87]
ds_read_b64_tr_b16 a[220:221], v14 offset:18432
v_mov_b32 v2, s73
v_cmp_eq_u32 vcc, 0, v1
v_mfma_f32_16x16x32_bf16 v[88:91], a[236:239], a[68:71], v[88:91]
ds_read_b64_tr_b16 a[222:223], v14 offset:18944
v_cndmask_b32 v5, v5, v2, vcc
s_waitcnt lgkmcnt(8)
v_mfma_f32_16x16x32_bf16 v[60:63], a[192:195], a[72:75], v[60:63]
ds_read_b64_tr_b16 a[224:225], v11 offset:19456
v_lshlrev_b32 v2, 7, v1
v_mov_b32 v4, 2147483392
v_mfma_f32_16x16x32_bf16 v[64:67], a[192:195], a[76:79], v[64:67]
ds_read_b64_tr_b16 a[226:227], v11 offset:19968
v_cmp_gt_u32 vcc, 12, v1
s_nop 1
v_cndmask_b32 v6, v4, v2, vcc
v_mfma_f32_16x16x32_bf16 v[68:71], a[196:199], a[72:75], v[68:71]
ds_read_b64_tr_b16 a[228:229], v12 offset:19456
s_mov_b32 vcc_hi, 0
v_mfma_f32_16x16x32_bf16 v[72:75], a[196:199], a[76:79], v[72:75]
ds_read_b64_tr_b16 a[230:231], v12 offset:19968
s_mov_b32 vcc_lo, s92
v_mfma_f32_16x16x32_bf16 v[76:79], a[200:203], a[72:75], v[76:79]
ds_read_b64_tr_b16 a[232:233], v13 offset:19456
v_cndmask_b32 v7, v4, v2, vcc
v_mfma_f32_16x16x32_bf16 v[80:83], a[200:203], a[76:79], v[80:83]
ds_read_b64_tr_b16 a[234:235], v13 offset:19968
s_mov_b32 vcc_lo, s93
v_mfma_f32_16x16x32_bf16 v[84:87], a[204:207], a[72:75], v[84:87]
ds_read_b64_tr_b16 a[236:237], v14 offset:19456
v_cndmask_b32 v10, v4, v2, vcc
v_mfma_f32_16x16x32_bf16 v[88:91], a[204:207], a[76:79], v[88:91]
ds_read_b64_tr_b16 a[238:239], v14 offset:19968
s_waitcnt lgkmcnt(8)
v_mfma_f32_16x16x32_bf16 v[60:63], a[208:211], a[80:83], v[60:63]
s_barrier
ds_read_b64_tr_b16 a[192:193], v250 offset:20480
v_mfma_f32_16x16x32_bf16 v[64:67], a[208:211], a[84:87], v[64:67]
ds_read_b64_tr_b16 a[194:195], v250 offset:20992
v_mfma_f32_16x16x32_bf16 v[68:71], a[212:215], a[80:83], v[68:71]
ds_read_b64_tr_b16 a[196:197], v251 offset:20480
v_mfma_f32_16x16x32_bf16 v[72:75], a[212:215], a[84:87], v[72:75]
ds_read_b64_tr_b16 a[198:199], v251 offset:20992
v_mfma_f32_16x16x32_bf16 v[76:79], a[216:219], a[80:83], v[76:79]
ds_read_b64_tr_b16 a[200:201], v250 offset:21504
v_mfma_f32_16x16x32_bf16 v[80:83], a[216:219], a[84:87], v[80:83]
ds_read_b64_tr_b16 a[202:203], v250 offset:22016
v_mfma_f32_16x16x32_bf16 v[84:87], a[220:223], a[80:83], v[84:87]
ds_read_b64_tr_b16 a[204:205], v251 offset:21504
v_mfma_f32_16x16x32_bf16 v[88:91], a[220:223], a[84:87], v[88:91]
ds_read_b64_tr_b16 a[206:207], v251 offset:22016
s_waitcnt lgkmcnt(8)
v_mfma_f32_16x16x32_bf16 v[60:63], a[224:227], a[88:91], v[60:63]
ds_read_b64_tr_b16 a[208:209], v250 offset:22528
v_mfma_f32_16x16x32_bf16 v[64:67], a[224:227], a[92:95], v[64:67]
ds_read_b64_tr_b16 a[210:211], v250 offset:23040
v_mfma_f32_16x16x32_bf16 v[68:71], a[228:231], a[88:91], v[68:71]
ds_read_b64_tr_b16 a[212:213], v251 offset:22528
v_mfma_f32_16x16x32_bf16 v[72:75], a[228:231], a[92:95], v[72:75]
ds_read_b64_tr_b16 a[214:215], v251 offset:23040
v_mfma_f32_16x16x32_bf16 v[76:79], a[232:235], a[88:91], v[76:79]
ds_read_b64_tr_b16 a[216:217], v250 offset:23552
v_mfma_f32_16x16x32_bf16 v[80:83], a[232:235], a[92:95], v[80:83]
ds_read_b64_tr_b16 a[218:219], v250 offset:24064
v_mfma_f32_16x16x32_bf16 v[84:87], a[236:239], a[88:91], v[84:87]
ds_read_b64_tr_b16 a[220:221], v251 offset:23552
v_mfma_f32_16x16x32_bf16 v[88:91], a[236:239], a[92:95], v[88:91]
ds_read_b64_tr_b16 a[222:223], v251 offset:24064
s_waitcnt lgkmcnt(8)
v_mfma_f32_16x16x32_bf16 v[28:31], a[192:195], v[172:175], 0
ds_read_b64_tr_b16 a[224:225], v250 offset:24576
v_mfma_f32_16x16x32_bf16 v[32:35], a[192:195], v[176:179], 0
ds_read_b64_tr_b16 a[226:227], v250 offset:25088
v_mfma_f32_16x16x32_bf16 v[36:39], a[196:199], v[172:175], 0
ds_read_b64_tr_b16 a[228:229], v251 offset:24576
v_cvt_pk_bf16_f32 v92, v60, v61
v_cvt_pk_bf16_f32 v93, v62, v63
v_mfma_f32_16x16x32_bf16 v[40:43], a[196:199], v[176:179], 0
ds_read_b64_tr_b16 a[230:231], v251 offset:25088
v_cvt_pk_bf16_f32 v94, v68, v69
v_mfma_f32_16x16x32_bf16 v[28:31], a[200:203], v[180:183], v[28:31]
ds_read_b64_tr_b16 a[232:233], v250 offset:25600
v_cvt_pk_bf16_f32 v95, v70, v71
v_mfma_f32_16x16x32_bf16 v[32:35], a[200:203], v[184:187], v[32:35]
ds_read_b64_tr_b16 a[234:235], v250 offset:26112
buffer_store_dwordx4 v[92:95], v20, s[32:35], s18 offen offset:0 sc1
v_mfma_f32_16x16x32_bf16 v[36:39], a[204:207], v[180:183], v[36:39]
ds_read_b64_tr_b16 a[236:237], v251 offset:25600
v_cvt_pk_bf16_f32 v96, v64, v65
v_mfma_f32_16x16x32_bf16 v[40:43], a[204:207], v[184:187], v[40:43]
ds_read_b64_tr_b16 a[238:239], v251 offset:26112
s_waitcnt lgkmcnt(8)
v_mfma_f32_16x16x32_bf16 v[28:31], a[208:211], v[188:191], v[28:31]
ds_read_b64_tr_b16 a[192:193], v250 offset:26624
v_mfma_f32_16x16x32_bf16 v[32:35], a[208:211], v[192:195], v[32:35]
ds_read_b64_tr_b16 a[194:195], v250 offset:27136
v_mfma_f32_16x16x32_bf16 v[36:39], a[212:215], v[188:191], v[36:39]
ds_read_b64_tr_b16 a[196:197], v251 offset:26624
v_cvt_pk_bf16_f32 v97, v66, v67
v_cvt_pk_bf16_f32 v98, v72, v73
v_mfma_f32_16x16x32_bf16 v[40:43], a[212:215], v[192:195], v[40:43]
ds_read_b64_tr_b16 a[198:199], v251 offset:27136
v_cvt_pk_bf16_f32 v99, v74, v75
buffer_store_dwordx4 v[96:99], v20, s[32:35], s18 offen offset:1024 sc1
v_mfma_f32_16x16x32_bf16 v[28:31], a[216:219], v[196:199], v[28:31]
ds_read_b64_tr_b16 a[200:201], v250 offset:27648
v_cvt_pk_bf16_f32 v100, v76, v77
v_mfma_f32_16x16x32_bf16 v[32:35], a[216:219], v[200:203], v[32:35]
ds_read_b64_tr_b16 a[202:203], v250 offset:28160
v_cvt_pk_bf16_f32 v101, v78, v79
v_mfma_f32_16x16x32_bf16 v[36:39], a[220:223], v[196:199], v[36:39]
ds_read_b64_tr_b16 a[204:205], v251 offset:27648
v_cvt_pk_bf16_f32 v102, v84, v85
v_mfma_f32_16x16x32_bf16 v[40:43], a[220:223], v[200:203], v[40:43]
ds_read_b64_tr_b16 a[206:207], v251 offset:28160
s_waitcnt lgkmcnt(8)
v_mfma_f32_16x16x32_bf16 v[28:31], a[224:227], v[204:207], v[28:31]
ds_read_b64_tr_b16 a[208:209], v250 offset:28672
v_mfma_f32_16x16x32_bf16 v[32:35], a[224:227], v[208:211], v[32:35]
ds_read_b64_tr_b16 a[210:211], v250 offset:29184
v_mfma_f32_16x16x32_bf16 v[36:39], a[228:231], v[204:207], v[36:39]
ds_read_b64_tr_b16 a[212:213], v251 offset:28672
v_cvt_pk_bf16_f32 v103, v86, v87
buffer_store_dwordx4 v[100:103], v20, s[32:35], s18 offen offset:2048 sc1
v_mfma_f32_16x16x32_bf16 v[40:43], a[228:231], v[208:211], v[40:43]
ds_read_b64_tr_b16 a[214:215], v251 offset:29184
v_cvt_pk_bf16_f32 v104, v80, v81
v_cvt_pk_bf16_f32 v105, v82, v83
v_mfma_f32_16x16x32_bf16 v[28:31], a[232:235], v[212:215], v[28:31]
ds_read_b64_tr_b16 a[216:217], v250 offset:29696
v_cvt_pk_bf16_f32 v106, v88, v89
v_mfma_f32_16x16x32_bf16 v[32:35], a[232:235], v[216:219], v[32:35]
ds_read_b64_tr_b16 a[218:219], v250 offset:30208
v_cvt_pk_bf16_f32 v107, v90, v91
v_mfma_f32_16x16x32_bf16 v[36:39], a[236:239], v[212:215], v[36:39]
ds_read_b64_tr_b16 a[220:221], v251 offset:29696
buffer_store_dwordx4 v[104:107], v20, s[32:35], s18 offen offset:3072 sc1
v_mfma_f32_16x16x32_bf16 v[40:43], a[236:239], v[216:219], v[40:43]
ds_read_b64_tr_b16 a[222:223], v251 offset:30208
s_waitcnt lgkmcnt(8)
v_mfma_f32_16x16x32_bf16 v[28:31], a[192:195], v[156:159], v[28:31]
ds_read_b64_tr_b16 a[224:225], v250 offset:30720
v_mfma_f32_16x16x32_bf16 v[32:35], a[192:195], v[160:163], v[32:35]
ds_read_b64_tr_b16 a[226:227], v250 offset:31232
v_mfma_f32_16x16x32_bf16 v[36:39], a[196:199], v[156:159], v[36:39]
ds_read_b64_tr_b16 a[228:229], v251 offset:30720
v_mfma_f32_16x16x32_bf16 v[40:43], a[196:199], v[160:163], v[40:43]
ds_read_b64_tr_b16 a[230:231], v251 offset:31232
v_mfma_f32_16x16x32_bf16 v[28:31], a[200:203], v[164:167], v[28:31]
ds_read_b64_tr_b16 a[232:233], v250 offset:31744
v_mfma_f32_16x16x32_bf16 v[32:35], a[200:203], v[168:171], v[32:35]
ds_read_b64_tr_b16 a[234:235], v250 offset:32256
v_mfma_f32_16x16x32_bf16 v[36:39], a[204:207], v[164:167], v[36:39]
ds_read_b64_tr_b16 a[236:237], v251 offset:31744
v_mfma_f32_16x16x32_bf16 v[40:43], a[204:207], v[168:171], v[40:43]
ds_read_b64_tr_b16 a[238:239], v251 offset:32256
s_waitcnt lgkmcnt(8)
v_mfma_f32_16x16x32_bf16 v[28:31], a[208:211], v[220:223], v[28:31]
ds_read_b64_tr_b16 a[192:193], v250 offset:32768
v_mfma_f32_16x16x32_bf16 v[32:35], a[208:211], v[224:227], v[32:35]
ds_read_b64_tr_b16 a[194:195], v250 offset:33280
v_mfma_f32_16x16x32_bf16 v[36:39], a[212:215], v[220:223], v[36:39]
ds_read_b64_tr_b16 a[196:197], v251 offset:32768
v_mfma_f32_16x16x32_bf16 v[40:43], a[212:215], v[224:227], v[40:43]
ds_read_b64_tr_b16 a[198:199], v251 offset:33280
v_mfma_f32_16x16x32_bf16 v[28:31], a[216:219], v[228:231], v[28:31]
ds_read_b64_tr_b16 a[200:201], v250 offset:33792
v_mfma_f32_16x16x32_bf16 v[32:35], a[216:219], v[232:235], v[32:35]
ds_read_b64_tr_b16 a[202:203], v250 offset:34304
v_mfma_f32_16x16x32_bf16 v[36:39], a[220:223], v[228:231], v[36:39]
ds_read_b64_tr_b16 a[204:205], v251 offset:33792
v_mfma_f32_16x16x32_bf16 v[40:43], a[220:223], v[232:235], v[40:43]
ds_read_b64_tr_b16 a[206:207], v251 offset:34304
s_waitcnt lgkmcnt(8)
v_mfma_f32_16x16x32_bf16 v[28:31], a[224:227], a[128:131], v[28:31]
ds_read_b64_tr_b16 a[208:209], v250 offset:34816
v_mfma_f32_16x16x32_bf16 v[32:35], a[224:227], a[132:135], v[32:35]
ds_read_b64_tr_b16 a[210:211], v250 offset:35328
v_mfma_f32_16x16x32_bf16 v[36:39], a[228:231], a[128:131], v[36:39]
ds_read_b64_tr_b16 a[212:213], v251 offset:34816
s_add_u32 s22, s15, 8192
v_mfma_f32_16x16x32_bf16 v[40:43], a[228:231], a[132:135], v[40:43]
ds_read_b64_tr_b16 a[214:215], v251 offset:35328
buffer_load_dword v23, v6, s[32:35], s22 offen sc1
v_mfma_f32_16x16x32_bf16 v[28:31], a[232:235], a[136:139], v[28:31]
ds_read_b64_tr_b16 a[216:217], v250 offset:35840
v_mfma_f32_16x16x32_bf16 v[32:35], a[232:235], a[140:143], v[32:35]
ds_read_b64_tr_b16 a[218:219], v250 offset:36352
v_mfma_f32_16x16x32_bf16 v[36:39], a[236:239], a[136:139], v[36:39]
ds_read_b64_tr_b16 a[220:221], v251 offset:35840
v_mfma_f32_16x16x32_bf16 v[40:43], a[236:239], a[140:143], v[40:43]
ds_read_b64_tr_b16 a[222:223], v251 offset:36352
s_waitcnt lgkmcnt(8)
v_mfma_f32_16x16x32_bf16 v[28:31], a[192:195], a[144:147], v[28:31]
s_waitcnt vmcnt(7)
s_barrier
ds_read_b64_tr_b16 a[224:225], v250 offset:36864
v_mfma_f32_16x16x32_bf16 v[32:35], a[192:195], a[148:151], v[32:35]
ds_read_b64_tr_b16 a[226:227], v250 offset:37376
v_mfma_f32_16x16x32_bf16 v[36:39], a[196:199], a[144:147], v[36:39]
ds_read_b64_tr_b16 a[228:229], v251 offset:36864
v_mfma_f32_16x16x32_bf16 v[40:43], a[196:199], a[148:151], v[40:43]
ds_read_b64_tr_b16 a[230:231], v251 offset:37376
v_mfma_f32_16x16x32_bf16 v[28:31], a[200:203], a[152:155], v[28:31]
ds_read_b64_tr_b16 a[232:233], v250 offset:37888
v_mfma_f32_16x16x32_bf16 v[32:35], a[200:203], a[156:159], v[32:35]
ds_read_b64_tr_b16 a[234:235], v250 offset:38400
v_mfma_f32_16x16x32_bf16 v[36:39], a[204:207], a[152:155], v[36:39]
ds_read_b64_tr_b16 a[236:237], v251 offset:37888
v_mfma_f32_16x16x32_bf16 v[40:43], a[204:207], a[156:159], v[40:43]
ds_read_b64_tr_b16 a[238:239], v251 offset:38400
s_waitcnt lgkmcnt(8)
v_mfma_f32_16x16x32_bf16 v[28:31], a[208:211], a[160:163], v[28:31]
ds_read_b64_tr_b16 a[192:193], v250 offset:38912
v_mfma_f32_16x16x32_bf16 v[32:35], a[208:211], a[164:167], v[32:35]
ds_read_b64_tr_b16 a[194:195], v250 offset:39424
v_mfma_f32_16x16x32_bf16 v[36:39], a[212:215], a[160:163], v[36:39]
ds_read_b64_tr_b16 a[196:197], v251 offset:38912
v_mfma_f32_16x16x32_bf16 v[40:43], a[212:215], a[164:167], v[40:43]
ds_read_b64_tr_b16 a[198:199], v251 offset:39424
v_mfma_f32_16x16x32_bf16 v[28:31], a[216:219], a[168:171], v[28:31]
ds_read_b64_tr_b16 a[200:201], v250 offset:39936
v_mfma_f32_16x16x32_bf16 v[32:35], a[216:219], a[172:175], v[32:35]
ds_read_b64_tr_b16 a[202:203], v250 offset:40448
v_mfma_f32_16x16x32_bf16 v[36:39], a[220:223], a[168:171], v[36:39]
ds_read_b64_tr_b16 a[204:205], v251 offset:39936
v_mfma_f32_16x16x32_bf16 v[40:43], a[220:223], a[172:175], v[40:43]
ds_read_b64_tr_b16 a[206:207], v251 offset:40448
s_waitcnt lgkmcnt(8)
v_mfma_f32_16x16x32_bf16 v[28:31], a[224:227], a[176:179], v[28:31]
ds_read_b64_tr_b16 a[208:209], v250 offset:0
v_mfma_f32_16x16x32_bf16 v[32:35], a[224:227], a[180:183], v[32:35]
ds_read_b64_tr_b16 a[210:211], v250 offset:512
v_mfma_f32_16x16x32_bf16 v[36:39], a[228:231], a[176:179], v[36:39]
ds_read_b64_tr_b16 a[212:213], v251 offset:0
v_mfma_f32_16x16x32_bf16 v[40:43], a[228:231], a[180:183], v[40:43]
ds_read_b64_tr_b16 a[214:215], v251 offset:512
v_mfma_f32_16x16x32_bf16 v[28:31], a[232:235], a[184:187], v[28:31]
ds_read_b64_tr_b16 a[216:217], v250 offset:1024
v_mfma_f32_16x16x32_bf16 v[32:35], a[232:235], a[188:191], v[32:35]
ds_read_b64_tr_b16 a[218:219], v250 offset:1536
v_mfma_f32_16x16x32_bf16 v[36:39], a[236:239], a[184:187], v[36:39]
ds_read_b64_tr_b16 a[220:221], v251 offset:1024
v_mfma_f32_16x16x32_bf16 v[40:43], a[236:239], a[188:191], v[40:43]
ds_read_b64_tr_b16 a[222:223], v251 offset:1536
s_waitcnt lgkmcnt(8)
v_mfma_f32_16x16x32_bf16 v[28:31], a[192:195], a[0:3], v[28:31]
ds_read_b64_tr_b16 a[224:225], v250 offset:2048
v_mfma_f32_16x16x32_bf16 v[32:35], a[192:195], a[4:7], v[32:35]
ds_read_b64_tr_b16 a[226:227], v250 offset:2560
v_mfma_f32_16x16x32_bf16 v[36:39], a[196:199], a[0:3], v[36:39]
ds_read_b64_tr_b16 a[228:229], v251 offset:2048
v_mfma_f32_16x16x32_bf16 v[40:43], a[196:199], a[4:7], v[40:43]
ds_read_b64_tr_b16 a[230:231], v251 offset:2560
v_mfma_f32_16x16x32_bf16 v[28:31], a[200:203], a[8:11], v[28:31]
ds_read_b64_tr_b16 a[232:233], v250 offset:3072
v_mfma_f32_16x16x32_bf16 v[32:35], a[200:203], a[12:15], v[32:35]
ds_read_b64_tr_b16 a[234:235], v250 offset:3584
v_mfma_f32_16x16x32_bf16 v[36:39], a[204:207], a[8:11], v[36:39]
ds_read_b64_tr_b16 a[236:237], v251 offset:3072
v_mfma_f32_16x16x32_bf16 v[40:43], a[204:207], a[12:15], v[40:43]
ds_read_b64_tr_b16 a[238:239], v251 offset:3584
s_waitcnt vmcnt(0)
v_cmp_ne_u32 vcc, s63, v23
s_nop 1
s_and_b32 vcc_lo, vcc_lo, 4095
s_cbranch_scc0 L_ok_13
s_add_u32 s73, s15, 8192
v_lshl_add_u32 v2, v1, 7, s73
s_mov_b32 s74, 200000
s_mov_b32 exec_lo, 0xfff
s_mov_b32 exec_hi, 0x0
L_poll_14:
buffer_load_dword v4, v2, s[32:35], 0 offen sc1
s_sub_u32 s74, s74, 1
s_waitcnt vmcnt(0)
v_cmp_eq_u32 vcc, s63, v4
s_cmp_eq_u32 s74, 0
s_cbranch_scc1 L_polld_15
s_cmp_eq_u64 vcc, exec
s_cbranch_scc0 L_poll_14
L_polld_15:
s_mov_b64 exec, -1
L_ok_13:
s_add_u32 s22, s78, 16384
buffer_store_dword v22, v5, s[32:35], s22 offen sc1
s_waitcnt lgkmcnt(8)
v_mfma_f32_16x16x32_bf16 v[28:31], a[208:211], a[16:19], v[28:31]
ds_read_b64_tr_b16 a[192:193], v250 offset:4096
v_mfma_f32_16x16x32_bf16 v[32:35], a[208:211], a[20:23], v[32:35]
ds_read_b64_tr_b16 a[194:195], v250 offset:4608
v_mfma_f32_16x16x32_bf16 v[36:39], a[212:215], a[16:19], v[36:39]
ds_read_b64_tr_b16 a[196:197], v251 offset:4096
s_lshl_b32 s81, s76, 6
v_mfma_f32_16x16x32_bf16 v[40:43], a[212:215], a[20:23], v[40:43]
ds_read_b64_tr_b16 a[198:199], v251 offset:4608
s_mul_i32 s73, s76, 36864
v_mfma_f32_16x16x32_bf16 v[28:31], a[216:219], a[24:27], v[28:31]
ds_read_b64_tr_b16 a[200:201], v250 offset:5120
s_sub_u32 s74, 2068480, s73
v_mfma_f32_16x16x32_bf16 v[32:35], a[216:219], a[28:31], v[32:35]
ds_read_b64_tr_b16 a[202:203], v250 offset:5632
s_add_u32 s73, s73, 1441792
v_mfma_f32_16x16x32_bf16 v[36:39], a[220:223], a[24:27], v[36:39]
ds_read_b64_tr_b16 a[204:205], v251 offset:5120
v_mfma_f32_16x16x32_bf16 v[40:43], a[220:223], a[28:31], v[40:43]
ds_read_b64_tr_b16 a[206:207], v251 offset:5632
s_waitcnt lgkmcnt(8)
v_mfma_f32_16x16x32_bf16 v[28:31], a[224:227], a[32:35], v[28:31]
ds_read_b64_tr_b16 a[208:209], v250 offset:6144
v_mfma_f32_16x16x32_bf16 v[32:35], a[224:227], a[36:39], v[32:35]
ds_read_b64_tr_b16 a[210:211], v250 offset:6656
v_mfma_f32_16x16x32_bf16 v[36:39], a[228:231], a[32:35], v[36:39]
ds_read_b64_tr_b16 a[212:213], v251 offset:6144
s_cmp_ge_u32 s76, 9
s_cselect_b32 s73, s74, s73
s_cselect_b32 s74, s74, 2147483392
s_cselect_b64 vcc, -1, 0
v_mfma_f32_16x16x32_bf16 v[40:43], a[228:231], a[36:39], v[40:43]
ds_read_b64_tr_b16 a[214:215], v251 offset:6656
v_cndmask_b32 v3, v17, v18, vcc
v_mfma_f32_16x16x32_bf16 v[28:31], a[232:235], a[40:43], v[28:31]
ds_read_b64_tr_b16 a[216:217], v250 offset:7168
buffer_load_dwordx4 v[116:119], v16, s[28:31], s81 offen
v_mfma_f32_16x16x32_bf16 v[32:35], a[232:235], a[44:47], v[32:35]
ds_read_b64_tr_b16 a[218:219], v250 offset:7680
buffer_load_dwordx4 v[108:111], v3, s[32:35], s73 offen sc1
v_mfma_f32_16x16x32_bf16 v[36:39], a[236:239], a[40:43], v[36:39]
ds_read_b64_tr_b16 a[220:221], v251 offset:7168
buffer_load_dword v120, v24, s[32:35], s74 offen sc1
v_mfma_f32_16x16x32_bf16 v[40:43], a[236:239], a[44:47], v[40:43]
ds_read_b64_tr_b16 a[222:223], v251 offset:7680
s_waitcnt lgkmcnt(8)
v_mfma_f32_16x16x32_bf16 v[28:31], a[192:195], a[48:51], v[28:31]
ds_read_b64_tr_b16 a[224:225], v250 offset:8192
v_mfma_f32_16x16x32_bf16 v[32:35], a[192:195], a[52:55], v[32:35]
ds_read_b64_tr_b16 a[226:227], v250 offset:8704
v_mfma_f32_16x16x32_bf16 v[36:39], a[196:199], a[48:51], v[36:39]
ds_read_b64_tr_b16 a[228:229], v251 offset:8192
s_add_u32 s73, s73, 755712
v_mfma_f32_16x16x32_bf16 v[40:43], a[196:199], a[52:55], v[40:43]
ds_read_b64_tr_b16 a[230:231], v251 offset:8704
s_add_u32 s74, s74, 755712
v_mfma_f32_16x16x32_bf16 v[28:31], a[200:203], a[56:59], v[28:31]
ds_read_b64_tr_b16 a[232:233], v250 offset:9216
buffer_load_dwordx4 v[112:115], v3, s[32:35], s73 offen sc1
v_mfma_f32_16x16x32_bf16 v[32:35], a[200:203], a[60:63], v[32:35]
ds_read_b64_tr_b16 a[234:235], v250 offset:9728
buffer_load_dword v122, v24, s[32:35], s74 offen sc1
v_mfma_f32_16x16x32_bf16 v[36:39], a[204:207], a[56:59], v[36:39]
ds_read_b64_tr_b16 a[236:237], v251 offset:9216
s_add_u32 s81, s81, 18432
v_mfma_f32_16x16x32_bf16 v[40:43], a[204:207], a[60:63], v[40:43]
ds_read_b64_tr_b16 a[238:239], v251 offset:9728
s_waitcnt lgkmcnt(8)
v_mfma_f32_16x16x32_bf16 v[28:31], a[208:211], a[64:67], v[28:31]
ds_read_b64_tr_b16 a[192:193], v252 offset:20480
v_mfma_f32_16x16x32_bf16 v[32:35], a[208:211], a[68:71], v[32:35]
ds_read_b64_tr_b16 a[194:195], v252 offset:20992
v_mfma_f32_16x16x32_bf16 v[36:39], a[212:215], a[64:67], v[36:39]
ds_read_b64_tr_b16 a[196:197], v253 offset:20480
s_sub_u32 s75, s77, 755712
v_mfma_f32_16x16x32_bf16 v[40:43], a[212:215], a[68:71], v[40:43]
ds_read_b64_tr_b16 a[198:199], v253 offset:20992
s_add_u32 s73, s73, s75
v_mfma_f32_16x16x32_bf16 v[28:31], a[216:219], a[72:75], v[28:31]
ds_read_b64_tr_b16 a[200:201], v252 offset:21504
s_add_u32 s74, s74, s75
v_mfma_f32_16x16x32_bf16 v[32:35], a[216:219], a[76:79], v[32:35]
ds_read_b64_tr_b16 a[202:203], v252 offset:22016
buffer_load_dwordx4 v[132:135], v16, s[28:31], s81 offen
v_mfma_f32_16x16x32_bf16 v[36:39], a[220:223], a[72:75], v[36:39]
ds_read_b64_tr_b16 a[204:205], v253 offset:21504
buffer_load_dwordx4 v[124:127], v3, s[32:35], s73 offen sc1
v_mfma_f32_16x16x32_bf16 v[40:43], a[220:223], a[76:79], v[40:43]
ds_read_b64_tr_b16 a[206:207], v253 offset:22016
s_waitcnt lgkmcnt(8)
v_mfma_f32_16x16x32_bf16 v[28:31], a[224:227], a[80:83], v[28:31]
ds_read_b64_tr_b16 a[208:209], v252 offset:22528
v_mfma_f32_16x16x32_bf16 v[32:35], a[224:227], a[84:87], v[32:35]
ds_read_b64_tr_b16 a[210:211], v252 offset:23040
v_mfma_f32_16x16x32_bf16 v[36:39], a[228:231], a[80:83], v[36:39]
ds_read_b64_tr_b16 a[212:213], v253 offset:22528
buffer_load_dword v136, v24, s[32:35], s74 offen sc1
v_mfma_f32_16x16x32_bf16 v[40:43], a[228:231], a[84:87], v[40:43]
ds_read_b64_tr_b16 a[214:215], v253 offset:23040
s_add_u32 s73, s73, 755712
v_mfma_f32_16x16x32_bf16 v[28:31], a[232:235], a[88:91], v[28:31]
ds_read_b64_tr_b16 a[216:217], v252 offset:23552
s_add_u32 s74, s74, 755712
v_mfma_f32_16x16x32_bf16 v[32:35], a[232:235], a[92:95], v[32:35]
ds_read_b64_tr_b16 a[218:219], v252 offset:24064
buffer_load_dwordx4 v[128:131], v3, s[32:35], s73 offen sc1
v_mfma_f32_16x16x32_bf16 v[36:39], a[236:239], a[88:91], v[36:39]
ds_read_b64_tr_b16 a[220:221], v253 offset:23552
buffer_load_dword v138, v24, s[32:35], s74 offen sc1
v_mfma_f32_16x16x32_bf16 v[40:43], a[236:239], a[92:95], v[40:43]
ds_read_b64_tr_b16 a[222:223], v253 offset:24064
s_waitcnt lgkmcnt(8)
v_mfma_f32_16x16x32_bf16 v[44:47], a[192:195], v[172:175], 0
ds_read_b64_tr_b16 a[224:225], v252 offset:24576
v_cvt_pk_bf16_f32 v92, v28, v29
v_mfma_f32_16x16x32_bf16 v[48:51], a[192:195], v[176:179], 0
ds_read_b64_tr_b16 a[226:227], v252 offset:25088
v_cvt_pk_bf16_f32 v93, v30, v31
v_mfma_f32_16x16x32_bf16 v[52:55], a[196:199], v[172:175], 0
ds_read_b64_tr_b16 a[228:229], v253 offset:24576
v_cvt_pk_bf16_f32 v94, v36, v37
v_mfma_f32_16x16x32_bf16 v[56:59], a[196:199], v[176:179], 0
ds_read_b64_tr_b16 a[230:231], v253 offset:25088
v_cvt_pk_bf16_f32 v95, v38, v39
v_mfma_f32_16x16x32_bf16 v[44:47], a[200:203], v[180:183], v[44:47]
ds_read_b64_tr_b16 a[232:233], v252 offset:25600
buffer_store_dwordx4 v[92:95], v20, s[32:35], s19 offen offset:0 sc1
v_mfma_f32_16x16x32_bf16 v[48:51], a[200:203], v[184:187], v[48:51]
ds_read_b64_tr_b16 a[234:235], v252 offset:26112
v_mfma_f32_16x16x32_bf16 v[52:55], a[204:207], v[180:183], v[52:55]
ds_read_b64_tr_b16 a[236:237], v253 offset:25600
v_mfma_f32_16x16x32_bf16 v[56:59], a[204:207], v[184:187], v[56:59]
ds_read_b64_tr_b16 a[238:239], v253 offset:26112
s_waitcnt lgkmcnt(8)
v_mfma_f32_16x16x32_bf16 v[44:47], a[208:211], v[188:191], v[44:47]
ds_read_b64_tr_b16 a[192:193], v252 offset:26624
v_mfma_f32_16x16x32_bf16 v[48:51], a[208:211], v[192:195], v[48:51]
ds_read_b64_tr_b16 a[194:195], v252 offset:27136
v_mfma_f32_16x16x32_bf16 v[52:55], a[212:215], v[188:191], v[52:55]
ds_read_b64_tr_b16 a[196:197], v253 offset:26624
v_cvt_pk_bf16_f32 v96, v32, v33
v_mfma_f32_16x16x32_bf16 v[56:59], a[212:215], v[192:195], v[56:59]
ds_read_b64_tr_b16 a[198:199], v253 offset:27136
v_cvt_pk_bf16_f32 v97, v34, v35
v_mfma_f32_16x16x32_bf16 v[44:47], a[216:219], v[196:199], v[44:47]
ds_read_b64_tr_b16 a[200:201], v252 offset:27648
v_cvt_pk_bf16_f32 v98, v40, v41
v_mfma_f32_16x16x32_bf16 v[48:51], a[216:219], v[200:203], v[48:51]
ds_read_b64_tr_b16 a[202:203], v252 offset:28160
v_cvt_pk_bf16_f32 v99, v42, v43
v_mfma_f32_16x16x32_bf16 v[52:55], a[220:223], v[196:199], v[52:55]
ds_read_b64_tr_b16 a[204:205], v253 offset:27648
buffer_store_dwordx4 v[96:99], v20, s[32:35], s19 offen offset:1024 sc1
v_mfma_f32_16x16x32_bf16 v[56:59], a[220:223], v[200:203], v[56:59]
ds_read_b64_tr_b16 a[206:207], v253 offset:28160
s_waitcnt lgkmcnt(8)
v_mfma_f32_16x16x32_bf16 v[44:47], a[224:227], v[204:207], v[44:47]
ds_read_b64_tr_b16 a[208:209], v252 offset:28672
v_mfma_f32_16x16x32_bf16 v[48:51], a[224:227], v[208:211], v[48:51]
ds_read_b64_tr_b16 a[210:211], v252 offset:29184
v_mfma_f32_16x16x32_bf16 v[52:55], a[228:231], v[204:207], v[52:55]
ds_read_b64_tr_b16 a[212:213], v253 offset:28672
v_mfma_f32_16x16x32_bf16 v[56:59], a[228:231], v[208:211], v[56:59]
ds_read_b64_tr_b16 a[214:215], v253 offset:29184
v_mfma_f32_16x16x32_bf16 v[44:47], a[232:235], v[212:215], v[44:47]
ds_read_b64_tr_b16 a[216:217], v252 offset:29696
v_mfma_f32_16x16x32_bf16 v[48:51], a[232:235], v[216:219], v[48:51]
ds_read_b64_tr_b16 a[218:219], v252 offset:30208
v_mfma_f32_16x16x32_bf16 v[52:55], a[236:239], v[212:215], v[52:55]
ds_read_b64_tr_b16 a[220:221], v253 offset:29696
v_mfma_f32_16x16x32_bf16 v[56:59], a[236:239], v[216:219], v[56:59]
ds_read_b64_tr_b16 a[222:223], v253 offset:30208
s_waitcnt lgkmcnt(8)
v_mfma_f32_16x16x32_bf16 v[44:47], a[192:195], v[156:159], v[44:47]
ds_read_b64_tr_b16 a[224:225], v252 offset:30720
v_mfma_f32_16x16x32_bf16 v[48:51], a[192:195], v[160:163], v[48:51]
ds_read_b64_tr_b16 a[226:227], v252 offset:31232
v_mfma_f32_16x16x32_bf16 v[52:55], a[196:199], v[156:159], v[52:55]
ds_read_b64_tr_b16 a[228:229], v253 offset:30720
v_mfma_f32_16x16x32_bf16 v[56:59], a[196:199], v[160:163], v[56:59]
ds_read_b64_tr_b16 a[230:231], v253 offset:31232
v_mfma_f32_16x16x32_bf16 v[44:47], a[200:203], v[164:167], v[44:47]
ds_read_b64_tr_b16 a[232:233], v252 offset:31744
v_mfma_f32_16x16x32_bf16 v[48:51], a[200:203], v[168:171], v[48:51]
ds_read_b64_tr_b16 a[234:235], v252 offset:32256
v_mfma_f32_16x16x32_bf16 v[52:55], a[204:207], v[164:167], v[52:55]
ds_read_b64_tr_b16 a[236:237], v253 offset:31744
v_mfma_f32_16x16x32_bf16 v[56:59], a[204:207], v[168:171], v[56:59]
ds_read_b64_tr_b16 a[238:239], v253 offset:32256
s_waitcnt lgkmcnt(8)
v_mfma_f32_16x16x32_bf16 v[44:47], a[208:211], v[220:223], v[44:47]
ds_read_b64_tr_b16 a[192:193], v252 offset:32768
v_mfma_f32_16x16x32_bf16 v[48:51], a[208:211], v[224:227], v[48:51]
ds_read_b64_tr_b16 a[194:195], v252 offset:33280
v_mfma_f32_16x16x32_bf16 v[52:55], a[212:215], v[220:223], v[52:55]
ds_read_b64_tr_b16 a[196:197], v253 offset:32768
v_mfma_f32_16x16x32_bf16 v[56:59], a[212:215], v[224:227], v[56:59]
ds_read_b64_tr_b16 a[198:199], v253 offset:33280
v_mfma_f32_16x16x32_bf16 v[44:47], a[216:219], v[228:231], v[44:47]
ds_read_b64_tr_b16 a[200:201], v252 offset:33792
v_mfma_f32_16x16x32_bf16 v[48:51], a[216:219], v[232:235], v[48:51]
ds_read_b64_tr_b16 a[202:203], v252 offset:34304
v_mfma_f32_16x16x32_bf16 v[52:55], a[220:223], v[228:231], v[52:55]
ds_read_b64_tr_b16 a[204:205], v253 offset:33792
v_mfma_f32_16x16x32_bf16 v[56:59], a[220:223], v[232:235], v[56:59]
ds_read_b64_tr_b16 a[206:207], v253 offset:34304
s_waitcnt lgkmcnt(8)
v_mfma_f32_16x16x32_bf16 v[44:47], a[224:227], a[128:131], v[44:47]
ds_read_b64_tr_b16 a[208:209], v252 offset:34816
v_mfma_f32_16x16x32_bf16 v[48:51], a[224:227], a[132:135], v[48:51]
ds_read_b64_tr_b16 a[210:211], v252 offset:35328
v_mfma_f32_16x16x32_bf16 v[52:55], a[228:231], a[128:131], v[52:55]
ds_read_b64_tr_b16 a[212:213], v253 offset:34816
s_add_u32 s22, s78, 16384
v_mfma_f32_16x16x32_bf16 v[56:59], a[228:231], a[132:135], v[56:59]
ds_read_b64_tr_b16 a[214:215], v253 offset:35328
buffer_load_dword v23, v7, s[32:35], s22 offen sc1
v_mfma_f32_16x16x32_bf16 v[44:47], a[232:235], a[136:139], v[44:47]
ds_read_b64_tr_b16 a[216:217], v252 offset:35840
v_mfma_f32_16x16x32_bf16 v[48:51], a[232:235], a[140:143], v[48:51]
ds_read_b64_tr_b16 a[218:219], v252 offset:36352
v_mfma_f32_16x16x32_bf16 v[52:55], a[236:239], a[136:139], v[52:55]
ds_read_b64_tr_b16 a[220:221], v253 offset:35840
v_mfma_f32_16x16x32_bf16 v[56:59], a[236:239], a[140:143], v[56:59]
ds_read_b64_tr_b16 a[222:223], v253 offset:36352
s_waitcnt lgkmcnt(8)
v_mfma_f32_16x16x32_bf16 v[44:47], a[192:195], a[144:147], v[44:47]
ds_read_b64_tr_b16 a[224:225], v252 offset:36864
v_mfma_f32_16x16x32_bf16 v[48:51], a[192:195], a[148:151], v[48:51]
ds_read_b64_tr_b16 a[226:227], v252 offset:37376
v_mfma_f32_16x16x32_bf16 v[52:55], a[196:199], a[144:147], v[52:55]
ds_read_b64_tr_b16 a[228:229], v253 offset:36864
v_mfma_f32_16x16x32_bf16 v[56:59], a[196:199], a[148:151], v[56:59]
ds_read_b64_tr_b16 a[230:231], v253 offset:37376
v_mfma_f32_16x16x32_bf16 v[44:47], a[200:203], a[152:155], v[44:47]
ds_read_b64_tr_b16 a[232:233], v252 offset:37888
v_mfma_f32_16x16x32_bf16 v[48:51], a[200:203], a[156:159], v[48:51]
ds_read_b64_tr_b16 a[234:235], v252 offset:38400
v_mfma_f32_16x16x32_bf16 v[52:55], a[204:207], a[152:155], v[52:55]
ds_read_b64_tr_b16 a[236:237], v253 offset:37888
v_mfma_f32_16x16x32_bf16 v[56:59], a[204:207], a[156:159], v[56:59]
ds_read_b64_tr_b16 a[238:239], v253 offset:38400
s_waitcnt lgkmcnt(8)
v_mfma_f32_16x16x32_bf16 v[44:47], a[208:211], a[160:163], v[44:47]
ds_read_b64_tr_b16 a[192:193], v252 offset:38912
v_mfma_f32_16x16x32_bf16 v[48:51], a[208:211], a[164:167], v[48:51]
ds_read_b64_tr_b16 a[194:195], v252 offset:39424
v_mfma_f32_16x16x32_bf16 v[52:55], a[212:215], a[160:163], v[52:55]
ds_read_b64_tr_b16 a[196:197], v253 offset:38912
v_mfma_f32_16x16x32_bf16 v[56:59], a[212:215], a[164:167], v[56:59]
ds_read_b64_tr_b16 a[198:199], v253 offset:39424
v_mfma_f32_16x16x32_bf16 v[44:47], a[216:219], a[168:171], v[44:47]
ds_read_b64_tr_b16 a[200:201], v252 offset:39936
v_mfma_f32_16x16x32_bf16 v[48:51], a[216:219], a[172:175], v[48:51]
ds_read_b64_tr_b16 a[202:203], v252 offset:40448
v_mfma_f32_16x16x32_bf16 v[52:55], a[220:223], a[168:171], v[52:55]
ds_read_b64_tr_b16 a[204:205], v253 offset:39936
v_mfma_f32_16x16x32_bf16 v[56:59], a[220:223], a[172:175], v[56:59]
ds_read_b64_tr_b16 a[206:207], v253 offset:40448
s_waitcnt vmcnt(1)
s_add_u32 s22, s78, 24576
buffer_store_dword v22, v5, s[32:35], s22 offen sc1
s_waitcnt lgkmcnt(8)
v_mfma_f32_16x16x32_bf16 v[44:47], a[224:227], a[176:179], v[44:47]
ds_read_b64_tr_b16 a[208:209], v252 offset:0
v_mfma_f32_16x16x32_bf16 v[48:51], a[224:227], a[180:183], v[48:51]
ds_read_b64_tr_b16 a[210:211], v252 offset:512
v_mfma_f32_16x16x32_bf16 v[52:55], a[228:231], a[176:179], v[52:55]
ds_read_b64_tr_b16 a[212:213], v253 offset:0
v_mfma_f32_16x16x32_bf16 v[56:59], a[228:231], a[180:183], v[56:59]
ds_read_b64_tr_b16 a[214:215], v253 offset:512
v_mfma_f32_16x16x32_bf16 v[44:47], a[232:235], a[184:187], v[44:47]
ds_read_b64_tr_b16 a[216:217], v252 offset:1024
v_mfma_f32_16x16x32_bf16 v[48:51], a[232:235], a[188:191], v[48:51]
ds_read_b64_tr_b16 a[218:219], v252 offset:1536
v_mfma_f32_16x16x32_bf16 v[52:55], a[236:239], a[184:187], v[52:55]
ds_read_b64_tr_b16 a[220:221], v253 offset:1024
v_mfma_f32_16x16x32_bf16 v[56:59], a[236:239], a[188:191], v[56:59]
ds_read_b64_tr_b16 a[222:223], v253 offset:1536
s_waitcnt lgkmcnt(8)
v_mfma_f32_16x16x32_bf16 v[44:47], a[192:195], a[0:3], v[44:47]
ds_read_b64_tr_b16 a[224:225], v252 offset:2048
v_mfma_f32_16x16x32_bf16 v[48:51], a[192:195], a[4:7], v[48:51]
ds_read_b64_tr_b16 a[226:227], v252 offset:2560
v_mfma_f32_16x16x32_bf16 v[52:55], a[196:199], a[0:3], v[52:55]
ds_read_b64_tr_b16 a[228:229], v253 offset:2048
v_mfma_f32_16x16x32_bf16 v[56:59], a[196:199], a[4:7], v[56:59]
ds_read_b64_tr_b16 a[230:231], v253 offset:2560
v_mfma_f32_16x16x32_bf16 v[44:47], a[200:203], a[8:11], v[44:47]
ds_read_b64_tr_b16 a[232:233], v252 offset:3072
v_mfma_f32_16x16x32_bf16 v[48:51], a[200:203], a[12:15], v[48:51]
ds_read_b64_tr_b16 a[234:235], v252 offset:3584
v_mfma_f32_16x16x32_bf16 v[52:55], a[204:207], a[8:11], v[52:55]
ds_read_b64_tr_b16 a[236:237], v253 offset:3072
v_mfma_f32_16x16x32_bf16 v[56:59], a[204:207], a[12:15], v[56:59]
ds_read_b64_tr_b16 a[238:239], v253 offset:3584
s_waitcnt vmcnt(1)
v_cmp_ne_u32 vcc, s63, v23
s_nop 1
s_and_b32 vcc_lo, vcc_lo, s92
s_cbranch_scc1 L_late_16
s_mov_b32 s92, 0
buffer_load_dwordx4 v[156:159], v20, s[32:35], s4 offen offset:0 sc1
buffer_load_dwordx4 v[160:163], v20, s[32:35], s4 offen offset:1024 sc1
buffer_load_dwordx4 v[164:167], v20, s[32:35], s5 offen offset:0 sc1
buffer_load_dwordx4 v[168:171], v20, s[32:35], s5 offen offset:1024 sc1
buffer_load_dwordx4 v[172:175], v20, s[32:35], s12 offen offset:0 sc1
buffer_load_dwordx4 v[176:179], v20, s[32:35], s12 offen offset:1024 sc1
L_late_16:
s_waitcnt lgkmcnt(8)
v_mfma_f32_16x16x32_bf16 v[44:47], a[208:211], a[16:19], v[44:47]
ds_read_b64_tr_b16 a[192:193], v252 offset:4096
v_mfma_f32_16x16x32_bf16 v[48:51], a[208:211], a[20:23], v[48:51]
ds_read_b64_tr_b16 a[194:195], v252 offset:4608
v_mfma_f32_16x16x32_bf16 v[52:55], a[212:215], a[16:19], v[52:55]
ds_read_b64_tr_b16 a[196:197], v253 offset:4096
v_mfma_f32_16x16x32_bf16 v[56:59], a[212:215], a[20:23], v[56:59]
ds_read_b64_tr_b16 a[198:199], v253 offset:4608
v_mfma_f32_16x16x32_bf16 v[44:47], a[216:219], a[24:27], v[44:47]
ds_read_b64_tr_b16 a[200:201], v252 offset:5120
v_mfma_f32_16x16x32_bf16 v[48:51], a[216:219], a[28:31], v[48:51]
ds_read_b64_tr_b16 a[202:203], v252 offset:5632
v_mfma_f32_16x16x32_bf16 v[52:55], a[220:223], a[24:27], v[52:55]
ds_read_b64_tr_b16 a[204:205], v253 offset:5120
v_mfma_f32_16x16x32_bf16 v[56:59], a[220:223], a[28:31], v[56:59]
ds_read_b64_tr_b16 a[206:207], v253 offset:5632
s_waitcnt lgkmcnt(8)
v_mfma_f32_16x16x32_bf16 v[44:47], a[224:227], a[32:35], v[44:47]
ds_read_b64_tr_b16 a[208:209], v252 offset:6144
v_mfma_f32_16x16x32_bf16 v[48:51], a[224:227], a[36:39], v[48:51]
ds_read_b64_tr_b16 a[210:211], v252 offset:6656
v_mfma_f32_16x16x32_bf16 v[52:55], a[228:231], a[32:35], v[52:55]
ds_read_b64_tr_b16 a[212:213], v253 offset:6144
v_mfma_f32_16x16x32_bf16 v[56:59], a[228:231], a[36:39], v[56:59]
ds_read_b64_tr_b16 a[214:215], v253 offset:6656
v_mfma_f32_16x16x32_bf16 v[44:47], a[232:235], a[40:43], v[44:47]
ds_read_b64_tr_b16 a[216:217], v252 offset:7168
v_mfma_f32_16x16x32_bf16 v[48:51], a[232:235], a[44:47], v[48:51]
ds_read_b64_tr_b16 a[218:219], v252 offset:7680
v_mfma_f32_16x16x32_bf16 v[52:55], a[236:239], a[40:43], v[52:55]
ds_read_b64_tr_b16 a[220:221], v253 offset:7168
v_mfma_f32_16x16x32_bf16 v[56:59], a[236:239], a[44:47], v[56:59]
ds_read_b64_tr_b16 a[222:223], v253 offset:7680
s_waitcnt lgkmcnt(8)
v_mfma_f32_16x16x32_bf16 v[44:47], a[192:195], a[48:51], v[44:47]
ds_read_b64_tr_b16 a[224:225], v252 offset:8192
v_mfma_f32_16x16x32_bf16 v[48:51], a[192:195], a[52:55], v[48:51]
ds_read_b64_tr_b16 a[226:227], v252 offset:8704
v_mfma_f32_16x16x32_bf16 v[52:55], a[196:199], a[48:51], v[52:55]
ds_read_b64_tr_b16 a[228:229], v253 offset:8192
v_mfma_f32_16x16x32_bf16 v[56:59], a[196:199], a[52:55], v[56:59]
ds_read_b64_tr_b16 a[230:231], v253 offset:8704
v_mfma_f32_16x16x32_bf16 v[44:47], a[200:203], a[56:59], v[44:47]
ds_read_b64_tr_b16 a[232:233], v252 offset:9216
v_mfma_f32_16x16x32_bf16 v[48:51], a[200:203], a[60:63], v[48:51]
ds_read_b64_tr_b16 a[234:235], v252 offset:9728
v_mfma_f32_16x16x32_bf16 v[52:55], a[204:207], a[56:59], v[52:55]
ds_read_b64_tr_b16 a[236:237], v253 offset:9216
v_mfma_f32_16x16x32_bf16 v[56:59], a[204:207], a[60:63], v[56:59]
ds_read_b64_tr_b16 a[238:239], v253 offset:9728
s_waitcnt lgkmcnt(8)
v_mfma_f32_16x16x32_bf16 v[44:47], a[208:211], a[64:67], v[44:47]
v_mfma_f32_16x16x32_bf16 v[48:51], a[208:211], a[68:71], v[48:51]
v_mfma_f32_16x16x32_bf16 v[52:55], a[212:215], a[64:67], v[52:55]
s_add_u32 s22, s78, 24576
v_mfma_f32_16x16x32_bf16 v[56:59], a[212:215], a[68:71], v[56:59]
buffer_load_dword v21, v10, s[32:35], s22 offen sc1
v_mfma_f32_16x16x32_bf16 v[44:47], a[216:219], a[72:75], v[44:47]
v_mfma_f32_16x16x32_bf16 v[48:51], a[216:219], a[76:79], v[48:51]
v_mfma_f32_16x16x32_bf16 v[52:55], a[220:223], a[72:75], v[52:55]
v_mfma_f32_16x16x32_bf16 v[56:59], a[220:223], a[76:79], v[56:59]
s_waitcnt lgkmcnt(0)
v_mfma_f32_16x16x32_bf16 v[44:47], a[224:227], a[80:83], v[44:47]
v_mfma_f32_16x16x32_bf16 v[48:51], a[224:227], a[84:87], v[48:51]
v_mfma_f32_16x16x32_bf16 v[52:55], a[228:231], a[80:83], v[52:55]
v_mfma_f32_16x16x32_bf16 v[56:59], a[228:231], a[84:87], v[56:59]
v_mfma_f32_16x16x32_bf16 v[44:47], a[232:235], a[88:91], v[44:47]
v_mfma_f32_16x16x32_bf16 v[48:51], a[232:235], a[92:95], v[48:51]
v_mfma_f32_16x16x32_bf16 v[52:55], a[236:239], a[88:91], v[52:55]
v_mfma_f32_16x16x32_bf16 v[56:59], a[236:239], a[92:95], v[56:59]
s_cmp_ge_u32 s76, 9
s_cbranch_scc1 L_mir_33
v_mov_b32 v3, v19
v_lshlrev_b32 v60, 16, v108
v_and_b32 v61, 0xffff0000, v108
v_lshlrev_b32 v62, 16, v109
v_and_b32 v63, 0xffff0000, v109
v_lshlrev_b32 v64, 16, v110
v_and_b32 v65, 0xffff0000, v110
v_lshlrev_b32 v66, 16, v111
v_and_b32 v67, 0xffff0000, v111
v_lshlrev_b32 v28, 16, v112
v_and_b32 v29, 0xffff0000, v112
v_lshlrev_b32 v30, 16, v113
v_and_b32 v31, 0xffff0000, v113
v_lshlrev_b32 v32, 16, v114
v_and_b32 v33, 0xffff0000, v114
v_lshlrev_b32 v34, 16, v115
v_and_b32 v35, 0xffff0000, v115
v_lshlrev_b32 v68, 16, v124
v_and_b32 v69, 0xffff0000, v124
v_lshlrev_b32 v70, 16, v125
v_and_b32 v71, 0xffff0000, v125
v_lshlrev_b32 v72, 16, v126
v_and_b32 v73, 0xffff0000, v126
v_lshlrev_b32 v74, 16, v127
v_and_b32 v75, 0xffff0000, v127
v_lshlrev_b32 v36, 16, v128
v_and_b32 v37, 0xffff0000, v128
v_lshlrev_b32 v38, 16, v129
v_and_b32 v39, 0xffff0000, v129
v_lshlrev_b32 v40, 16, v130
v_and_b32 v41, 0xffff0000, v130
v_lshlrev_b32 v42, 16, v131
v_and_b32 v43, 0xffff0000, v131
s_branch L_join_34
L_mir_33:
ds_bpermute_b32 v60, v25, v110
ds_bpermute_b32 v64, v25, v108
ds_bpermute_b32 v28, v25, v114
ds_bpermute_b32 v32, v25, v112
ds_bpermute_b32 v68, v25, v126
ds_bpermute_b32 v72, v25, v124
ds_bpermute_b32 v36, v25, v130
ds_bpermute_b32 v40, v25, v128
v_xor_b32 v3, 0x80000000, v19
v_cmp_gt_u32 vcc, 16, v1
v_and_b32 v61, 0xffff0000, v111
v_lshlrev_b32 v62, 16, v111
v_and_b32 v63, 0xffff0000, v110
v_and_b32 v65, 0xffff0000, v109
v_lshlrev_b32 v66, 16, v109
v_and_b32 v67, 0xffff0000, v108
v_and_b32 v29, 0xffff0000, v115
v_lshlrev_b32 v30, 16, v115
v_and_b32 v31, 0xffff0000, v114
v_and_b32 v33, 0xffff0000, v113
v_lshlrev_b32 v34, 16, v113
v_and_b32 v35, 0xffff0000, v112
v_and_b32 v69, 0xffff0000, v127
v_lshlrev_b32 v70, 16, v127
v_and_b32 v71, 0xffff0000, v126
v_and_b32 v73, 0xffff0000, v125
v_lshlrev_b32 v74, 16, v125
v_and_b32 v75, 0xffff0000, v124
v_and_b32 v37, 0xffff0000, v131
v_lshlrev_b32 v38, 16, v131
v_and_b32 v39, 0xffff0000, v130
v_and_b32 v41, 0xffff0000, v129
v_lshlrev_b32 v42, 16, v129
v_and_b32 v43, 0xffff0000, v128
s_waitcnt lgkmcnt(0)
v_cndmask_b32 v64, v64, v60, vcc
v_cndmask_b32 v60, v60, v120, vcc
v_lshlrev_b32 v64, 16, v64
v_lshlrev_b32 v60, 16, v60
v_cndmask_b32 v32, v32, v28, vcc
v_cndmask_b32 v28, v28, v122, vcc
v_lshlrev_b32 v32, 16, v32
v_lshlrev_b32 v28, 16, v28
v_cndmask_b32 v72, v72, v68, vcc
v_cndmask_b32 v68, v68, v136, vcc
v_lshlrev_b32 v72, 16, v72
v_lshlrev_b32 v68, 16, v68
v_cndmask_b32 v40, v40, v36, vcc
v_cndmask_b32 v36, v36, v138, vcc
v_lshlrev_b32 v40, 16, v40
v_lshlrev_b32 v36, 16, v36
L_join_34:
v_fma_f32 v60, v3, v28, v60
v_fma_f32 v61, v3, v29, v61
v_fma_f32 v62, v3, v30, v62
v_fma_f32 v63, v3, v31, v63
v_fma_f32 v64, v3, v32, v64
v_fma_f32 v65, v3, v33, v65
v_fma_f32 v66, v3, v34, v66
v_fma_f32 v67, v3, v35, v67
v_mul_f32 v60, v238, v60
v_mul_f32 v61, v238, v61
v_mul_f32 v62, v238, v62
v_mul_f32 v63, v238, v63
v_mul_f32 v64, v238, v64
v_mul_f32 v65, v238, v65
v_mul_f32 v66, v238, v66
v_mul_f32 v67, v238, v67
v_lshlrev_b32 v108, 16, v116
v_and_b32 v109, 0xffff0000, v116
v_lshlrev_b32 v110, 16, v117
v_and_b32 v111, 0xffff0000, v117
v_lshlrev_b32 v112, 16, v118
v_and_b32 v113, 0xffff0000, v118
v_lshlrev_b32 v114, 16, v119
v_and_b32 v115, 0xffff0000, v119
v_fma_f32 v68, v3, v36, v68
v_fma_f32 v69, v3, v37, v69
v_fma_f32 v70, v3, v38, v70
v_fma_f32 v71, v3, v39, v71
v_fma_f32 v72, v3, v40, v72
v_fma_f32 v73, v3, v41, v73
v_fma_f32 v74, v3, v42, v74
v_fma_f32 v75, v3, v43, v75
v_mul_f32 v68, v239, v68
v_mul_f32 v69, v239, v69
v_mul_f32 v70, v239, v70
v_mul_f32 v71, v239, v71
v_mul_f32 v72, v239, v72
v_mul_f32 v73, v239, v73
v_mul_f32 v74, v239, v74
v_mul_f32 v75, v239, v75
v_lshlrev_b32 v124, 16, v132
v_and_b32 v125, 0xffff0000, v132
v_lshlrev_b32 v126, 16, v133
v_and_b32 v127, 0xffff0000, v133
v_lshlrev_b32 v128, 16, v134
v_and_b32 v129, 0xffff0000, v134
v_lshlrev_b32 v130, 16, v135
v_and_b32 v131, 0xffff0000, v135
s_cmp_eq_u32 s92, 0
s_cbranch_scc1 L_fin_early
s_add_u32 s73, s78, 16384
v_lshl_add_u32 v2, v1, 7, s73
s_mov_b32 s74, 200000
s_mov_b32 exec_lo, s92
s_mov_b32 exec_hi, 0
L_poll_35:
buffer_load_dword v4, v2, s[32:35], 0 offen sc1
s_sub_u32 s74, s74, 1
s_waitcnt vmcnt(0)
v_cmp_eq_u32 vcc, s63, v4
s_cmp_eq_u32 s74, 0
s_cbranch_scc1 L_polld_36
s_cmp_eq_u64 vcc, exec
s_cbranch_scc0 L_poll_35
L_polld_36:
s_mov_b64 exec, -1
buffer_load_dwordx4 v[156:159], v20, s[32:35], s4 offen offset:0 sc1
buffer_load_dwordx4 v[160:163], v20, s[32:35], s4 offen offset:1024 sc1
buffer_load_dwordx4 v[164:167], v20, s[32:35], s5 offen offset:0 sc1
buffer_load_dwordx4 v[168:171], v20, s[32:35], s5 offen offset:1024 sc1
buffer_load_dwordx4 v[172:175], v20, s[32:35], s12 offen offset:0 sc1
buffer_load_dwordx4 v[176:179], v20, s[32:35], s12 offen offset:1024 sc1
L_fin_early:
s_waitcnt vmcnt(0)
v_cmp_ne_u32 vcc, s63, v21
s_nop 1
s_and_b32 vcc_lo, vcc_lo, s93
s_cbranch_scc0 L_fin_go
s_add_u32 s73, s78, 24576
v_lshl_add_u32 v2, v1, 7, s73
s_mov_b32 s74, 200000
s_mov_b32 exec_lo, s93
s_mov_b32 exec_hi, 0
L_poll_37:
buffer_load_dword v4, v2, s[32:35], 0 offen sc1
s_sub_u32 s74, s74, 1
s_waitcnt vmcnt(0)
v_cmp_eq_u32 vcc, s63, v4
s_cmp_eq_u32 s74, 0
s_cbranch_scc1 L_polld_38
s_cmp_eq_u64 vcc, exec
s_cbranch_scc0 L_poll_37
L_polld_38:
s_mov_b64 exec, -1
L_fin_go:
buffer_load_dwordx4 v[180:183], v20, s[32:35], s25 offen offset:0 sc1
buffer_load_dwordx4 v[184:187], v20, s[32:35], s25 offen offset:1024 sc1
v_mfma_f32_16x16x32_bf16 v[44:47], v[246:249], v[156:159], v[44:47]
v_mfma_f32_16x16x32_bf16 v[52:55], v[244:247], v[156:159], v[52:55]
v_mfma_f32_16x16x32_bf16 v[48:51], v[246:249], v[160:163], v[48:51]
v_mfma_f32_16x16x32_bf16 v[56:59], v[244:247], v[160:163], v[56:59]
v_mfma_f32_16x16x32_bf16 v[44:47], v[246:249], v[164:167], v[44:47]
v_mfma_f32_16x16x32_bf16 v[52:55], v[244:247], v[164:167], v[52:55]
v_mfma_f32_16x16x32_bf16 v[48:51], v[246:249], v[168:171], v[48:51]
v_mfma_f32_16x16x32_bf16 v[56:59], v[244:247], v[168:171], v[56:59]
v_mfma_f32_16x16x32_bf16 v[44:47], v[246:249], v[172:175], v[44:47]
v_mfma_f32_16x16x32_bf16 v[52:55], v[244:247], v[172:175], v[52:55]
v_mfma_f32_16x16x32_bf16 v[48:51], v[246:249], v[176:179], v[48:51]
v_mfma_f32_16x16x32_bf16 v[56:59], v[244:247], v[176:179], v[56:59]
s_waitcnt vmcnt(0)
v_mfma_f32_16x16x32_bf16 v[44:47], v[246:249], v[180:183], v[44:47]
v_mfma_f32_16x16x32_bf16 v[52:55], v[244:247], v[180:183], v[52:55]
v_mfma_f32_16x16x32_bf16 v[48:51], v[246:249], v[184:187], v[48:51]
v_mfma_f32_16x16x32_bf16 v[56:59], v[244:247], v[184:187], v[56:59]
s_nop 4
v_mul_f32 v76, v240, v44
v_mul_f32 v77, v240, v45
v_mul_f32 v78, v240, v46
v_mul_f32 v79, v240, v47
v_mul_f32 v80, v240, v52
v_mul_f32 v81, v240, v53
v_mul_f32 v82, v240, v54
v_mul_f32 v83, v240, v55
v_mul_f32 v84, v241, v48
v_mul_f32 v85, v241, v49
v_mul_f32 v86, v241, v50
v_mul_f32 v87, v241, v51
v_mul_f32 v88, v241, v56
v_mul_f32 v89, v241, v57
v_mul_f32 v90, v241, v58
v_mul_f32 v91, v241, v59
v_exp_f32 v76, v76
v_mul_f32 v60, v60, v44
v_exp_f32 v77, v77
v_mul_f32 v61, v61, v45
v_exp_f32 v78, v78
v_mul_f32 v62, v62, v46
v_exp_f32 v79, v79
v_mul_f32 v63, v63, v47
v_exp_f32 v80, v80
v_mul_f32 v64, v64, v52
v_exp_f32 v81, v81
v_mul_f32 v65, v65, v53
v_exp_f32 v82, v82
v_mul_f32 v66, v66, v54
v_exp_f32 v83, v83
v_mul_f32 v67, v67, v55
v_exp_f32 v84, v84
v_mul_f32 v68, v68, v48
v_exp_f32 v85, v85
v_mul_f32 v69, v69, v49
v_exp_f32 v86, v86
v_mul_f32 v70, v70, v50
v_exp_f32 v87, v87
v_mul_f32 v71, v71, v51
v_exp_f32 v88, v88
v_mul_f32 v72, v72, v56
v_exp_f32 v89, v89
v_mul_f32 v73, v73, v57
v_exp_f32 v90, v90
v_mul_f32 v74, v74, v58
v_exp_f32 v91, v91
v_mul_f32 v75, v75, v59
v_add_f32 v76, 1.0, v76
v_add_f32 v77, 1.0, v77
v_add_f32 v78, 1.0, v78
v_add_f32 v79, 1.0, v79
v_add_f32 v80, 1.0, v80
v_add_f32 v81, 1.0, v81
v_add_f32 v82, 1.0, v82
v_add_f32 v83, 1.0, v83
v_add_f32 v84, 1.0, v84
v_add_f32 v85, 1.0, v85
v_add_f32 v86, 1.0, v86
v_add_f32 v87, 1.0, v87
v_add_f32 v88, 1.0, v88
v_add_f32 v89, 1.0, v89
v_add_f32 v90, 1.0, v90
v_add_f32 v91, 1.0, v91
v_rcp_f32 v76, v76
v_rcp_f32 v77, v77
v_rcp_f32 v78, v78
v_rcp_f32 v79, v79
v_rcp_f32 v80, v80
v_rcp_f32 v81, v81
v_rcp_f32 v82, v82
v_rcp_f32 v83, v83
v_mul_f32 v76, v76, v60
v_mul_f32 v77, v77, v61
v_mul_f32 v78, v78, v62
v_mul_f32 v79, v79, v63
v_mul_f32 v80, v80, v64
v_mul_f32 v81, v81, v65
v_mul_f32 v82, v82, v66
v_mul_f32 v83, v83, v67
ds_write_b128 v26, v[76:79] offset:0
ds_write_b128 v26, v[80:83] offset:64
v_rcp_f32 v84, v84
v_rcp_f32 v85, v85
v_rcp_f32 v86, v86
v_rcp_f32 v87, v87
v_rcp_f32 v88, v88
v_rcp_f32 v89, v89
v_rcp_f32 v90, v90
v_rcp_f32 v91, v91
v_mul_f32 v84, v84, v68
v_mul_f32 v85, v85, v69
v_mul_f32 v86, v86, v70
v_mul_f32 v87, v87, v71
v_mul_f32 v88, v88, v72
v_mul_f32 v89, v89, v73
v_mul_f32 v90, v90, v74
v_mul_f32 v91, v91, v75
ds_write_b128 v26, v[84:87] offset:2304
ds_write_b128 v26, v[88:91] offset:2368
s_waitcnt lgkmcnt(2)
ds_read_b128 v[76:79], v27 offset:0
ds_read_b128 v[80:83], v27 offset:16
s_lshl_b32 s73, s76, 6
s_waitcnt lgkmcnt(2)
ds_read_b128 v[84:87], v27 offset:2304
ds_read_b128 v[88:91], v27 offset:2320
s_add_u32 s74, s73, 0
s_waitcnt lgkmcnt(2)
v_add_f32 v76, v76, v108
v_add_f32 v77, v77, v109
v_add_f32 v78, v78, v110
v_add_f32 v79, v79, v111
v_add_f32 v80, v80, v112
v_add_f32 v81, v81, v113
v_add_f32 v82, v82, v114
v_add_f32 v83, v83, v115
v_cvt_pk_bf16_f32 v116, v76, v77
v_cvt_pk_bf16_f32 v117, v78, v79
v_cvt_pk_bf16_f32 v118, v80, v81
v_cvt_pk_bf16_f32 v119, v82, v83
buffer_store_dwordx4 v[116:119], v16, s[52:55], s74 offen
s_add_u32 s74, s73, 18432
s_waitcnt lgkmcnt(0)
v_add_f32 v84, v84, v124
v_add_f32 v85, v85, v125
v_add_f32 v86, v86, v126
v_add_f32 v87, v87, v127
v_add_f32 v88, v88, v128
v_add_f32 v89, v89, v129
v_add_f32 v90, v90, v130
v_add_f32 v91, v91, v131
v_cvt_pk_bf16_f32 v132, v84, v85
v_cvt_pk_bf16_f32 v133, v86, v87
v_cvt_pk_bf16_f32 v134, v88, v89
v_cvt_pk_bf16_f32 v135, v90, v91
buffer_store_dwordx4 v[132:135], v16, s[52:55], s74 offen
s_endpgm
L_ffn4_tail:
s_waitcnt lgkmcnt(8)
v_mfma_f32_16x16x32_bf16 v[28:31], a[192:195], a[0:3], 0
ds_read_b64_tr_b16 a[224:225], v11 offset:2048
s_add_u32 m0, s64, 30720
v_mfma_f32_16x16x32_bf16 v[32:35], a[192:195], a[4:7], 0
ds_read_b64_tr_b16 a[226:227], v11 offset:2560
s_add_u32 s67, s65, 4423680
v_mfma_f32_16x16x32_bf16 v[36:39], a[196:199], a[0:3], 0
ds_read_b64_tr_b16 a[228:229], v12 offset:2048
buffer_load_dwordx4 v10, s[36:39], s67 offen lds
v_mfma_f32_16x16x32_bf16 v[40:43], a[196:199], a[4:7], 0
ds_read_b64_tr_b16 a[230:231], v12 offset:2560
s_add_u32 s22, s15, 0
v_mfma_f32_16x16x32_bf16 v[44:47], a[200:203], a[0:3], 0
ds_read_b64_tr_b16 a[232:233], v13 offset:2048
buffer_load_dword v23, v7, s[32:35], s22 offen sc1
v_mfma_f32_16x16x32_bf16 v[48:51], a[200:203], a[4:7], 0
ds_read_b64_tr_b16 a[234:235], v13 offset:2560
buffer_load_dwordx4 v10, s[40:43], s67 offen offset:1024 lds
v_mfma_f32_16x16x32_bf16 v[52:55], a[204:207], a[0:3], 0
ds_read_b64_tr_b16 a[236:237], v14 offset:2048
v_max_f32 v92, 0, v92
v_mfma_f32_16x16x32_bf16 v[56:59], a[204:207], a[4:7], 0
ds_read_b64_tr_b16 a[238:239], v14 offset:2560
s_waitcnt lgkmcnt(8)
v_mfma_f32_16x16x32_bf16 v[60:63], a[208:211], a[0:3], 0
ds_read_b64_tr_b16 a[192:193], v11 offset:3072
v_max_f32 v93, 0, v93
v_mfma_f32_16x16x32_bf16 v[64:67], a[208:211], a[4:7], 0
ds_read_b64_tr_b16 a[194:195], v11 offset:3584
v_max_f32 v94, 0, v94
v_mfma_f32_16x16x32_bf16 v[68:71], a[212:215], a[0:3], 0
ds_read_b64_tr_b16 a[196:197], v12 offset:3072
v_max_f32 v95, 0, v95
v_mfma_f32_16x16x32_bf16 v[72:75], a[212:215], a[4:7], 0
ds_read_b64_tr_b16 a[198:199], v12 offset:3584
s_lshr_b32 s19, s6, 1
v_mfma_f32_16x16x32_bf16 v[76:79], a[216:219], a[0:3], 0
ds_read_b64_tr_b16 a[200:201], v13 offset:3072
s_lshl_b32 s98, s19, 1
v_mfma_f32_16x16x32_bf16 v[80:83], a[216:219], a[4:7], 0
ds_read_b64_tr_b16 a[202:203], v13 offset:3584
s_lshr_b32 s17, 0x09, s98
v_mfma_f32_16x16x32_bf16 v[84:87], a[220:223], a[0:3], 0
ds_read_b64_tr_b16 a[204:205], v14 offset:3072
s_and_b32 s17, s17, 3
v_mfma_f32_16x16x32_bf16 v[88:91], a[220:223], a[4:7], 0
ds_read_b64_tr_b16 a[206:207], v14 offset:3584
s_waitcnt lgkmcnt(8)
v_mfma_f32_16x16x32_bf16 v[28:31], a[224:227], a[8:11], v[28:31]
ds_read_b64_tr_b16 a[208:209], v11 offset:4096
s_add_u32 m0, s64, 32768
v_mfma_f32_16x16x32_bf16 v[32:35], a[224:227], a[12:15], v[32:35]
ds_read_b64_tr_b16 a[210:211], v11 offset:4608
s_add_u32 s67, s65, 4718592
v_mfma_f32_16x16x32_bf16 v[36:39], a[228:231], a[8:11], v[36:39]
ds_read_b64_tr_b16 a[212:213], v12 offset:4096
buffer_load_dwordx4 v10, s[36:39], s67 offen lds
v_mfma_f32_16x16x32_bf16 v[40:43], a[228:231], a[12:15], v[40:43]
ds_read_b64_tr_b16 a[214:215], v12 offset:4608
v_mul_f32 v92, v92, v124
v_mfma_f32_16x16x32_bf16 v[44:47], a[232:235], a[8:11], v[44:47]
ds_read_b64_tr_b16 a[216:217], v13 offset:4096
v_mul_f32 v93, v93, v125
v_mfma_f32_16x16x32_bf16 v[48:51], a[232:235], a[12:15], v[48:51]
ds_read_b64_tr_b16 a[218:219], v13 offset:4608
buffer_load_dwordx4 v10, s[40:43], s67 offen offset:1024 lds
v_mfma_f32_16x16x32_bf16 v[52:55], a[236:239], a[8:11], v[52:55]
ds_read_b64_tr_b16 a[220:221], v14 offset:4096
v_mul_f32 v94, v94, v126
v_mfma_f32_16x16x32_bf16 v[56:59], a[236:239], a[12:15], v[56:59]
ds_read_b64_tr_b16 a[222:223], v14 offset:4608
s_waitcnt lgkmcnt(8)
v_mfma_f32_16x16x32_bf16 v[60:63], a[192:195], a[8:11], v[60:63]
ds_read_b64_tr_b16 a[224:225], v11 offset:5120
v_mul_f32 v95, v95, v127
v_mfma_f32_16x16x32_bf16 v[64:67], a[192:195], a[12:15], v[64:67]
ds_read_b64_tr_b16 a[226:227], v11 offset:5632
v_cvt_pk_bf16_f32 v172, v92, v93
v_mfma_f32_16x16x32_bf16 v[68:71], a[196:199], a[8:11], v[68:71]
ds_read_b64_tr_b16 a[228:229], v12 offset:5120
s_lshr_b32 s18, 0x12, s98
v_mfma_f32_16x16x32_bf16 v[72:75], a[196:199], a[12:15], v[72:75]
ds_read_b64_tr_b16 a[230:231], v12 offset:5632
s_and_b32 s18, s18, 3
v_mfma_f32_16x16x32_bf16 v[76:79], a[200:203], a[8:11], v[76:79]
ds_read_b64_tr_b16 a[232:233], v13 offset:5120
s_lshl_b32 s8, s17, 7
v_mfma_f32_16x16x32_bf16 v[80:83], a[200:203], a[12:15], v[80:83]
ds_read_b64_tr_b16 a[234:235], v13 offset:5632
s_add_u32 s11, s92, s8
v_mfma_f32_16x16x32_bf16 v[84:87], a[204:207], a[8:11], v[84:87]
ds_read_b64_tr_b16 a[236:237], v14 offset:5120
s_add_u32 s96, s93, s8
v_mfma_f32_16x16x32_bf16 v[88:91], a[204:207], a[12:15], v[88:91]
ds_read_b64_tr_b16 a[238:239], v14 offset:5632
s_waitcnt lgkmcnt(8)
v_mfma_f32_16x16x32_bf16 v[28:31], a[208:211], a[16:19], v[28:31]
s_waitcnt vmcnt(29)
s_barrier
ds_read_b64_tr_b16 a[192:193], v11 offset:6144
v_mfma_f32_16x16x32_bf16 v[32:35], a[208:211], a[20:23], v[32:35]
ds_read_b64_tr_b16 a[194:195], v11 offset:6656
s_add_u32 m0, s64, 34816
v_mfma_f32_16x16x32_bf16 v[36:39], a[212:215], a[16:19], v[36:39]
ds_read_b64_tr_b16 a[196:197], v12 offset:6144
s_add_u32 s67, s65, 5013504
buffer_load_dwordx4 v10, s[36:39], s67 offen lds
v_mfma_f32_16x16x32_bf16 v[40:43], a[212:215], a[20:23], v[40:43]
ds_read_b64_tr_b16 a[198:199], v12 offset:6656
v_cvt_pk_bf16_f32 v173, v94, v95
v_mfma_f32_16x16x32_bf16 v[44:47], a[216:219], a[16:19], v[44:47]
ds_read_b64_tr_b16 a[200:201], v13 offset:6144
v_max_f32 v96, 0, v96
v_mfma_f32_16x16x32_bf16 v[48:51], a[216:219], a[20:23], v[48:51]
ds_read_b64_tr_b16 a[202:203], v13 offset:6656
buffer_load_dwordx4 v10, s[40:43], s67 offen offset:1024 lds
v_mfma_f32_16x16x32_bf16 v[52:55], a[220:223], a[16:19], v[52:55]
ds_read_b64_tr_b16 a[204:205], v14 offset:6144
v_max_f32 v97, 0, v97
v_mfma_f32_16x16x32_bf16 v[56:59], a[220:223], a[20:23], v[56:59]
ds_read_b64_tr_b16 a[206:207], v14 offset:6656
s_waitcnt lgkmcnt(8)
v_mfma_f32_16x16x32_bf16 v[60:63], a[224:227], a[16:19], v[60:63]
ds_read_b64_tr_b16 a[208:209], v11 offset:7168
v_max_f32 v98, 0, v98
v_mfma_f32_16x16x32_bf16 v[64:67], a[224:227], a[20:23], v[64:67]
ds_read_b64_tr_b16 a[210:211], v11 offset:7680
v_max_f32 v99, 0, v99
v_mfma_f32_16x16x32_bf16 v[68:71], a[228:231], a[16:19], v[68:71]
ds_read_b64_tr_b16 a[212:213], v12 offset:7168
s_add_u32 s8, s66, s8
v_mfma_f32_16x16x32_bf16 v[72:75], a[228:231], a[20:23], v[72:75]
ds_read_b64_tr_b16 a[214:215], v12 offset:7680
s_mul_i32 s17, s17, 81920
v_mfma_f32_16x16x32_bf16 v[76:79], a[232:235], a[16:19], v[76:79]
ds_read_b64_tr_b16 a[216:217], v13 offset:7168
s_add_u32 s17, s17, s14
v_mfma_f32_16x16x32_bf16 v[80:83], a[232:235], a[20:23], v[80:83]
ds_read_b64_tr_b16 a[218:219], v13 offset:7680
s_lshl_b32 s9, s18, 7
v_mfma_f32_16x16x32_bf16 v[84:87], a[236:239], a[16:19], v[84:87]
ds_read_b64_tr_b16 a[220:221], v14 offset:7168
s_add_u32 s13, s92, s9
v_mfma_f32_16x16x32_bf16 v[88:91], a[236:239], a[20:23], v[88:91]
ds_read_b64_tr_b16 a[222:223], v14 offset:7680
s_waitcnt vmcnt(5)
v_cmp_ne_u32 vcc, s68, v23
s_nop 1
s_and_b32 vcc_lo, vcc_lo, 3
s_cbranch_scc0 L_ok_17
s_mov_b32 s74, 200000
s_add_u32 s73, s15, 0
L_sp_18:
buffer_load_dword v4, v7, s[32:35], s73 offen sc1
s_sub_u32 s74, s74, 1
s_waitcnt vmcnt(0)
v_cmp_ne_u32 vcc, s68, v4
s_cmp_eq_u32 s74, 0
s_cbranch_scc1 L_spd_19
s_and_b32 vcc_lo, vcc_lo, 3
s_cbranch_scc1 L_sp_18
L_spd_19:
L_ok_17:
s_waitcnt lgkmcnt(8)
v_mfma_f32_16x16x32_bf16 v[28:31], a[192:195], a[24:27], v[28:31]
ds_read_b64_tr_b16 a[224:225], v11 offset:8192
s_add_u32 m0, s64, 0
v_mfma_f32_16x16x32_bf16 v[32:35], a[192:195], a[28:31], v[32:35]
ds_read_b64_tr_b16 a[226:227], v11 offset:8704
s_add_u32 s67, s8, 0
v_mfma_f32_16x16x32_bf16 v[36:39], a[196:199], a[24:27], v[36:39]
ds_read_b64_tr_b16 a[228:229], v12 offset:8192
buffer_load_dwordx4 v15, s[44:47], s67 offen lds
v_mfma_f32_16x16x32_bf16 v[40:43], a[196:199], a[28:31], v[40:43]
ds_read_b64_tr_b16 a[230:231], v12 offset:8704
v_mul_f32 v96, v96, v128
v_mfma_f32_16x16x32_bf16 v[44:47], a[200:203], a[24:27], v[44:47]
ds_read_b64_tr_b16 a[232:233], v13 offset:8192
v_mul_f32 v97, v97, v129
v_mfma_f32_16x16x32_bf16 v[48:51], a[200:203], a[28:31], v[48:51]
ds_read_b64_tr_b16 a[234:235], v13 offset:8704
buffer_load_dwordx4 v15, s[48:51], s67 offen offset:1024 lds
v_mfma_f32_16x16x32_bf16 v[52:55], a[204:207], a[24:27], v[52:55]
ds_read_b64_tr_b16 a[236:237], v14 offset:8192
v_mul_f32 v98, v98, v130
v_mfma_f32_16x16x32_bf16 v[56:59], a[204:207], a[28:31], v[56:59]
ds_read_b64_tr_b16 a[238:239], v14 offset:8704
s_waitcnt lgkmcnt(8)
v_mfma_f32_16x16x32_bf16 v[60:63], a[208:211], a[24:27], v[60:63]
ds_read_b64_tr_b16 a[192:193], v11 offset:9216
v_mul_f32 v99, v99, v131
v_mfma_f32_16x16x32_bf16 v[64:67], a[208:211], a[28:31], v[64:67]
ds_read_b64_tr_b16 a[194:195], v11 offset:9728
s_add_u32 s97, s93, s9
v_mfma_f32_16x16x32_bf16 v[68:71], a[212:215], a[24:27], v[68:71]
ds_read_b64_tr_b16 a[196:197], v12 offset:9216
s_add_u32 s9, s66, s9
v_mfma_f32_16x16x32_bf16 v[72:75], a[212:215], a[28:31], v[72:75]
ds_read_b64_tr_b16 a[198:199], v12 offset:9728
s_mul_i32 s18, s18, 81920
v_mfma_f32_16x16x32_bf16 v[76:79], a[216:219], a[24:27], v[76:79]
ds_read_b64_tr_b16 a[200:201], v13 offset:9216
s_add_u32 s18, s18, s14
v_mfma_f32_16x16x32_bf16 v[80:83], a[216:219], a[28:31], v[80:83]
ds_read_b64_tr_b16 a[202:203], v13 offset:9728
s_lshl_b32 s10, s19, 7
v_mfma_f32_16x16x32_bf16 v[84:87], a[220:223], a[24:27], v[84:87]
ds_read_b64_tr_b16 a[204:205], v14 offset:9216
v_mfma_f32_16x16x32_bf16 v[88:91], a[220:223], a[28:31], v[88:91]
ds_read_b64_tr_b16 a[206:207], v14 offset:9728
s_waitcnt lgkmcnt(8)
v_mfma_f32_16x16x32_bf16 v[28:31], a[224:227], a[32:35], v[28:31]
ds_read_b64_tr_b16 a[208:209], v11 offset:10240
s_add_u32 m0, s64, 2048
v_mfma_f32_16x16x32_bf16 v[32:35], a[224:227], a[36:39], v[32:35]
ds_read_b64_tr_b16 a[210:211], v11 offset:10752
s_add_u32 s67, s8, 73728
v_mfma_f32_16x16x32_bf16 v[36:39], a[228:231], a[32:35], v[36:39]
ds_read_b64_tr_b16 a[212:213], v12 offset:10240
buffer_load_dwordx4 v15, s[44:47], s67 offen lds
v_cvt_pk_bf16_f32 v176, v96, v97
v_mfma_f32_16x16x32_bf16 v[40:43], a[228:231], a[36:39], v[40:43]
ds_read_b64_tr_b16 a[214:215], v12 offset:10752
v_cvt_pk_bf16_f32 v177, v98, v99
v_mfma_f32_16x16x32_bf16 v[44:47], a[232:235], a[32:35], v[44:47]
ds_read_b64_tr_b16 a[216:217], v13 offset:10240
v_max_f32 v100, 0, v100
v_mfma_f32_16x16x32_bf16 v[48:51], a[232:235], a[36:39], v[48:51]
ds_read_b64_tr_b16 a[218:219], v13 offset:10752
buffer_load_dwordx4 v15, s[48:51], s67 offen offset:1024 lds
v_mfma_f32_16x16x32_bf16 v[52:55], a[236:239], a[32:35], v[52:55]
ds_read_b64_tr_b16 a[220:221], v14 offset:10240
v_max_f32 v101, 0, v101
v_mfma_f32_16x16x32_bf16 v[56:59], a[236:239], a[36:39], v[56:59]
ds_read_b64_tr_b16 a[222:223], v14 offset:10752
s_waitcnt lgkmcnt(8)
v_mfma_f32_16x16x32_bf16 v[60:63], a[192:195], a[32:35], v[60:63]
ds_read_b64_tr_b16 a[224:225], v11 offset:11264
v_max_f32 v102, 0, v102
v_mfma_f32_16x16x32_bf16 v[64:67], a[192:195], a[36:39], v[64:67]
ds_read_b64_tr_b16 a[226:227], v11 offset:11776
s_add_u32 s16, s92, s10
v_mfma_f32_16x16x32_bf16 v[68:71], a[196:199], a[32:35], v[68:71]
ds_read_b64_tr_b16 a[228:229], v12 offset:11264
s_add_u32 s98, s93, s10
v_mfma_f32_16x16x32_bf16 v[72:75], a[196:199], a[36:39], v[72:75]
ds_read_b64_tr_b16 a[230:231], v12 offset:11776
s_add_u32 s10, s66, s10
v_mfma_f32_16x16x32_bf16 v[76:79], a[200:203], a[32:35], v[76:79]
ds_read_b64_tr_b16 a[232:233], v13 offset:11264
s_mul_i32 s19, s19, 81920
v_mfma_f32_16x16x32_bf16 v[80:83], a[200:203], a[36:39], v[80:83]
ds_read_b64_tr_b16 a[234:235], v13 offset:11776
s_add_u32 s19, s19, s14
v_mfma_f32_16x16x32_bf16 v[84:87], a[204:207], a[32:35], v[84:87]
ds_read_b64_tr_b16 a[236:237], v14 offset:11264
s_add_u32 s80, s94, 0
v_mfma_f32_16x16x32_bf16 v[88:91], a[204:207], a[36:39], v[88:91]
ds_read_b64_tr_b16 a[238:239], v14 offset:11776
s_waitcnt lgkmcnt(8)
v_mfma_f32_16x16x32_bf16 v[28:31], a[208:211], a[40:43], v[28:31]
s_barrier
ds_read_b64_tr_b16 a[192:193], v11 offset:12288
v_mfma_f32_16x16x32_bf16 v[32:35], a[208:211], a[44:47], v[32:35]
ds_read_b64_tr_b16 a[194:195], v11 offset:12800
s_add_u32 m0, s64, 4096
v_mfma_f32_16x16x32_bf16 v[36:39], a[212:215], a[40:43], v[36:39]
ds_read_b64_tr_b16 a[196:197], v12 offset:12288
s_add_u32 s67, s8, 147456
v_mfma_f32_16x16x32_bf16 v[40:43], a[212:215], a[44:47], v[40:43]
ds_read_b64_tr_b16 a[198:199], v12 offset:12800
buffer_load_dwordx4 v15, s[44:47], s67 offen lds
v_mfma_f32_16x16x32_bf16 v[44:47], a[216:219], a[40:43], v[44:47]
ds_read_b64_tr_b16 a[200:201], v13 offset:12288
v_max_f32 v103, 0, v103
v_mfma_f32_16x16x32_bf16 v[48:51], a[216:219], a[44:47], v[48:51]
ds_read_b64_tr_b16 a[202:203], v13 offset:12800
v_mul_f32 v100, v100, v132
v_mfma_f32_16x16x32_bf16 v[52:55], a[220:223], a[40:43], v[52:55]
ds_read_b64_tr_b16 a[204:205], v14 offset:12288
buffer_load_dwordx4 v15, s[48:51], s67 offen offset:1024 lds
v_mfma_f32_16x16x32_bf16 v[56:59], a[220:223], a[44:47], v[56:59]
ds_read_b64_tr_b16 a[206:207], v14 offset:12800
s_waitcnt lgkmcnt(8)
v_mfma_f32_16x16x32_bf16 v[60:63], a[224:227], a[40:43], v[60:63]
ds_read_b64_tr_b16 a[208:209], v11 offset:13312
buffer_load_dwordx4 a[252:255], v20, s[44:47], s24 offen offset:0
v_mfma_f32_16x16x32_bf16 v[64:67], a[224:227], a[44:47], v[64:67]
ds_read_b64_tr_b16 a[210:211], v11 offset:13824
buffer_load_dwordx4 a[252:255], v20, s[44:47], s24 offen offset:1024
v_mfma_f32_16x16x32_bf16 v[68:71], a[228:231], a[40:43], v[68:71]
ds_read_b64_tr_b16 a[212:213], v12 offset:13312
s_add_u32 s24, s24, 2048
v_mfma_f32_16x16x32_bf16 v[72:75], a[228:231], a[44:47], v[72:75]
ds_read_b64_tr_b16 a[214:215], v12 offset:13824
v_mul_f32 v101, v101, v133
v_mfma_f32_16x16x32_bf16 v[76:79], a[232:235], a[40:43], v[76:79]
ds_read_b64_tr_b16 a[216:217], v13 offset:13312
v_mul_f32 v102, v102, v134
v_mfma_f32_16x16x32_bf16 v[80:83], a[232:235], a[44:47], v[80:83]
ds_read_b64_tr_b16 a[218:219], v13 offset:13824
v_mul_f32 v103, v103, v135
v_mfma_f32_16x16x32_bf16 v[84:87], a[236:239], a[40:43], v[84:87]
ds_read_b64_tr_b16 a[220:221], v14 offset:13312
buffer_load_dwordx4 a[128:131], v20, s[32:35], s80 offen offset:0 sc1
v_mfma_f32_16x16x32_bf16 v[88:91], a[236:239], a[44:47], v[88:91]
ds_read_b64_tr_b16 a[222:223], v14 offset:13824
s_waitcnt lgkmcnt(8)
v_mfma_f32_16x16x32_bf16 v[28:31], a[192:195], a[48:51], v[28:31]
ds_read_b64_tr_b16 a[224:225], v11 offset:14336
s_add_u32 m0, s64, 6144
v_mfma_f32_16x16x32_bf16 v[32:35], a[192:195], a[52:55], v[32:35]
ds_read_b64_tr_b16 a[226:227], v11 offset:14848
s_add_u32 s67, s8, 221184
v_mfma_f32_16x16x32_bf16 v[36:39], a[196:199], a[48:51], v[36:39]
ds_read_b64_tr_b16 a[228:229], v12 offset:14336
buffer_load_dwordx4 v15, s[44:47], s67 offen lds
v_mfma_f32_16x16x32_bf16 v[40:43], a[196:199], a[52:55], v[40:43]
ds_read_b64_tr_b16 a[230:231], v12 offset:14848
v_cvt_pk_bf16_f32 v174, v100, v101
v_mfma_f32_16x16x32_bf16 v[44:47], a[200:203], a[48:51], v[44:47]
ds_read_b64_tr_b16 a[232:233], v13 offset:14336
v_cvt_pk_bf16_f32 v175, v102, v103
v_mfma_f32_16x16x32_bf16 v[48:51], a[200:203], a[52:55], v[48:51]
ds_read_b64_tr_b16 a[234:235], v13 offset:14848
buffer_load_dwordx4 v15, s[48:51], s67 offen offset:1024 lds
v_mfma_f32_16x16x32_bf16 v[52:55], a[204:207], a[48:51], v[52:55]
ds_read_b64_tr_b16 a[236:237], v14 offset:14336
v_max_f32 v104, 0, v104
v_mfma_f32_16x16x32_bf16 v[56:59], a[204:207], a[52:55], v[56:59]
ds_read_b64_tr_b16 a[238:239], v14 offset:14848
s_waitcnt lgkmcnt(8)
v_mfma_f32_16x16x32_bf16 v[60:63], a[208:211], a[48:51], v[60:63]
ds_read_b64_tr_b16 a[192:193], v11 offset:15360
v_max_f32 v105, 0, v105
v_mfma_f32_16x16x32_bf16 v[64:67], a[208:211], a[52:55], v[64:67]
ds_read_b64_tr_b16 a[194:195], v11 offset:15872
buffer_load_dwordx4 a[132:135], v20, s[32:35], s80 offen offset:1024 sc1
v_mfma_f32_16x16x32_bf16 v[68:71], a[212:215], a[48:51], v[68:71]
ds_read_b64_tr_b16 a[196:197], v12 offset:15360
v_mfma_f32_16x16x32_bf16 v[72:75], a[212:215], a[52:55], v[72:75]
ds_read_b64_tr_b16 a[198:199], v12 offset:15872
v_mfma_f32_16x16x32_bf16 v[76:79], a[216:219], a[48:51], v[76:79]
ds_read_b64_tr_b16 a[200:201], v13 offset:15360
v_mfma_f32_16x16x32_bf16 v[80:83], a[216:219], a[52:55], v[80:83]
ds_read_b64_tr_b16 a[202:203], v13 offset:15872
v_mfma_f32_16x16x32_bf16 v[84:87], a[220:223], a[48:51], v[84:87]
ds_read_b64_tr_b16 a[204:205], v14 offset:15360
v_mfma_f32_16x16x32_bf16 v[88:91], a[220:223], a[52:55], v[88:91]
ds_read_b64_tr_b16 a[206:207], v14 offset:15872
s_waitcnt lgkmcnt(8)
v_mfma_f32_16x16x32_bf16 v[28:31], a[224:227], a[56:59], v[28:31]
ds_read_b64_tr_b16 a[208:209], v11 offset:16384
s_add_u32 m0, s64, 8192
v_mfma_f32_16x16x32_bf16 v[32:35], a[224:227], a[60:63], v[32:35]
ds_read_b64_tr_b16 a[210:211], v11 offset:16896
s_add_u32 s67, s9, 0
v_mfma_f32_16x16x32_bf16 v[36:39], a[228:231], a[56:59], v[36:39]
ds_read_b64_tr_b16 a[212:213], v12 offset:16384
buffer_load_dwordx4 v15, s[44:47], s67 offen lds
v_mfma_f32_16x16x32_bf16 v[40:43], a[228:231], a[60:63], v[40:43]
ds_read_b64_tr_b16 a[214:215], v12 offset:16896
v_max_f32 v106, 0, v106
v_mfma_f32_16x16x32_bf16 v[44:47], a[232:235], a[56:59], v[44:47]
ds_read_b64_tr_b16 a[216:217], v13 offset:16384
v_max_f32 v107, 0, v107
v_mfma_f32_16x16x32_bf16 v[48:51], a[232:235], a[60:63], v[48:51]
ds_read_b64_tr_b16 a[218:219], v13 offset:16896
buffer_load_dwordx4 v15, s[48:51], s67 offen offset:1024 lds
v_mfma_f32_16x16x32_bf16 v[52:55], a[236:239], a[56:59], v[52:55]
ds_read_b64_tr_b16 a[220:221], v14 offset:16384
v_mul_f32 v104, v104, v136
v_mfma_f32_16x16x32_bf16 v[56:59], a[236:239], a[60:63], v[56:59]
ds_read_b64_tr_b16 a[222:223], v14 offset:16896
s_waitcnt lgkmcnt(8)
v_mfma_f32_16x16x32_bf16 v[60:63], a[192:195], a[56:59], v[60:63]
ds_read_b64_tr_b16 a[224:225], v11 offset:17408
v_mul_f32 v105, v105, v137
v_mfma_f32_16x16x32_bf16 v[64:67], a[192:195], a[60:63], v[64:67]
ds_read_b64_tr_b16 a[226:227], v11 offset:17920
v_mul_f32 v106, v106, v138
v_mfma_f32_16x16x32_bf16 v[68:71], a[196:199], a[56:59], v[68:71]
ds_read_b64_tr_b16 a[228:229], v12 offset:17408
v_mfma_f32_16x16x32_bf16 v[72:75], a[196:199], a[60:63], v[72:75]
ds_read_b64_tr_b16 a[230:231], v12 offset:17920
v_mfma_f32_16x16x32_bf16 v[76:79], a[200:203], a[56:59], v[76:79]
ds_read_b64_tr_b16 a[232:233], v13 offset:17408
v_mfma_f32_16x16x32_bf16 v[80:83], a[200:203], a[60:63], v[80:83]
ds_read_b64_tr_b16 a[234:235], v13 offset:17920
v_mfma_f32_16x16x32_bf16 v[84:87], a[204:207], a[56:59], v[84:87]
ds_read_b64_tr_b16 a[236:237], v14 offset:17408
v_mfma_f32_16x16x32_bf16 v[88:91], a[204:207], a[60:63], v[88:91]
ds_read_b64_tr_b16 a[238:239], v14 offset:17920
s_waitcnt lgkmcnt(8)
v_mfma_f32_16x16x32_bf16 v[28:31], a[208:211], a[64:67], v[28:31]
s_barrier
ds_read_b64_tr_b16 a[192:193], v11 offset:18432
v_mfma_f32_16x16x32_bf16 v[32:35], a[208:211], a[68:71], v[32:35]
ds_read_b64_tr_b16 a[194:195], v11 offset:18944
s_add_u32 m0, s64, 10240
v_mfma_f32_16x16x32_bf16 v[36:39], a[212:215], a[64:67], v[36:39]
ds_read_b64_tr_b16 a[196:197], v12 offset:18432
s_add_u32 s67, s9, 73728
v_mfma_f32_16x16x32_bf16 v[40:43], a[212:215], a[68:71], v[40:43]
ds_read_b64_tr_b16 a[198:199], v12 offset:18944
buffer_load_dwordx4 v15, s[44:47], s67 offen lds
v_mfma_f32_16x16x32_bf16 v[44:47], a[216:219], a[64:67], v[44:47]
ds_read_b64_tr_b16 a[200:201], v13 offset:18432
v_mul_f32 v107, v107, v139
v_mfma_f32_16x16x32_bf16 v[48:51], a[216:219], a[68:71], v[48:51]
ds_read_b64_tr_b16 a[202:203], v13 offset:18944
v_cvt_pk_bf16_f32 v178, v104, v105
v_mfma_f32_16x16x32_bf16 v[52:55], a[220:223], a[64:67], v[52:55]
ds_read_b64_tr_b16 a[204:205], v14 offset:18432
buffer_load_dwordx4 v15, s[48:51], s67 offen offset:1024 lds
v_mfma_f32_16x16x32_bf16 v[56:59], a[220:223], a[68:71], v[56:59]
ds_read_b64_tr_b16 a[206:207], v14 offset:18944
s_waitcnt lgkmcnt(8)
v_mfma_f32_16x16x32_bf16 v[60:63], a[224:227], a[64:67], v[60:63]
ds_read_b64_tr_b16 a[208:209], v11 offset:19456
v_cvt_pk_bf16_f32 v179, v106, v107
v_mfma_f32_16x16x32_bf16 v[64:67], a[224:227], a[68:71], v[64:67]
ds_read_b64_tr_b16 a[210:211], v11 offset:19968
v_max_f32 v108, 0, v108
v_mfma_f32_16x16x32_bf16 v[68:71], a[228:231], a[64:67], v[68:71]
ds_read_b64_tr_b16 a[212:213], v12 offset:19456
v_max_f32 v109, 0, v109
v_mfma_f32_16x16x32_bf16 v[72:75], a[228:231], a[68:71], v[72:75]
ds_read_b64_tr_b16 a[214:215], v12 offset:19968
buffer_load_dwordx4 a[136:139], v20, s[32:35], s80 offen offset:2048 sc1
v_mfma_f32_16x16x32_bf16 v[76:79], a[232:235], a[64:67], v[76:79]
ds_read_b64_tr_b16 a[216:217], v13 offset:19456
v_mfma_f32_16x16x32_bf16 v[80:83], a[232:235], a[68:71], v[80:83]
ds_read_b64_tr_b16 a[218:219], v13 offset:19968
v_mfma_f32_16x16x32_bf16 v[84:87], a[236:239], a[64:67], v[84:87]
ds_read_b64_tr_b16 a[220:221], v14 offset:19456
v_mfma_f32_16x16x32_bf16 v[88:91], a[236:239], a[68:71], v[88:91]
ds_read_b64_tr_b16 a[222:223], v14 offset:19968
s_waitcnt lgkmcnt(8)
v_mfma_f32_16x16x32_bf16 v[28:31], a[192:195], a[72:75], v[28:31]
ds_read_b64_tr_b16 a[224:225], v11 offset:20480
s_add_u32 m0, s64, 12288
v_mfma_f32_16x16x32_bf16 v[32:35], a[192:195], a[76:79], v[32:35]
ds_read_b64_tr_b16 a[226:227], v11 offset:20992
s_add_u32 s67, s9, 147456
v_mfma_f32_16x16x32_bf16 v[36:39], a[196:199], a[72:75], v[36:39]
ds_read_b64_tr_b16 a[228:229], v12 offset:20480
buffer_load_dwordx4 v15, s[44:47], s67 offen lds
v_mfma_f32_16x16x32_bf16 v[40:43], a[196:199], a[76:79], v[40:43]
ds_read_b64_tr_b16 a[230:231], v12 offset:20992
v_max_f32 v110, 0, v110
v_mfma_f32_16x16x32_bf16 v[44:47], a[200:203], a[72:75], v[44:47]
ds_read_b64_tr_b16 a[232:233], v13 offset:20480
v_max_f32 v111, 0, v111
v_mfma_f32_16x16x32_bf16 v[48:51], a[200:203], a[76:79], v[48:51]
ds_read_b64_tr_b16 a[234:235], v13 offset:20992
buffer_load_dwordx4 v15, s[48:51], s67 offen offset:1024 lds
v_mfma_f32_16x16x32_bf16 v[52:55], a[204:207], a[72:75], v[52:55]
ds_read_b64_tr_b16 a[236:237], v14 offset:20480
v_mul_f32 v108, v108, v140
v_mfma_f32_16x16x32_bf16 v[56:59], a[204:207], a[76:79], v[56:59]
ds_read_b64_tr_b16 a[238:239], v14 offset:20992
s_waitcnt lgkmcnt(8)
v_mfma_f32_16x16x32_bf16 v[60:63], a[208:211], a[72:75], v[60:63]
ds_read_b64_tr_b16 a[192:193], v11 offset:21504
v_mul_f32 v109, v109, v141
v_mfma_f32_16x16x32_bf16 v[64:67], a[208:211], a[76:79], v[64:67]
ds_read_b64_tr_b16 a[194:195], v11 offset:22016
v_mul_f32 v110, v110, v142
v_mfma_f32_16x16x32_bf16 v[68:71], a[212:215], a[72:75], v[68:71]
ds_read_b64_tr_b16 a[196:197], v12 offset:21504
buffer_load_dwordx4 a[140:143], v20, s[32:35], s80 offen offset:3072 sc1
v_mfma_f32_16x16x32_bf16 v[72:75], a[212:215], a[76:79], v[72:75]
ds_read_b64_tr_b16 a[198:199], v12 offset:22016
v_mfma_f32_16x16x32_bf16 v[76:79], a[216:219], a[72:75], v[76:79]
ds_read_b64_tr_b16 a[200:201], v13 offset:21504
v_mfma_f32_16x16x32_bf16 v[80:83], a[216:219], a[76:79], v[80:83]
ds_read_b64_tr_b16 a[202:203], v13 offset:22016
v_mfma_f32_16x16x32_bf16 v[84:87], a[220:223], a[72:75], v[84:87]
ds_read_b64_tr_b16 a[204:205], v14 offset:21504
v_mfma_f32_16x16x32_bf16 v[88:91], a[220:223], a[76:79], v[88:91]
ds_read_b64_tr_b16 a[206:207], v14 offset:22016
s_waitcnt lgkmcnt(8)
v_mfma_f32_16x16x32_bf16 v[28:31], a[224:227], a[80:83], v[28:31]
ds_read_b64_tr_b16 a[208:209], v11 offset:22528
s_add_u32 m0, s64, 14336
v_mfma_f32_16x16x32_bf16 v[32:35], a[224:227], a[84:87], v[32:35]
ds_read_b64_tr_b16 a[210:211], v11 offset:23040
s_add_u32 s67, s9, 221184
v_mfma_f32_16x16x32_bf16 v[36:39], a[228:231], a[80:83], v[36:39]
ds_read_b64_tr_b16 a[212:213], v12 offset:22528
buffer_load_dwordx4 v15, s[44:47], s67 offen lds
v_mfma_f32_16x16x32_bf16 v[40:43], a[228:231], a[84:87], v[40:43]
ds_read_b64_tr_b16 a[214:215], v12 offset:23040
v_mul_f32 v111, v111, v143
v_mfma_f32_16x16x32_bf16 v[44:47], a[232:235], a[80:83], v[44:47]
ds_read_b64_tr_b16 a[216:217], v13 offset:22528
v_cvt_pk_bf16_f32 v180, v108, v109
v_mfma_f32_16x16x32_bf16 v[48:51], a[232:235], a[84:87], v[48:51]
ds_read_b64_tr_b16 a[218:219], v13 offset:23040
buffer_load_dwordx4 v15, s[48:51], s67 offen offset:1024 lds
v_mfma_f32_16x16x32_bf16 v[52:55], a[236:239], a[80:83], v[52:55]
ds_read_b64_tr_b16 a[220:221], v14 offset:22528
v_cvt_pk_bf16_f32 v181, v110, v111
v_mfma_f32_16x16x32_bf16 v[56:59], a[236:239], a[84:87], v[56:59]
ds_read_b64_tr_b16 a[222:223], v14 offset:23040
s_waitcnt lgkmcnt(8)
v_mfma_f32_16x16x32_bf16 v[60:63], a[192:195], a[80:83], v[60:63]
ds_read_b64_tr_b16 a[224:225], v11 offset:23552
v_max_f32 v112, 0, v112
v_mfma_f32_16x16x32_bf16 v[64:67], a[192:195], a[84:87], v[64:67]
ds_read_b64_tr_b16 a[226:227], v11 offset:24064
s_add_u32 s80, s95, 0
v_mfma_f32_16x16x32_bf16 v[68:71], a[196:199], a[80:83], v[68:71]
ds_read_b64_tr_b16 a[228:229], v12 offset:23552
v_mfma_f32_16x16x32_bf16 v[72:75], a[196:199], a[84:87], v[72:75]
ds_read_b64_tr_b16 a[230:231], v12 offset:24064
v_mfma_f32_16x16x32_bf16 v[76:79], a[200:203], a[80:83], v[76:79]
ds_read_b64_tr_b16 a[232:233], v13 offset:23552
v_mfma_f32_16x16x32_bf16 v[80:83], a[200:203], a[84:87], v[80:83]
ds_read_b64_tr_b16 a[234:235], v13 offset:24064
v_mfma_f32_16x16x32_bf16 v[84:87], a[204:207], a[80:83], v[84:87]
ds_read_b64_tr_b16 a[236:237], v14 offset:23552
v_mfma_f32_16x16x32_bf16 v[88:91], a[204:207], a[84:87], v[88:91]
ds_read_b64_tr_b16 a[238:239], v14 offset:24064
s_waitcnt lgkmcnt(8)
v_mfma_f32_16x16x32_bf16 v[28:31], a[208:211], a[88:91], v[28:31]
s_barrier
ds_read_b64_tr_b16 a[192:193], v11 offset:24576
v_mfma_f32_16x16x32_bf16 v[32:35], a[208:211], a[92:95], v[32:35]
ds_read_b64_tr_b16 a[194:195], v11 offset:25088
s_add_u32 s22, s15, 2048
buffer_store_dword v22, v21, s[32:35], s22 offen sc1
v_mfma_f32_16x16x32_bf16 v[36:39], a[212:215], a[88:91], v[36:39]
ds_read_b64_tr_b16 a[196:197], v12 offset:24576
s_add_u32 m0, s64, 16384
v_mfma_f32_16x16x32_bf16 v[40:43], a[212:215], a[92:95], v[40:43]
ds_read_b64_tr_b16 a[198:199], v12 offset:25088
s_add_u32 s67, s11, 0
v_mfma_f32_16x16x32_bf16 v[44:47], a[216:219], a[88:91], v[44:47]
ds_read_b64_tr_b16 a[200:201], v13 offset:24576
buffer_load_dwordx4 v15, s[44:47], s67 offen lds
v_mfma_f32_16x16x32_bf16 v[48:51], a[216:219], a[92:95], v[48:51]
ds_read_b64_tr_b16 a[202:203], v13 offset:25088
v_max_f32 v113, 0, v113
v_mfma_f32_16x16x32_bf16 v[52:55], a[220:223], a[88:91], v[52:55]
ds_read_b64_tr_b16 a[204:205], v14 offset:24576
v_max_f32 v114, 0, v114
v_mfma_f32_16x16x32_bf16 v[56:59], a[220:223], a[92:95], v[56:59]
ds_read_b64_tr_b16 a[206:207], v14 offset:25088
s_waitcnt lgkmcnt(8)
v_mfma_f32_16x16x32_bf16 v[60:63], a[224:227], a[88:91], v[60:63]
ds_read_b64_tr_b16 a[208:209], v11 offset:25600
buffer_load_dwordx4 v15, s[48:51], s67 offen offset:1024 lds
v_mfma_f32_16x16x32_bf16 v[64:67], a[224:227], a[92:95], v[64:67]
ds_read_b64_tr_b16 a[210:211], v11 offset:26112
buffer_store_dwordx4 v[172:175], v20, s[32:35], s21 offen offset:0 sc1
v_mfma_f32_16x16x32_bf16 v[68:71], a[228:231], a[88:91], v[68:71]
ds_read_b64_tr_b16 a[212:213], v12 offset:25600
buffer_store_dwordx4 v[176:179], v20, s[32:35], s21 offen offset:1024 sc1
v_mfma_f32_16x16x32_bf16 v[72:75], a[228:231], a[92:95], v[72:75]
ds_read_b64_tr_b16 a[214:215], v12 offset:26112
v_max_f32 v115, 0, v115
v_mfma_f32_16x16x32_bf16 v[76:79], a[232:235], a[88:91], v[76:79]
ds_read_b64_tr_b16 a[216:217], v13 offset:25600
v_mul_f32 v112, v112, v144
v_mfma_f32_16x16x32_bf16 v[80:83], a[232:235], a[92:95], v[80:83]
ds_read_b64_tr_b16 a[218:219], v13 offset:26112
v_mul_f32 v113, v113, v145
v_mfma_f32_16x16x32_bf16 v[84:87], a[236:239], a[88:91], v[84:87]
ds_read_b64_tr_b16 a[220:221], v14 offset:25600
v_mfma_f32_16x16x32_bf16 v[88:91], a[236:239], a[92:95], v[88:91]
ds_read_b64_tr_b16 a[222:223], v14 offset:26112
s_waitcnt lgkmcnt(8)
v_mfma_f32_16x16x32_bf16 v[28:31], a[192:195], a[96:99], v[28:31]
ds_read_b64_tr_b16 a[224:225], v11 offset:26624
s_add_u32 m0, s64, 18432
v_mfma_f32_16x16x32_bf16 v[32:35], a[192:195], a[100:103], v[32:35]
ds_read_b64_tr_b16 a[226:227], v11 offset:27136
s_add_u32 s67, s96, 0
v_mfma_f32_16x16x32_bf16 v[36:39], a[196:199], a[96:99], v[36:39]
ds_read_b64_tr_b16 a[228:229], v12 offset:26624
buffer_load_dwordx4 v15, s[44:47], s67 offen lds
v_mfma_f32_16x16x32_bf16 v[40:43], a[196:199], a[100:103], v[40:43]
ds_read_b64_tr_b16 a[230:231], v12 offset:27136
v_mul_f32 v114, v114, v146
v_mfma_f32_16x16x32_bf16 v[44:47], a[200:203], a[96:99], v[44:47]
ds_read_b64_tr_b16 a[232:233], v13 offset:26624
v_mul_f32 v115, v115, v147
v_mfma_f32_16x16x32_bf16 v[48:51], a[200:203], a[100:103], v[48:51]
ds_read_b64_tr_b16 a[234:235], v13 offset:27136
buffer_load_dwordx4 v15, s[48:51], s67 offen offset:1024 lds
v_mfma_f32_16x16x32_bf16 v[52:55], a[204:207], a[96:99], v[52:55]
ds_read_b64_tr_b16 a[236:237], v14 offset:26624
v_cvt_pk_bf16_f32 v184, v112, v113
v_mfma_f32_16x16x32_bf16 v[56:59], a[204:207], a[100:103], v[56:59]
ds_read_b64_tr_b16 a[238:239], v14 offset:27136
s_waitcnt lgkmcnt(8)
v_mfma_f32_16x16x32_bf16 v[60:63], a[208:211], a[96:99], v[60:63]
ds_read_b64_tr_b16 a[192:193], v11 offset:27648
v_cvt_pk_bf16_f32 v185, v114, v115
v_mfma_f32_16x16x32_bf16 v[64:67], a[208:211], a[100:103], v[64:67]
ds_read_b64_tr_b16 a[194:195], v11 offset:28160
v_max_f32 v116, 0, v116
v_mfma_f32_16x16x32_bf16 v[68:71], a[212:215], a[96:99], v[68:71]
ds_read_b64_tr_b16 a[196:197], v12 offset:27648
buffer_load_dwordx4 a[144:147], v20, s[32:35], s80 offen offset:0 sc1
v_mfma_f32_16x16x32_bf16 v[72:75], a[212:215], a[100:103], v[72:75]
ds_read_b64_tr_b16 a[198:199], v12 offset:28160
v_mfma_f32_16x16x32_bf16 v[76:79], a[216:219], a[96:99], v[76:79]
ds_read_b64_tr_b16 a[200:201], v13 offset:27648
v_mfma_f32_16x16x32_bf16 v[80:83], a[216:219], a[100:103], v[80:83]
ds_read_b64_tr_b16 a[202:203], v13 offset:28160
v_mfma_f32_16x16x32_bf16 v[84:87], a[220:223], a[96:99], v[84:87]
ds_read_b64_tr_b16 a[204:205], v14 offset:27648
v_mfma_f32_16x16x32_bf16 v[88:91], a[220:223], a[100:103], v[88:91]
ds_read_b64_tr_b16 a[206:207], v14 offset:28160
s_waitcnt lgkmcnt(8)
v_mfma_f32_16x16x32_bf16 v[28:31], a[224:227], a[104:107], v[28:31]
ds_read_b64_tr_b16 a[208:209], v11 offset:28672
s_add_u32 m0, s64, 20480
v_mfma_f32_16x16x32_bf16 v[32:35], a[224:227], a[108:111], v[32:35]
ds_read_b64_tr_b16 a[210:211], v11 offset:29184
s_add_u32 s67, s11, 73728
v_mfma_f32_16x16x32_bf16 v[36:39], a[228:231], a[104:107], v[36:39]
ds_read_b64_tr_b16 a[212:213], v12 offset:28672
buffer_load_dwordx4 v15, s[44:47], s67 offen lds
v_mfma_f32_16x16x32_bf16 v[40:43], a[228:231], a[108:111], v[40:43]
ds_read_b64_tr_b16 a[214:215], v12 offset:29184
v_max_f32 v117, 0, v117
v_mfma_f32_16x16x32_bf16 v[44:47], a[232:235], a[104:107], v[44:47]
ds_read_b64_tr_b16 a[216:217], v13 offset:28672
v_max_f32 v118, 0, v118
v_mfma_f32_16x16x32_bf16 v[48:51], a[232:235], a[108:111], v[48:51]
ds_read_b64_tr_b16 a[218:219], v13 offset:29184
buffer_load_dwordx4 v15, s[48:51], s67 offen offset:1024 lds
v_mfma_f32_16x16x32_bf16 v[52:55], a[236:239], a[104:107], v[52:55]
ds_read_b64_tr_b16 a[220:221], v14 offset:28672
v_max_f32 v119, 0, v119
v_mfma_f32_16x16x32_bf16 v[56:59], a[236:239], a[108:111], v[56:59]
ds_read_b64_tr_b16 a[222:223], v14 offset:29184
s_waitcnt lgkmcnt(8)
v_mfma_f32_16x16x32_bf16 v[60:63], a[192:195], a[104:107], v[60:63]
ds_read_b64_tr_b16 a[224:225], v11 offset:29696
v_mul_f32 v116, v116, v148
v_mfma_f32_16x16x32_bf16 v[64:67], a[192:195], a[108:111], v[64:67]
ds_read_b64_tr_b16 a[226:227], v11 offset:30208
buffer_load_dwordx4 a[148:151], v20, s[32:35], s80 offen offset:1024 sc1
v_mfma_f32_16x16x32_bf16 v[68:71], a[196:199], a[104:107], v[68:71]
ds_read_b64_tr_b16 a[228:229], v12 offset:29696
v_mfma_f32_16x16x32_bf16 v[72:75], a[196:199], a[108:111], v[72:75]
ds_read_b64_tr_b16 a[230:231], v12 offset:30208
v_mfma_f32_16x16x32_bf16 v[76:79], a[200:203], a[104:107], v[76:79]
ds_read_b64_tr_b16 a[232:233], v13 offset:29696
v_mfma_f32_16x16x32_bf16 v[80:83], a[200:203], a[108:111], v[80:83]
ds_read_b64_tr_b16 a[234:235], v13 offset:30208
v_mfma_f32_16x16x32_bf16 v[84:87], a[204:207], a[104:107], v[84:87]
ds_read_b64_tr_b16 a[236:237], v14 offset:29696
v_mfma_f32_16x16x32_bf16 v[88:91], a[204:207], a[108:111], v[88:91]
ds_read_b64_tr_b16 a[238:239], v14 offset:30208
s_waitcnt lgkmcnt(8)
v_mfma_f32_16x16x32_bf16 v[28:31], a[208:211], a[112:115], v[28:31]
s_waitcnt vmcnt(33)
s_barrier
ds_read_b64_tr_b16 a[192:193], v11 offset:30720
v_mfma_f32_16x16x32_bf16 v[32:35], a[208:211], a[116:119], v[32:35]
ds_read_b64_tr_b16 a[194:195], v11 offset:31232
s_add_u32 m0, s64, 22528
v_mfma_f32_16x16x32_bf16 v[36:39], a[212:215], a[112:115], v[36:39]
ds_read_b64_tr_b16 a[196:197], v12 offset:30720
s_add_u32 s67, s96, 73728
v_mfma_f32_16x16x32_bf16 v[40:43], a[212:215], a[116:119], v[40:43]
ds_read_b64_tr_b16 a[198:199], v12 offset:31232
buffer_load_dwordx4 v15, s[44:47], s67 offen lds
v_mfma_f32_16x16x32_bf16 v[44:47], a[216:219], a[112:115], v[44:47]
ds_read_b64_tr_b16 a[200:201], v13 offset:30720
v_mul_f32 v117, v117, v149
v_mfma_f32_16x16x32_bf16 v[48:51], a[216:219], a[116:119], v[48:51]
ds_read_b64_tr_b16 a[202:203], v13 offset:31232
v_mul_f32 v118, v118, v150
v_mfma_f32_16x16x32_bf16 v[52:55], a[220:223], a[112:115], v[52:55]
ds_read_b64_tr_b16 a[204:205], v14 offset:30720
buffer_load_dwordx4 v15, s[48:51], s67 offen offset:1024 lds
v_mfma_f32_16x16x32_bf16 v[56:59], a[220:223], a[116:119], v[56:59]
ds_read_b64_tr_b16 a[206:207], v14 offset:31232
s_waitcnt lgkmcnt(8)
v_mfma_f32_16x16x32_bf16 v[60:63], a[224:227], a[112:115], v[60:63]
ds_read_b64_tr_b16 a[208:209], v11 offset:31744
v_mul_f32 v119, v119, v151
v_mfma_f32_16x16x32_bf16 v[64:67], a[224:227], a[116:119], v[64:67]
ds_read_b64_tr_b16 a[210:211], v11 offset:32256
v_cvt_pk_bf16_f32 v182, v116, v117
v_mfma_f32_16x16x32_bf16 v[68:71], a[228:231], a[112:115], v[68:71]
ds_read_b64_tr_b16 a[212:213], v12 offset:31744
v_cvt_pk_bf16_f32 v183, v118, v119
v_mfma_f32_16x16x32_bf16 v[72:75], a[228:231], a[116:119], v[72:75]
ds_read_b64_tr_b16 a[214:215], v12 offset:32256
buffer_load_dwordx4 a[152:155], v20, s[32:35], s80 offen offset:2048 sc1
v_mfma_f32_16x16x32_bf16 v[76:79], a[232:235], a[112:115], v[76:79]
ds_read_b64_tr_b16 a[216:217], v13 offset:31744
v_mfma_f32_16x16x32_bf16 v[80:83], a[232:235], a[116:119], v[80:83]
ds_read_b64_tr_b16 a[218:219], v13 offset:32256
v_mfma_f32_16x16x32_bf16 v[84:87], a[236:239], a[112:115], v[84:87]
ds_read_b64_tr_b16 a[220:221], v14 offset:31744
v_mfma_f32_16x16x32_bf16 v[88:91], a[236:239], a[116:119], v[88:91]
ds_read_b64_tr_b16 a[222:223], v14 offset:32256
s_waitcnt lgkmcnt(8)
v_mfma_f32_16x16x32_bf16 v[28:31], a[192:195], a[120:123], v[28:31]
ds_read_b64_tr_b16 a[224:225], v11 offset:32768
s_add_u32 m0, s64, 24576
v_mfma_f32_16x16x32_bf16 v[32:35], a[192:195], a[124:127], v[32:35]
ds_read_b64_tr_b16 a[226:227], v11 offset:33280
s_add_u32 s67, s13, 0
v_mfma_f32_16x16x32_bf16 v[36:39], a[196:199], a[120:123], v[36:39]
ds_read_b64_tr_b16 a[228:229], v12 offset:32768
buffer_load_dwordx4 v15, s[44:47], s67 offen lds
v_mfma_f32_16x16x32_bf16 v[40:43], a[196:199], a[124:127], v[40:43]
ds_read_b64_tr_b16 a[230:231], v12 offset:33280
v_max_f32 v120, 0, v120
v_mfma_f32_16x16x32_bf16 v[44:47], a[200:203], a[120:123], v[44:47]
ds_read_b64_tr_b16 a[232:233], v13 offset:32768
v_max_f32 v121, 0, v121
v_mfma_f32_16x16x32_bf16 v[48:51], a[200:203], a[124:127], v[48:51]
ds_read_b64_tr_b16 a[234:235], v13 offset:33280
buffer_load_dwordx4 v15, s[48:51], s67 offen offset:1024 lds
v_mfma_f32_16x16x32_bf16 v[52:55], a[204:207], a[120:123], v[52:55]
ds_read_b64_tr_b16 a[236:237], v14 offset:32768
v_max_f32 v122, 0, v122
v_mfma_f32_16x16x32_bf16 v[56:59], a[204:207], a[124:127], v[56:59]
ds_read_b64_tr_b16 a[238:239], v14 offset:33280
s_waitcnt lgkmcnt(8)
v_mfma_f32_16x16x32_bf16 v[60:63], a[208:211], a[120:123], v[60:63]
ds_read_b64_tr_b16 a[192:193], v11 offset:33792
v_max_f32 v123, 0, v123
v_mfma_f32_16x16x32_bf16 v[64:67], a[208:211], a[124:127], v[64:67]
ds_read_b64_tr_b16 a[194:195], v11 offset:34304
v_mul_f32 v120, v120, v152
v_mfma_f32_16x16x32_bf16 v[68:71], a[212:215], a[120:123], v[68:71]
ds_read_b64_tr_b16 a[196:197], v12 offset:33792
buffer_load_dwordx4 a[156:159], v20, s[32:35], s80 offen offset:3072 sc1
v_mfma_f32_16x16x32_bf16 v[72:75], a[212:215], a[124:127], v[72:75]
ds_read_b64_tr_b16 a[198:199], v12 offset:34304
v_mfma_f32_16x16x32_bf16 v[76:79], a[216:219], a[120:123], v[76:79]
ds_read_b64_tr_b16 a[200:201], v13 offset:33792
v_mfma_f32_16x16x32_bf16 v[80:83], a[216:219], a[124:127], v[80:83]
ds_read_b64_tr_b16 a[202:203], v13 offset:34304
v_mfma_f32_16x16x32_bf16 v[84:87], a[220:223], a[120:123], v[84:87]
ds_read_b64_tr_b16 a[204:205], v14 offset:33792
v_mfma_f32_16x16x32_bf16 v[88:91], a[220:223], a[124:127], v[88:91]
ds_read_b64_tr_b16 a[206:207], v14 offset:34304
s_waitcnt lgkmcnt(8)
v_mfma_f32_16x16x32_bf16 v[28:31], a[224:227], v[220:223], v[28:31]
ds_read_b64_tr_b16 a[208:209], v11 offset:34816
s_add_u32 m0, s64, 26624
v_mfma_f32_16x16x32_bf16 v[32:35], a[224:227], v[224:227], v[32:35]
ds_read_b64_tr_b16 a[210:211], v11 offset:35328
s_add_u32 s67, s97, 0
v_mfma_f32_16x16x32_bf16 v[36:39], a[228:231], v[220:223], v[36:39]
ds_read_b64_tr_b16 a[212:213], v12 offset:34816
buffer_load_dwordx4 v15, s[44:47], s67 offen lds
v_mfma_f32_16x16x32_bf16 v[40:43], a[228:231], v[224:227], v[40:43]
ds_read_b64_tr_b16 a[214:215], v12 offset:35328
v_mul_f32 v121, v121, v153
v_mfma_f32_16x16x32_bf16 v[44:47], a[232:235], v[220:223], v[44:47]
ds_read_b64_tr_b16 a[216:217], v13 offset:34816
v_mul_f32 v122, v122, v154
v_mfma_f32_16x16x32_bf16 v[48:51], a[232:235], v[224:227], v[48:51]
ds_read_b64_tr_b16 a[218:219], v13 offset:35328
buffer_load_dwordx4 v15, s[48:51], s67 offen offset:1024 lds
v_mfma_f32_16x16x32_bf16 v[52:55], a[236:239], v[220:223], v[52:55]
ds_read_b64_tr_b16 a[220:221], v14 offset:34816
v_mul_f32 v123, v123, v155
v_mfma_f32_16x16x32_bf16 v[56:59], a[236:239], v[224:227], v[56:59]
ds_read_b64_tr_b16 a[222:223], v14 offset:35328
s_waitcnt lgkmcnt(8)
v_mfma_f32_16x16x32_bf16 v[60:63], a[192:195], v[220:223], v[60:63]
ds_read_b64_tr_b16 a[224:225], v11 offset:35840
v_cvt_pk_bf16_f32 v186, v120, v121
v_mfma_f32_16x16x32_bf16 v[64:67], a[192:195], v[224:227], v[64:67]
ds_read_b64_tr_b16 a[226:227], v11 offset:36352
v_cvt_pk_bf16_f32 v187, v122, v123
v_mfma_f32_16x16x32_bf16 v[68:71], a[196:199], v[220:223], v[68:71]
ds_read_b64_tr_b16 a[228:229], v12 offset:35840
v_mfma_f32_16x16x32_bf16 v[72:75], a[196:199], v[224:227], v[72:75]
ds_read_b64_tr_b16 a[230:231], v12 offset:36352
v_mfma_f32_16x16x32_bf16 v[76:79], a[200:203], v[220:223], v[76:79]
ds_read_b64_tr_b16 a[232:233], v13 offset:35840
v_mfma_f32_16x16x32_bf16 v[80:83], a[200:203], v[224:227], v[80:83]
ds_read_b64_tr_b16 a[234:235], v13 offset:36352
v_mfma_f32_16x16x32_bf16 v[84:87], a[204:207], v[220:223], v[84:87]
ds_read_b64_tr_b16 a[236:237], v14 offset:35840
v_mfma_f32_16x16x32_bf16 v[88:91], a[204:207], v[224:227], v[88:91]
ds_read_b64_tr_b16 a[238:239], v14 offset:36352
s_waitcnt lgkmcnt(8)
v_mfma_f32_16x16x32_bf16 v[92:95], a[208:211], v[228:231], v[28:31]
s_waitcnt vmcnt(37)
s_barrier
ds_read_b64_tr_b16 a[192:193], v11 offset:0
v_mfma_f32_16x16x32_bf16 v[96:99], a[208:211], v[232:235], v[32:35]
ds_read_b64_tr_b16 a[194:195], v11 offset:512
s_add_u32 m0, s64, 28672
v_mfma_f32_16x16x32_bf16 v[100:103], a[212:215], v[228:231], v[36:39]
ds_read_b64_tr_b16 a[196:197], v12 offset:0
s_add_u32 s67, s13, 73728
v_mfma_f32_16x16x32_bf16 v[104:107], a[212:215], v[232:235], v[40:43]
ds_read_b64_tr_b16 a[198:199], v12 offset:512
buffer_load_dwordx4 v15, s[44:47], s67 offen lds
v_mfma_f32_16x16x32_bf16 v[108:111], a[216:219], v[228:231], v[44:47]
ds_read_b64_tr_b16 a[200:201], v13 offset:0
v_mfma_f32_16x16x32_bf16 v[112:115], a[216:219], v[232:235], v[48:51]
ds_read_b64_tr_b16 a[202:203], v13 offset:512
v_mfma_f32_16x16x32_bf16 v[116:119], a[220:223], v[228:231], v[52:55]
ds_read_b64_tr_b16 a[204:205], v14 offset:0
buffer_load_dwordx4 v15, s[48:51], s67 offen offset:1024 lds
v_mfma_f32_16x16x32_bf16 v[120:123], a[220:223], v[232:235], v[56:59]
ds_read_b64_tr_b16 a[206:207], v14 offset:512
s_waitcnt lgkmcnt(8)
v_mfma_f32_16x16x32_bf16 v[124:127], a[224:227], v[228:231], v[60:63]
ds_read_b64_tr_b16 a[208:209], v11 offset:1024
buffer_store_dwordx4 v[180:183], v20, s[32:35], s21 offen offset:2048 sc1
v_mfma_f32_16x16x32_bf16 v[128:131], a[224:227], v[232:235], v[64:67]
ds_read_b64_tr_b16 a[210:211], v11 offset:1536
buffer_store_dwordx4 v[184:187], v20, s[32:35], s21 offen offset:3072 sc1
v_mfma_f32_16x16x32_bf16 v[132:135], a[228:231], v[228:231], v[68:71]
ds_read_b64_tr_b16 a[212:213], v12 offset:1024
s_add_u32 s21, s21, 16384
v_mfma_f32_16x16x32_bf16 v[136:139], a[228:231], v[232:235], v[72:75]
ds_read_b64_tr_b16 a[214:215], v12 offset:1536
buffer_load_dwordx4 a[252:255], v255, s[56:59], s3 offen
v_mfma_f32_16x16x32_bf16 v[140:143], a[232:235], v[228:231], v[76:79]
ds_read_b64_tr_b16 a[216:217], v13 offset:1024
v_mfma_f32_16x16x32_bf16 v[144:147], a[232:235], v[232:235], v[80:83]
ds_read_b64_tr_b16 a[218:219], v13 offset:1536
v_mfma_f32_16x16x32_bf16 v[148:151], a[236:239], v[228:231], v[84:87]
ds_read_b64_tr_b16 a[220:221], v14 offset:1024
v_mfma_f32_16x16x32_bf16 v[152:155], a[236:239], v[232:235], v[88:91]
ds_read_b64_tr_b16 a[222:223], v14 offset:1536
s_waitcnt lgkmcnt(8)
v_mfma_f32_16x16x32_bf16 v[28:31], a[192:195], v[188:191], 0
ds_read_b64_tr_b16 a[224:225], v11 offset:2048
s_add_u32 m0, s64, 30720
v_mfma_f32_16x16x32_bf16 v[32:35], a[192:195], v[192:195], 0
ds_read_b64_tr_b16 a[226:227], v11 offset:2560
s_add_u32 s67, s97, 73728
v_mfma_f32_16x16x32_bf16 v[36:39], a[196:199], v[188:191], 0
ds_read_b64_tr_b16 a[228:229], v12 offset:2048
buffer_load_dwordx4 v15, s[44:47], s67 offen lds
s_add_u32 s22, s15, 2048
v_mfma_f32_16x16x32_bf16 v[40:43], a[196:199], v[192:195], 0
ds_read_b64_tr_b16 a[230:231], v12 offset:2560
buffer_load_dword v23, v7, s[32:35], s22 offen sc1
v_max_f32 v92, 0, v92
v_mfma_f32_16x16x32_bf16 v[44:47], a[200:203], v[188:191], 0
ds_read_b64_tr_b16 a[232:233], v13 offset:2048
v_max_f32 v93, 0, v93
v_max_f32 v94, 0, v94
v_mfma_f32_16x16x32_bf16 v[48:51], a[200:203], v[192:195], 0
ds_read_b64_tr_b16 a[234:235], v13 offset:2560
buffer_load_dwordx4 v15, s[48:51], s67 offen offset:1024 lds
v_max_f32 v95, 0, v95
v_mfma_f32_16x16x32_bf16 v[52:55], a[204:207], v[188:191], 0
ds_read_b64_tr_b16 a[236:237], v14 offset:2048
s_add_u32 m0, s64, 32768
s_add_u32 s67, s11, 147456
v_mfma_f32_16x16x32_bf16 v[56:59], a[204:207], v[192:195], 0
ds_read_b64_tr_b16 a[238:239], v14 offset:2560
v_mul_f32 v92, v92, v124
s_waitcnt lgkmcnt(8)
v_mfma_f32_16x16x32_bf16 v[28:31], a[208:211], v[196:199], v[28:31]
ds_read_b64_tr_b16 a[192:193], v11 offset:3072
buffer_load_dwordx4 v15, s[44:47], s67 offen lds
v_mul_f32 v93, v93, v125
v_mfma_f32_16x16x32_bf16 v[32:35], a[208:211], v[200:203], v[32:35]
ds_read_b64_tr_b16 a[194:195], v11 offset:3584
v_mul_f32 v94, v94, v126
v_mul_f32 v95, v95, v127
v_mfma_f32_16x16x32_bf16 v[36:39], a[212:215], v[196:199], v[36:39]
ds_read_b64_tr_b16 a[196:197], v12 offset:3072
v_cvt_pk_bf16_f32 v156, v92, v93
v_cvt_pk_bf16_f32 v157, v94, v95
v_mfma_f32_16x16x32_bf16 v[40:43], a[212:215], v[200:203], v[40:43]
ds_read_b64_tr_b16 a[198:199], v12 offset:3584
buffer_load_dwordx4 v15, s[48:51], s67 offen offset:1024 lds
v_max_f32 v96, 0, v96
v_mfma_f32_16x16x32_bf16 v[44:47], a[216:219], v[196:199], v[44:47]
ds_read_b64_tr_b16 a[200:201], v13 offset:3072
v_max_f32 v97, 0, v97
v_max_f32 v98, 0, v98
v_mfma_f32_16x16x32_bf16 v[48:51], a[216:219], v[200:203], v[48:51]
ds_read_b64_tr_b16 a[202:203], v13 offset:3584
v_max_f32 v99, 0, v99
v_mul_f32 v96, v96, v128
v_mfma_f32_16x16x32_bf16 v[52:55], a[220:223], v[196:199], v[52:55]
ds_read_b64_tr_b16 a[204:205], v14 offset:3072
v_mul_f32 v97, v97, v129
v_mul_f32 v98, v98, v130
v_mfma_f32_16x16x32_bf16 v[56:59], a[220:223], v[200:203], v[56:59]
ds_read_b64_tr_b16 a[206:207], v14 offset:3584
v_mul_f32 v99, v99, v131
v_cvt_pk_bf16_f32 v160, v96, v97
v_cvt_pk_bf16_f32 v161, v98, v99
v_max_f32 v100, 0, v100
v_max_f32 v101, 0, v101
v_max_f32 v102, 0, v102
v_max_f32 v103, 0, v103
v_mul_f32 v100, v100, v132
v_mul_f32 v101, v101, v133
v_mul_f32 v102, v102, v134
v_mul_f32 v103, v103, v135
s_waitcnt lgkmcnt(8)
v_mfma_f32_16x16x32_bf16 v[28:31], a[224:227], v[204:207], v[28:31]
s_waitcnt vmcnt(40)
s_barrier
ds_read_b64_tr_b16 a[208:209], v11 offset:4096
v_mfma_f32_16x16x32_bf16 v[32:35], a[224:227], v[208:211], v[32:35]
ds_read_b64_tr_b16 a[210:211], v11 offset:4608
s_add_u32 m0, s64, 34816
v_mfma_f32_16x16x32_bf16 v[36:39], a[228:231], v[204:207], v[36:39]
ds_read_b64_tr_b16 a[212:213], v12 offset:4096
s_add_u32 s67, s96, 147456
buffer_load_dwordx4 v15, s[44:47], s67 offen lds
v_mfma_f32_16x16x32_bf16 v[40:43], a[228:231], v[208:211], v[40:43]
ds_read_b64_tr_b16 a[214:215], v12 offset:4608
v_cvt_pk_bf16_f32 v158, v100, v101
v_cvt_pk_bf16_f32 v159, v102, v103
v_mfma_f32_16x16x32_bf16 v[44:47], a[232:235], v[204:207], v[44:47]
ds_read_b64_tr_b16 a[216:217], v13 offset:4096
buffer_store_dwordx4 v[156:159], v20, s[32:35], s21 offen offset:0 sc1
v_max_f32 v104, 0, v104
v_mfma_f32_16x16x32_bf16 v[48:51], a[232:235], v[208:211], v[48:51]
ds_read_b64_tr_b16 a[218:219], v13 offset:4608
buffer_load_dwordx4 v15, s[48:51], s67 offen offset:1024 lds
v_max_f32 v105, 0, v105
v_mfma_f32_16x16x32_bf16 v[52:55], a[236:239], v[204:207], v[52:55]
ds_read_b64_tr_b16 a[220:221], v14 offset:4096
s_add_u32 m0, s64, 36864
s_add_u32 s67, s11, 221184
v_mfma_f32_16x16x32_bf16 v[56:59], a[236:239], v[208:211], v[56:59]
ds_read_b64_tr_b16 a[222:223], v14 offset:4608
v_max_f32 v106, 0, v106
s_waitcnt lgkmcnt(8)
v_mfma_f32_16x16x32_bf16 v[28:31], a[192:195], v[212:215], v[28:31]
ds_read_b64_tr_b16 a[224:225], v11 offset:5120
buffer_load_dwordx4 v15, s[44:47], s67 offen lds
v_max_f32 v107, 0, v107
v_mfma_f32_16x16x32_bf16 v[32:35], a[192:195], v[216:219], v[32:35]
ds_read_b64_tr_b16 a[226:227], v11 offset:5632
v_mul_f32 v104, v104, v136
v_mul_f32 v105, v105, v137
v_mfma_f32_16x16x32_bf16 v[36:39], a[196:199], v[212:215], v[36:39]
ds_read_b64_tr_b16 a[228:229], v12 offset:5120
v_mul_f32 v106, v106, v138
v_mul_f32 v107, v107, v139
v_mfma_f32_16x16x32_bf16 v[40:43], a[196:199], v[216:219], v[40:43]
ds_read_b64_tr_b16 a[230:231], v12 offset:5632
buffer_load_dwordx4 v15, s[48:51], s67 offen offset:1024 lds
v_cvt_pk_bf16_f32 v162, v104, v105
v_mfma_f32_16x16x32_bf16 v[44:47], a[200:203], v[212:215], v[44:47]
ds_read_b64_tr_b16 a[232:233], v13 offset:5120
v_cvt_pk_bf16_f32 v163, v106, v107
buffer_store_dwordx4 v[160:163], v20, s[32:35], s21 offen offset:1024 sc1
v_mfma_f32_16x16x32_bf16 v[48:51], a[200:203], v[216:219], v[48:51]
ds_read_b64_tr_b16 a[234:235], v13 offset:5632
v_max_f32 v108, 0, v108
v_max_f32 v109, 0, v109
v_mfma_f32_16x16x32_bf16 v[52:55], a[204:207], v[212:215], v[52:55]
ds_read_b64_tr_b16 a[236:237], v14 offset:5120
v_max_f32 v110, 0, v110
v_max_f32 v111, 0, v111
v_mfma_f32_16x16x32_bf16 v[56:59], a[204:207], v[216:219], v[56:59]
ds_read_b64_tr_b16 a[238:239], v14 offset:5632
v_mul_f32 v108, v108, v140
v_mul_f32 v109, v109, v141
v_mul_f32 v110, v110, v142
v_mul_f32 v111, v111, v143
v_cvt_pk_bf16_f32 v164, v108, v109
v_cvt_pk_bf16_f32 v165, v110, v111
v_max_f32 v112, 0, v112
v_max_f32 v113, 0, v113
v_max_f32 v114, 0, v114
v_max_f32 v115, 0, v115
s_waitcnt lgkmcnt(8)
v_mfma_f32_16x16x32_bf16 v[28:31], a[208:211], v[172:175], v[28:31]
ds_read_b64_tr_b16 a[192:193], v11 offset:6144
s_add_u32 m0, s64, 38912
v_mfma_f32_16x16x32_bf16 v[32:35], a[208:211], v[176:179], v[32:35]
ds_read_b64_tr_b16 a[194:195], v11 offset:6656
s_add_u32 s67, s96, 221184
v_mfma_f32_16x16x32_bf16 v[36:39], a[212:215], v[172:175], v[36:39]
ds_read_b64_tr_b16 a[196:197], v12 offset:6144
buffer_load_dwordx4 v15, s[44:47], s67 offen lds
v_mul_f32 v112, v112, v144
v_mfma_f32_16x16x32_bf16 v[40:43], a[212:215], v[176:179], v[40:43]
ds_read_b64_tr_b16 a[198:199], v12 offset:6656
v_mul_f32 v113, v113, v145
v_mul_f32 v114, v114, v146
v_mfma_f32_16x16x32_bf16 v[44:47], a[216:219], v[172:175], v[44:47]
ds_read_b64_tr_b16 a[200:201], v13 offset:6144
v_mul_f32 v115, v115, v147
v_cvt_pk_bf16_f32 v168, v112, v113
v_mfma_f32_16x16x32_bf16 v[48:51], a[216:219], v[176:179], v[48:51]
ds_read_b64_tr_b16 a[202:203], v13 offset:6656
buffer_load_dwordx4 v15, s[48:51], s67 offen offset:1024 lds
v_cvt_pk_bf16_f32 v169, v114, v115
v_mfma_f32_16x16x32_bf16 v[52:55], a[220:223], v[172:175], v[52:55]
ds_read_b64_tr_b16 a[204:205], v14 offset:6144
v_max_f32 v116, 0, v116
v_max_f32 v117, 0, v117
v_mfma_f32_16x16x32_bf16 v[56:59], a[220:223], v[176:179], v[56:59]
ds_read_b64_tr_b16 a[206:207], v14 offset:6656
v_max_f32 v118, 0, v118
s_waitcnt lgkmcnt(8)
v_mfma_f32_16x16x32_bf16 v[28:31], a[224:227], v[180:183], v[28:31]
ds_read_b64_tr_b16 a[208:209], v11 offset:7168
v_max_f32 v119, 0, v119
v_mul_f32 v116, v116, v148
v_mfma_f32_16x16x32_bf16 v[32:35], a[224:227], v[184:187], v[32:35]
ds_read_b64_tr_b16 a[210:211], v11 offset:7680
v_mul_f32 v117, v117, v149
v_mul_f32 v118, v118, v150
v_mfma_f32_16x16x32_bf16 v[36:39], a[228:231], v[180:183], v[36:39]
ds_read_b64_tr_b16 a[212:213], v12 offset:7168
v_mul_f32 v119, v119, v151
v_cvt_pk_bf16_f32 v166, v116, v117
v_mfma_f32_16x16x32_bf16 v[40:43], a[228:231], v[184:187], v[40:43]
ds_read_b64_tr_b16 a[214:215], v12 offset:7680
v_cvt_pk_bf16_f32 v167, v118, v119
buffer_store_dwordx4 v[164:167], v20, s[32:35], s21 offen offset:2048 sc1
v_mfma_f32_16x16x32_bf16 v[44:47], a[232:235], v[180:183], v[44:47]
ds_read_b64_tr_b16 a[216:217], v13 offset:7168
v_max_f32 v120, 0, v120
v_max_f32 v121, 0, v121
v_mfma_f32_16x16x32_bf16 v[48:51], a[232:235], v[184:187], v[48:51]
ds_read_b64_tr_b16 a[218:219], v13 offset:7680
v_max_f32 v122, 0, v122
v_max_f32 v123, 0, v123
v_mfma_f32_16x16x32_bf16 v[52:55], a[236:239], v[180:183], v[52:55]
ds_read_b64_tr_b16 a[220:221], v14 offset:7168
v_mul_f32 v120, v120, v152
v_mul_f32 v121, v121, v153
v_mfma_f32_16x16x32_bf16 v[56:59], a[236:239], v[184:187], v[56:59]
ds_read_b64_tr_b16 a[222:223], v14 offset:7680
v_mul_f32 v122, v122, v154
v_mul_f32 v123, v123, v155
v_cvt_pk_bf16_f32 v170, v120, v121
v_cvt_pk_bf16_f32 v171, v122, v123
buffer_store_dwordx4 v[168:171], v20, s[32:35], s21 offen offset:3072 sc1
s_add_u32 s21, s21, 16384
s_waitcnt vmcnt(13)
v_cmp_ne_u32 vcc, s63, v23
s_nop 1
s_and_b32 vcc_lo, vcc_lo, 3
s_cbranch_scc0 L_ok_20
s_mov_b32 s74, 200000
s_add_u32 s73, s15, 2048
L_sp_21:
buffer_load_dword v4, v7, s[32:35], s73 offen sc1
s_sub_u32 s74, s74, 1
s_waitcnt vmcnt(0)
v_cmp_ne_u32 vcc, s63, v4
s_cmp_eq_u32 s74, 0
s_cbranch_scc1 L_spd_22
s_and_b32 vcc_lo, vcc_lo, 3
s_cbranch_scc1 L_sp_21
L_spd_22:
L_ok_20:
s_waitcnt lgkmcnt(8)
v_mfma_f32_16x16x32_bf16 v[28:31], a[192:195], v[156:159], v[28:31]
s_barrier
ds_read_b64_tr_b16 a[224:225], v11 offset:8192
v_mfma_f32_16x16x32_bf16 v[32:35], a[192:195], v[160:163], v[32:35]
ds_read_b64_tr_b16 a[226:227], v11 offset:8704
s_add_u32 s22, s15, 4096
buffer_store_dword v22, v21, s[32:35], s22 offen sc1
v_mfma_f32_16x16x32_bf16 v[36:39], a[196:199], v[156:159], v[36:39]
ds_read_b64_tr_b16 a[228:229], v12 offset:8192
s_add_u32 m0, s64, 0
v_mfma_f32_16x16x32_bf16 v[40:43], a[196:199], v[160:163], v[40:43]
ds_read_b64_tr_b16 a[230:231], v12 offset:8704
s_add_u32 s67, s13, 147456
v_mfma_f32_16x16x32_bf16 v[44:47], a[200:203], v[156:159], v[44:47]
ds_read_b64_tr_b16 a[232:233], v13 offset:8192
buffer_load_dwordx4 v15, s[44:47], s67 offen lds
v_mfma_f32_16x16x32_bf16 v[48:51], a[200:203], v[160:163], v[48:51]
ds_read_b64_tr_b16 a[234:235], v13 offset:8704
s_add_u32 s80, s94, 16384
v_mfma_f32_16x16x32_bf16 v[52:55], a[204:207], v[156:159], v[52:55]
ds_read_b64_tr_b16 a[236:237], v14 offset:8192
buffer_load_dwordx4 a[0:3], v20, s[32:35], s80 offen offset:0 sc1
v_mfma_f32_16x16x32_bf16 v[56:59], a[204:207], v[160:163], v[56:59]
ds_read_b64_tr_b16 a[238:239], v14 offset:8704
s_waitcnt lgkmcnt(8)
v_mfma_f32_16x16x32_bf16 v[28:31], a[208:211], v[164:167], v[28:31]
ds_read_b64_tr_b16 a[192:193], v11 offset:9216
buffer_load_dwordx4 v15, s[48:51], s67 offen offset:1024 lds
v_mfma_f32_16x16x32_bf16 v[32:35], a[208:211], v[168:171], v[32:35]
ds_read_b64_tr_b16 a[194:195], v11 offset:9728
v_mfma_f32_16x16x32_bf16 v[36:39], a[212:215], v[164:167], v[36:39]
ds_read_b64_tr_b16 a[196:197], v12 offset:9216
v_mfma_f32_16x16x32_bf16 v[40:43], a[212:215], v[168:171], v[40:43]
ds_read_b64_tr_b16 a[198:199], v12 offset:9728
v_mfma_f32_16x16x32_bf16 v[44:47], a[216:219], v[164:167], v[44:47]
ds_read_b64_tr_b16 a[200:201], v13 offset:9216
v_mfma_f32_16x16x32_bf16 v[48:51], a[216:219], v[168:171], v[48:51]
ds_read_b64_tr_b16 a[202:203], v13 offset:9728
v_mfma_f32_16x16x32_bf16 v[52:55], a[220:223], v[164:167], v[52:55]
ds_read_b64_tr_b16 a[204:205], v14 offset:9216
v_mfma_f32_16x16x32_bf16 v[56:59], a[220:223], v[168:171], v[56:59]
ds_read_b64_tr_b16 a[206:207], v14 offset:9728
s_waitcnt lgkmcnt(8)
v_mfma_f32_16x16x32_bf16 v[60:63], a[224:227], v[188:191], 0
ds_read_b64_tr_b16 a[208:209], v11 offset:10240
s_add_u32 m0, s64, 2048
v_mfma_f32_16x16x32_bf16 v[64:67], a[224:227], v[192:195], 0
ds_read_b64_tr_b16 a[210:211], v11 offset:10752
s_add_u32 s67, s97, 147456
v_mfma_f32_16x16x32_bf16 v[68:71], a[228:231], v[188:191], 0
ds_read_b64_tr_b16 a[212:213], v12 offset:10240
buffer_load_dwordx4 v15, s[44:47], s67 offen lds
v_mfma_f32_16x16x32_bf16 v[72:75], a[228:231], v[192:195], 0
ds_read_b64_tr_b16 a[214:215], v12 offset:10752
buffer_load_dwordx4 a[4:7], v20, s[32:35], s80 offen offset:1024 sc1
v_mfma_f32_16x16x32_bf16 v[76:79], a[232:235], v[188:191], 0
ds_read_b64_tr_b16 a[216:217], v13 offset:10240
buffer_load_dwordx4 a[8:11], v20, s[32:35], s80 offen offset:2048 sc1
v_mfma_f32_16x16x32_bf16 v[80:83], a[232:235], v[192:195], 0
ds_read_b64_tr_b16 a[218:219], v13 offset:10752
buffer_load_dwordx4 v15, s[48:51], s67 offen offset:1024 lds
v_mfma_f32_16x16x32_bf16 v[84:87], a[236:239], v[188:191], 0
ds_read_b64_tr_b16 a[220:221], v14 offset:10240
v_mfma_f32_16x16x32_bf16 v[88:91], a[236:239], v[192:195], 0
ds_read_b64_tr_b16 a[222:223], v14 offset:10752
s_waitcnt lgkmcnt(8)
v_mfma_f32_16x16x32_bf16 v[60:63], a[192:195], v[196:199], v[60:63]
ds_read_b64_tr_b16 a[224:225], v11 offset:11264
v_mfma_f32_16x16x32_bf16 v[64:67], a[192:195], v[200:203], v[64:67]
ds_read_b64_tr_b16 a[226:227], v11 offset:11776
v_mfma_f32_16x16x32_bf16 v[68:71], a[196:199], v[196:199], v[68:71]
ds_read_b64_tr_b16 a[228:229], v12 offset:11264
v_mfma_f32_16x16x32_bf16 v[72:75], a[196:199], v[200:203], v[72:75]
ds_read_b64_tr_b16 a[230:231], v12 offset:11776
v_mfma_f32_16x16x32_bf16 v[76:79], a[200:203], v[196:199], v[76:79]
ds_read_b64_tr_b16 a[232:233], v13 offset:11264
v_mfma_f32_16x16x32_bf16 v[80:83], a[200:203], v[200:203], v[80:83]
ds_read_b64_tr_b16 a[234:235], v13 offset:11776
v_mfma_f32_16x16x32_bf16 v[84:87], a[204:207], v[196:199], v[84:87]
ds_read_b64_tr_b16 a[236:237], v14 offset:11264
v_mfma_f32_16x16x32_bf16 v[88:91], a[204:207], v[200:203], v[88:91]
ds_read_b64_tr_b16 a[238:239], v14 offset:11776
s_waitcnt lgkmcnt(8)
v_mfma_f32_16x16x32_bf16 v[60:63], a[208:211], v[204:207], v[60:63]
s_barrier
ds_read_b64_tr_b16 a[192:193], v11 offset:12288
v_mfma_f32_16x16x32_bf16 v[64:67], a[208:211], v[208:211], v[64:67]
ds_read_b64_tr_b16 a[194:195], v11 offset:12800
s_add_u32 m0, s64, 4096
v_mfma_f32_16x16x32_bf16 v[68:71], a[212:215], v[204:207], v[68:71]
ds_read_b64_tr_b16 a[196:197], v12 offset:12288
s_add_u32 s67, s13, 221184
v_mfma_f32_16x16x32_bf16 v[72:75], a[212:215], v[208:211], v[72:75]
ds_read_b64_tr_b16 a[198:199], v12 offset:12800
buffer_load_dwordx4 v15, s[44:47], s67 offen lds
v_mfma_f32_16x16x32_bf16 v[76:79], a[216:219], v[204:207], v[76:79]
ds_read_b64_tr_b16 a[200:201], v13 offset:12288
buffer_load_dwordx4 a[12:15], v20, s[32:35], s80 offen offset:3072 sc1
v_mfma_f32_16x16x32_bf16 v[80:83], a[216:219], v[208:211], v[80:83]
ds_read_b64_tr_b16 a[202:203], v13 offset:12800
s_add_u32 s80, s95, 16384
v_mfma_f32_16x16x32_bf16 v[84:87], a[220:223], v[204:207], v[84:87]
ds_read_b64_tr_b16 a[204:205], v14 offset:12288
buffer_load_dwordx4 v15, s[48:51], s67 offen offset:1024 lds
v_mfma_f32_16x16x32_bf16 v[88:91], a[220:223], v[208:211], v[88:91]
ds_read_b64_tr_b16 a[206:207], v14 offset:12800
s_waitcnt lgkmcnt(8)
v_mfma_f32_16x16x32_bf16 v[60:63], a[224:227], v[212:215], v[60:63]
ds_read_b64_tr_b16 a[208:209], v11 offset:13312
v_mfma_f32_16x16x32_bf16 v[64:67], a[224:227], v[216:219], v[64:67]
ds_read_b64_tr_b16 a[210:211], v11 offset:13824
v_mfma_f32_16x16x32_bf16 v[68:71], a[228:231], v[212:215], v[68:71]
ds_read_b64_tr_b16 a[212:213], v12 offset:13312
v_mfma_f32_16x16x32_bf16 v[72:75], a[228:231], v[216:219], v[72:75]
ds_read_b64_tr_b16 a[214:215], v12 offset:13824
v_mfma_f32_16x16x32_bf16 v[76:79], a[232:235], v[212:215], v[76:79]
ds_read_b64_tr_b16 a[216:217], v13 offset:13312
v_mfma_f32_16x16x32_bf16 v[80:83], a[232:235], v[216:219], v[80:83]
ds_read_b64_tr_b16 a[218:219], v13 offset:13824
v_mfma_f32_16x16x32_bf16 v[84:87], a[236:239], v[212:215], v[84:87]
ds_read_b64_tr_b16 a[220:221], v14 offset:13312
v_mfma_f32_16x16x32_bf16 v[88:91], a[236:239], v[216:219], v[88:91]
ds_read_b64_tr_b16 a[222:223], v14 offset:13824
s_waitcnt lgkmcnt(8)
v_mfma_f32_16x16x32_bf16 v[60:63], a[192:195], v[172:175], v[60:63]
ds_read_b64_tr_b16 a[224:225], v11 offset:14336
s_add_u32 m0, s64, 6144
v_mfma_f32_16x16x32_bf16 v[64:67], a[192:195], v[176:179], v[64:67]
ds_read_b64_tr_b16 a[226:227], v11 offset:14848
s_add_u32 s67, s97, 221184
v_mfma_f32_16x16x32_bf16 v[68:71], a[196:199], v[172:175], v[68:71]
ds_read_b64_tr_b16 a[228:229], v12 offset:14336
buffer_load_dwordx4 v15, s[44:47], s67 offen lds
v_mfma_f32_16x16x32_bf16 v[72:75], a[196:199], v[176:179], v[72:75]
ds_read_b64_tr_b16 a[230:231], v12 offset:14848
buffer_load_dwordx4 a[16:19], v20, s[32:35], s80 offen offset:0 sc1
v_mfma_f32_16x16x32_bf16 v[76:79], a[200:203], v[172:175], v[76:79]
ds_read_b64_tr_b16 a[232:233], v13 offset:14336
buffer_load_dwordx4 a[20:23], v20, s[32:35], s80 offen offset:1024 sc1
v_mfma_f32_16x16x32_bf16 v[80:83], a[200:203], v[176:179], v[80:83]
ds_read_b64_tr_b16 a[234:235], v13 offset:14848
buffer_load_dwordx4 v15, s[48:51], s67 offen offset:1024 lds
v_mfma_f32_16x16x32_bf16 v[84:87], a[204:207], v[172:175], v[84:87]
ds_read_b64_tr_b16 a[236:237], v14 offset:14336
s_add_u32 s22, s15, 4096
v_mfma_f32_16x16x32_bf16 v[88:91], a[204:207], v[176:179], v[88:91]
ds_read_b64_tr_b16 a[238:239], v14 offset:14848
s_waitcnt lgkmcnt(8)
v_mfma_f32_16x16x32_bf16 v[60:63], a[208:211], v[180:183], v[60:63]
ds_read_b64_tr_b16 a[192:193], v11 offset:15360
buffer_load_dword v23, v7, s[32:35], s22 offen sc1
v_mfma_f32_16x16x32_bf16 v[64:67], a[208:211], v[184:187], v[64:67]
ds_read_b64_tr_b16 a[194:195], v11 offset:15872
v_mfma_f32_16x16x32_bf16 v[68:71], a[212:215], v[180:183], v[68:71]
ds_read_b64_tr_b16 a[196:197], v12 offset:15360
v_mfma_f32_16x16x32_bf16 v[72:75], a[212:215], v[184:187], v[72:75]
ds_read_b64_tr_b16 a[198:199], v12 offset:15872
v_mfma_f32_16x16x32_bf16 v[76:79], a[216:219], v[180:183], v[76:79]
ds_read_b64_tr_b16 a[200:201], v13 offset:15360
v_mfma_f32_16x16x32_bf16 v[80:83], a[216:219], v[184:187], v[80:83]
ds_read_b64_tr_b16 a[202:203], v13 offset:15872
v_mfma_f32_16x16x32_bf16 v[84:87], a[220:223], v[180:183], v[84:87]
ds_read_b64_tr_b16 a[204:205], v14 offset:15360
v_mfma_f32_16x16x32_bf16 v[88:91], a[220:223], v[184:187], v[88:91]
ds_read_b64_tr_b16 a[206:207], v14 offset:15872
s_waitcnt lgkmcnt(8)
v_mfma_f32_16x16x32_bf16 v[60:63], a[224:227], v[156:159], v[60:63]
s_waitcnt vmcnt(16)
s_barrier
ds_read_b64_tr_b16 a[208:209], v11 offset:16384
v_mfma_f32_16x16x32_bf16 v[64:67], a[224:227], v[160:163], v[64:67]
ds_read_b64_tr_b16 a[210:211], v11 offset:16896
s_add_u32 s22, s15, 6144
buffer_store_dword v22, v21, s[32:35], s22 offen sc1
v_mfma_f32_16x16x32_bf16 v[68:71], a[228:231], v[156:159], v[68:71]
ds_read_b64_tr_b16 a[212:213], v12 offset:16384
s_add_u32 m0, s64, 8192
v_mfma_f32_16x16x32_bf16 v[72:75], a[228:231], v[160:163], v[72:75]
ds_read_b64_tr_b16 a[214:215], v12 offset:16896
s_add_u32 s67, s10, 0
v_mfma_f32_16x16x32_bf16 v[76:79], a[232:235], v[156:159], v[76:79]
ds_read_b64_tr_b16 a[216:217], v13 offset:16384
buffer_load_dwordx4 v15, s[44:47], s67 offen lds
v_mfma_f32_16x16x32_bf16 v[80:83], a[232:235], v[160:163], v[80:83]
ds_read_b64_tr_b16 a[218:219], v13 offset:16896
buffer_load_dwordx4 a[24:27], v20, s[32:35], s80 offen offset:2048 sc1
v_mfma_f32_16x16x32_bf16 v[84:87], a[236:239], v[156:159], v[84:87]
ds_read_b64_tr_b16 a[220:221], v14 offset:16384
buffer_load_dwordx4 a[28:31], v20, s[32:35], s80 offen offset:3072 sc1
v_mfma_f32_16x16x32_bf16 v[88:91], a[236:239], v[160:163], v[88:91]
ds_read_b64_tr_b16 a[222:223], v14 offset:16896
s_waitcnt lgkmcnt(8)
v_mfma_f32_16x16x32_bf16 v[60:63], a[192:195], v[164:167], v[60:63]
ds_read_b64_tr_b16 a[224:225], v11 offset:17408
buffer_load_dwordx4 v15, s[48:51], s67 offen offset:1024 lds
v_mfma_f32_16x16x32_bf16 v[64:67], a[192:195], v[168:171], v[64:67]
ds_read_b64_tr_b16 a[226:227], v11 offset:17920
v_mfma_f32_16x16x32_bf16 v[68:71], a[196:199], v[164:167], v[68:71]
ds_read_b64_tr_b16 a[228:229], v12 offset:17408
v_mfma_f32_16x16x32_bf16 v[72:75], a[196:199], v[168:171], v[72:75]
ds_read_b64_tr_b16 a[230:231], v12 offset:17920
v_mfma_f32_16x16x32_bf16 v[76:79], a[200:203], v[164:167], v[76:79]
ds_read_b64_tr_b16 a[232:233], v13 offset:17408
v_mfma_f32_16x16x32_bf16 v[80:83], a[200:203], v[168:171], v[80:83]
ds_read_b64_tr_b16 a[234:235], v13 offset:17920
v_mfma_f32_16x16x32_bf16 v[84:87], a[204:207], v[164:167], v[84:87]
ds_read_b64_tr_b16 a[236:237], v14 offset:17408
v_mfma_f32_16x16x32_bf16 v[88:91], a[204:207], v[168:171], v[88:91]
ds_read_b64_tr_b16 a[238:239], v14 offset:17920
s_waitcnt lgkmcnt(8)
v_mfma_f32_16x16x32_bf16 v[28:31], a[208:211], a[128:131], v[28:31]
ds_read_b64_tr_b16 a[192:193], v11 offset:18432
s_add_u32 m0, s64, 10240
v_mfma_f32_16x16x32_bf16 v[32:35], a[208:211], a[132:135], v[32:35]
ds_read_b64_tr_b16 a[194:195], v11 offset:18944
s_add_u32 s67, s10, 73728
v_mfma_f32_16x16x32_bf16 v[36:39], a[212:215], a[128:131], v[36:39]
ds_read_b64_tr_b16 a[196:197], v12 offset:18432
buffer_load_dwordx4 v15, s[44:47], s67 offen lds
v_mfma_f32_16x16x32_bf16 v[40:43], a[212:215], a[132:135], v[40:43]
ds_read_b64_tr_b16 a[198:199], v12 offset:18944
buffer_load_dwordx4 a[252:255], v255, s[56:59], s3 offen
v_mfma_f32_16x16x32_bf16 v[44:47], a[216:219], a[128:131], v[44:47]
ds_read_b64_tr_b16 a[200:201], v13 offset:18432
v_mfma_f32_16x16x32_bf16 v[48:51], a[216:219], a[132:135], v[48:51]
ds_read_b64_tr_b16 a[202:203], v13 offset:18944
buffer_load_dwordx4 v15, s[48:51], s67 offen offset:1024 lds
v_mfma_f32_16x16x32_bf16 v[52:55], a[220:223], a[128:131], v[52:55]
ds_read_b64_tr_b16 a[204:205], v14 offset:18432
v_mfma_f32_16x16x32_bf16 v[56:59], a[220:223], a[132:135], v[56:59]
ds_read_b64_tr_b16 a[206:207], v14 offset:18944
s_waitcnt lgkmcnt(8)
v_mfma_f32_16x16x32_bf16 v[28:31], a[224:227], a[136:139], v[28:31]
ds_read_b64_tr_b16 a[208:209], v11 offset:19456
v_mfma_f32_16x16x32_bf16 v[32:35], a[224:227], a[140:143], v[32:35]
ds_read_b64_tr_b16 a[210:211], v11 offset:19968
v_mfma_f32_16x16x32_bf16 v[36:39], a[228:231], a[136:139], v[36:39]
ds_read_b64_tr_b16 a[212:213], v12 offset:19456
v_mfma_f32_16x16x32_bf16 v[40:43], a[228:231], a[140:143], v[40:43]
ds_read_b64_tr_b16 a[214:215], v12 offset:19968
v_mfma_f32_16x16x32_bf16 v[44:47], a[232:235], a[136:139], v[44:47]
ds_read_b64_tr_b16 a[216:217], v13 offset:19456
v_mfma_f32_16x16x32_bf16 v[48:51], a[232:235], a[140:143], v[48:51]
ds_read_b64_tr_b16 a[218:219], v13 offset:19968
v_mfma_f32_16x16x32_bf16 v[52:55], a[236:239], a[136:139], v[52:55]
ds_read_b64_tr_b16 a[220:221], v14 offset:19456
v_mfma_f32_16x16x32_bf16 v[56:59], a[236:239], a[140:143], v[56:59]
ds_read_b64_tr_b16 a[222:223], v14 offset:19968
s_waitcnt vmcnt(8)
v_cmp_ne_u32 vcc, s63, v23
s_nop 1
s_and_b32 vcc_lo, vcc_lo, 3
s_cbranch_scc0 L_ok_23
s_mov_b32 s74, 200000
s_add_u32 s73, s15, 4096
L_sp_24:
buffer_load_dword v4, v7, s[32:35], s73 offen sc1
s_sub_u32 s74, s74, 1
s_waitcnt vmcnt(0)
v_cmp_ne_u32 vcc, s63, v4
s_cmp_eq_u32 s74, 0
s_cbranch_scc1 L_spd_25
s_and_b32 vcc_lo, vcc_lo, 3
s_cbranch_scc1 L_sp_24
L_spd_25:
L_ok_23:
s_waitcnt lgkmcnt(8)
v_mfma_f32_16x16x32_bf16 v[28:31], a[192:195], a[144:147], v[28:31]
s_barrier
ds_read_b64_tr_b16 a[224:225], v11 offset:20480
v_mfma_f32_16x16x32_bf16 v[32:35], a[192:195], a[148:151], v[32:35]
ds_read_b64_tr_b16 a[226:227], v11 offset:20992
s_add_u32 m0, s64, 12288
v_mfma_f32_16x16x32_bf16 v[36:39], a[196:199], a[144:147], v[36:39]
ds_read_b64_tr_b16 a[228:229], v12 offset:20480
s_add_u32 s67, s10, 147456
v_mfma_f32_16x16x32_bf16 v[40:43], a[196:199], a[148:151], v[40:43]
ds_read_b64_tr_b16 a[230:231], v12 offset:20992
buffer_load_dwordx4 v15, s[44:47], s67 offen lds
v_mfma_f32_16x16x32_bf16 v[44:47], a[200:203], a[144:147], v[44:47]
ds_read_b64_tr_b16 a[232:233], v13 offset:20480
s_add_u32 s80, s94, 32768
v_mfma_f32_16x16x32_bf16 v[48:51], a[200:203], a[148:151], v[48:51]
ds_read_b64_tr_b16 a[234:235], v13 offset:20992
buffer_load_dwordx4 a[32:35], v20, s[32:35], s80 offen offset:0 sc1
v_mfma_f32_16x16x32_bf16 v[52:55], a[204:207], a[144:147], v[52:55]
ds_read_b64_tr_b16 a[236:237], v14 offset:20480
buffer_load_dwordx4 v15, s[48:51], s67 offen offset:1024 lds
v_mfma_f32_16x16x32_bf16 v[56:59], a[204:207], a[148:151], v[56:59]
ds_read_b64_tr_b16 a[238:239], v14 offset:20992
s_waitcnt lgkmcnt(8)
v_mfma_f32_16x16x32_bf16 v[28:31], a[208:211], a[152:155], v[28:31]
ds_read_b64_tr_b16 a[192:193], v11 offset:21504
v_mfma_f32_16x16x32_bf16 v[32:35], a[208:211], a[156:159], v[32:35]
ds_read_b64_tr_b16 a[194:195], v11 offset:22016
v_mfma_f32_16x16x32_bf16 v[36:39], a[212:215], a[152:155], v[36:39]
ds_read_b64_tr_b16 a[196:197], v12 offset:21504
v_mfma_f32_16x16x32_bf16 v[40:43], a[212:215], a[156:159], v[40:43]
ds_read_b64_tr_b16 a[198:199], v12 offset:22016
v_mfma_f32_16x16x32_bf16 v[44:47], a[216:219], a[152:155], v[44:47]
ds_read_b64_tr_b16 a[200:201], v13 offset:21504
v_mfma_f32_16x16x32_bf16 v[48:51], a[216:219], a[156:159], v[48:51]
ds_read_b64_tr_b16 a[202:203], v13 offset:22016
v_mfma_f32_16x16x32_bf16 v[52:55], a[220:223], a[152:155], v[52:55]
ds_read_b64_tr_b16 a[204:205], v14 offset:21504
v_mfma_f32_16x16x32_bf16 v[56:59], a[220:223], a[156:159], v[56:59]
ds_read_b64_tr_b16 a[206:207], v14 offset:22016
s_waitcnt lgkmcnt(8)
v_mfma_f32_16x16x32_bf16 v[28:31], a[224:227], a[0:3], v[28:31]
ds_read_b64_tr_b16 a[208:209], v11 offset:22528
s_add_u32 m0, s64, 14336
v_mfma_f32_16x16x32_bf16 v[32:35], a[224:227], a[4:7], v[32:35]
ds_read_b64_tr_b16 a[210:211], v11 offset:23040
s_add_u32 s67, s10, 221184
v_mfma_f32_16x16x32_bf16 v[36:39], a[228:231], a[0:3], v[36:39]
ds_read_b64_tr_b16 a[212:213], v12 offset:22528
buffer_load_dwordx4 v15, s[44:47], s67 offen lds
v_mfma_f32_16x16x32_bf16 v[40:43], a[228:231], a[4:7], v[40:43]
ds_read_b64_tr_b16 a[214:215], v12 offset:23040
buffer_load_dwordx4 a[36:39], v20, s[32:35], s80 offen offset:1024 sc1
v_mfma_f32_16x16x32_bf16 v[44:47], a[232:235], a[0:3], v[44:47]
ds_read_b64_tr_b16 a[216:217], v13 offset:22528
buffer_load_dwordx4 a[40:43], v20, s[32:35], s80 offen offset:2048 sc1
v_mfma_f32_16x16x32_bf16 v[48:51], a[232:235], a[4:7], v[48:51]
ds_read_b64_tr_b16 a[218:219], v13 offset:23040
buffer_load_dwordx4 v15, s[48:51], s67 offen offset:1024 lds
v_mfma_f32_16x16x32_bf16 v[52:55], a[236:239], a[0:3], v[52:55]
ds_read_b64_tr_b16 a[220:221], v14 offset:22528
buffer_load_dwordx4 a[44:47], v20, s[32:35], s80 offen offset:3072 sc1
v_mfma_f32_16x16x32_bf16 v[56:59], a[236:239], a[4:7], v[56:59]
ds_read_b64_tr_b16 a[222:223], v14 offset:23040
s_waitcnt lgkmcnt(8)
v_mfma_f32_16x16x32_bf16 v[28:31], a[192:195], a[8:11], v[28:31]
ds_read_b64_tr_b16 a[224:225], v11 offset:23552
s_add_u32 s22, s15, 6144
v_mfma_f32_16x16x32_bf16 v[32:35], a[192:195], a[12:15], v[32:35]
ds_read_b64_tr_b16 a[226:227], v11 offset:24064
buffer_load_dword v23, v7, s[32:35], s22 offen sc1
v_mfma_f32_16x16x32_bf16 v[36:39], a[196:199], a[8:11], v[36:39]
ds_read_b64_tr_b16 a[228:229], v12 offset:23552
v_mfma_f32_16x16x32_bf16 v[40:43], a[196:199], a[12:15], v[40:43]
ds_read_b64_tr_b16 a[230:231], v12 offset:24064
v_mfma_f32_16x16x32_bf16 v[44:47], a[200:203], a[8:11], v[44:47]
ds_read_b64_tr_b16 a[232:233], v13 offset:23552
v_mfma_f32_16x16x32_bf16 v[48:51], a[200:203], a[12:15], v[48:51]
ds_read_b64_tr_b16 a[234:235], v13 offset:24064
v_mfma_f32_16x16x32_bf16 v[52:55], a[204:207], a[8:11], v[52:55]
ds_read_b64_tr_b16 a[236:237], v14 offset:23552
v_mfma_f32_16x16x32_bf16 v[56:59], a[204:207], a[12:15], v[56:59]
ds_read_b64_tr_b16 a[238:239], v14 offset:24064
s_waitcnt vmcnt(13)
s_waitcnt lgkmcnt(8)
v_mfma_f32_16x16x32_bf16 v[28:31], a[208:211], a[16:19], v[28:31]
s_barrier
ds_read_b64_tr_b16 a[192:193], v11 offset:24576
v_mfma_f32_16x16x32_bf16 v[32:35], a[208:211], a[20:23], v[32:35]
ds_read_b64_tr_b16 a[194:195], v11 offset:25088
s_add_u32 m0, s64, 16384
v_mfma_f32_16x16x32_bf16 v[36:39], a[212:215], a[16:19], v[36:39]
ds_read_b64_tr_b16 a[196:197], v12 offset:24576
s_add_u32 s67, s16, 0
v_mfma_f32_16x16x32_bf16 v[40:43], a[212:215], a[20:23], v[40:43]
ds_read_b64_tr_b16 a[198:199], v12 offset:25088
buffer_load_dwordx4 v15, s[44:47], s67 offen lds
v_mfma_f32_16x16x32_bf16 v[44:47], a[216:219], a[16:19], v[44:47]
ds_read_b64_tr_b16 a[200:201], v13 offset:24576
s_add_u32 s80, s95, 32768
v_mfma_f32_16x16x32_bf16 v[48:51], a[216:219], a[20:23], v[48:51]
ds_read_b64_tr_b16 a[202:203], v13 offset:25088
buffer_load_dwordx4 a[48:51], v20, s[32:35], s80 offen offset:0 sc1
v_mfma_f32_16x16x32_bf16 v[52:55], a[220:223], a[16:19], v[52:55]
ds_read_b64_tr_b16 a[204:205], v14 offset:24576
buffer_load_dwordx4 v15, s[48:51], s67 offen offset:1024 lds
v_mfma_f32_16x16x32_bf16 v[56:59], a[220:223], a[20:23], v[56:59]
ds_read_b64_tr_b16 a[206:207], v14 offset:25088
s_waitcnt lgkmcnt(8)
v_mfma_f32_16x16x32_bf16 v[28:31], a[224:227], a[24:27], v[28:31]
ds_read_b64_tr_b16 a[208:209], v11 offset:25600
v_mfma_f32_16x16x32_bf16 v[32:35], a[224:227], a[28:31], v[32:35]
ds_read_b64_tr_b16 a[210:211], v11 offset:26112
v_mfma_f32_16x16x32_bf16 v[36:39], a[228:231], a[24:27], v[36:39]
ds_read_b64_tr_b16 a[212:213], v12 offset:25600
v_mfma_f32_16x16x32_bf16 v[40:43], a[228:231], a[28:31], v[40:43]
ds_read_b64_tr_b16 a[214:215], v12 offset:26112
v_mfma_f32_16x16x32_bf16 v[44:47], a[232:235], a[24:27], v[44:47]
ds_read_b64_tr_b16 a[216:217], v13 offset:25600
v_mfma_f32_16x16x32_bf16 v[48:51], a[232:235], a[28:31], v[48:51]
ds_read_b64_tr_b16 a[218:219], v13 offset:26112
v_mfma_f32_16x16x32_bf16 v[52:55], a[236:239], a[24:27], v[52:55]
ds_read_b64_tr_b16 a[220:221], v14 offset:25600
v_mfma_f32_16x16x32_bf16 v[56:59], a[236:239], a[28:31], v[56:59]
ds_read_b64_tr_b16 a[222:223], v14 offset:26112
s_waitcnt lgkmcnt(8)
v_mfma_f32_16x16x32_bf16 v[60:63], a[192:195], a[128:131], v[60:63]
ds_read_b64_tr_b16 a[224:225], v11 offset:26624
s_add_u32 m0, s64, 18432
v_mfma_f32_16x16x32_bf16 v[64:67], a[192:195], a[132:135], v[64:67]
ds_read_b64_tr_b16 a[226:227], v11 offset:27136
s_add_u32 s67, s98, 0
v_mfma_f32_16x16x32_bf16 v[68:71], a[196:199], a[128:131], v[68:71]
ds_read_b64_tr_b16 a[228:229], v12 offset:26624
buffer_load_dwordx4 v15, s[44:47], s67 offen lds
v_mfma_f32_16x16x32_bf16 v[72:75], a[196:199], a[132:135], v[72:75]
ds_read_b64_tr_b16 a[230:231], v12 offset:27136
buffer_load_dwordx4 a[52:55], v20, s[32:35], s80 offen offset:1024 sc1
v_mfma_f32_16x16x32_bf16 v[76:79], a[200:203], a[128:131], v[76:79]
ds_read_b64_tr_b16 a[232:233], v13 offset:26624
buffer_load_dwordx4 a[56:59], v20, s[32:35], s80 offen offset:2048 sc1
v_mfma_f32_16x16x32_bf16 v[80:83], a[200:203], a[132:135], v[80:83]
ds_read_b64_tr_b16 a[234:235], v13 offset:27136
buffer_load_dwordx4 v15, s[48:51], s67 offen offset:1024 lds
v_mfma_f32_16x16x32_bf16 v[84:87], a[204:207], a[128:131], v[84:87]
ds_read_b64_tr_b16 a[236:237], v14 offset:26624
buffer_load_dwordx4 a[60:63], v20, s[32:35], s80 offen offset:3072 sc1
v_mfma_f32_16x16x32_bf16 v[88:91], a[204:207], a[132:135], v[88:91]
ds_read_b64_tr_b16 a[238:239], v14 offset:27136
s_waitcnt lgkmcnt(8)
v_mfma_f32_16x16x32_bf16 v[60:63], a[208:211], a[136:139], v[60:63]
ds_read_b64_tr_b16 a[192:193], v11 offset:27648
v_mfma_f32_16x16x32_bf16 v[64:67], a[208:211], a[140:143], v[64:67]
ds_read_b64_tr_b16 a[194:195], v11 offset:28160
v_mfma_f32_16x16x32_bf16 v[68:71], a[212:215], a[136:139], v[68:71]
ds_read_b64_tr_b16 a[196:197], v12 offset:27648
v_mfma_f32_16x16x32_bf16 v[72:75], a[212:215], a[140:143], v[72:75]
ds_read_b64_tr_b16 a[198:199], v12 offset:28160
v_mfma_f32_16x16x32_bf16 v[76:79], a[216:219], a[136:139], v[76:79]
ds_read_b64_tr_b16 a[200:201], v13 offset:27648
v_mfma_f32_16x16x32_bf16 v[80:83], a[216:219], a[140:143], v[80:83]
ds_read_b64_tr_b16 a[202:203], v13 offset:28160
v_mfma_f32_16x16x32_bf16 v[84:87], a[220:223], a[136:139], v[84:87]
ds_read_b64_tr_b16 a[204:205], v14 offset:27648
v_mfma_f32_16x16x32_bf16 v[88:91], a[220:223], a[140:143], v[88:91]
ds_read_b64_tr_b16 a[206:207], v14 offset:28160
s_waitcnt vmcnt(8)
v_cmp_ne_u32 vcc, s63, v23
s_nop 1
s_and_b32 vcc_lo, vcc_lo, 3
s_cbranch_scc0 L_ok_26
s_mov_b32 s74, 200000
s_add_u32 s73, s15, 6144
L_sp_27:
buffer_load_dword v4, v7, s[32:35], s73 offen sc1
s_sub_u32 s74, s74, 1
s_waitcnt vmcnt(0)
v_cmp_ne_u32 vcc, s63, v4
s_cmp_eq_u32 s74, 0
s_cbranch_scc1 L_spd_28
s_and_b32 vcc_lo, vcc_lo, 3
s_cbranch_scc1 L_sp_27
L_spd_28:
L_ok_26:
s_waitcnt lgkmcnt(8)
v_mfma_f32_16x16x32_bf16 v[60:63], a[224:227], a[144:147], v[60:63]
s_barrier
ds_read_b64_tr_b16 a[208:209], v11 offset:28672
v_mfma_f32_16x16x32_bf16 v[64:67], a[224:227], a[148:151], v[64:67]
ds_read_b64_tr_b16 a[210:211], v11 offset:29184
s_add_u32 m0, s64, 20480
v_mfma_f32_16x16x32_bf16 v[68:71], a[228:231], a[144:147], v[68:71]
ds_read_b64_tr_b16 a[212:213], v12 offset:28672
s_add_u32 s67, s16, 73728
v_mfma_f32_16x16x32_bf16 v[72:75], a[228:231], a[148:151], v[72:75]
ds_read_b64_tr_b16 a[214:215], v12 offset:29184
buffer_load_dwordx4 v15, s[44:47], s67 offen lds
v_mfma_f32_16x16x32_bf16 v[76:79], a[232:235], a[144:147], v[76:79]
ds_read_b64_tr_b16 a[216:217], v13 offset:28672
s_add_u32 s80, s94, 49152
v_mfma_f32_16x16x32_bf16 v[80:83], a[232:235], a[148:151], v[80:83]
ds_read_b64_tr_b16 a[218:219], v13 offset:29184
buffer_load_dwordx4 a[64:67], v20, s[32:35], s80 offen offset:0 sc1
v_mfma_f32_16x16x32_bf16 v[84:87], a[236:239], a[144:147], v[84:87]
ds_read_b64_tr_b16 a[220:221], v14 offset:28672
buffer_load_dwordx4 v15, s[48:51], s67 offen offset:1024 lds
v_mfma_f32_16x16x32_bf16 v[88:91], a[236:239], a[148:151], v[88:91]
ds_read_b64_tr_b16 a[222:223], v14 offset:29184
s_waitcnt lgkmcnt(8)
v_mfma_f32_16x16x32_bf16 v[60:63], a[192:195], a[152:155], v[60:63]
ds_read_b64_tr_b16 a[224:225], v11 offset:29696
buffer_load_dwordx4 a[68:71], v20, s[32:35], s80 offen offset:1024 sc1
v_mfma_f32_16x16x32_bf16 v[64:67], a[192:195], a[156:159], v[64:67]
ds_read_b64_tr_b16 a[226:227], v11 offset:30208
buffer_load_dwordx4 a[72:75], v20, s[32:35], s80 offen offset:2048 sc1
v_mfma_f32_16x16x32_bf16 v[68:71], a[196:199], a[152:155], v[68:71]
ds_read_b64_tr_b16 a[228:229], v12 offset:29696
buffer_load_dwordx4 a[76:79], v20, s[32:35], s80 offen offset:3072 sc1
v_mfma_f32_16x16x32_bf16 v[72:75], a[196:199], a[156:159], v[72:75]
ds_read_b64_tr_b16 a[230:231], v12 offset:30208
v_mfma_f32_16x16x32_bf16 v[76:79], a[200:203], a[152:155], v[76:79]
ds_read_b64_tr_b16 a[232:233], v13 offset:29696
v_mfma_f32_16x16x32_bf16 v[80:83], a[200:203], a[156:159], v[80:83]
ds_read_b64_tr_b16 a[234:235], v13 offset:30208
v_mfma_f32_16x16x32_bf16 v[84:87], a[204:207], a[152:155], v[84:87]
ds_read_b64_tr_b16 a[236:237], v14 offset:29696
v_mfma_f32_16x16x32_bf16 v[88:91], a[204:207], a[156:159], v[88:91]
ds_read_b64_tr_b16 a[238:239], v14 offset:30208
s_waitcnt lgkmcnt(8)
v_mfma_f32_16x16x32_bf16 v[60:63], a[208:211], a[0:3], v[60:63]
ds_read_b64_tr_b16 a[192:193], v11 offset:30720
s_add_u32 m0, s64, 22528
v_mfma_f32_16x16x32_bf16 v[64:67], a[208:211], a[4:7], v[64:67]
ds_read_b64_tr_b16 a[194:195], v11 offset:31232
s_add_u32 s67, s98, 73728
v_mfma_f32_16x16x32_bf16 v[68:71], a[212:215], a[0:3], v[68:71]
ds_read_b64_tr_b16 a[196:197], v12 offset:30720
buffer_load_dwordx4 v15, s[44:47], s67 offen lds
s_add_u32 s80, s95, 49152
v_mfma_f32_16x16x32_bf16 v[72:75], a[212:215], a[4:7], v[72:75]
ds_read_b64_tr_b16 a[198:199], v12 offset:31232
buffer_load_dwordx4 a[80:83], v20, s[32:35], s80 offen offset:0 sc1
buffer_load_dwordx4 a[84:87], v20, s[32:35], s80 offen offset:1024 sc1
v_mfma_f32_16x16x32_bf16 v[76:79], a[216:219], a[0:3], v[76:79]
ds_read_b64_tr_b16 a[200:201], v13 offset:30720
buffer_load_dwordx4 a[88:91], v20, s[32:35], s80 offen offset:2048 sc1
buffer_load_dwordx4 a[92:95], v20, s[32:35], s80 offen offset:3072 sc1
v_mfma_f32_16x16x32_bf16 v[80:83], a[216:219], a[4:7], v[80:83]
ds_read_b64_tr_b16 a[202:203], v13 offset:31232
buffer_load_dwordx4 v15, s[48:51], s67 offen offset:1024 lds
v_and_b32 v250, 3, v1
v_mfma_f32_16x16x32_bf16 v[84:87], a[220:223], a[0:3], v[84:87]
ds_read_b64_tr_b16 a[204:205], v14 offset:30720
v_cmp_eq_u32 vcc, 0, v250
v_cmp_eq_u32 s[74:75], 2, v250
v_mfma_f32_16x16x32_bf16 v[88:91], a[220:223], a[4:7], v[88:91]
ds_read_b64_tr_b16 a[206:207], v14 offset:31232
v_bfe_u32 v251, v1, 2, 2
s_waitcnt lgkmcnt(8)
v_mfma_f32_16x16x32_bf16 v[60:63], a[224:227], a[8:11], v[60:63]
ds_read_b64_tr_b16 a[208:209], v11 offset:31744
v_lshrrev_b32 v252, 4, v1
v_cndmask_b32 v236, v237, v236, vcc
v_mfma_f32_16x16x32_bf16 v[64:67], a[224:227], a[12:15], v[64:67]
ds_read_b64_tr_b16 a[210:211], v11 offset:32256
v_cndmask_b32 v238, v239, v238, s[74:75]
v_cndmask_b32 v240, v241, v240, vcc
v_mfma_f32_16x16x32_bf16 v[68:71], a[228:231], a[8:11], v[68:71]
ds_read_b64_tr_b16 a[212:213], v12 offset:31744
v_cndmask_b32 v242, v243, v242, s[74:75]
v_cmp_gt_u32 vcc, 2, v250
v_mfma_f32_16x16x32_bf16 v[72:75], a[228:231], a[12:15], v[72:75]
ds_read_b64_tr_b16 a[214:215], v12 offset:32256
v_cmp_eq_u32 s[74:75], v251, v252
v_mfma_f32_16x16x32_bf16 v[76:79], a[232:235], a[8:11], v[76:79]
ds_read_b64_tr_b16 a[216:217], v13 offset:31744
v_cndmask_b32 v236, v238, v236, vcc
v_mfma_f32_16x16x32_bf16 v[80:83], a[232:235], a[12:15], v[80:83]
ds_read_b64_tr_b16 a[218:219], v13 offset:32256
v_cndmask_b32 v240, v242, v240, vcc
v_mfma_f32_16x16x32_bf16 v[84:87], a[236:239], a[8:11], v[84:87]
ds_read_b64_tr_b16 a[220:221], v14 offset:31744
v_cndmask_b32 v236, 0, v236, s[74:75]
v_mfma_f32_16x16x32_bf16 v[88:91], a[236:239], a[12:15], v[88:91]
ds_read_b64_tr_b16 a[222:223], v14 offset:32256
s_waitcnt lgkmcnt(8)
v_mfma_f32_16x16x32_bf16 v[60:63], a[192:195], a[16:19], v[60:63]
s_barrier
ds_read_b64_tr_b16 a[224:225], v11 offset:32768
v_mfma_f32_16x16x32_bf16 v[64:67], a[192:195], a[20:23], v[64:67]
ds_read_b64_tr_b16 a[226:227], v11 offset:33280
s_add_u32 m0, s64, 24576
v_mfma_f32_16x16x32_bf16 v[68:71], a[196:199], a[16:19], v[68:71]
ds_read_b64_tr_b16 a[228:229], v12 offset:32768
s_add_u32 s67, s16, 147456
buffer_load_dwordx4 v15, s[44:47], s67 offen lds
v_mfma_f32_16x16x32_bf16 v[72:75], a[196:199], a[20:23], v[72:75]
ds_read_b64_tr_b16 a[230:231], v12 offset:33280
v_cndmask_b32 v240, 0, v240, s[74:75]
v_mov_b32 v237, v236
v_mfma_f32_16x16x32_bf16 v[76:79], a[200:203], a[16:19], v[76:79]
ds_read_b64_tr_b16 a[232:233], v13 offset:32768
v_mov_b32 v241, v240
v_permlane32_swap_b32 v237, v236
v_mfma_f32_16x16x32_bf16 v[80:83], a[200:203], a[20:23], v[80:83]
ds_read_b64_tr_b16 a[234:235], v13 offset:33280
buffer_load_dwordx4 v15, s[48:51], s67 offen offset:1024 lds
v_permlane32_swap_b32 v241, v240
v_mfma_f32_16x16x32_bf16 v[84:87], a[204:207], a[16:19], v[84:87]
ds_read_b64_tr_b16 a[236:237], v14 offset:32768
v_add_f32 v236, v236, v237
v_add_f32 v240, v240, v241
v_mfma_f32_16x16x32_bf16 v[88:91], a[204:207], a[20:23], v[88:91]
ds_read_b64_tr_b16 a[238:239], v14 offset:33280
s_waitcnt lgkmcnt(8)
v_mfma_f32_16x16x32_bf16 v[60:63], a[208:211], a[24:27], v[60:63]
ds_read_b64_tr_b16 a[192:193], v11 offset:33792
v_mov_b32 v237, v236
v_mfma_f32_16x16x32_bf16 v[64:67], a[208:211], a[28:31], v[64:67]
ds_read_b64_tr_b16 a[194:195], v11 offset:34304
v_mov_b32 v241, v240
v_mfma_f32_16x16x32_bf16 v[68:71], a[212:215], a[24:27], v[68:71]
ds_read_b64_tr_b16 a[196:197], v12 offset:33792
v_permlane16_swap_b32 v237, v236
v_mfma_f32_16x16x32_bf16 v[72:75], a[212:215], a[28:31], v[72:75]
ds_read_b64_tr_b16 a[198:199], v12 offset:34304
v_permlane16_swap_b32 v241, v240
v_mfma_f32_16x16x32_bf16 v[76:79], a[216:219], a[24:27], v[76:79]
ds_read_b64_tr_b16 a[200:201], v13 offset:33792
v_add_f32 v236, v236, v237
v_mfma_f32_16x16x32_bf16 v[80:83], a[216:219], a[28:31], v[80:83]
ds_read_b64_tr_b16 a[202:203], v13 offset:34304
v_add_f32 v240, v240, v241
v_mfma_f32_16x16x32_bf16 v[84:87], a[220:223], a[24:27], v[84:87]
ds_read_b64_tr_b16 a[204:205], v14 offset:33792
v_mul_f32 v237, v18, v18
v_mfma_f32_16x16x32_bf16 v[88:91], a[220:223], a[28:31], v[88:91]
ds_read_b64_tr_b16 a[206:207], v14 offset:34304
s_waitcnt lgkmcnt(8)
v_mfma_f32_16x16x32_bf16 v[28:31], a[224:227], a[32:35], v[28:31]
ds_read_b64_tr_b16 a[208:209], v11 offset:34816
s_add_u32 m0, s64, 26624
v_mfma_f32_16x16x32_bf16 v[32:35], a[224:227], a[36:39], v[32:35]
ds_read_b64_tr_b16 a[210:211], v11 offset:35328
s_add_u32 s67, s98, 147456
v_mfma_f32_16x16x32_bf16 v[36:39], a[228:231], a[32:35], v[36:39]
ds_read_b64_tr_b16 a[212:213], v12 offset:34816
buffer_load_dwordx4 v15, s[44:47], s67 offen lds
v_mul_f32 v241, v19, v19
v_mfma_f32_16x16x32_bf16 v[40:43], a[228:231], a[36:39], v[40:43]
ds_read_b64_tr_b16 a[214:215], v12 offset:35328
v_mov_b32 v238, 0x3ae38e39
v_mov_b32 v239, 0x3ae38e39
v_mfma_f32_16x16x32_bf16 v[44:47], a[232:235], a[32:35], v[44:47]
ds_read_b64_tr_b16 a[216:217], v13 offset:34816
v_fma_f32 v236, v236, v238, -v237
v_fma_f32 v240, v240, v239, -v241
v_mfma_f32_16x16x32_bf16 v[48:51], a[232:235], a[36:39], v[48:51]
ds_read_b64_tr_b16 a[218:219], v13 offset:35328
buffer_load_dwordx4 v15, s[48:51], s67 offen offset:1024 lds
v_max_f32 v236, 0, v236
v_mfma_f32_16x16x32_bf16 v[52:55], a[236:239], a[32:35], v[52:55]
ds_read_b64_tr_b16 a[220:221], v14 offset:34816
v_max_f32 v240, 0, v240
v_mfma_f32_16x16x32_bf16 v[56:59], a[236:239], a[36:39], v[56:59]
ds_read_b64_tr_b16 a[222:223], v14 offset:35328
s_waitcnt lgkmcnt(8)
v_mfma_f32_16x16x32_bf16 v[28:31], a[192:195], a[40:43], v[28:31]
ds_read_b64_tr_b16 a[224:225], v11 offset:35840
v_cvt_pk_bf16_f32 v236, v236, v236
v_mfma_f32_16x16x32_bf16 v[32:35], a[192:195], a[44:47], v[32:35]
ds_read_b64_tr_b16 a[226:227], v11 offset:36352
v_cvt_pk_bf16_f32 v240, v240, v240
v_mfma_f32_16x16x32_bf16 v[36:39], a[196:199], a[40:43], v[36:39]
ds_read_b64_tr_b16 a[228:229], v12 offset:35840
v_lshlrev_b32 v236, 16, v236
v_mfma_f32_16x16x32_bf16 v[40:43], a[196:199], a[44:47], v[40:43]
ds_read_b64_tr_b16 a[230:231], v12 offset:36352
v_lshlrev_b32 v240, 16, v240
v_mfma_f32_16x16x32_bf16 v[44:47], a[200:203], a[40:43], v[44:47]
ds_read_b64_tr_b16 a[232:233], v13 offset:35840
v_add_f32 v236, 0x3727c5ac, v236
v_mfma_f32_16x16x32_bf16 v[48:51], a[200:203], a[44:47], v[48:51]
ds_read_b64_tr_b16 a[234:235], v13 offset:36352
v_add_f32 v240, 0x3727c5ac, v240
v_mfma_f32_16x16x32_bf16 v[52:55], a[204:207], a[40:43], v[52:55]
ds_read_b64_tr_b16 a[236:237], v14 offset:35840
v_cvt_pk_bf16_f32 v236, v236, v236
v_mfma_f32_16x16x32_bf16 v[56:59], a[204:207], a[44:47], v[56:59]
ds_read_b64_tr_b16 a[238:239], v14 offset:36352
s_waitcnt vmcnt(16)
s_waitcnt lgkmcnt(8)
v_mfma_f32_16x16x32_bf16 v[28:31], a[208:211], a[48:51], v[28:31]
s_barrier
ds_read_b64_tr_b16 a[192:193], v11 offset:36864
v_mfma_f32_16x16x32_bf16 v[32:35], a[208:211], a[52:55], v[32:35]
ds_read_b64_tr_b16 a[194:195], v11 offset:37376
s_add_u32 m0, s64, 28672
v_mfma_f32_16x16x32_bf16 v[36:39], a[212:215], a[48:51], v[36:39]
ds_read_b64_tr_b16 a[196:197], v12 offset:36864
s_add_u32 s67, s16, 221184
buffer_load_dwordx4 v15, s[44:47], s67 offen lds
v_mfma_f32_16x16x32_bf16 v[40:43], a[212:215], a[52:55], v[40:43]
ds_read_b64_tr_b16 a[198:199], v12 offset:37376
v_cvt_pk_bf16_f32 v240, v240, v240
v_lshlrev_b32 v236, 16, v236
v_mfma_f32_16x16x32_bf16 v[44:47], a[216:219], a[48:51], v[44:47]
ds_read_b64_tr_b16 a[200:201], v13 offset:36864
v_lshlrev_b32 v240, 16, v240
v_sqrt_f32 v236, v236
v_mfma_f32_16x16x32_bf16 v[48:51], a[216:219], a[52:55], v[48:51]
ds_read_b64_tr_b16 a[202:203], v13 offset:37376
buffer_load_dwordx4 v15, s[48:51], s67 offen offset:1024 lds
v_sqrt_f32 v240, v240
v_mfma_f32_16x16x32_bf16 v[52:55], a[220:223], a[48:51], v[52:55]
ds_read_b64_tr_b16 a[204:205], v14 offset:36864
v_cvt_pk_bf16_f32 v236, v236, v236
v_cvt_pk_bf16_f32 v240, v240, v240
v_mfma_f32_16x16x32_bf16 v[56:59], a[220:223], a[52:55], v[56:59]
ds_read_b64_tr_b16 a[206:207], v14 offset:37376
v_lshlrev_b32 v236, 16, v236
s_waitcnt lgkmcnt(8)
v_mfma_f32_16x16x32_bf16 v[28:31], a[224:227], a[56:59], v[28:31]
ds_read_b64_tr_b16 a[208:209], v11 offset:37888
v_lshlrev_b32 v240, 16, v240
v_mfma_f32_16x16x32_bf16 v[32:35], a[224:227], a[60:63], v[32:35]
ds_read_b64_tr_b16 a[210:211], v11 offset:38400
v_mul_f32 v236, v236, v236
v_mfma_f32_16x16x32_bf16 v[36:39], a[228:231], a[56:59], v[36:39]
ds_read_b64_tr_b16 a[212:213], v12 offset:37888
v_mul_f32 v240, v240, v240
v_mfma_f32_16x16x32_bf16 v[40:43], a[228:231], a[60:63], v[40:43]
ds_read_b64_tr_b16 a[214:215], v12 offset:38400
v_rcp_f32 v238, v236
v_mfma_f32_16x16x32_bf16 v[44:47], a[232:235], a[56:59], v[44:47]
ds_read_b64_tr_b16 a[216:217], v13 offset:37888
v_rcp_f32 v239, v240
v_mfma_f32_16x16x32_bf16 v[48:51], a[232:235], a[60:63], v[48:51]
ds_read_b64_tr_b16 a[218:219], v13 offset:38400
v_mul_f32 v240, 0xbfb8aa3b, v238
v_mfma_f32_16x16x32_bf16 v[52:55], a[236:239], a[56:59], v[52:55]
ds_read_b64_tr_b16 a[220:221], v14 offset:37888
v_mul_f32 v241, 0xbfb8aa3b, v239
v_mfma_f32_16x16x32_bf16 v[56:59], a[236:239], a[60:63], v[56:59]
ds_read_b64_tr_b16 a[222:223], v14 offset:38400
s_waitcnt vmcnt(12)
s_waitcnt lgkmcnt(8)
v_mfma_f32_16x16x32_bf16 v[28:31], a[192:195], a[64:67], v[28:31]
ds_read_b64_tr_b16 a[224:225], v11 offset:38912
s_add_u32 m0, s64, 30720
v_mfma_f32_16x16x32_bf16 v[32:35], a[192:195], a[68:71], v[32:35]
ds_read_b64_tr_b16 a[226:227], v11 offset:39424
s_add_u32 s67, s98, 221184
v_mfma_f32_16x16x32_bf16 v[36:39], a[196:199], a[64:67], v[36:39]
ds_read_b64_tr_b16 a[228:229], v12 offset:38912
buffer_load_dwordx4 v15, s[44:47], s67 offen lds
s_add_u32 s79, s64, 0
v_mfma_f32_16x16x32_bf16 v[40:43], a[196:199], a[68:71], v[40:43]
ds_read_b64_tr_b16 a[230:231], v12 offset:39424
s_lshl_b32 s73, s60, 5
s_lshl_b32 s74, s61, 7
v_mfma_f32_16x16x32_bf16 v[44:47], a[200:203], a[64:67], v[44:47]
ds_read_b64_tr_b16 a[232:233], v13 offset:38912
s_add_u32 s73, s73, s74
s_lshl_b32 s78, s60, 11
v_mfma_f32_16x16x32_bf16 v[48:51], a[200:203], a[68:71], v[48:51]
ds_read_b64_tr_b16 a[234:235], v13 offset:39424
buffer_load_dwordx4 v15, s[48:51], s67 offen offset:1024 lds
s_add_u32 s78, s78, s15
v_mfma_f32_16x16x32_bf16 v[52:55], a[204:207], a[64:67], v[52:55]
ds_read_b64_tr_b16 a[236:237], v14 offset:38912
s_cmp_lt_u32 s61, 8
s_cselect_b32 s77, 256, 0
s_sub_u32 s77, s77, 128
v_mfma_f32_16x16x32_bf16 v[56:59], a[204:207], a[68:71], v[56:59]
ds_read_b64_tr_b16 a[238:239], v14 offset:39424
v_lshrrev_b32 v2, 2, v1
s_waitcnt lgkmcnt(8)
v_mfma_f32_16x16x32_bf16 v[28:31], a[208:211], a[72:75], v[28:31]
ds_read_b64_tr_b16 a[192:193], v11 offset:39936
v_mul_u32_u24 v8, 144, v2
v_add_u32 v2, s73, v2
v_mfma_f32_16x16x32_bf16 v[32:35], a[208:211], a[76:79], v[32:35]
ds_read_b64_tr_b16 a[194:195], v11 offset:40448
v_mul_u32_u24 v2, 1152, v2
v_mfma_f32_16x16x32_bf16 v[36:39], a[212:215], a[72:75], v[36:39]
ds_read_b64_tr_b16 a[196:197], v12 offset:39936
v_and_b32 v3, 3, v1
v_mfma_f32_16x16x32_bf16 v[40:43], a[212:215], a[76:79], v[40:43]
ds_read_b64_tr_b16 a[198:199], v12 offset:40448
v_lshl_add_u32 v16, v3, 4, v2
v_mfma_f32_16x16x32_bf16 v[44:47], a[216:219], a[72:75], v[44:47]
ds_read_b64_tr_b16 a[200:201], v13 offset:39936
v_lshl_add_u32 v8, v3, 5, v8
v_mfma_f32_16x16x32_bf16 v[48:51], a[216:219], a[76:79], v[48:51]
ds_read_b64_tr_b16 a[202:203], v13 offset:40448
v_add_u32 v27, s79, v8
v_mfma_f32_16x16x32_bf16 v[52:55], a[220:223], a[72:75], v[52:55]
ds_read_b64_tr_b16 a[204:205], v14 offset:39936
v_and_b32 v9, 15, v1
v_mfma_f32_16x16x32_bf16 v[56:59], a[220:223], a[76:79], v[56:59]
ds_read_b64_tr_b16 a[206:207], v14 offset:40448
s_waitcnt vmcnt(9)
s_waitcnt lgkmcnt(8)
v_mfma_f32_16x16x32_bf16 v[28:31], a[224:227], a[80:83], v[28:31]
s_barrier
ds_read_b64_tr_b16 a[208:209], v11 offset:0
v_mfma_f32_16x16x32_bf16 v[32:35], a[224:227], a[84:87], v[32:35]
ds_read_b64_tr_b16 a[210:211], v11 offset:512
v_mfma_f32_16x16x32_bf16 v[36:39], a[228:231], a[80:83], v[36:39]
ds_read_b64_tr_b16 a[212:213], v12 offset:0
v_add_u32 v2, s73, v9
v_lshrrev_b32 v3, 4, v1
v_mfma_f32_16x16x32_bf16 v[40:43], a[228:231], a[84:87], v[40:43]
ds_read_b64_tr_b16 a[214:215], v12 offset:512
v_sub_u32 v4, 2048, v2
v_min_u32 v4, v4, v2
v_mfma_f32_16x16x32_bf16 v[44:47], a[232:235], a[80:83], v[44:47]
ds_read_b64_tr_b16 a[216:217], v13 offset:0
v_cmp_gt_u32 vcc, 1024, v2
v_and_b32 v8, 1, v4
v_mfma_f32_16x16x32_bf16 v[48:51], a[232:235], a[84:87], v[48:51]
ds_read_b64_tr_b16 a[218:219], v13 offset:512
v_mul_u32_u24 v8, 377856, v8
v_lshrrev_b32 v4, 1, v4
v_mfma_f32_16x16x32_bf16 v[52:55], a[236:239], a[80:83], v[52:55]
ds_read_b64_tr_b16 a[220:221], v14 offset:0
v_cndmask_b32 v19, 1.0, -1.0, vcc
v_lshl_add_u32 v4, v4, 4, v8
v_mfma_f32_16x16x32_bf16 v[56:59], a[236:239], a[84:87], v[56:59]
ds_read_b64_tr_b16 a[222:223], v14 offset:512
v_mul_u32_u24 v8, 9216, v3
s_waitcnt lgkmcnt(8)
v_mfma_f32_16x16x32_bf16 v[28:31], a[192:195], a[88:91], v[28:31]
ds_read_b64_tr_b16 a[224:225], v11 offset:1024
v_cmp_eq_u32 vcc, 0, v3
v_mfma_f32_16x16x32_bf16 v[32:35], a[192:195], a[92:95], v[32:35]
ds_read_b64_tr_b16 a[226:227], v11 offset:1536
v_add_u32 v17, v4, v8
v_mfma_f32_16x16x32_bf16 v[36:39], a[196:199], a[88:91], v[36:39]
ds_read_b64_tr_b16 a[228:229], v12 offset:1024
v_sub_u32 v8, v4, v8
v_mfma_f32_16x16x32_bf16 v[40:43], a[196:199], a[92:95], v[40:43]
ds_read_b64_tr_b16 a[230:231], v12 offset:1536
v_add_u32 v18, 27648, v8
v_mfma_f32_16x16x32_bf16 v[44:47], a[200:203], a[88:91], v[44:47]
ds_read_b64_tr_b16 a[232:233], v13 offset:1024
v_add_u32 v8, 36864, v8
v_mfma_f32_16x16x32_bf16 v[48:51], a[200:203], a[92:95], v[48:51]
ds_read_b64_tr_b16 a[234:235], v13 offset:1536
v_mov_b32 v2, 2147483392
v_mfma_f32_16x16x32_bf16 v[52:55], a[204:207], a[88:91], v[52:55]
ds_read_b64_tr_b16 a[236:237], v14 offset:1024
v_subrev_u32 v4, 16, v1
v_mfma_f32_16x16x32_bf16 v[56:59], a[204:207], a[92:95], v[56:59]
ds_read_b64_tr_b16 a[238:239], v14 offset:1536
s_waitcnt lgkmcnt(8)
v_mfma_f32_16x16x32_bf16 v[60:63], a[208:211], a[32:35], v[60:63]
ds_read_b64_tr_b16 a[192:193], v11 offset:2048
v_mfma_f32_16x16x32_bf16 v[64:67], a[208:211], a[36:39], v[64:67]
ds_read_b64_tr_b16 a[194:195], v11 offset:2560
v_mfma_f32_16x16x32_bf16 v[68:71], a[212:215], a[32:35], v[68:71]
ds_read_b64_tr_b16 a[196:197], v12 offset:2048
v_cvt_pk_bf16_f32 v92, v28, v29
v_cvt_pk_bf16_f32 v93, v30, v31
v_mfma_f32_16x16x32_bf16 v[72:75], a[212:215], a[36:39], v[72:75]
ds_read_b64_tr_b16 a[198:199], v12 offset:2560
v_cvt_pk_bf16_f32 v94, v36, v37
v_cvt_pk_bf16_f32 v95, v38, v39
v_mfma_f32_16x16x32_bf16 v[76:79], a[216:219], a[32:35], v[76:79]
ds_read_b64_tr_b16 a[200:201], v13 offset:2048
buffer_store_dwordx4 v[92:95], v20, s[32:35], s17 offen offset:0 sc1
v_cvt_pk_bf16_f32 v96, v32, v33
v_mfma_f32_16x16x32_bf16 v[80:83], a[216:219], a[36:39], v[80:83]
ds_read_b64_tr_b16 a[202:203], v13 offset:2560
v_cndmask_b32 v24, v2, v8, vcc
v_and_b32 v4, 63, v4
v_mfma_f32_16x16x32_bf16 v[84:87], a[220:223], a[32:35], v[84:87]
ds_read_b64_tr_b16 a[204:205], v14 offset:2048
v_lshlrev_b32 v25, 2, v4
v_mul_u32_u24 v9, 144, v9
v_mfma_f32_16x16x32_bf16 v[88:91], a[220:223], a[36:39], v[88:91]
ds_read_b64_tr_b16 a[206:207], v14 offset:2560
v_lshl_add_u32 v9, v3, 4, v9
s_waitcnt lgkmcnt(8)
v_mfma_f32_16x16x32_bf16 v[60:63], a[224:227], a[40:43], v[60:63]
ds_read_b64_tr_b16 a[208:209], v11 offset:3072
v_add_u32 v26, s79, v9
s_and_b32 s73, s6, 1
v_mfma_f32_16x16x32_bf16 v[64:67], a[224:227], a[44:47], v[64:67]
ds_read_b64_tr_b16 a[210:211], v11 offset:3584
s_lshl_b32 s74, s73, 11
s_lshl_b32 s75, s6, 12
v_mfma_f32_16x16x32_bf16 v[68:71], a[228:231], a[40:43], v[68:71]
ds_read_b64_tr_b16 a[212:213], v12 offset:3072
s_sub_u32 s20, s19, s75
s_add_u32 s20, s20, s74
v_mfma_f32_16x16x32_bf16 v[72:75], a[228:231], a[44:47], v[72:75]
ds_read_b64_tr_b16 a[214:215], v12 offset:3584
s_xor_b32 s74, s74, 2048
s_add_u32 s19, s19, s74
v_mfma_f32_16x16x32_bf16 v[76:79], a[232:235], a[40:43], v[76:79]
ds_read_b64_tr_b16 a[216:217], v13 offset:3072
s_cmp_eq_u32 s73, 0
s_cselect_b64 vcc, -1, 0
v_cndmask_b32 v250, v11, v13, vcc
v_mfma_f32_16x16x32_bf16 v[80:83], a[232:235], a[44:47], v[80:83]
ds_read_b64_tr_b16 a[218:219], v13 offset:3584
v_cndmask_b32 v251, v12, v14, vcc
v_cndmask_b32 v252, v13, v11, vcc
v_mfma_f32_16x16x32_bf16 v[84:87], a[236:239], a[40:43], v[84:87]
ds_read_b64_tr_b16 a[220:221], v14 offset:3072
v_cndmask_b32 v253, v14, v12, vcc
v_mfma_f32_16x16x32_bf16 v[88:91], a[236:239], a[44:47], v[88:91]
ds_read_b64_tr_b16 a[222:223], v14 offset:3584
s_waitcnt lgkmcnt(8)
v_mfma_f32_16x16x32_bf16 v[60:63], a[192:195], a[48:51], v[60:63]
s_barrier
ds_read_b64_tr_b16 a[224:225], v11 offset:4096
v_mfma_f32_16x16x32_bf16 v[64:67], a[192:195], a[52:55], v[64:67]
ds_read_b64_tr_b16 a[226:227], v11 offset:4608
v_mfma_f32_16x16x32_bf16 v[68:71], a[196:199], a[48:51], v[68:71]
ds_read_b64_tr_b16 a[228:229], v12 offset:4096
v_cvt_pk_bf16_f32 v97, v34, v35
v_cvt_pk_bf16_f32 v98, v40, v41
v_mfma_f32_16x16x32_bf16 v[72:75], a[196:199], a[52:55], v[72:75]
ds_read_b64_tr_b16 a[230:231], v12 offset:4608
v_cvt_pk_bf16_f32 v99, v42, v43
buffer_store_dwordx4 v[96:99], v20, s[32:35], s17 offen offset:1024 sc1
v_mfma_f32_16x16x32_bf16 v[76:79], a[200:203], a[48:51], v[76:79]
ds_read_b64_tr_b16 a[232:233], v13 offset:4096
v_cvt_pk_bf16_f32 v100, v44, v45
v_cvt_pk_bf16_f32 v101, v46, v47
v_mfma_f32_16x16x32_bf16 v[80:83], a[200:203], a[52:55], v[80:83]
ds_read_b64_tr_b16 a[234:235], v13 offset:4608
v_cvt_pk_bf16_f32 v102, v52, v53
s_mul_i32 s76, s7, 6
v_mfma_f32_16x16x32_bf16 v[84:87], a[204:207], a[48:51], v[84:87]
ds_read_b64_tr_b16 a[236:237], v14 offset:4096
s_add_u32 s76, s76, s6
s_xor_b32 s73, s6, 2
v_mfma_f32_16x16x32_bf16 v[88:91], a[204:207], a[52:55], v[88:91]
ds_read_b64_tr_b16 a[238:239], v14 offset:4608
s_andn2_b32 s73, s73, 1
s_waitcnt lgkmcnt(8)
v_mfma_f32_16x16x32_bf16 v[60:63], a[208:211], a[56:59], v[60:63]
ds_read_b64_tr_b16 a[192:193], v11 offset:5120
s_xor_b32 s74, s6, 1
s_xor_b32 s75, s62, 4
v_mfma_f32_16x16x32_bf16 v[64:67], a[208:211], a[60:63], v[64:67]
ds_read_b64_tr_b16 a[194:195], v11 offset:5632
s_lshl_b32 s93, 1, s75
s_cmp_eq_u32 s6, 4
s_cselect_b32 s73, 0, s73
s_cselect_b32 s74, 3, s74
s_cselect_b32 s75, 2, 4
s_cselect_b32 s93, 0, s93
v_mfma_f32_16x16x32_bf16 v[68:71], a[212:215], a[56:59], v[68:71]
ds_read_b64_tr_b16 a[196:197], v12 offset:5120
s_lshl_b32 s73, s73, 12
s_add_u32 s4, s20, s73
v_mfma_f32_16x16x32_bf16 v[72:75], a[212:215], a[60:63], v[72:75]
ds_read_b64_tr_b16 a[198:199], v12 offset:5632
s_add_u32 s5, s4, 4096
s_lshl_b32 s75, s75, 12
v_mfma_f32_16x16x32_bf16 v[76:79], a[216:219], a[56:59], v[76:79]
ds_read_b64_tr_b16 a[200:201], v13 offset:5120
s_add_u32 s12, s20, s75
s_lshl_b32 s74, s74, 12
v_mfma_f32_16x16x32_bf16 v[80:83], a[216:219], a[60:63], v[80:83]
ds_read_b64_tr_b16 a[202:203], v13 offset:5632
s_add_u32 s25, s20, s74
s_lshl_b32 s92, 0x2222, s7
v_mfma_f32_16x16x32_bf16 v[84:87], a[220:223], a[56:59], v[84:87]
ds_read_b64_tr_b16 a[204:205], v14 offset:5120
s_lshl_b32 s73, s7, 2
s_lshl_b32 s73, 1, s73
v_mfma_f32_16x16x32_bf16 v[88:91], a[220:223], a[60:63], v[88:91]
ds_read_b64_tr_b16 a[206:207], v14 offset:5632
s_waitcnt lgkmcnt(8)
v_mfma_f32_16x16x32_bf16 v[60:63], a[224:227], a[64:67], v[60:63]
ds_read_b64_tr_b16 a[208:209], v11 offset:6144
v_mfma_f32_16x16x32_bf16 v[64:67], a[224:227], a[68:71], v[64:67]
ds_read_b64_tr_b16 a[210:211], v11 offset:6656
v_mfma_f32_16x16x32_bf16 v[68:71], a[228:231], a[64:67], v[68:71]
ds_read_b64_tr_b16 a[212:213], v12 offset:6144
v_cvt_pk_bf16_f32 v103, v54, v55
buffer_store_dwordx4 v[100:103], v20, s[32:35], s17 offen offset:2048 sc1
v_mfma_f32_16x16x32_bf16 v[72:75], a[228:231], a[68:71], v[72:75]
ds_read_b64_tr_b16 a[214:215], v12 offset:6656
v_cvt_pk_bf16_f32 v104, v48, v49
v_cvt_pk_bf16_f32 v105, v50, v51
v_mfma_f32_16x16x32_bf16 v[76:79], a[232:235], a[64:67], v[76:79]
ds_read_b64_tr_b16 a[216:217], v13 offset:6144
v_cvt_pk_bf16_f32 v106, v56, v57
v_cvt_pk_bf16_f32 v107, v58, v59
v_mfma_f32_16x16x32_bf16 v[80:83], a[232:235], a[68:71], v[80:83]
ds_read_b64_tr_b16 a[218:219], v13 offset:6656
buffer_store_dwordx4 v[104:107], v20, s[32:35], s17 offen offset:3072 sc1
s_or_b32 s92, s92, s73
v_mfma_f32_16x16x32_bf16 v[84:87], a[236:239], a[64:67], v[84:87]
ds_read_b64_tr_b16 a[220:221], v14 offset:6144
s_lshl_b32 s73, 1, s62
s_or_b32 s73, s73, s93
v_mfma_f32_16x16x32_bf16 v[88:91], a[236:239], a[68:71], v[88:91]
ds_read_b64_tr_b16 a[222:223], v14 offset:6656
s_andn2_b32 s92, s92, s73
s_waitcnt lgkmcnt(8)
v_mfma_f32_16x16x32_bf16 v[60:63], a[192:195], a[72:75], v[60:63]
ds_read_b64_tr_b16 a[224:225], v11 offset:7168
s_lshl_b32 s73, s62, 7
v_mov_b32 v5, 2147483392
v_mfma_f32_16x16x32_bf16 v[64:67], a[192:195], a[76:79], v[64:67]
ds_read_b64_tr_b16 a[226:227], v11 offset:7680
v_mov_b32 v2, s73
v_cmp_eq_u32 vcc, 0, v1
v_mfma_f32_16x16x32_bf16 v[68:71], a[196:199], a[72:75], v[68:71]
ds_read_b64_tr_b16 a[228:229], v12 offset:7168
v_cndmask_b32 v5, v5, v2, vcc
v_lshlrev_b32 v2, 7, v1
v_mfma_f32_16x16x32_bf16 v[72:75], a[196:199], a[76:79], v[72:75]
ds_read_b64_tr_b16 a[230:231], v12 offset:7680
v_mov_b32 v4, 2147483392
v_cmp_gt_u32 vcc, 12, v1
v_mfma_f32_16x16x32_bf16 v[76:79], a[200:203], a[72:75], v[76:79]
ds_read_b64_tr_b16 a[232:233], v13 offset:7168
v_cndmask_b32 v6, v4, v2, vcc
s_mov_b32 vcc_hi, 0
v_mfma_f32_16x16x32_bf16 v[80:83], a[200:203], a[76:79], v[80:83]
ds_read_b64_tr_b16 a[234:235], v13 offset:7680
s_mov_b32 vcc_lo, s92
v_cndmask_b32 v7, v4, v2, vcc
v_mfma_f32_16x16x32_bf16 v[84:87], a[204:207], a[72:75], v[84:87]
ds_read_b64_tr_b16 a[236:237], v14 offset:7168
s_mov_b32 vcc_lo, s93
v_cndmask_b32 v10, v4, v2, vcc
v_mfma_f32_16x16x32_bf16 v[88:91], a[204:207], a[76:79], v[88:91]
ds_read_b64_tr_b16 a[238:239], v14 offset:7680
s_waitcnt lgkmcnt(8)
v_mfma_f32_16x16x32_bf16 v[60:63], a[208:211], a[80:83], v[60:63]
s_barrier
ds_read_b64_tr_b16 a[192:193], v11 offset:8192
v_mfma_f32_16x16x32_bf16 v[64:67], a[208:211], a[84:87], v[64:67]
ds_read_b64_tr_b16 a[194:195], v11 offset:8704
v_mfma_f32_16x16x32_bf16 v[68:71], a[212:215], a[80:83], v[68:71]
ds_read_b64_tr_b16 a[196:197], v12 offset:8192
v_mfma_f32_16x16x32_bf16 v[72:75], a[212:215], a[84:87], v[72:75]
ds_read_b64_tr_b16 a[198:199], v12 offset:8704
v_mfma_f32_16x16x32_bf16 v[76:79], a[216:219], a[80:83], v[76:79]
ds_read_b64_tr_b16 a[200:201], v13 offset:8192
v_mfma_f32_16x16x32_bf16 v[80:83], a[216:219], a[84:87], v[80:83]
ds_read_b64_tr_b16 a[202:203], v13 offset:8704
v_mfma_f32_16x16x32_bf16 v[84:87], a[220:223], a[80:83], v[84:87]
ds_read_b64_tr_b16 a[204:205], v14 offset:8192
v_mfma_f32_16x16x32_bf16 v[88:91], a[220:223], a[84:87], v[88:91]
ds_read_b64_tr_b16 a[206:207], v14 offset:8704
s_waitcnt lgkmcnt(8)
v_mfma_f32_16x16x32_bf16 v[60:63], a[224:227], a[88:91], v[60:63]
ds_read_b64_tr_b16 a[208:209], v11 offset:9216
v_mfma_f32_16x16x32_bf16 v[64:67], a[224:227], a[92:95], v[64:67]
ds_read_b64_tr_b16 a[210:211], v11 offset:9728
v_mfma_f32_16x16x32_bf16 v[68:71], a[228:231], a[88:91], v[68:71]
ds_read_b64_tr_b16 a[212:213], v12 offset:9216
v_mfma_f32_16x16x32_bf16 v[72:75], a[228:231], a[92:95], v[72:75]
ds_read_b64_tr_b16 a[214:215], v12 offset:9728
v_mfma_f32_16x16x32_bf16 v[76:79], a[232:235], a[88:91], v[76:79]
ds_read_b64_tr_b16 a[216:217], v13 offset:9216
v_mfma_f32_16x16x32_bf16 v[80:83], a[232:235], a[92:95], v[80:83]
ds_read_b64_tr_b16 a[218:219], v13 offset:9728
v_mfma_f32_16x16x32_bf16 v[84:87], a[236:239], a[88:91], v[84:87]
ds_read_b64_tr_b16 a[220:221], v14 offset:9216
v_mfma_f32_16x16x32_bf16 v[88:91], a[236:239], a[92:95], v[88:91]
ds_read_b64_tr_b16 a[222:223], v14 offset:9728
s_waitcnt lgkmcnt(8)
v_mfma_f32_16x16x32_bf16 v[28:31], a[192:195], v[188:191], 0
ds_read_b64_tr_b16 a[224:225], v11 offset:10240
v_mfma_f32_16x16x32_bf16 v[32:35], a[192:195], v[192:195], 0
ds_read_b64_tr_b16 a[226:227], v11 offset:10752
v_mfma_f32_16x16x32_bf16 v[36:39], a[196:199], v[188:191], 0
ds_read_b64_tr_b16 a[228:229], v12 offset:10240
v_cvt_pk_bf16_f32 v92, v60, v61
v_mfma_f32_16x16x32_bf16 v[40:43], a[196:199], v[192:195], 0
ds_read_b64_tr_b16 a[230:231], v12 offset:10752
v_cvt_pk_bf16_f32 v93, v62, v63
v_mfma_f32_16x16x32_bf16 v[44:47], a[200:203], v[188:191], 0
ds_read_b64_tr_b16 a[232:233], v13 offset:10240
v_cvt_pk_bf16_f32 v94, v68, v69
v_mfma_f32_16x16x32_bf16 v[48:51], a[200:203], v[192:195], 0
ds_read_b64_tr_b16 a[234:235], v13 offset:10752
v_cvt_pk_bf16_f32 v95, v70, v71
v_mfma_f32_16x16x32_bf16 v[52:55], a[204:207], v[188:191], 0
ds_read_b64_tr_b16 a[236:237], v14 offset:10240
buffer_store_dwordx4 v[92:95], v20, s[32:35], s18 offen offset:0 sc1
v_mfma_f32_16x16x32_bf16 v[56:59], a[204:207], v[192:195], 0
ds_read_b64_tr_b16 a[238:239], v14 offset:10752
s_waitcnt lgkmcnt(8)
v_mfma_f32_16x16x32_bf16 v[28:31], a[208:211], v[196:199], v[28:31]
ds_read_b64_tr_b16 a[192:193], v11 offset:11264
v_cvt_pk_bf16_f32 v96, v64, v65
v_mfma_f32_16x16x32_bf16 v[32:35], a[208:211], v[200:203], v[32:35]
ds_read_b64_tr_b16 a[194:195], v11 offset:11776
buffer_load_dwordx4 a[252:255], v255, s[56:59], s3 offen
v_mfma_f32_16x16x32_bf16 v[36:39], a[212:215], v[196:199], v[36:39]
ds_read_b64_tr_b16 a[196:197], v12 offset:11264
v_mfma_f32_16x16x32_bf16 v[40:43], a[212:215], v[200:203], v[40:43]
ds_read_b64_tr_b16 a[198:199], v12 offset:11776
v_mfma_f32_16x16x32_bf16 v[44:47], a[216:219], v[196:199], v[44:47]
ds_read_b64_tr_b16 a[200:201], v13 offset:11264
v_mfma_f32_16x16x32_bf16 v[48:51], a[216:219], v[200:203], v[48:51]
ds_read_b64_tr_b16 a[202:203], v13 offset:11776
v_mfma_f32_16x16x32_bf16 v[52:55], a[220:223], v[196:199], v[52:55]
ds_read_b64_tr_b16 a[204:205], v14 offset:11264
v_mfma_f32_16x16x32_bf16 v[56:59], a[220:223], v[200:203], v[56:59]
ds_read_b64_tr_b16 a[206:207], v14 offset:11776
s_waitcnt lgkmcnt(8)
v_mfma_f32_16x16x32_bf16 v[28:31], a[224:227], v[204:207], v[28:31]
s_barrier
ds_read_b64_tr_b16 a[208:209], v11 offset:12288
v_mfma_f32_16x16x32_bf16 v[32:35], a[224:227], v[208:211], v[32:35]
ds_read_b64_tr_b16 a[210:211], v11 offset:12800
v_mfma_f32_16x16x32_bf16 v[36:39], a[228:231], v[204:207], v[36:39]
ds_read_b64_tr_b16 a[212:213], v12 offset:12288
v_cvt_pk_bf16_f32 v97, v66, v67
v_mfma_f32_16x16x32_bf16 v[40:43], a[228:231], v[208:211], v[40:43]
ds_read_b64_tr_b16 a[214:215], v12 offset:12800
v_cvt_pk_bf16_f32 v98, v72, v73
v_mfma_f32_16x16x32_bf16 v[44:47], a[232:235], v[204:207], v[44:47]
ds_read_b64_tr_b16 a[216:217], v13 offset:12288
v_cvt_pk_bf16_f32 v99, v74, v75
v_mfma_f32_16x16x32_bf16 v[48:51], a[232:235], v[208:211], v[48:51]
ds_read_b64_tr_b16 a[218:219], v13 offset:12800
buffer_store_dwordx4 v[96:99], v20, s[32:35], s18 offen offset:1024 sc1
v_mfma_f32_16x16x32_bf16 v[52:55], a[236:239], v[204:207], v[52:55]
ds_read_b64_tr_b16 a[220:221], v14 offset:12288
v_cvt_pk_bf16_f32 v100, v76, v77
v_mfma_f32_16x16x32_bf16 v[56:59], a[236:239], v[208:211], v[56:59]
ds_read_b64_tr_b16 a[222:223], v14 offset:12800
s_waitcnt lgkmcnt(8)
v_mfma_f32_16x16x32_bf16 v[28:31], a[192:195], v[212:215], v[28:31]
ds_read_b64_tr_b16 a[224:225], v11 offset:13312
v_cvt_pk_bf16_f32 v101, v78, v79
v_mfma_f32_16x16x32_bf16 v[32:35], a[192:195], v[216:219], v[32:35]
ds_read_b64_tr_b16 a[226:227], v11 offset:13824
v_cvt_pk_bf16_f32 v102, v84, v85
v_mfma_f32_16x16x32_bf16 v[36:39], a[196:199], v[212:215], v[36:39]
ds_read_b64_tr_b16 a[228:229], v12 offset:13312
v_mfma_f32_16x16x32_bf16 v[40:43], a[196:199], v[216:219], v[40:43]
ds_read_b64_tr_b16 a[230:231], v12 offset:13824
v_mfma_f32_16x16x32_bf16 v[44:47], a[200:203], v[212:215], v[44:47]
ds_read_b64_tr_b16 a[232:233], v13 offset:13312
v_mfma_f32_16x16x32_bf16 v[48:51], a[200:203], v[216:219], v[48:51]
ds_read_b64_tr_b16 a[234:235], v13 offset:13824
v_mfma_f32_16x16x32_bf16 v[52:55], a[204:207], v[212:215], v[52:55]
ds_read_b64_tr_b16 a[236:237], v14 offset:13312
v_mfma_f32_16x16x32_bf16 v[56:59], a[204:207], v[216:219], v[56:59]
ds_read_b64_tr_b16 a[238:239], v14 offset:13824
s_waitcnt lgkmcnt(8)
v_mfma_f32_16x16x32_bf16 v[28:31], a[208:211], v[172:175], v[28:31]
ds_read_b64_tr_b16 a[192:193], v11 offset:14336
v_mfma_f32_16x16x32_bf16 v[32:35], a[208:211], v[176:179], v[32:35]
ds_read_b64_tr_b16 a[194:195], v11 offset:14848
v_mfma_f32_16x16x32_bf16 v[36:39], a[212:215], v[172:175], v[36:39]
ds_read_b64_tr_b16 a[196:197], v12 offset:14336
v_cvt_pk_bf16_f32 v103, v86, v87
v_mfma_f32_16x16x32_bf16 v[40:43], a[212:215], v[176:179], v[40:43]
ds_read_b64_tr_b16 a[198:199], v12 offset:14848
buffer_store_dwordx4 v[100:103], v20, s[32:35], s18 offen offset:2048 sc1
v_mfma_f32_16x16x32_bf16 v[44:47], a[216:219], v[172:175], v[44:47]
ds_read_b64_tr_b16 a[200:201], v13 offset:14336
v_cvt_pk_bf16_f32 v104, v80, v81
v_mfma_f32_16x16x32_bf16 v[48:51], a[216:219], v[176:179], v[48:51]
ds_read_b64_tr_b16 a[202:203], v13 offset:14848
v_cvt_pk_bf16_f32 v105, v82, v83
v_mfma_f32_16x16x32_bf16 v[52:55], a[220:223], v[172:175], v[52:55]
ds_read_b64_tr_b16 a[204:205], v14 offset:14336
v_cvt_pk_bf16_f32 v106, v88, v89
v_mfma_f32_16x16x32_bf16 v[56:59], a[220:223], v[176:179], v[56:59]
ds_read_b64_tr_b16 a[206:207], v14 offset:14848
s_waitcnt lgkmcnt(8)
v_mfma_f32_16x16x32_bf16 v[28:31], a[224:227], v[180:183], v[28:31]
ds_read_b64_tr_b16 a[208:209], v11 offset:15360
v_cvt_pk_bf16_f32 v107, v90, v91
v_mfma_f32_16x16x32_bf16 v[32:35], a[224:227], v[184:187], v[32:35]
ds_read_b64_tr_b16 a[210:211], v11 offset:15872
buffer_store_dwordx4 v[104:107], v20, s[32:35], s18 offen offset:3072 sc1
v_mfma_f32_16x16x32_bf16 v[36:39], a[228:231], v[180:183], v[36:39]
ds_read_b64_tr_b16 a[212:213], v12 offset:15360
v_mfma_f32_16x16x32_bf16 v[40:43], a[228:231], v[184:187], v[40:43]
ds_read_b64_tr_b16 a[214:215], v12 offset:15872
v_mfma_f32_16x16x32_bf16 v[44:47], a[232:235], v[180:183], v[44:47]
ds_read_b64_tr_b16 a[216:217], v13 offset:15360
v_mfma_f32_16x16x32_bf16 v[48:51], a[232:235], v[184:187], v[48:51]
ds_read_b64_tr_b16 a[218:219], v13 offset:15872
v_mfma_f32_16x16x32_bf16 v[52:55], a[236:239], v[180:183], v[52:55]
ds_read_b64_tr_b16 a[220:221], v14 offset:15360
v_mfma_f32_16x16x32_bf16 v[56:59], a[236:239], v[184:187], v[56:59]
ds_read_b64_tr_b16 a[222:223], v14 offset:15872
s_waitcnt lgkmcnt(8)
v_mfma_f32_16x16x32_bf16 v[28:31], a[192:195], v[156:159], v[28:31]
s_barrier
ds_read_b64_tr_b16 a[224:225], v11 offset:16384
v_mfma_f32_16x16x32_bf16 v[32:35], a[192:195], v[160:163], v[32:35]
ds_read_b64_tr_b16 a[226:227], v11 offset:16896
v_mfma_f32_16x16x32_bf16 v[36:39], a[196:199], v[156:159], v[36:39]
ds_read_b64_tr_b16 a[228:229], v12 offset:16384
s_add_u32 s22, s15, 8192
v_mfma_f32_16x16x32_bf16 v[40:43], a[196:199], v[160:163], v[40:43]
ds_read_b64_tr_b16 a[230:231], v12 offset:16896
buffer_load_dword v23, v6, s[32:35], s22 offen sc1
v_mfma_f32_16x16x32_bf16 v[44:47], a[200:203], v[156:159], v[44:47]
ds_read_b64_tr_b16 a[232:233], v13 offset:16384
v_mfma_f32_16x16x32_bf16 v[48:51], a[200:203], v[160:163], v[48:51]
ds_read_b64_tr_b16 a[234:235], v13 offset:16896
v_mfma_f32_16x16x32_bf16 v[52:55], a[204:207], v[156:159], v[52:55]
ds_read_b64_tr_b16 a[236:237], v14 offset:16384
v_mfma_f32_16x16x32_bf16 v[56:59], a[204:207], v[160:163], v[56:59]
ds_read_b64_tr_b16 a[238:239], v14 offset:16896
s_waitcnt lgkmcnt(8)
v_mfma_f32_16x16x32_bf16 v[28:31], a[208:211], v[164:167], v[28:31]
ds_read_b64_tr_b16 a[192:193], v11 offset:17408
v_mfma_f32_16x16x32_bf16 v[32:35], a[208:211], v[168:171], v[32:35]
ds_read_b64_tr_b16 a[194:195], v11 offset:17920
v_mfma_f32_16x16x32_bf16 v[36:39], a[212:215], v[164:167], v[36:39]
ds_read_b64_tr_b16 a[196:197], v12 offset:17408
v_mfma_f32_16x16x32_bf16 v[40:43], a[212:215], v[168:171], v[40:43]
ds_read_b64_tr_b16 a[198:199], v12 offset:17920
v_mfma_f32_16x16x32_bf16 v[44:47], a[216:219], v[164:167], v[44:47]
ds_read_b64_tr_b16 a[200:201], v13 offset:17408
v_mfma_f32_16x16x32_bf16 v[48:51], a[216:219], v[168:171], v[48:51]
ds_read_b64_tr_b16 a[202:203], v13 offset:17920
v_mfma_f32_16x16x32_bf16 v[52:55], a[220:223], v[164:167], v[52:55]
ds_read_b64_tr_b16 a[204:205], v14 offset:17408
v_mfma_f32_16x16x32_bf16 v[56:59], a[220:223], v[168:171], v[56:59]
ds_read_b64_tr_b16 a[206:207], v14 offset:17920
s_waitcnt lgkmcnt(8)
v_mfma_f32_16x16x32_bf16 v[28:31], a[224:227], a[128:131], v[28:31]
ds_read_b64_tr_b16 a[208:209], v11 offset:18432
v_mfma_f32_16x16x32_bf16 v[32:35], a[224:227], a[132:135], v[32:35]
ds_read_b64_tr_b16 a[210:211], v11 offset:18944
v_mfma_f32_16x16x32_bf16 v[36:39], a[228:231], a[128:131], v[36:39]
ds_read_b64_tr_b16 a[212:213], v12 offset:18432
v_mfma_f32_16x16x32_bf16 v[40:43], a[228:231], a[132:135], v[40:43]
ds_read_b64_tr_b16 a[214:215], v12 offset:18944
v_mfma_f32_16x16x32_bf16 v[44:47], a[232:235], a[128:131], v[44:47]
ds_read_b64_tr_b16 a[216:217], v13 offset:18432
v_mfma_f32_16x16x32_bf16 v[48:51], a[232:235], a[132:135], v[48:51]
ds_read_b64_tr_b16 a[218:219], v13 offset:18944
v_mfma_f32_16x16x32_bf16 v[52:55], a[236:239], a[128:131], v[52:55]
ds_read_b64_tr_b16 a[220:221], v14 offset:18432
v_mfma_f32_16x16x32_bf16 v[56:59], a[236:239], a[132:135], v[56:59]
ds_read_b64_tr_b16 a[222:223], v14 offset:18944
s_waitcnt lgkmcnt(8)
v_mfma_f32_16x16x32_bf16 v[28:31], a[192:195], a[136:139], v[28:31]
ds_read_b64_tr_b16 a[224:225], v11 offset:19456
v_mfma_f32_16x16x32_bf16 v[32:35], a[192:195], a[140:143], v[32:35]
ds_read_b64_tr_b16 a[226:227], v11 offset:19968
v_mfma_f32_16x16x32_bf16 v[36:39], a[196:199], a[136:139], v[36:39]
ds_read_b64_tr_b16 a[228:229], v12 offset:19456
v_mfma_f32_16x16x32_bf16 v[40:43], a[196:199], a[140:143], v[40:43]
ds_read_b64_tr_b16 a[230:231], v12 offset:19968
v_mfma_f32_16x16x32_bf16 v[44:47], a[200:203], a[136:139], v[44:47]
ds_read_b64_tr_b16 a[232:233], v13 offset:19456
v_mfma_f32_16x16x32_bf16 v[48:51], a[200:203], a[140:143], v[48:51]
ds_read_b64_tr_b16 a[234:235], v13 offset:19968
v_mfma_f32_16x16x32_bf16 v[52:55], a[204:207], a[136:139], v[52:55]
ds_read_b64_tr_b16 a[236:237], v14 offset:19456
v_mfma_f32_16x16x32_bf16 v[56:59], a[204:207], a[140:143], v[56:59]
ds_read_b64_tr_b16 a[238:239], v14 offset:19968
s_waitcnt vmcnt(0)
v_cmp_ne_u32 vcc, s63, v23
s_nop 1
s_and_b32 vcc_lo, vcc_lo, 4095
s_cbranch_scc0 L_ok_29
s_add_u32 s73, s15, 8192
v_lshl_add_u32 v2, v1, 7, s73
s_mov_b32 s74, 200000
s_mov_b32 exec_lo, 0xfff
s_mov_b32 exec_hi, 0x0
L_poll_30:
buffer_load_dword v4, v2, s[32:35], 0 offen sc1
s_sub_u32 s74, s74, 1
s_waitcnt vmcnt(0)
v_cmp_eq_u32 vcc, s63, v4
s_cmp_eq_u32 s74, 0
s_cbranch_scc1 L_polld_31
s_cmp_eq_u64 vcc, exec
s_cbranch_scc0 L_poll_30
L_polld_31:
s_mov_b64 exec, -1
L_ok_29:
s_add_u32 s22, s78, 16384
buffer_store_dword v22, v5, s[32:35], s22 offen sc1
s_waitcnt lgkmcnt(8)
v_mfma_f32_16x16x32_bf16 v[28:31], a[208:211], a[144:147], v[28:31]
s_barrier
ds_read_b64_tr_b16 a[192:193], v11 offset:20480
v_mfma_f32_16x16x32_bf16 v[32:35], a[208:211], a[148:151], v[32:35]
ds_read_b64_tr_b16 a[194:195], v11 offset:20992
v_mfma_f32_16x16x32_bf16 v[36:39], a[212:215], a[144:147], v[36:39]
ds_read_b64_tr_b16 a[196:197], v12 offset:20480
s_lshl_b32 s81, s76, 6
v_mfma_f32_16x16x32_bf16 v[40:43], a[212:215], a[148:151], v[40:43]
ds_read_b64_tr_b16 a[198:199], v12 offset:20992
s_mul_i32 s73, s76, 36864
v_mfma_f32_16x16x32_bf16 v[44:47], a[216:219], a[144:147], v[44:47]
ds_read_b64_tr_b16 a[200:201], v13 offset:20480
s_sub_u32 s74, 2068480, s73
v_mfma_f32_16x16x32_bf16 v[48:51], a[216:219], a[148:151], v[48:51]
ds_read_b64_tr_b16 a[202:203], v13 offset:20992
s_add_u32 s73, s73, 1441792
v_mfma_f32_16x16x32_bf16 v[52:55], a[220:223], a[144:147], v[52:55]
ds_read_b64_tr_b16 a[204:205], v14 offset:20480
s_cmp_ge_u32 s76, 9
s_cselect_b32 s73, s74, s73
s_cselect_b32 s74, s74, 2147483392
s_cselect_b64 vcc, -1, 0
v_mfma_f32_16x16x32_bf16 v[56:59], a[220:223], a[148:151], v[56:59]
ds_read_b64_tr_b16 a[206:207], v14 offset:20992
s_waitcnt lgkmcnt(8)
v_mfma_f32_16x16x32_bf16 v[28:31], a[224:227], a[152:155], v[28:31]
ds_read_b64_tr_b16 a[208:209], v11 offset:21504
v_cndmask_b32 v3, v17, v18, vcc
v_mfma_f32_16x16x32_bf16 v[32:35], a[224:227], a[156:159], v[32:35]
ds_read_b64_tr_b16 a[210:211], v11 offset:22016
buffer_load_dwordx4 v[116:119], v16, s[28:31], s81 offen
v_mfma_f32_16x16x32_bf16 v[36:39], a[228:231], a[152:155], v[36:39]
ds_read_b64_tr_b16 a[212:213], v12 offset:21504
buffer_load_dwordx4 v[108:111], v3, s[32:35], s73 offen sc1
v_mfma_f32_16x16x32_bf16 v[40:43], a[228:231], a[156:159], v[40:43]
ds_read_b64_tr_b16 a[214:215], v12 offset:22016
buffer_load_dword v120, v24, s[32:35], s74 offen sc1
v_mfma_f32_16x16x32_bf16 v[44:47], a[232:235], a[152:155], v[44:47]
ds_read_b64_tr_b16 a[216:217], v13 offset:21504
s_add_u32 s73, s73, 755712
v_mfma_f32_16x16x32_bf16 v[48:51], a[232:235], a[156:159], v[48:51]
ds_read_b64_tr_b16 a[218:219], v13 offset:22016
s_add_u32 s74, s74, 755712
v_mfma_f32_16x16x32_bf16 v[52:55], a[236:239], a[152:155], v[52:55]
ds_read_b64_tr_b16 a[220:221], v14 offset:21504
buffer_load_dwordx4 v[112:115], v3, s[32:35], s73 offen sc1
v_mfma_f32_16x16x32_bf16 v[56:59], a[236:239], a[156:159], v[56:59]
ds_read_b64_tr_b16 a[222:223], v14 offset:22016
s_waitcnt lgkmcnt(8)
v_mfma_f32_16x16x32_bf16 v[28:31], a[192:195], a[0:3], v[28:31]
ds_read_b64_tr_b16 a[224:225], v11 offset:22528
v_mfma_f32_16x16x32_bf16 v[32:35], a[192:195], a[4:7], v[32:35]
ds_read_b64_tr_b16 a[226:227], v11 offset:23040
v_mfma_f32_16x16x32_bf16 v[36:39], a[196:199], a[0:3], v[36:39]
ds_read_b64_tr_b16 a[228:229], v12 offset:22528
buffer_load_dword v122, v24, s[32:35], s74 offen sc1
v_mfma_f32_16x16x32_bf16 v[40:43], a[196:199], a[4:7], v[40:43]
ds_read_b64_tr_b16 a[230:231], v12 offset:23040
s_add_u32 s81, s81, 18432
v_mfma_f32_16x16x32_bf16 v[44:47], a[200:203], a[0:3], v[44:47]
ds_read_b64_tr_b16 a[232:233], v13 offset:22528
s_sub_u32 s75, s77, 755712
v_mfma_f32_16x16x32_bf16 v[48:51], a[200:203], a[4:7], v[48:51]
ds_read_b64_tr_b16 a[234:235], v13 offset:23040
s_add_u32 s73, s73, s75
v_mfma_f32_16x16x32_bf16 v[52:55], a[204:207], a[0:3], v[52:55]
ds_read_b64_tr_b16 a[236:237], v14 offset:22528
s_add_u32 s74, s74, s75
v_mfma_f32_16x16x32_bf16 v[56:59], a[204:207], a[4:7], v[56:59]
ds_read_b64_tr_b16 a[238:239], v14 offset:23040
s_waitcnt lgkmcnt(8)
v_mfma_f32_16x16x32_bf16 v[28:31], a[208:211], a[8:11], v[28:31]
ds_read_b64_tr_b16 a[192:193], v11 offset:23552
buffer_load_dwordx4 v[132:135], v16, s[28:31], s81 offen
v_mfma_f32_16x16x32_bf16 v[32:35], a[208:211], a[12:15], v[32:35]
ds_read_b64_tr_b16 a[194:195], v11 offset:24064
buffer_load_dwordx4 v[124:127], v3, s[32:35], s73 offen sc1
v_mfma_f32_16x16x32_bf16 v[36:39], a[212:215], a[8:11], v[36:39]
ds_read_b64_tr_b16 a[196:197], v12 offset:23552
buffer_load_dword v136, v24, s[32:35], s74 offen sc1
v_mfma_f32_16x16x32_bf16 v[40:43], a[212:215], a[12:15], v[40:43]
ds_read_b64_tr_b16 a[198:199], v12 offset:24064
s_add_u32 s73, s73, 755712
v_mfma_f32_16x16x32_bf16 v[44:47], a[216:219], a[8:11], v[44:47]
ds_read_b64_tr_b16 a[200:201], v13 offset:23552
s_add_u32 s74, s74, 755712
v_mfma_f32_16x16x32_bf16 v[48:51], a[216:219], a[12:15], v[48:51]
ds_read_b64_tr_b16 a[202:203], v13 offset:24064
buffer_load_dwordx4 v[128:131], v3, s[32:35], s73 offen sc1
v_mfma_f32_16x16x32_bf16 v[52:55], a[220:223], a[8:11], v[52:55]
ds_read_b64_tr_b16 a[204:205], v14 offset:23552
buffer_load_dword v138, v24, s[32:35], s74 offen sc1
v_mfma_f32_16x16x32_bf16 v[56:59], a[220:223], a[12:15], v[56:59]
ds_read_b64_tr_b16 a[206:207], v14 offset:24064
s_waitcnt lgkmcnt(8)
v_mfma_f32_16x16x32_bf16 v[28:31], a[224:227], a[16:19], v[28:31]
s_barrier
ds_read_b64_tr_b16 a[208:209], v11 offset:24576
v_mfma_f32_16x16x32_bf16 v[32:35], a[224:227], a[20:23], v[32:35]
ds_read_b64_tr_b16 a[210:211], v11 offset:25088
v_mfma_f32_16x16x32_bf16 v[36:39], a[228:231], a[16:19], v[36:39]
ds_read_b64_tr_b16 a[212:213], v12 offset:24576
s_add_u32 s76, s76, 1
v_mfma_f32_16x16x32_bf16 v[40:43], a[228:231], a[20:23], v[40:43]
ds_read_b64_tr_b16 a[214:215], v12 offset:25088
s_lshl_b32 s81, s76, 6
v_mfma_f32_16x16x32_bf16 v[44:47], a[232:235], a[16:19], v[44:47]
ds_read_b64_tr_b16 a[216:217], v13 offset:24576
s_mul_i32 s73, s76, 36864
v_mfma_f32_16x16x32_bf16 v[48:51], a[232:235], a[20:23], v[48:51]
ds_read_b64_tr_b16 a[218:219], v13 offset:25088
s_sub_u32 s74, 2068480, s73
v_mfma_f32_16x16x32_bf16 v[52:55], a[236:239], a[16:19], v[52:55]
ds_read_b64_tr_b16 a[220:221], v14 offset:24576
s_add_u32 s73, s73, 1441792
v_mfma_f32_16x16x32_bf16 v[56:59], a[236:239], a[20:23], v[56:59]
ds_read_b64_tr_b16 a[222:223], v14 offset:25088
s_waitcnt lgkmcnt(8)
v_mfma_f32_16x16x32_bf16 v[28:31], a[192:195], a[24:27], v[28:31]
ds_read_b64_tr_b16 a[224:225], v11 offset:25600
s_cmp_ge_u32 s76, 9
s_cselect_b32 s73, s74, s73
s_cselect_b32 s74, s74, 2147483392
s_cselect_b64 vcc, -1, 0
v_mfma_f32_16x16x32_bf16 v[32:35], a[192:195], a[28:31], v[32:35]
ds_read_b64_tr_b16 a[226:227], v11 offset:26112
v_cndmask_b32 v3, v17, v18, vcc
v_mfma_f32_16x16x32_bf16 v[36:39], a[196:199], a[24:27], v[36:39]
ds_read_b64_tr_b16 a[228:229], v12 offset:25600
buffer_load_dwordx4 v[148:151], v16, s[28:31], s81 offen
v_mfma_f32_16x16x32_bf16 v[40:43], a[196:199], a[28:31], v[40:43]
ds_read_b64_tr_b16 a[230:231], v12 offset:26112
buffer_load_dwordx4 v[140:143], v3, s[32:35], s73 offen sc1
v_mfma_f32_16x16x32_bf16 v[44:47], a[200:203], a[24:27], v[44:47]
ds_read_b64_tr_b16 a[232:233], v13 offset:25600
buffer_load_dword v152, v24, s[32:35], s74 offen sc1
v_mfma_f32_16x16x32_bf16 v[48:51], a[200:203], a[28:31], v[48:51]
ds_read_b64_tr_b16 a[234:235], v13 offset:26112
s_add_u32 s73, s73, 755712
v_mfma_f32_16x16x32_bf16 v[52:55], a[204:207], a[24:27], v[52:55]
ds_read_b64_tr_b16 a[236:237], v14 offset:25600
s_add_u32 s74, s74, 755712
v_mfma_f32_16x16x32_bf16 v[56:59], a[204:207], a[28:31], v[56:59]
ds_read_b64_tr_b16 a[238:239], v14 offset:26112
s_waitcnt lgkmcnt(8)
v_mfma_f32_16x16x32_bf16 v[28:31], a[208:211], a[32:35], v[28:31]
ds_read_b64_tr_b16 a[192:193], v11 offset:26624
v_mfma_f32_16x16x32_bf16 v[32:35], a[208:211], a[36:39], v[32:35]
ds_read_b64_tr_b16 a[194:195], v11 offset:27136
v_mfma_f32_16x16x32_bf16 v[36:39], a[212:215], a[32:35], v[36:39]
ds_read_b64_tr_b16 a[196:197], v12 offset:26624
buffer_load_dwordx4 v[144:147], v3, s[32:35], s73 offen sc1
buffer_load_dword v154, v24, s[32:35], s74 offen sc1
v_mfma_f32_16x16x32_bf16 v[40:43], a[212:215], a[36:39], v[40:43]
ds_read_b64_tr_b16 a[198:199], v12 offset:27136
s_add_u32 s81, s81, 18432
v_mfma_f32_16x16x32_bf16 v[44:47], a[216:219], a[32:35], v[44:47]
ds_read_b64_tr_b16 a[200:201], v13 offset:26624
s_sub_u32 s75, s77, 755712
v_mfma_f32_16x16x32_bf16 v[48:51], a[216:219], a[36:39], v[48:51]
ds_read_b64_tr_b16 a[202:203], v13 offset:27136
s_add_u32 s73, s73, s75
v_mfma_f32_16x16x32_bf16 v[52:55], a[220:223], a[32:35], v[52:55]
ds_read_b64_tr_b16 a[204:205], v14 offset:26624
s_add_u32 s74, s74, s75
v_mfma_f32_16x16x32_bf16 v[56:59], a[220:223], a[36:39], v[56:59]
ds_read_b64_tr_b16 a[206:207], v14 offset:27136
s_waitcnt lgkmcnt(8)
v_mfma_f32_16x16x32_bf16 v[28:31], a[224:227], a[40:43], v[28:31]
ds_read_b64_tr_b16 a[208:209], v11 offset:27648
buffer_load_dwordx4 v[100:103], v16, s[28:31], s81 offen
v_mfma_f32_16x16x32_bf16 v[32:35], a[224:227], a[44:47], v[32:35]
ds_read_b64_tr_b16 a[210:211], v11 offset:28160
buffer_load_dwordx4 v[92:95], v3, s[32:35], s73 offen sc1
v_mfma_f32_16x16x32_bf16 v[36:39], a[228:231], a[40:43], v[36:39]
ds_read_b64_tr_b16 a[212:213], v12 offset:27648
buffer_load_dword v104, v24, s[32:35], s74 offen sc1
v_mfma_f32_16x16x32_bf16 v[40:43], a[228:231], a[44:47], v[40:43]
ds_read_b64_tr_b16 a[214:215], v12 offset:28160
s_add_u32 s73, s73, 755712
v_mfma_f32_16x16x32_bf16 v[44:47], a[232:235], a[40:43], v[44:47]
ds_read_b64_tr_b16 a[216:217], v13 offset:27648
s_add_u32 s74, s74, 755712
v_mfma_f32_16x16x32_bf16 v[48:51], a[232:235], a[44:47], v[48:51]
ds_read_b64_tr_b16 a[218:219], v13 offset:28160
buffer_load_dwordx4 v[96:99], v3, s[32:35], s73 offen sc1
v_mfma_f32_16x16x32_bf16 v[52:55], a[236:239], a[40:43], v[52:55]
ds_read_b64_tr_b16 a[220:221], v14 offset:27648
buffer_load_dword v106, v24, s[32:35], s74 offen sc1
v_mfma_f32_16x16x32_bf16 v[56:59], a[236:239], a[44:47], v[56:59]
ds_read_b64_tr_b16 a[222:223], v14 offset:28160
s_waitcnt lgkmcnt(8)
v_mfma_f32_16x16x32_bf16 v[28:31], a[192:195], a[48:51], v[28:31]
ds_read_b64_tr_b16 a[224:225], v11 offset:28672
v_mfma_f32_16x16x32_bf16 v[32:35], a[192:195], a[52:55], v[32:35]
ds_read_b64_tr_b16 a[226:227], v11 offset:29184
v_mfma_f32_16x16x32_bf16 v[36:39], a[196:199], a[48:51], v[36:39]
ds_read_b64_tr_b16 a[228:229], v12 offset:28672
s_add_u32 s22, s78, 16384
v_mfma_f32_16x16x32_bf16 v[40:43], a[196:199], a[52:55], v[40:43]
ds_read_b64_tr_b16 a[230:231], v12 offset:29184
buffer_load_dword v23, v7, s[32:35], s22 offen sc1
v_mfma_f32_16x16x32_bf16 v[44:47], a[200:203], a[48:51], v[44:47]
ds_read_b64_tr_b16 a[232:233], v13 offset:28672
v_mfma_f32_16x16x32_bf16 v[48:51], a[200:203], a[52:55], v[48:51]
ds_read_b64_tr_b16 a[234:235], v13 offset:29184
v_mfma_f32_16x16x32_bf16 v[52:55], a[204:207], a[48:51], v[52:55]
ds_read_b64_tr_b16 a[236:237], v14 offset:28672
v_mfma_f32_16x16x32_bf16 v[56:59], a[204:207], a[52:55], v[56:59]
ds_read_b64_tr_b16 a[238:239], v14 offset:29184
s_waitcnt lgkmcnt(8)
v_mfma_f32_16x16x32_bf16 v[28:31], a[208:211], a[56:59], v[28:31]
ds_read_b64_tr_b16 a[192:193], v11 offset:29696
v_mfma_f32_16x16x32_bf16 v[32:35], a[208:211], a[60:63], v[32:35]
ds_read_b64_tr_b16 a[194:195], v11 offset:30208
v_mfma_f32_16x16x32_bf16 v[36:39], a[212:215], a[56:59], v[36:39]
ds_read_b64_tr_b16 a[196:197], v12 offset:29696
v_mfma_f32_16x16x32_bf16 v[40:43], a[212:215], a[60:63], v[40:43]
ds_read_b64_tr_b16 a[198:199], v12 offset:30208
v_mfma_f32_16x16x32_bf16 v[44:47], a[216:219], a[56:59], v[44:47]
ds_read_b64_tr_b16 a[200:201], v13 offset:29696
v_mfma_f32_16x16x32_bf16 v[48:51], a[216:219], a[60:63], v[48:51]
ds_read_b64_tr_b16 a[202:203], v13 offset:30208
v_mfma_f32_16x16x32_bf16 v[52:55], a[220:223], a[56:59], v[52:55]
ds_read_b64_tr_b16 a[204:205], v14 offset:29696
v_mfma_f32_16x16x32_bf16 v[56:59], a[220:223], a[60:63], v[56:59]
ds_read_b64_tr_b16 a[206:207], v14 offset:30208
s_waitcnt lgkmcnt(8)
v_mfma_f32_16x16x32_bf16 v[28:31], a[224:227], a[64:67], v[28:31]
ds_read_b64_tr_b16 a[208:209], v11 offset:30720
v_mfma_f32_16x16x32_bf16 v[32:35], a[224:227], a[68:71], v[32:35]
ds_read_b64_tr_b16 a[210:211], v11 offset:31232
v_mfma_f32_16x16x32_bf16 v[36:39], a[228:231], a[64:67], v[36:39]
ds_read_b64_tr_b16 a[212:213], v12 offset:30720
v_mfma_f32_16x16x32_bf16 v[40:43], a[228:231], a[68:71], v[40:43]
ds_read_b64_tr_b16 a[214:215], v12 offset:31232
v_mfma_f32_16x16x32_bf16 v[44:47], a[232:235], a[64:67], v[44:47]
ds_read_b64_tr_b16 a[216:217], v13 offset:30720
v_mfma_f32_16x16x32_bf16 v[48:51], a[232:235], a[68:71], v[48:51]
ds_read_b64_tr_b16 a[218:219], v13 offset:31232
v_mfma_f32_16x16x32_bf16 v[52:55], a[236:239], a[64:67], v[52:55]
ds_read_b64_tr_b16 a[220:221], v14 offset:30720
v_mfma_f32_16x16x32_bf16 v[56:59], a[236:239], a[68:71], v[56:59]
ds_read_b64_tr_b16 a[222:223], v14 offset:31232
s_waitcnt lgkmcnt(8)
v_mfma_f32_16x16x32_bf16 v[28:31], a[192:195], a[72:75], v[28:31]
ds_read_b64_tr_b16 a[224:225], v11 offset:31744
v_mfma_f32_16x16x32_bf16 v[32:35], a[192:195], a[76:79], v[32:35]
ds_read_b64_tr_b16 a[226:227], v11 offset:32256
v_mfma_f32_16x16x32_bf16 v[36:39], a[196:199], a[72:75], v[36:39]
ds_read_b64_tr_b16 a[228:229], v12 offset:31744
v_mfma_f32_16x16x32_bf16 v[40:43], a[196:199], a[76:79], v[40:43]
ds_read_b64_tr_b16 a[230:231], v12 offset:32256
v_mfma_f32_16x16x32_bf16 v[44:47], a[200:203], a[72:75], v[44:47]
ds_read_b64_tr_b16 a[232:233], v13 offset:31744
v_mfma_f32_16x16x32_bf16 v[48:51], a[200:203], a[76:79], v[48:51]
ds_read_b64_tr_b16 a[234:235], v13 offset:32256
v_mfma_f32_16x16x32_bf16 v[52:55], a[204:207], a[72:75], v[52:55]
ds_read_b64_tr_b16 a[236:237], v14 offset:31744
v_mfma_f32_16x16x32_bf16 v[56:59], a[204:207], a[76:79], v[56:59]
ds_read_b64_tr_b16 a[238:239], v14 offset:32256
s_waitcnt lgkmcnt(8)
v_mfma_f32_16x16x32_bf16 v[28:31], a[208:211], a[80:83], v[28:31]
v_mfma_f32_16x16x32_bf16 v[32:35], a[208:211], a[84:87], v[32:35]
v_mfma_f32_16x16x32_bf16 v[36:39], a[212:215], a[80:83], v[36:39]
v_mfma_f32_16x16x32_bf16 v[40:43], a[212:215], a[84:87], v[40:43]
v_mfma_f32_16x16x32_bf16 v[44:47], a[216:219], a[80:83], v[44:47]
v_mfma_f32_16x16x32_bf16 v[48:51], a[216:219], a[84:87], v[48:51]
v_mfma_f32_16x16x32_bf16 v[52:55], a[220:223], a[80:83], v[52:55]
v_mfma_f32_16x16x32_bf16 v[56:59], a[220:223], a[84:87], v[56:59]
s_waitcnt lgkmcnt(0)
v_mfma_f32_16x16x32_bf16 v[28:31], a[224:227], a[88:91], v[28:31]
v_mfma_f32_16x16x32_bf16 v[32:35], a[224:227], a[92:95], v[32:35]
v_mfma_f32_16x16x32_bf16 v[36:39], a[228:231], a[88:91], v[36:39]
v_mfma_f32_16x16x32_bf16 v[40:43], a[228:231], a[92:95], v[40:43]
v_mfma_f32_16x16x32_bf16 v[44:47], a[232:235], a[88:91], v[44:47]
v_mfma_f32_16x16x32_bf16 v[48:51], a[232:235], a[92:95], v[48:51]
v_mfma_f32_16x16x32_bf16 v[52:55], a[236:239], a[88:91], v[52:55]
v_mfma_f32_16x16x32_bf16 v[56:59], a[236:239], a[92:95], v[56:59]
s_waitcnt vmcnt(0)
v_cmp_ne_u32 vcc, s63, v23
s_nop 1
s_and_b32 vcc_lo, vcc_lo, s92
s_cbranch_scc1 L_late_32
s_mov_b32 s92, 0
buffer_load_dwordx4 v[156:159], v20, s[32:35], s4 offen offset:0 sc1
buffer_load_dwordx4 v[160:163], v20, s[32:35], s4 offen offset:1024 sc1
buffer_load_dwordx4 v[164:167], v20, s[32:35], s4 offen offset:2048 sc1
buffer_load_dwordx4 v[168:171], v20, s[32:35], s4 offen offset:3072 sc1
buffer_load_dwordx4 v[172:175], v20, s[32:35], s5 offen offset:0 sc1
buffer_load_dwordx4 v[176:179], v20, s[32:35], s5 offen offset:1024 sc1
buffer_load_dwordx4 v[180:183], v20, s[32:35], s5 offen offset:2048 sc1
buffer_load_dwordx4 v[184:187], v20, s[32:35], s5 offen offset:3072 sc1
buffer_load_dwordx4 v[188:191], v20, s[32:35], s12 offen offset:0 sc1
buffer_load_dwordx4 v[192:195], v20, s[32:35], s12 offen offset:1024 sc1
buffer_load_dwordx4 v[196:199], v20, s[32:35], s12 offen offset:2048 sc1
buffer_load_dwordx4 v[200:203], v20, s[32:35], s12 offen offset:3072 sc1
buffer_load_dwordx4 v[204:207], v20, s[32:35], s25 offen offset:0 sc1
buffer_load_dwordx4 v[208:211], v20, s[32:35], s25 offen offset:1024 sc1
buffer_load_dwordx4 v[212:215], v20, s[32:35], s25 offen offset:2048 sc1
buffer_load_dwordx4 v[216:219], v20, s[32:35], s25 offen offset:3072 sc1
L_late_32:
s_cmp_ge_u32 s76, 9
s_cbranch_scc1 L_mir_39
v_mov_b32 v3, v19
v_lshlrev_b32 v76, 16, v140
v_and_b32 v77, 0xffff0000, v140
v_lshlrev_b32 v78, 16, v141
v_and_b32 v79, 0xffff0000, v141
v_lshlrev_b32 v80, 16, v142
v_and_b32 v81, 0xffff0000, v142
v_lshlrev_b32 v82, 16, v143
v_and_b32 v83, 0xffff0000, v143
v_lshlrev_b32 v220, 16, v144
v_and_b32 v221, 0xffff0000, v144
v_lshlrev_b32 v222, 16, v145
v_and_b32 v223, 0xffff0000, v145
v_lshlrev_b32 v224, 16, v146
v_and_b32 v225, 0xffff0000, v146
v_lshlrev_b32 v226, 16, v147
v_and_b32 v227, 0xffff0000, v147
v_lshlrev_b32 v84, 16, v92
v_and_b32 v85, 0xffff0000, v92
v_lshlrev_b32 v86, 16, v93
v_and_b32 v87, 0xffff0000, v93
v_lshlrev_b32 v88, 16, v94
v_and_b32 v89, 0xffff0000, v94
v_lshlrev_b32 v90, 16, v95
v_and_b32 v91, 0xffff0000, v95
v_lshlrev_b32 v228, 16, v96
v_and_b32 v229, 0xffff0000, v96
v_lshlrev_b32 v230, 16, v97
v_and_b32 v231, 0xffff0000, v97
v_lshlrev_b32 v232, 16, v98
v_and_b32 v233, 0xffff0000, v98
v_lshlrev_b32 v234, 16, v99
v_and_b32 v235, 0xffff0000, v99
s_branch L_join_40
L_mir_39:
ds_bpermute_b32 v76, v25, v142
ds_bpermute_b32 v80, v25, v140
ds_bpermute_b32 v220, v25, v146
ds_bpermute_b32 v224, v25, v144
ds_bpermute_b32 v84, v25, v94
ds_bpermute_b32 v88, v25, v92
ds_bpermute_b32 v228, v25, v98
ds_bpermute_b32 v232, v25, v96
v_xor_b32 v3, 0x80000000, v19
v_cmp_gt_u32 vcc, 16, v1
v_and_b32 v77, 0xffff0000, v143
v_lshlrev_b32 v78, 16, v143
v_and_b32 v79, 0xffff0000, v142
v_and_b32 v81, 0xffff0000, v141
v_lshlrev_b32 v82, 16, v141
v_and_b32 v83, 0xffff0000, v140
v_and_b32 v221, 0xffff0000, v147
v_lshlrev_b32 v222, 16, v147
v_and_b32 v223, 0xffff0000, v146
v_and_b32 v225, 0xffff0000, v145
v_lshlrev_b32 v226, 16, v145
v_and_b32 v227, 0xffff0000, v144
v_and_b32 v85, 0xffff0000, v95
v_lshlrev_b32 v86, 16, v95
v_and_b32 v87, 0xffff0000, v94
v_and_b32 v89, 0xffff0000, v93
v_lshlrev_b32 v90, 16, v93
v_and_b32 v91, 0xffff0000, v92
v_and_b32 v229, 0xffff0000, v99
v_lshlrev_b32 v230, 16, v99
v_and_b32 v231, 0xffff0000, v98
v_and_b32 v233, 0xffff0000, v97
v_lshlrev_b32 v234, 16, v97
v_and_b32 v235, 0xffff0000, v96
s_waitcnt lgkmcnt(0)
v_cndmask_b32 v80, v80, v76, vcc
v_cndmask_b32 v76, v76, v152, vcc
v_lshlrev_b32 v80, 16, v80
v_lshlrev_b32 v76, 16, v76
v_cndmask_b32 v224, v224, v220, vcc
v_cndmask_b32 v220, v220, v154, vcc
v_lshlrev_b32 v224, 16, v224
v_lshlrev_b32 v220, 16, v220
v_cndmask_b32 v88, v88, v84, vcc
v_cndmask_b32 v84, v84, v104, vcc
v_lshlrev_b32 v88, 16, v88
v_lshlrev_b32 v84, 16, v84
v_cndmask_b32 v232, v232, v228, vcc
v_cndmask_b32 v228, v228, v106, vcc
v_lshlrev_b32 v232, 16, v232
v_lshlrev_b32 v228, 16, v228
L_join_40:
v_fma_f32 v76, v3, v220, v76
v_fma_f32 v77, v3, v221, v77
v_fma_f32 v78, v3, v222, v78
v_fma_f32 v79, v3, v223, v79
v_fma_f32 v80, v3, v224, v80
v_fma_f32 v81, v3, v225, v81
v_fma_f32 v82, v3, v226, v82
v_fma_f32 v83, v3, v227, v83
v_mul_f32 v76, v238, v76
v_mul_f32 v77, v238, v77
v_mul_f32 v78, v238, v78
v_mul_f32 v79, v238, v79
v_mul_f32 v80, v238, v80
v_mul_f32 v81, v238, v81
v_mul_f32 v82, v238, v82
v_mul_f32 v83, v238, v83
v_lshlrev_b32 v140, 16, v148
v_and_b32 v141, 0xffff0000, v148
v_lshlrev_b32 v142, 16, v149
v_and_b32 v143, 0xffff0000, v149
v_lshlrev_b32 v144, 16, v150
v_and_b32 v145, 0xffff0000, v150
v_lshlrev_b32 v146, 16, v151
v_and_b32 v147, 0xffff0000, v151
v_fma_f32 v84, v3, v228, v84
v_fma_f32 v85, v3, v229, v85
v_fma_f32 v86, v3, v230, v86
v_fma_f32 v87, v3, v231, v87
v_fma_f32 v88, v3, v232, v88
v_fma_f32 v89, v3, v233, v89
v_fma_f32 v90, v3, v234, v90
v_fma_f32 v91, v3, v235, v91
v_mul_f32 v84, v239, v84
v_mul_f32 v85, v239, v85
v_mul_f32 v86, v239, v86
v_mul_f32 v87, v239, v87
v_mul_f32 v88, v239, v88
v_mul_f32 v89, v239, v89
v_mul_f32 v90, v239, v90
v_mul_f32 v91, v239, v91
v_lshlrev_b32 v92, 16, v100
v_and_b32 v93, 0xffff0000, v100
v_lshlrev_b32 v94, 16, v101
v_and_b32 v95, 0xffff0000, v101
v_lshlrev_b32 v96, 16, v102
v_and_b32 v97, 0xffff0000, v102
v_lshlrev_b32 v98, 16, v103
v_and_b32 v99, 0xffff0000, v103
s_sub_u32 s76, s76, 1
s_cmp_ge_u32 s76, 9
s_cbranch_scc1 L_mir_41
v_mov_b32 v3, v19
v_lshlrev_b32 v60, 16, v108
v_and_b32 v61, 0xffff0000, v108
v_lshlrev_b32 v62, 16, v109
v_and_b32 v63, 0xffff0000, v109
v_lshlrev_b32 v64, 16, v110
v_and_b32 v65, 0xffff0000, v110
v_lshlrev_b32 v66, 16, v111
v_and_b32 v67, 0xffff0000, v111
v_lshlrev_b32 v220, 16, v112
v_and_b32 v221, 0xffff0000, v112
v_lshlrev_b32 v222, 16, v113
v_and_b32 v223, 0xffff0000, v113
v_lshlrev_b32 v224, 16, v114
v_and_b32 v225, 0xffff0000, v114
v_lshlrev_b32 v226, 16, v115
v_and_b32 v227, 0xffff0000, v115
v_lshlrev_b32 v68, 16, v124
v_and_b32 v69, 0xffff0000, v124
v_lshlrev_b32 v70, 16, v125
v_and_b32 v71, 0xffff0000, v125
v_lshlrev_b32 v72, 16, v126
v_and_b32 v73, 0xffff0000, v126
v_lshlrev_b32 v74, 16, v127
v_and_b32 v75, 0xffff0000, v127
v_lshlrev_b32 v228, 16, v128
v_and_b32 v229, 0xffff0000, v128
v_lshlrev_b32 v230, 16, v129
v_and_b32 v231, 0xffff0000, v129
v_lshlrev_b32 v232, 16, v130
v_and_b32 v233, 0xffff0000, v130
v_lshlrev_b32 v234, 16, v131
v_and_b32 v235, 0xffff0000, v131
s_branch L_join_42
L_mir_41:
ds_bpermute_b32 v60, v25, v110
ds_bpermute_b32 v64, v25, v108
ds_bpermute_b32 v220, v25, v114
ds_bpermute_b32 v224, v25, v112
ds_bpermute_b32 v68, v25, v126
ds_bpermute_b32 v72, v25, v124
ds_bpermute_b32 v228, v25, v130
ds_bpermute_b32 v232, v25, v128
v_xor_b32 v3, 0x80000000, v19
v_cmp_gt_u32 vcc, 16, v1
v_and_b32 v61, 0xffff0000, v111
v_lshlrev_b32 v62, 16, v111
v_and_b32 v63, 0xffff0000, v110
v_and_b32 v65, 0xffff0000, v109
v_lshlrev_b32 v66, 16, v109
v_and_b32 v67, 0xffff0000, v108
v_and_b32 v221, 0xffff0000, v115
v_lshlrev_b32 v222, 16, v115
v_and_b32 v223, 0xffff0000, v114
v_and_b32 v225, 0xffff0000, v113
v_lshlrev_b32 v226, 16, v113
v_and_b32 v227, 0xffff0000, v112
v_and_b32 v69, 0xffff0000, v127
v_lshlrev_b32 v70, 16, v127
v_and_b32 v71, 0xffff0000, v126
v_and_b32 v73, 0xffff0000, v125
v_lshlrev_b32 v74, 16, v125
v_and_b32 v75, 0xffff0000, v124
v_and_b32 v229, 0xffff0000, v131
v_lshlrev_b32 v230, 16, v131
v_and_b32 v231, 0xffff0000, v130
v_and_b32 v233, 0xffff0000, v129
v_lshlrev_b32 v234, 16, v129
v_and_b32 v235, 0xffff0000, v128
s_waitcnt lgkmcnt(0)
v_cndmask_b32 v64, v64, v60, vcc
v_cndmask_b32 v60, v60, v120, vcc
v_lshlrev_b32 v64, 16, v64
v_lshlrev_b32 v60, 16, v60
v_cndmask_b32 v224, v224, v220, vcc
v_cndmask_b32 v220, v220, v122, vcc
v_lshlrev_b32 v224, 16, v224
v_lshlrev_b32 v220, 16, v220
v_cndmask_b32 v72, v72, v68, vcc
v_cndmask_b32 v68, v68, v136, vcc
v_lshlrev_b32 v72, 16, v72
v_lshlrev_b32 v68, 16, v68
v_cndmask_b32 v232, v232, v228, vcc
v_cndmask_b32 v228, v228, v138, vcc
v_lshlrev_b32 v232, 16, v232
v_lshlrev_b32 v228, 16, v228
L_join_42:
v_fma_f32 v60, v3, v220, v60
v_fma_f32 v61, v3, v221, v61
v_fma_f32 v62, v3, v222, v62
v_fma_f32 v63, v3, v223, v63
v_fma_f32 v64, v3, v224, v64
v_fma_f32 v65, v3, v225, v65
v_fma_f32 v66, v3, v226, v66
v_fma_f32 v67, v3, v227, v67
v_mul_f32 v60, v238, v60
v_mul_f32 v61, v238, v61
v_mul_f32 v62, v238, v62
v_mul_f32 v63, v238, v63
v_mul_f32 v64, v238, v64
v_mul_f32 v65, v238, v65
v_mul_f32 v66, v238, v66
v_mul_f32 v67, v238, v67
v_lshlrev_b32 v108, 16, v116
v_and_b32 v109, 0xffff0000, v116
v_lshlrev_b32 v110, 16, v117
v_and_b32 v111, 0xffff0000, v117
v_lshlrev_b32 v112, 16, v118
v_and_b32 v113, 0xffff0000, v118
v_lshlrev_b32 v114, 16, v119
v_and_b32 v115, 0xffff0000, v119
v_fma_f32 v68, v3, v228, v68
v_fma_f32 v69, v3, v229, v69
v_fma_f32 v70, v3, v230, v70
v_fma_f32 v71, v3, v231, v71
v_fma_f32 v72, v3, v232, v72
v_fma_f32 v73, v3, v233, v73
v_fma_f32 v74, v3, v234, v74
v_fma_f32 v75, v3, v235, v75
v_mul_f32 v68, v239, v68
v_mul_f32 v69, v239, v69
v_mul_f32 v70, v239, v70
v_mul_f32 v71, v239, v71
v_mul_f32 v72, v239, v72
v_mul_f32 v73, v239, v73
v_mul_f32 v74, v239, v74
v_mul_f32 v75, v239, v75
v_lshlrev_b32 v124, 16, v132
v_and_b32 v125, 0xffff0000, v132
v_lshlrev_b32 v126, 16, v133
v_and_b32 v127, 0xffff0000, v133
v_lshlrev_b32 v128, 16, v134
v_and_b32 v129, 0xffff0000, v134
v_lshlrev_b32 v130, 16, v135
v_and_b32 v131, 0xffff0000, v135
s_cmp_eq_u32 s92, 0
s_cbranch_scc1 L_fin4_early
s_add_u32 s73, s78, 16384
v_lshl_add_u32 v2, v1, 7, s73
s_mov_b32 s74, 200000
s_mov_b32 exec_lo, s92
s_mov_b32 exec_hi, 0
L_poll_43:
buffer_load_dword v4, v2, s[32:35], 0 offen sc1
s_sub_u32 s74, s74, 1
s_waitcnt vmcnt(0)
v_cmp_eq_u32 vcc, s63, v4
s_cmp_eq_u32 s74, 0
s_cbranch_scc1 L_polld_44
s_cmp_eq_u64 vcc, exec
s_cbranch_scc0 L_poll_43
L_polld_44:
s_mov_b64 exec, -1
buffer_load_dwordx4 v[156:159], v20, s[32:35], s4 offen offset:0 sc1
buffer_load_dwordx4 v[160:163], v20, s[32:35], s4 offen offset:1024 sc1
buffer_load_dwordx4 v[164:167], v20, s[32:35], s4 offen offset:2048 sc1
buffer_load_dwordx4 v[168:171], v20, s[32:35], s4 offen offset:3072 sc1
buffer_load_dwordx4 v[172:175], v20, s[32:35], s5 offen offset:0 sc1
buffer_load_dwordx4 v[176:179], v20, s[32:35], s5 offen offset:1024 sc1
buffer_load_dwordx4 v[180:183], v20, s[32:35], s5 offen offset:2048 sc1
buffer_load_dwordx4 v[184:187], v20, s[32:35], s5 offen offset:3072 sc1
buffer_load_dwordx4 v[188:191], v20, s[32:35], s12 offen offset:0 sc1
buffer_load_dwordx4 v[192:195], v20, s[32:35], s12 offen offset:1024 sc1
buffer_load_dwordx4 v[196:199], v20, s[32:35], s12 offen offset:2048 sc1
buffer_load_dwordx4 v[200:203], v20, s[32:35], s12 offen offset:3072 sc1
buffer_load_dwordx4 v[204:207], v20, s[32:35], s25 offen offset:0 sc1
buffer_load_dwordx4 v[208:211], v20, s[32:35], s25 offen offset:1024 sc1
buffer_load_dwordx4 v[212:215], v20, s[32:35], s25 offen offset:2048 sc1
buffer_load_dwordx4 v[216:219], v20, s[32:35], s25 offen offset:3072 sc1
L_fin4_early:
s_waitcnt vmcnt(0)
v_mfma_f32_16x16x32_bf16 v[28:31], v[246:249], v[156:159], v[28:31]
v_mfma_f32_16x16x32_bf16 v[36:39], v[244:247], v[156:159], v[36:39]
v_mfma_f32_16x16x32_bf16 v[32:35], v[246:249], v[160:163], v[32:35]
v_mfma_f32_16x16x32_bf16 v[40:43], v[244:247], v[160:163], v[40:43]
v_mfma_f32_16x16x32_bf16 v[28:31], v[246:249], v[172:175], v[28:31]
v_mfma_f32_16x16x32_bf16 v[36:39], v[244:247], v[172:175], v[36:39]
v_mfma_f32_16x16x32_bf16 v[32:35], v[246:249], v[176:179], v[32:35]
v_mfma_f32_16x16x32_bf16 v[40:43], v[244:247], v[176:179], v[40:43]
v_mfma_f32_16x16x32_bf16 v[28:31], v[246:249], v[188:191], v[28:31]
v_mfma_f32_16x16x32_bf16 v[36:39], v[244:247], v[188:191], v[36:39]
v_mfma_f32_16x16x32_bf16 v[32:35], v[246:249], v[192:195], v[32:35]
v_mfma_f32_16x16x32_bf16 v[40:43], v[244:247], v[192:195], v[40:43]
v_mfma_f32_16x16x32_bf16 v[28:31], v[246:249], v[204:207], v[28:31]
v_mfma_f32_16x16x32_bf16 v[36:39], v[244:247], v[204:207], v[36:39]
v_mfma_f32_16x16x32_bf16 v[32:35], v[246:249], v[208:211], v[32:35]
v_mfma_f32_16x16x32_bf16 v[40:43], v[244:247], v[208:211], v[40:43]
v_mfma_f32_16x16x32_bf16 v[44:47], v[246:249], v[164:167], v[44:47]
v_mfma_f32_16x16x32_bf16 v[52:55], v[244:247], v[164:167], v[52:55]
v_mfma_f32_16x16x32_bf16 v[48:51], v[246:249], v[168:171], v[48:51]
v_mfma_f32_16x16x32_bf16 v[56:59], v[244:247], v[168:171], v[56:59]
v_mfma_f32_16x16x32_bf16 v[44:47], v[246:249], v[180:183], v[44:47]
v_mfma_f32_16x16x32_bf16 v[52:55], v[244:247], v[180:183], v[52:55]
v_mfma_f32_16x16x32_bf16 v[48:51], v[246:249], v[184:187], v[48:51]
v_mfma_f32_16x16x32_bf16 v[56:59], v[244:247], v[184:187], v[56:59]
v_mfma_f32_16x16x32_bf16 v[44:47], v[246:249], v[196:199], v[44:47]
v_mfma_f32_16x16x32_bf16 v[52:55], v[244:247], v[196:199], v[52:55]
v_mfma_f32_16x16x32_bf16 v[48:51], v[246:249], v[200:203], v[48:51]
v_mfma_f32_16x16x32_bf16 v[56:59], v[244:247], v[200:203], v[56:59]
v_mfma_f32_16x16x32_bf16 v[44:47], v[246:249], v[212:215], v[44:47]
v_mfma_f32_16x16x32_bf16 v[52:55], v[244:247], v[212:215], v[52:55]
v_mfma_f32_16x16x32_bf16 v[48:51], v[246:249], v[216:219], v[48:51]
v_mfma_f32_16x16x32_bf16 v[56:59], v[244:247], v[216:219], v[56:59]
v_mul_f32 v156, v240, v28
v_mul_f32 v157, v240, v29
v_mul_f32 v158, v240, v30
v_mul_f32 v159, v240, v31
v_mul_f32 v160, v240, v36
v_mul_f32 v161, v240, v37
v_mul_f32 v162, v240, v38
v_mul_f32 v163, v240, v39
v_mul_f32 v164, v241, v32
v_mul_f32 v165, v241, v33
v_mul_f32 v166, v241, v34
v_mul_f32 v167, v241, v35
v_mul_f32 v168, v241, v40
v_mul_f32 v169, v241, v41
v_mul_f32 v170, v241, v42
v_mul_f32 v171, v241, v43
v_mul_f32 v172, v240, v44
v_mul_f32 v173, v240, v45
v_mul_f32 v174, v240, v46
v_mul_f32 v175, v240, v47
v_mul_f32 v176, v240, v52
v_mul_f32 v177, v240, v53
v_mul_f32 v178, v240, v54
v_mul_f32 v179, v240, v55
v_mul_f32 v180, v241, v48
v_mul_f32 v181, v241, v49
v_mul_f32 v182, v241, v50
v_mul_f32 v183, v241, v51
v_mul_f32 v184, v241, v56
v_mul_f32 v185, v241, v57
v_mul_f32 v186, v241, v58
v_mul_f32 v187, v241, v59
v_exp_f32 v156, v156
v_mul_f32 v60, v60, v28
v_exp_f32 v157, v157
v_mul_f32 v61, v61, v29
v_exp_f32 v158, v158
v_mul_f32 v62, v62, v30
v_exp_f32 v159, v159
v_mul_f32 v63, v63, v31
v_exp_f32 v160, v160
v_mul_f32 v64, v64, v36
v_exp_f32 v161, v161
v_mul_f32 v65, v65, v37
v_exp_f32 v162, v162
v_mul_f32 v66, v66, v38
v_exp_f32 v163, v163
v_mul_f32 v67, v67, v39
v_exp_f32 v164, v164
v_mul_f32 v68, v68, v32
v_exp_f32 v165, v165
v_mul_f32 v69, v69, v33
v_exp_f32 v166, v166
v_mul_f32 v70, v70, v34
v_exp_f32 v167, v167
v_mul_f32 v71, v71, v35
v_exp_f32 v168, v168
v_mul_f32 v72, v72, v40
v_exp_f32 v169, v169
v_mul_f32 v73, v73, v41
v_exp_f32 v170, v170
v_mul_f32 v74, v74, v42
v_exp_f32 v171, v171
v_mul_f32 v75, v75, v43
v_exp_f32 v172, v172
v_mul_f32 v76, v76, v44
v_exp_f32 v173, v173
v_mul_f32 v77, v77, v45
v_exp_f32 v174, v174
v_mul_f32 v78, v78, v46
v_exp_f32 v175, v175
v_mul_f32 v79, v79, v47
v_exp_f32 v176, v176
v_mul_f32 v80, v80, v52
v_exp_f32 v177, v177
v_mul_f32 v81, v81, v53
v_exp_f32 v178, v178
v_mul_f32 v82, v82, v54
v_exp_f32 v179, v179
v_mul_f32 v83, v83, v55
v_exp_f32 v180, v180
v_mul_f32 v84, v84, v48
v_exp_f32 v181, v181
v_mul_f32 v85, v85, v49
v_exp_f32 v182, v182
v_mul_f32 v86, v86, v50
v_exp_f32 v183, v183
v_mul_f32 v87, v87, v51
v_exp_f32 v184, v184
v_mul_f32 v88, v88, v56
v_exp_f32 v185, v185
v_mul_f32 v89, v89, v57
v_exp_f32 v186, v186
v_mul_f32 v90, v90, v58
v_exp_f32 v187, v187
v_mul_f32 v91, v91, v59
v_add_f32 v156, 1.0, v156
v_add_f32 v157, 1.0, v157
v_add_f32 v158, 1.0, v158
v_add_f32 v159, 1.0, v159
v_add_f32 v160, 1.0, v160
v_add_f32 v161, 1.0, v161
v_add_f32 v162, 1.0, v162
v_add_f32 v163, 1.0, v163
v_add_f32 v164, 1.0, v164
v_add_f32 v165, 1.0, v165
v_add_f32 v166, 1.0, v166
v_add_f32 v167, 1.0, v167
v_add_f32 v168, 1.0, v168
v_add_f32 v169, 1.0, v169
v_add_f32 v170, 1.0, v170
v_add_f32 v171, 1.0, v171
v_add_f32 v172, 1.0, v172
v_add_f32 v173, 1.0, v173
v_add_f32 v174, 1.0, v174
v_add_f32 v175, 1.0, v175
v_add_f32 v176, 1.0, v176
v_add_f32 v177, 1.0, v177
v_add_f32 v178, 1.0, v178
v_add_f32 v179, 1.0, v179
v_add_f32 v180, 1.0, v180
v_add_f32 v181, 1.0, v181
v_add_f32 v182, 1.0, v182
v_add_f32 v183, 1.0, v183
v_add_f32 v184, 1.0, v184
v_add_f32 v185, 1.0, v185
v_add_f32 v186, 1.0, v186
v_add_f32 v187, 1.0, v187
v_rcp_f32 v156, v156
v_rcp_f32 v157, v157
v_rcp_f32 v158, v158
v_rcp_f32 v159, v159
v_rcp_f32 v160, v160
v_rcp_f32 v161, v161
v_rcp_f32 v162, v162
v_rcp_f32 v163, v163
v_mul_f32 v156, v156, v60
v_mul_f32 v157, v157, v61
v_mul_f32 v158, v158, v62
v_mul_f32 v159, v159, v63
v_mul_f32 v160, v160, v64
v_mul_f32 v161, v161, v65
v_mul_f32 v162, v162, v66
v_mul_f32 v163, v163, v67
ds_write_b128 v26, v[156:159] offset:0
ds_write_b128 v26, v[160:163] offset:64
v_rcp_f32 v164, v164
v_rcp_f32 v165, v165
v_rcp_f32 v166, v166
v_rcp_f32 v167, v167
v_rcp_f32 v168, v168
v_rcp_f32 v169, v169
v_rcp_f32 v170, v170
v_rcp_f32 v171, v171
v_mul_f32 v164, v164, v68
v_mul_f32 v165, v165, v69
v_mul_f32 v166, v166, v70
v_mul_f32 v167, v167, v71
v_mul_f32 v168, v168, v72
v_mul_f32 v169, v169, v73
v_mul_f32 v170, v170, v74
v_mul_f32 v171, v171, v75
ds_write_b128 v26, v[164:167] offset:2304
ds_write_b128 v26, v[168:171] offset:2368
s_waitcnt lgkmcnt(2)
ds_read_b128 v[156:159], v27 offset:0
ds_read_b128 v[160:163], v27 offset:16
v_rcp_f32 v172, v172
v_rcp_f32 v173, v173
v_rcp_f32 v174, v174
v_rcp_f32 v175, v175
v_rcp_f32 v176, v176
v_rcp_f32 v177, v177
v_rcp_f32 v178, v178
v_rcp_f32 v179, v179
v_mul_f32 v172, v172, v76
v_mul_f32 v173, v173, v77
v_mul_f32 v174, v174, v78
v_mul_f32 v175, v175, v79
v_mul_f32 v176, v176, v80
v_mul_f32 v177, v177, v81
v_mul_f32 v178, v178, v82
v_mul_f32 v179, v179, v83
ds_write_b128 v26, v[172:175] offset:32768
ds_write_b128 v26, v[176:179] offset:32832
s_waitcnt lgkmcnt(2)
ds_read_b128 v[164:167], v27 offset:2304
ds_read_b128 v[168:171], v27 offset:2320
v_rcp_f32 v180, v180
v_rcp_f32 v181, v181
v_rcp_f32 v182, v182
v_rcp_f32 v183, v183
v_rcp_f32 v184, v184
v_rcp_f32 v185, v185
v_rcp_f32 v186, v186
v_rcp_f32 v187, v187
v_mul_f32 v180, v180, v84
v_mul_f32 v181, v181, v85
v_mul_f32 v182, v182, v86
v_mul_f32 v183, v183, v87
v_mul_f32 v184, v184, v88
v_mul_f32 v185, v185, v89
v_mul_f32 v186, v186, v90
v_mul_f32 v187, v187, v91
ds_write_b128 v26, v[180:183] offset:35072
ds_write_b128 v26, v[184:187] offset:35136
s_waitcnt lgkmcnt(2)
ds_read_b128 v[172:175], v27 offset:32768
ds_read_b128 v[176:179], v27 offset:32784
s_lshl_b32 s73, s76, 6
s_waitcnt lgkmcnt(2)
ds_read_b128 v[180:183], v27 offset:35072
ds_read_b128 v[184:187], v27 offset:35088
s_add_u32 s74, s73, 0
v_add_f32 v156, v156, v108
v_add_f32 v157, v157, v109
v_add_f32 v158, v158, v110
v_add_f32 v159, v159, v111
v_add_f32 v160, v160, v112
v_add_f32 v161, v161, v113
v_add_f32 v162, v162, v114
v_add_f32 v163, v163, v115
v_cvt_pk_bf16_f32 v116, v156, v157
v_cvt_pk_bf16_f32 v117, v158, v159
v_cvt_pk_bf16_f32 v118, v160, v161
v_cvt_pk_bf16_f32 v119, v162, v163
buffer_store_dwordx4 v[116:119], v16, s[52:55], s74 offen
s_add_u32 s74, s73, 18432
v_add_f32 v164, v164, v124
v_add_f32 v165, v165, v125
v_add_f32 v166, v166, v126
v_add_f32 v167, v167, v127
v_add_f32 v168, v168, v128
v_add_f32 v169, v169, v129
v_add_f32 v170, v170, v130
v_add_f32 v171, v171, v131
v_cvt_pk_bf16_f32 v132, v164, v165
v_cvt_pk_bf16_f32 v133, v166, v167
v_cvt_pk_bf16_f32 v134, v168, v169
v_cvt_pk_bf16_f32 v135, v170, v171
buffer_store_dwordx4 v[132:135], v16, s[52:55], s74 offen
s_add_u32 s74, s73, 64
s_waitcnt lgkmcnt(2)
v_add_f32 v172, v172, v140
v_add_f32 v173, v173, v141
v_add_f32 v174, v174, v142
v_add_f32 v175, v175, v143
v_add_f32 v176, v176, v144
v_add_f32 v177, v177, v145
v_add_f32 v178, v178, v146
v_add_f32 v179, v179, v147
v_cvt_pk_bf16_f32 v148, v172, v173
v_cvt_pk_bf16_f32 v149, v174, v175
v_cvt_pk_bf16_f32 v150, v176, v177
v_cvt_pk_bf16_f32 v151, v178, v179
buffer_store_dwordx4 v[148:151], v16, s[52:55], s74 offen
s_add_u32 s74, s73, 18496
s_waitcnt lgkmcnt(0)
v_add_f32 v180, v180, v92
v_add_f32 v181, v181, v93
v_add_f32 v182, v182, v94
v_add_f32 v183, v183, v95
v_add_f32 v184, v184, v96
v_add_f32 v185, v185, v97
v_add_f32 v186, v186, v98
v_add_f32 v187, v187, v99
v_cvt_pk_bf16_f32 v100, v180, v181
v_cvt_pk_bf16_f32 v101, v182, v183
v_cvt_pk_bf16_f32 v102, v184, v185
v_cvt_pk_bf16_f32 v103, v186, v187
buffer_store_dwordx4 v[100:103], v16, s[52:55], s74 offen
s_endpgm
L_ffn4_pre:
s_mul_i32 s69, s61, 3
s_lshr_b32 s73, s62, 2
s_add_u32 s69, s69, s73
v_mov_b32 v26, v8
s_lshr_b32 s73, s60, 1
s_lshl_b32 s74, s69, 3
s_add_u32 s73, s73, s74
s_and_b32 s74, s60, 1
v_lshrrev_b32 v2, 5, v1
v_xor_b32 v3, s74, v2
v_lshlrev_b32 v4, 1, v3
v_sub_u32 v4, 1, v4
s_lshl_b32 s75, s74, 10
v_lshlrev_b32 v7, 11, v2
v_mov_b32 v8, s75
s_cmp_eq_u32 s74, 0
s_cselect_b64 vcc, -1, 0
v_cndmask_b32 v7, v8, v7, vcc
v_mad_i32_i24 v7, v4, s73, v7
v_and_b32 v3, 31, v1
v_lshlrev_b32 v3, 2, v3
v_mul_i32_i24 v4, 2304, v4
s_add_u32 s75, s75, 512
v_mov_b32 v8, s75
s_cmp_eq_u32 s73, 0
s_cselect_b32 vcc_hi, -1, 0
s_mov_b32 vcc_lo, 0
v_cndmask_b32 v8, v7, v8, vcc
s_mov_b32 s79, 1152
v_mad_u32_u24 v8, v8, s79, v3
v_mad_u32_u24 v7, v7, s79, v3
buffer_load_dword v28, v8, s[28:31], 0 offen offset:0
buffer_load_dword v29, v8, s[28:31], 0 offen offset:128
buffer_load_dword v30, v8, s[28:31], 0 offen offset:256
buffer_load_dword v31, v8, s[28:31], 0 offen offset:384
buffer_load_dword v32, v8, s[28:31], 0 offen offset:512
buffer_load_dword v33, v8, s[28:31], 0 offen offset:640
buffer_load_dword v34, v8, s[28:31], 0 offen offset:768
buffer_load_dword v35, v8, s[28:31], 0 offen offset:896
buffer_load_dword v36, v8, s[28:31], 0 offen offset:1024
v_add_u32 v7, v7, v4
buffer_load_dword v37, v7, s[28:31], 0 offen offset:0
buffer_load_dword v38, v7, s[28:31], 0 offen offset:128
buffer_load_dword v39, v7, s[28:31], 0 offen offset:256
buffer_load_dword v40, v7, s[28:31], 0 offen offset:384
buffer_load_dword v41, v7, s[28:31], 0 offen offset:512
buffer_load_dword v42, v7, s[28:31], 0 offen offset:640
buffer_load_dword v43, v7, s[28:31], 0 offen offset:768
buffer_load_dword v44, v7, s[28:31], 0 offen offset:896
buffer_load_dword v45, v7, s[28:31], 0 offen offset:1024
v_add_u32 v7, v7, v4
buffer_load_dword v46, v7, s[28:31], 0 offen offset:0
buffer_load_dword v47, v7, s[28:31], 0 offen offset:128
buffer_load_dword v48, v7, s[28:31], 0 offen offset:256
buffer_load_dword v49, v7, s[28:31], 0 offen offset:384
buffer_load_dword v50, v7, s[28:31], 0 offen offset:512
buffer_load_dword v51, v7, s[28:31], 0 offen offset:640
buffer_load_dword v52, v7, s[28:31], 0 offen offset:768
buffer_load_dword v53, v7, s[28:31], 0 offen offset:896
buffer_load_dword v54, v7, s[28:31], 0 offen offset:1024
v_add_u32 v7, v7, v4
buffer_load_dword v55, v7, s[28:31], 0 offen offset:0
buffer_load_dword v56, v7, s[28:31], 0 offen offset:128
buffer_load_dword v57, v7, s[28:31], 0 offen offset:256
buffer_load_dword v58, v7, s[28:31], 0 offen offset:384
buffer_load_dword v59, v7, s[28:31], 0 offen offset:512
buffer_load_dword v60, v7, s[28:31], 0 offen offset:640
buffer_load_dword v61, v7, s[28:31], 0 offen offset:768
buffer_load_dword v62, v7, s[28:31], 0 offen offset:896
buffer_load_dword v63, v7, s[28:31], 0 offen offset:1024
s_lshl_b32 s73, s69, 2
s_add_u32 s73, s73, s60
s_mul_i32 s73, s73, 27
v_lshrrev_b32 v4, 0, v1
v_add_u32 v2, s73, v4
v_mul_u32_u24 v3, 7282, v2
v_lshrrev_b32 v3, 22, v3
v_mul_u32_u24 v7, 576, v3
v_sub_u32 v2, v2, v7
v_mul_u32_u24 v2, 9216, v2
v_mul_u32_u24 v7, 640, v3
v_add_u32 v2, v2, v7
v_cmp_le_u32 vcc, 6, v3
s_nop 1
v_cndmask_b32 v7, 0, 4, vcc
v_cmp_le_u32 vcc, 9, v3
s_nop 1
v_cndmask_b32 v7, v7, 8, vcc
v_mad_u32_u24 v8, v3, 5, v7
v_and_b32 v3, 0, v1
v_add_u32 v7, v7, v3
v_lshl_add_u32 v2, v7, 7, v2
v_cmp_gt_u32 vcc, 27, v4
v_mov_b32 v7, 2147483392
s_nop 0
v_cndmask_b32 v2, v7, v2, vcc
s_mov_b32 s94, 5308416
s_mov_b32 s95, 0x20000
s_mov_b32 s92, s16
s_mov_b32 s93, s17
buffer_load_dword a252, v2, s[92:95], 0 offen
s_mov_b32 s92, s18
s_mov_b32 s93, s19
buffer_load_dword a252, v2, s[92:95], 0 offen
s_mov_b32 s32, s26
s_mov_b32 s33, s27
s_mov_b32 s34, 36962304
s_mov_b32 s35, 0x20000
s_mov_b32 s70, 0x00003f80
s_mov_b32 s71, 0x3f800000
s_mov_b32 s72, 0x3f803f80
s_lshl_b32 s73, s60, 1
v_lshrrev_b32 v70, 5, v1
v_add_u32 v70, s73, v70
v_mul_u32_u24 v70, 1280, v70
v_and_b32 v69, 31, v1
v_lshl_add_u32 v70, v69, 2, v70
v_add_u32 v70, 30720, v70
v_mov_b32 v71, 0
s_waitcnt vmcnt(29)
v_dot2_f32_bf16 v64, v28, s72, 0
v_dot2_f32_bf16 v65, v28, v28, 0
v_dot2_f32_bf16 v64, v29, s72, v64
v_dot2_f32_bf16 v65, v29, v29, v65
v_dot2_f32_bf16 v64, v30, s72, v64
v_dot2_f32_bf16 v65, v30, v30, v65
v_dot2_f32_bf16 v64, v31, s72, v64
v_dot2_f32_bf16 v65, v31, v31, v65
v_dot2_f32_bf16 v64, v32, s72, v64
v_dot2_f32_bf16 v65, v32, v32, v65
v_dot2_f32_bf16 v64, v33, s72, v64
v_dot2_f32_bf16 v65, v33, v33, v65
v_dot2_f32_bf16 v64, v34, s72, v64
v_dot2_f32_bf16 v65, v34, v34, v65
v_dot2_f32_bf16 v64, v35, s72, v64
v_dot2_f32_bf16 v65, v35, v35, v65
v_dot2_f32_bf16 v64, v36, s72, v64
v_dot2_f32_bf16 v65, v36, v36, v65
ds_write_b32 v70, v71 offset:1152
s_nop 0
v_add_f32_dpp v64, v64, v64 row_ror:8 row_mask:0xf bank_mask:0xf
v_add_f32_dpp v65, v65, v65 row_ror:8 row_mask:0xf bank_mask:0xf
s_nop 0
v_add_f32_dpp v64, v64, v64 row_ror:4 row_mask:0xf bank_mask:0xf
v_add_f32_dpp v65, v65, v65 row_ror:4 row_mask:0xf bank_mask:0xf
s_nop 0
v_add_f32_dpp v64, v64, v64 row_ror:2 row_mask:0xf bank_mask:0xf
v_add_f32_dpp v65, v65, v65 row_ror:2 row_mask:0xf bank_mask:0xf
s_nop 0
v_add_f32_dpp v64, v64, v64 row_ror:1 row_mask:0xf bank_mask:0xf
v_add_f32_dpp v65, v65, v65 row_ror:1 row_mask:0xf bank_mask:0xf
v_mov_b32 v68, v64
v_mov_b32 v69, v65
s_nop 0
v_permlane16_swap_b32 v68, v64
v_permlane16_swap_b32 v69, v65
v_add_f32 v64, v64, v68
v_add_f32 v65, v65, v69
v_mul_f32 v64, 0x3ae38e39, v64
v_cvt_pk_bf16_f32 v66, v64, v64
v_lshlrev_b32 v66, 16, v66
v_mul_f32 v68, v64, v64
v_dot2_f32_bf16 v72, v28, s70, v66 neg_lo:[0,0,1]
v_mov_b32 v67, 0x3ae38e39
v_dot2_f32_bf16 v73, v28, s71, v66 neg_lo:[0,0,1]
v_fma_f32 v65, v65, v67, -v68
v_dot2_f32_bf16 v74, v29, s70, v66 neg_lo:[0,0,1]
v_max_f32 v65, 0, v65
v_dot2_f32_bf16 v75, v29, s71, v66 neg_lo:[0,0,1]
v_cvt_pk_bf16_f32 v65, v65, v65
v_dot2_f32_bf16 v76, v30, s70, v66 neg_lo:[0,0,1]
v_lshlrev_b32 v65, 16, v65
v_dot2_f32_bf16 v77, v30, s71, v66 neg_lo:[0,0,1]
v_add_f32 v65, 0x3727c5ac, v65
v_dot2_f32_bf16 v78, v31, s70, v66 neg_lo:[0,0,1]
v_cvt_pk_bf16_f32 v65, v65, v65
v_dot2_f32_bf16 v79, v31, s71, v66 neg_lo:[0,0,1]
v_lshlrev_b32 v65, 16, v65
v_dot2_f32_bf16 v80, v32, s70, v66 neg_lo:[0,0,1]
v_sqrt_f32 v65, v65
v_dot2_f32_bf16 v81, v32, s71, v66 neg_lo:[0,0,1]
v_cvt_pk_bf16_f32 v65, v65, v65
v_dot2_f32_bf16 v82, v33, s70, v66 neg_lo:[0,0,1]
v_lshlrev_b32 v65, 16, v65
v_dot2_f32_bf16 v83, v33, s71, v66 neg_lo:[0,0,1]
v_rcp_f32 v67, v65
v_dot2_f32_bf16 v84, v34, s70, v66 neg_lo:[0,0,1]
v_dot2_f32_bf16 v85, v34, s71, v66 neg_lo:[0,0,1]
v_dot2_f32_bf16 v86, v35, s70, v66 neg_lo:[0,0,1]
v_dot2_f32_bf16 v87, v35, s71, v66 neg_lo:[0,0,1]
v_dot2_f32_bf16 v88, v36, s70, v66 neg_lo:[0,0,1]
v_dot2_f32_bf16 v89, v36, s71, v66 neg_lo:[0,0,1]
v_cvt_pk_bf16_f32 v28, v72, v73
v_cvt_pk_bf16_f32 v29, v74, v75
v_cvt_pk_bf16_f32 v30, v76, v77
v_cvt_pk_bf16_f32 v31, v78, v79
v_cvt_pk_bf16_f32 v32, v80, v81
v_cvt_pk_bf16_f32 v33, v82, v83
v_cvt_pk_bf16_f32 v34, v84, v85
v_cvt_pk_bf16_f32 v35, v86, v87
v_cvt_pk_bf16_f32 v36, v88, v89
v_lshlrev_b32 v72, 16, v28
v_and_b32 v73, 0xffff0000, v28
v_mul_f32 v72, v72, v67
v_mul_f32 v73, v73, v67
v_cvt_pk_bf16_f32 v28, v72, v73
ds_write_b32 v70, v28 offset:0
v_lshlrev_b32 v74, 16, v29
v_and_b32 v75, 0xffff0000, v29
v_mul_f32 v74, v74, v67
v_mul_f32 v75, v75, v67
v_cvt_pk_bf16_f32 v29, v74, v75
ds_write_b32 v70, v29 offset:128
v_lshlrev_b32 v76, 16, v30
v_and_b32 v77, 0xffff0000, v30
v_mul_f32 v76, v76, v67
v_mul_f32 v77, v77, v67
v_cvt_pk_bf16_f32 v30, v76, v77
ds_write_b32 v70, v30 offset:256
v_lshlrev_b32 v78, 16, v31
v_and_b32 v79, 0xffff0000, v31
v_mul_f32 v78, v78, v67
v_mul_f32 v79, v79, v67
v_cvt_pk_bf16_f32 v31, v78, v79
ds_write_b32 v70, v31 offset:384
v_lshlrev_b32 v80, 16, v32
v_and_b32 v81, 0xffff0000, v32
v_mul_f32 v80, v80, v67
v_mul_f32 v81, v81, v67
v_cvt_pk_bf16_f32 v32, v80, v81
ds_write_b32 v70, v32 offset:512
v_lshlrev_b32 v82, 16, v33
v_and_b32 v83, 0xffff0000, v33
v_mul_f32 v82, v82, v67
v_mul_f32 v83, v83, v67
v_cvt_pk_bf16_f32 v33, v82, v83
ds_write_b32 v70, v33 offset:640
v_lshlrev_b32 v84, 16, v34
v_and_b32 v85, 0xffff0000, v34
v_mul_f32 v84, v84, v67
v_mul_f32 v85, v85, v67
v_cvt_pk_bf16_f32 v34, v84, v85
ds_write_b32 v70, v34 offset:768
v_lshlrev_b32 v86, 16, v35
v_and_b32 v87, 0xffff0000, v35
v_mul_f32 v86, v86, v67
v_mul_f32 v87, v87, v67
v_cvt_pk_bf16_f32 v35, v86, v87
ds_write_b32 v70, v35 offset:896
v_lshlrev_b32 v88, 16, v36
v_and_b32 v89, 0xffff0000, v36
v_mul_f32 v88, v88, v67
v_mul_f32 v89, v89, v67
v_cvt_pk_bf16_f32 v36, v88, v89
ds_write_b32 v70, v36 offset:1024
v_add_u32 v70, 40960, v70
s_waitcnt vmcnt(20)
v_dot2_f32_bf16 v64, v37, s72, 0
v_dot2_f32_bf16 v65, v37, v37, 0
v_dot2_f32_bf16 v64, v38, s72, v64
v_dot2_f32_bf16 v65, v38, v38, v65
v_dot2_f32_bf16 v64, v39, s72, v64
v_dot2_f32_bf16 v65, v39, v39, v65
v_dot2_f32_bf16 v64, v40, s72, v64
v_dot2_f32_bf16 v65, v40, v40, v65
v_dot2_f32_bf16 v64, v41, s72, v64
v_dot2_f32_bf16 v65, v41, v41, v65
v_dot2_f32_bf16 v64, v42, s72, v64
v_dot2_f32_bf16 v65, v42, v42, v65
v_dot2_f32_bf16 v64, v43, s72, v64
v_dot2_f32_bf16 v65, v43, v43, v65
v_dot2_f32_bf16 v64, v44, s72, v64
v_dot2_f32_bf16 v65, v44, v44, v65
v_dot2_f32_bf16 v64, v45, s72, v64
v_dot2_f32_bf16 v65, v45, v45, v65
ds_write_b32 v70, v71 offset:1152
s_nop 0
v_add_f32_dpp v64, v64, v64 row_ror:8 row_mask:0xf bank_mask:0xf
v_add_f32_dpp v65, v65, v65 row_ror:8 row_mask:0xf bank_mask:0xf
s_nop 0
v_add_f32_dpp v64, v64, v64 row_ror:4 row_mask:0xf bank_mask:0xf
v_add_f32_dpp v65, v65, v65 row_ror:4 row_mask:0xf bank_mask:0xf
s_nop 0
v_add_f32_dpp v64, v64, v64 row_ror:2 row_mask:0xf bank_mask:0xf
v_add_f32_dpp v65, v65, v65 row_ror:2 row_mask:0xf bank_mask:0xf
s_nop 0
v_add_f32_dpp v64, v64, v64 row_ror:1 row_mask:0xf bank_mask:0xf
v_add_f32_dpp v65, v65, v65 row_ror:1 row_mask:0xf bank_mask:0xf
v_mov_b32 v68, v64
v_mov_b32 v69, v65
s_nop 0
v_permlane16_swap_b32 v68, v64
v_permlane16_swap_b32 v69, v65
v_add_f32 v64, v64, v68
v_add_f32 v65, v65, v69
v_mul_f32 v64, 0x3ae38e39, v64
v_cvt_pk_bf16_f32 v66, v64, v64
v_lshlrev_b32 v66, 16, v66
v_mul_f32 v68, v64, v64
v_dot2_f32_bf16 v72, v37, s70, v66 neg_lo:[0,0,1]
v_mov_b32 v67, 0x3ae38e39
v_dot2_f32_bf16 v73, v37, s71, v66 neg_lo:[0,0,1]
v_fma_f32 v65, v65, v67, -v68
v_dot2_f32_bf16 v74, v38, s70, v66 neg_lo:[0,0,1]
v_max_f32 v65, 0, v65
v_dot2_f32_bf16 v75, v38, s71, v66 neg_lo:[0,0,1]
v_cvt_pk_bf16_f32 v65, v65, v65
v_dot2_f32_bf16 v76, v39, s70, v66 neg_lo:[0,0,1]
v_lshlrev_b32 v65, 16, v65
v_dot2_f32_bf16 v77, v39, s71, v66 neg_lo:[0,0,1]
v_add_f32 v65, 0x3727c5ac, v65
v_dot2_f32_bf16 v78, v40, s70, v66 neg_lo:[0,0,1]
v_cvt_pk_bf16_f32 v65, v65, v65
v_dot2_f32_bf16 v79, v40, s71, v66 neg_lo:[0,0,1]
v_lshlrev_b32 v65, 16, v65
v_dot2_f32_bf16 v80, v41, s70, v66 neg_lo:[0,0,1]
v_sqrt_f32 v65, v65
v_dot2_f32_bf16 v81, v41, s71, v66 neg_lo:[0,0,1]
v_cvt_pk_bf16_f32 v65, v65, v65
v_dot2_f32_bf16 v82, v42, s70, v66 neg_lo:[0,0,1]
v_lshlrev_b32 v65, 16, v65
v_dot2_f32_bf16 v83, v42, s71, v66 neg_lo:[0,0,1]
v_rcp_f32 v67, v65
v_dot2_f32_bf16 v84, v43, s70, v66 neg_lo:[0,0,1]
v_dot2_f32_bf16 v85, v43, s71, v66 neg_lo:[0,0,1]
v_dot2_f32_bf16 v86, v44, s70, v66 neg_lo:[0,0,1]
v_dot2_f32_bf16 v87, v44, s71, v66 neg_lo:[0,0,1]
v_dot2_f32_bf16 v88, v45, s70, v66 neg_lo:[0,0,1]
v_dot2_f32_bf16 v89, v45, s71, v66 neg_lo:[0,0,1]
v_cvt_pk_bf16_f32 v37, v72, v73
v_cvt_pk_bf16_f32 v38, v74, v75
v_cvt_pk_bf16_f32 v39, v76, v77
v_cvt_pk_bf16_f32 v40, v78, v79
v_cvt_pk_bf16_f32 v41, v80, v81
v_cvt_pk_bf16_f32 v42, v82, v83
v_cvt_pk_bf16_f32 v43, v84, v85
v_cvt_pk_bf16_f32 v44, v86, v87
v_cvt_pk_bf16_f32 v45, v88, v89
v_lshlrev_b32 v72, 16, v37
v_and_b32 v73, 0xffff0000, v37
v_mul_f32 v72, v72, v67
v_mul_f32 v73, v73, v67
v_cvt_pk_bf16_f32 v37, v72, v73
ds_write_b32 v70, v37 offset:0
v_lshlrev_b32 v74, 16, v38
v_and_b32 v75, 0xffff0000, v38
v_mul_f32 v74, v74, v67
v_mul_f32 v75, v75, v67
v_cvt_pk_bf16_f32 v38, v74, v75
ds_write_b32 v70, v38 offset:128
v_lshlrev_b32 v76, 16, v39
v_and_b32 v77, 0xffff0000, v39
v_mul_f32 v76, v76, v67
v_mul_f32 v77, v77, v67
v_cvt_pk_bf16_f32 v39, v76, v77
ds_write_b32 v70, v39 offset:256
v_lshlrev_b32 v78, 16, v40
v_and_b32 v79, 0xffff0000, v40
v_mul_f32 v78, v78, v67
v_mul_f32 v79, v79, v67
v_cvt_pk_bf16_f32 v40, v78, v79
ds_write_b32 v70, v40 offset:384
v_lshlrev_b32 v80, 16, v41
v_and_b32 v81, 0xffff0000, v41
v_mul_f32 v80, v80, v67
v_mul_f32 v81, v81, v67
v_cvt_pk_bf16_f32 v41, v80, v81
ds_write_b32 v70, v41 offset:512
v_lshlrev_b32 v82, 16, v42
v_and_b32 v83, 0xffff0000, v42
v_mul_f32 v82, v82, v67
v_mul_f32 v83, v83, v67
v_cvt_pk_bf16_f32 v42, v82, v83
ds_write_b32 v70, v42 offset:640
v_lshlrev_b32 v84, 16, v43
v_and_b32 v85, 0xffff0000, v43
v_mul_f32 v84, v84, v67
v_mul_f32 v85, v85, v67
v_cvt_pk_bf16_f32 v43, v84, v85
ds_write_b32 v70, v43 offset:768
v_lshlrev_b32 v86, 16, v44
v_and_b32 v87, 0xffff0000, v44
v_mul_f32 v86, v86, v67
v_mul_f32 v87, v87, v67
v_cvt_pk_bf16_f32 v44, v86, v87
ds_write_b32 v70, v44 offset:896
v_lshlrev_b32 v88, 16, v45
v_and_b32 v89, 0xffff0000, v45
v_mul_f32 v88, v88, v67
v_mul_f32 v89, v89, v67
v_cvt_pk_bf16_f32 v45, v88, v89
ds_write_b32 v70, v45 offset:1024
v_add_u32 v70, 40960, v70
s_waitcnt vmcnt(11)
v_dot2_f32_bf16 v64, v46, s72, 0
v_dot2_f32_bf16 v65, v46, v46, 0
v_dot2_f32_bf16 v64, v47, s72, v64
v_dot2_f32_bf16 v65, v47, v47, v65
v_dot2_f32_bf16 v64, v48, s72, v64
v_dot2_f32_bf16 v65, v48, v48, v65
v_dot2_f32_bf16 v64, v49, s72, v64
v_dot2_f32_bf16 v65, v49, v49, v65
v_dot2_f32_bf16 v64, v50, s72, v64
v_dot2_f32_bf16 v65, v50, v50, v65
v_dot2_f32_bf16 v64, v51, s72, v64
v_dot2_f32_bf16 v65, v51, v51, v65
v_dot2_f32_bf16 v64, v52, s72, v64
v_dot2_f32_bf16 v65, v52, v52, v65
v_dot2_f32_bf16 v64, v53, s72, v64
v_dot2_f32_bf16 v65, v53, v53, v65
v_dot2_f32_bf16 v64, v54, s72, v64
v_dot2_f32_bf16 v65, v54, v54, v65
ds_write_b32 v70, v71 offset:1152
s_nop 0
v_add_f32_dpp v64, v64, v64 row_ror:8 row_mask:0xf bank_mask:0xf
v_add_f32_dpp v65, v65, v65 row_ror:8 row_mask:0xf bank_mask:0xf
s_nop 0
v_add_f32_dpp v64, v64, v64 row_ror:4 row_mask:0xf bank_mask:0xf
v_add_f32_dpp v65, v65, v65 row_ror:4 row_mask:0xf bank_mask:0xf
s_nop 0
v_add_f32_dpp v64, v64, v64 row_ror:2 row_mask:0xf bank_mask:0xf
v_add_f32_dpp v65, v65, v65 row_ror:2 row_mask:0xf bank_mask:0xf
s_nop 0
v_add_f32_dpp v64, v64, v64 row_ror:1 row_mask:0xf bank_mask:0xf
v_add_f32_dpp v65, v65, v65 row_ror:1 row_mask:0xf bank_mask:0xf
v_mov_b32 v68, v64
v_mov_b32 v69, v65
s_nop 0
v_permlane16_swap_b32 v68, v64
v_permlane16_swap_b32 v69, v65
v_add_f32 v64, v64, v68
v_add_f32 v65, v65, v69
v_mul_f32 v64, 0x3ae38e39, v64
v_cvt_pk_bf16_f32 v66, v64, v64
v_lshlrev_b32 v66, 16, v66
v_mul_f32 v68, v64, v64
v_dot2_f32_bf16 v72, v46, s70, v66 neg_lo:[0,0,1]
v_mov_b32 v67, 0x3ae38e39
v_dot2_f32_bf16 v73, v46, s71, v66 neg_lo:[0,0,1]
v_fma_f32 v65, v65, v67, -v68
v_dot2_f32_bf16 v74, v47, s70, v66 neg_lo:[0,0,1]
v_max_f32 v65, 0, v65
v_dot2_f32_bf16 v75, v47, s71, v66 neg_lo:[0,0,1]
v_cvt_pk_bf16_f32 v65, v65, v65
v_dot2_f32_bf16 v76, v48, s70, v66 neg_lo:[0,0,1]
v_lshlrev_b32 v65, 16, v65
v_dot2_f32_bf16 v77, v48, s71, v66 neg_lo:[0,0,1]
v_add_f32 v65, 0x3727c5ac, v65
v_dot2_f32_bf16 v78, v49, s70, v66 neg_lo:[0,0,1]
v_cvt_pk_bf16_f32 v65, v65, v65
v_dot2_f32_bf16 v79, v49, s71, v66 neg_lo:[0,0,1]
v_lshlrev_b32 v65, 16, v65
v_dot2_f32_bf16 v80, v50, s70, v66 neg_lo:[0,0,1]
v_sqrt_f32 v65, v65
v_dot2_f32_bf16 v81, v50, s71, v66 neg_lo:[0,0,1]
v_cvt_pk_bf16_f32 v65, v65, v65
v_dot2_f32_bf16 v82, v51, s70, v66 neg_lo:[0,0,1]
v_lshlrev_b32 v65, 16, v65
v_dot2_f32_bf16 v83, v51, s71, v66 neg_lo:[0,0,1]
v_rcp_f32 v67, v65
v_dot2_f32_bf16 v84, v52, s70, v66 neg_lo:[0,0,1]
v_dot2_f32_bf16 v85, v52, s71, v66 neg_lo:[0,0,1]
v_dot2_f32_bf16 v86, v53, s70, v66 neg_lo:[0,0,1]
v_dot2_f32_bf16 v87, v53, s71, v66 neg_lo:[0,0,1]
v_dot2_f32_bf16 v88, v54, s70, v66 neg_lo:[0,0,1]
v_dot2_f32_bf16 v89, v54, s71, v66 neg_lo:[0,0,1]
v_cvt_pk_bf16_f32 v46, v72, v73
v_cvt_pk_bf16_f32 v47, v74, v75
v_cvt_pk_bf16_f32 v48, v76, v77
v_cvt_pk_bf16_f32 v49, v78, v79
v_cvt_pk_bf16_f32 v50, v80, v81
v_cvt_pk_bf16_f32 v51, v82, v83
v_cvt_pk_bf16_f32 v52, v84, v85
v_cvt_pk_bf16_f32 v53, v86, v87
v_cvt_pk_bf16_f32 v54, v88, v89
v_lshlrev_b32 v72, 16, v46
v_and_b32 v73, 0xffff0000, v46
v_mul_f32 v72, v72, v67
v_mul_f32 v73, v73, v67
v_cvt_pk_bf16_f32 v46, v72, v73
ds_write_b32 v70, v46 offset:0
v_lshlrev_b32 v74, 16, v47
v_and_b32 v75, 0xffff0000, v47
v_mul_f32 v74, v74, v67
v_mul_f32 v75, v75, v67
v_cvt_pk_bf16_f32 v47, v74, v75
ds_write_b32 v70, v47 offset:128
v_lshlrev_b32 v76, 16, v48
v_and_b32 v77, 0xffff0000, v48
v_mul_f32 v76, v76, v67
v_mul_f32 v77, v77, v67
v_cvt_pk_bf16_f32 v48, v76, v77
ds_write_b32 v70, v48 offset:256
v_lshlrev_b32 v78, 16, v49
v_and_b32 v79, 0xffff0000, v49
v_mul_f32 v78, v78, v67
v_mul_f32 v79, v79, v67
v_cvt_pk_bf16_f32 v49, v78, v79
ds_write_b32 v70, v49 offset:384
v_lshlrev_b32 v80, 16, v50
v_and_b32 v81, 0xffff0000, v50
v_mul_f32 v80, v80, v67
v_mul_f32 v81, v81, v67
v_cvt_pk_bf16_f32 v50, v80, v81
ds_write_b32 v70, v50 offset:512
v_lshlrev_b32 v82, 16, v51
v_and_b32 v83, 0xffff0000, v51
v_mul_f32 v82, v82, v67
v_mul_f32 v83, v83, v67
v_cvt_pk_bf16_f32 v51, v82, v83
ds_write_b32 v70, v51 offset:640
v_lshlrev_b32 v84, 16, v52
v_and_b32 v85, 0xffff0000, v52
v_mul_f32 v84, v84, v67
v_mul_f32 v85, v85, v67
v_cvt_pk_bf16_f32 v52, v84, v85
ds_write_b32 v70, v52 offset:768
v_lshlrev_b32 v86, 16, v53
v_and_b32 v87, 0xffff0000, v53
v_mul_f32 v86, v86, v67
v_mul_f32 v87, v87, v67
v_cvt_pk_bf16_f32 v53, v86, v87
ds_write_b32 v70, v53 offset:896
v_lshlrev_b32 v88, 16, v54
v_and_b32 v89, 0xffff0000, v54
v_mul_f32 v88, v88, v67
v_mul_f32 v89, v89, v67
v_cvt_pk_bf16_f32 v54, v88, v89
ds_write_b32 v70, v54 offset:1024
v_add_u32 v70, 40960, v70
s_waitcnt vmcnt(2)
v_dot2_f32_bf16 v64, v55, s72, 0
v_dot2_f32_bf16 v65, v55, v55, 0
v_dot2_f32_bf16 v64, v56, s72, v64
v_dot2_f32_bf16 v65, v56, v56, v65
v_dot2_f32_bf16 v64, v57, s72, v64
v_dot2_f32_bf16 v65, v57, v57, v65
v_dot2_f32_bf16 v64, v58, s72, v64
v_dot2_f32_bf16 v65, v58, v58, v65
v_dot2_f32_bf16 v64, v59, s72, v64
v_dot2_f32_bf16 v65, v59, v59, v65
v_dot2_f32_bf16 v64, v60, s72, v64
v_dot2_f32_bf16 v65, v60, v60, v65
v_dot2_f32_bf16 v64, v61, s72, v64
v_dot2_f32_bf16 v65, v61, v61, v65
v_dot2_f32_bf16 v64, v62, s72, v64
v_dot2_f32_bf16 v65, v62, v62, v65
v_dot2_f32_bf16 v64, v63, s72, v64
v_dot2_f32_bf16 v65, v63, v63, v65
ds_write_b32 v70, v71 offset:1152
s_nop 0
v_add_f32_dpp v64, v64, v64 row_ror:8 row_mask:0xf bank_mask:0xf
v_add_f32_dpp v65, v65, v65 row_ror:8 row_mask:0xf bank_mask:0xf
s_nop 0
v_add_f32_dpp v64, v64, v64 row_ror:4 row_mask:0xf bank_mask:0xf
v_add_f32_dpp v65, v65, v65 row_ror:4 row_mask:0xf bank_mask:0xf
s_nop 0
v_add_f32_dpp v64, v64, v64 row_ror:2 row_mask:0xf bank_mask:0xf
v_add_f32_dpp v65, v65, v65 row_ror:2 row_mask:0xf bank_mask:0xf
s_nop 0
v_add_f32_dpp v64, v64, v64 row_ror:1 row_mask:0xf bank_mask:0xf
v_add_f32_dpp v65, v65, v65 row_ror:1 row_mask:0xf bank_mask:0xf
v_mov_b32 v68, v64
v_mov_b32 v69, v65
s_nop 0
v_permlane16_swap_b32 v68, v64
v_permlane16_swap_b32 v69, v65
v_add_f32 v64, v64, v68
v_add_f32 v65, v65, v69
v_mul_f32 v64, 0x3ae38e39, v64
v_cvt_pk_bf16_f32 v66, v64, v64
v_lshlrev_b32 v66, 16, v66
v_mul_f32 v68, v64, v64
v_dot2_f32_bf16 v72, v55, s70, v66 neg_lo:[0,0,1]
v_mov_b32 v67, 0x3ae38e39
v_dot2_f32_bf16 v73, v55, s71, v66 neg_lo:[0,0,1]
v_fma_f32 v65, v65, v67, -v68
v_dot2_f32_bf16 v74, v56, s70, v66 neg_lo:[0,0,1]
v_max_f32 v65, 0, v65
v_dot2_f32_bf16 v75, v56, s71, v66 neg_lo:[0,0,1]
v_cvt_pk_bf16_f32 v65, v65, v65
v_dot2_f32_bf16 v76, v57, s70, v66 neg_lo:[0,0,1]
v_lshlrev_b32 v65, 16, v65
v_dot2_f32_bf16 v77, v57, s71, v66 neg_lo:[0,0,1]
v_add_f32 v65, 0x3727c5ac, v65
v_dot2_f32_bf16 v78, v58, s70, v66 neg_lo:[0,0,1]
v_cvt_pk_bf16_f32 v65, v65, v65
v_dot2_f32_bf16 v79, v58, s71, v66 neg_lo:[0,0,1]
v_lshlrev_b32 v65, 16, v65
v_dot2_f32_bf16 v80, v59, s70, v66 neg_lo:[0,0,1]
v_sqrt_f32 v65, v65
v_dot2_f32_bf16 v81, v59, s71, v66 neg_lo:[0,0,1]
v_cvt_pk_bf16_f32 v65, v65, v65
v_dot2_f32_bf16 v82, v60, s70, v66 neg_lo:[0,0,1]
v_lshlrev_b32 v65, 16, v65
v_dot2_f32_bf16 v83, v60, s71, v66 neg_lo:[0,0,1]
v_rcp_f32 v67, v65
v_dot2_f32_bf16 v84, v61, s70, v66 neg_lo:[0,0,1]
v_dot2_f32_bf16 v85, v61, s71, v66 neg_lo:[0,0,1]
v_dot2_f32_bf16 v86, v62, s70, v66 neg_lo:[0,0,1]
v_dot2_f32_bf16 v87, v62, s71, v66 neg_lo:[0,0,1]
v_dot2_f32_bf16 v88, v63, s70, v66 neg_lo:[0,0,1]
v_dot2_f32_bf16 v89, v63, s71, v66 neg_lo:[0,0,1]
v_cvt_pk_bf16_f32 v55, v72, v73
v_cvt_pk_bf16_f32 v56, v74, v75
v_cvt_pk_bf16_f32 v57, v76, v77
v_cvt_pk_bf16_f32 v58, v78, v79
v_cvt_pk_bf16_f32 v59, v80, v81
v_cvt_pk_bf16_f32 v60, v82, v83
v_cvt_pk_bf16_f32 v61, v84, v85
v_cvt_pk_bf16_f32 v62, v86, v87
v_cvt_pk_bf16_f32 v63, v88, v89
v_lshlrev_b32 v72, 16, v55
v_and_b32 v73, 0xffff0000, v55
v_mul_f32 v72, v72, v67
v_mul_f32 v73, v73, v67
v_cvt_pk_bf16_f32 v55, v72, v73
ds_write_b32 v70, v55 offset:0
v_lshlrev_b32 v74, 16, v56
v_and_b32 v75, 0xffff0000, v56
v_mul_f32 v74, v74, v67
v_mul_f32 v75, v75, v67
v_cvt_pk_bf16_f32 v56, v74, v75
ds_write_b32 v70, v56 offset:128
v_lshlrev_b32 v76, 16, v57
v_and_b32 v77, 0xffff0000, v57
v_mul_f32 v76, v76, v67
v_mul_f32 v77, v77, v67
v_cvt_pk_bf16_f32 v57, v76, v77
ds_write_b32 v70, v57 offset:256
v_lshlrev_b32 v78, 16, v58
v_and_b32 v79, 0xffff0000, v58
v_mul_f32 v78, v78, v67
v_mul_f32 v79, v79, v67
v_cvt_pk_bf16_f32 v58, v78, v79
ds_write_b32 v70, v58 offset:384
v_lshlrev_b32 v80, 16, v59
v_and_b32 v81, 0xffff0000, v59
v_mul_f32 v80, v80, v67
v_mul_f32 v81, v81, v67
v_cvt_pk_bf16_f32 v59, v80, v81
ds_write_b32 v70, v59 offset:512
v_lshlrev_b32 v82, 16, v60
v_and_b32 v83, 0xffff0000, v60
v_mul_f32 v82, v82, v67
v_mul_f32 v83, v83, v67
v_cvt_pk_bf16_f32 v60, v82, v83
ds_write_b32 v70, v60 offset:640
v_lshlrev_b32 v84, 16, v61
v_and_b32 v85, 0xffff0000, v61
v_mul_f32 v84, v84, v67
v_mul_f32 v85, v85, v67
v_cvt_pk_bf16_f32 v61, v84, v85
ds_write_b32 v70, v61 offset:768
v_lshlrev_b32 v86, 16, v62
v_and_b32 v87, 0xffff0000, v62
v_mul_f32 v86, v86, v67
v_mul_f32 v87, v87, v67
v_cvt_pk_bf16_f32 v62, v86, v87
ds_write_b32 v70, v62 offset:896
v_lshlrev_b32 v88, 16, v63
v_and_b32 v89, 0xffff0000, v63
v_mul_f32 v88, v88, v67
v_mul_f32 v89, v89, v67
v_cvt_pk_bf16_f32 v63, v88, v89
ds_write_b32 v70, v63 offset:1024
s_waitcnt lgkmcnt(0)
s_barrier
v_mov_b32 v28, v0
s_mov_b32 s80, 3
s_cmp_eq_u32 s69, 0
s_cselect_b32 s81, 80, 0
s_add_u32 s81, s81, 640
s_lshl_b32 s73, s69, 3
s_mov_b32 s76, 331776
L_fold_45:
v_mul_u32_u24 v30, 52429, v28
v_lshrrev_b32 v30, 22, v30
v_mul_u32_u24 v29, 80, v30
v_sub_u32 v29, v28, v29
v_cmp_le_u32 vcc, 8, v30
s_nop 1
v_cndmask_b32 v31, v30, 0, vcc
v_lshrrev_b32 v32, 1, v31
v_mul_u32_u24 v32, 40960, v32
v_and_b32 v31, 1, v31
v_mul_u32_u24 v31, 5120, v31
v_add3_u32 v32, v32, v31, s76
v_subrev_u32 v32, 299776, v32
v_subrev_u32 v31, 1280, v32
v_cndmask_b32 v31, v31, v32, vcc
v_lshlrev_b32 v37, 3, v29
v_sub_u32 v33, v31, v37
v_sub_u32 v34, v32, v37
v_add_u32 v31, v31, v37
v_add_u32 v32, v32, v37
ds_read_b64 v[44:45], v31 offset:0
ds_read_b64 v[52:53], v33 offset:1144
ds_read_b32 v54, v33 offset:1152
ds_read_b64 v[46:47], v32 offset:0
ds_read_b64 v[56:57], v34 offset:1144
ds_read_b32 v58, v34 offset:1152
ds_read_b64 v[48:49], v31 offset:2560
ds_read_b64 v[60:61], v33 offset:3704
ds_read_b32 v62, v33 offset:3712
ds_read_b64 v[50:51], v32 offset:2560
ds_read_b64 v[64:65], v34 offset:3704
ds_read_b32 v66, v34 offset:3712
v_add_u32 v39, s73, v30
v_cmp_eq_u32 s[74:75], 0, v39
v_mov_b32 v35, 512
s_or_b64 s[74:75], s[74:75], vcc
v_cndmask_b32 v39, v39, v35, vcc
v_cndmask_b32 v35, 1.0, 0, s[74:75]
v_mul_u32_u24 v39, 640, v39
v_add_u32 v39, v39, v37
v_add_u32 v39, 65536, v39
v_add_u32 v40, 663552, v39
v_add_u32 v41, 995328, v39
v_cndmask_b32 v36, v40, v41, vcc
v_cndmask_b32 v41, v41, v40, vcc
v_mov_b32 v40, v36
v_cmp_le_u32 vcc, s81, v28
v_mov_b32 v36, 2147483392
s_nop 0
v_cndmask_b32 v39, v39, v36, vcc
v_cndmask_b32 v40, v40, v36, vcc
v_cndmask_b32 v41, v41, v36, vcc
v_cmp_eq_u32 vcc, 72, v29
v_mov_b32 v38, 0xffff
v_add_u32 v28, 256, v28
v_cndmask_b32 v36, 1.0, 0.5, vcc
v_cndmask_b32 v37, 0, v38, vcc
v_cmp_gt_u32 vcc, 72, v29
s_waitcnt lgkmcnt(0)
s_nop 0
v_cndmask_b32 v37, v37, -1, vcc
v_cndmask_b32 v38, 0, -1, vcc
v_lshlrev_b32 v76, 16, v54
v_lshlrev_b32 v77, 16, v58
v_lshlrev_b32 v78, 16, v62
v_lshlrev_b32 v79, 16, v66
v_dot2_f32_bf16 v69, v46, s70, v77
v_dot2_f32_bf16 v73, v46, s70, v77 neg_lo:[0,0,1]
v_dot2_f32_bf16 v71, v50, s70, v79
v_dot2_f32_bf16 v75, v50, s70, v79 neg_lo:[0,0,1]
v_dot2_f32_bf16 v68, v44, s70, v76
v_dot2_f32_bf16 v72, v44, s70, v76 neg_lo:[0,0,1]
v_dot2_f32_bf16 v70, v48, s70, v78
v_dot2_f32_bf16 v74, v48, s70, v78 neg_lo:[0,0,1]
v_fma_f32 v68, v35, v69, v68
v_fma_f32 v72, -v35, v73, v72
v_fma_f32 v70, v35, v71, v70
v_fma_f32 v74, -v35, v75, v74
v_add_f32 v80, v68, v70
v_sub_f32 v82, v68, v70
v_sub_f32 v84, v72, v74
v_add_f32 v86, v72, v74
v_mul_f32 v80, v80, v36
v_mul_f32 v82, v82, v36
v_and_b32 v76, 0xffff0000, v53
v_and_b32 v77, 0xffff0000, v57
v_and_b32 v78, 0xffff0000, v61
v_and_b32 v79, 0xffff0000, v65
v_dot2_f32_bf16 v69, v46, s71, v77
v_dot2_f32_bf16 v73, v46, s71, v77 neg_lo:[0,0,1]
v_dot2_f32_bf16 v71, v50, s71, v79
v_dot2_f32_bf16 v75, v50, s71, v79 neg_lo:[0,0,1]
v_dot2_f32_bf16 v68, v44, s71, v76
v_dot2_f32_bf16 v72, v44, s71, v76 neg_lo:[0,0,1]
v_dot2_f32_bf16 v70, v48, s71, v78
v_dot2_f32_bf16 v74, v48, s71, v78 neg_lo:[0,0,1]
v_fma_f32 v68, v35, v69, v68
v_fma_f32 v72, -v35, v73, v72
v_fma_f32 v70, v35, v71, v70
v_fma_f32 v74, -v35, v75, v74
v_add_f32 v81, v68, v70
v_sub_f32 v83, v68, v70
v_sub_f32 v85, v72, v74
v_add_f32 v87, v72, v74
v_cvt_pk_bf16_f32 v88, v80, v81
v_and_b32 v88, v88, v37
v_cvt_pk_bf16_f32 v90, v82, v83
v_and_b32 v90, v90, v37
v_cvt_pk_bf16_f32 v92, v84, v85
v_and_b32 v92, v92, v37
v_cvt_pk_bf16_f32 v94, v86, v87
v_and_b32 v94, v94, v37
v_lshlrev_b32 v76, 16, v53
v_lshlrev_b32 v77, 16, v57
v_lshlrev_b32 v78, 16, v61
v_lshlrev_b32 v79, 16, v65
v_dot2_f32_bf16 v69, v47, s70, v77
v_dot2_f32_bf16 v73, v47, s70, v77 neg_lo:[0,0,1]
v_dot2_f32_bf16 v71, v51, s70, v79
v_dot2_f32_bf16 v75, v51, s70, v79 neg_lo:[0,0,1]
v_dot2_f32_bf16 v68, v45, s70, v76
v_dot2_f32_bf16 v72, v45, s70, v76 neg_lo:[0,0,1]
v_dot2_f32_bf16 v70, v49, s70, v78
v_dot2_f32_bf16 v74, v49, s70, v78 neg_lo:[0,0,1]
v_fma_f32 v68, v35, v69, v68
v_fma_f32 v72, -v35, v73, v72
v_fma_f32 v70, v35, v71, v70
v_fma_f32 v74, -v35, v75, v74
v_add_f32 v80, v68, v70
v_sub_f32 v82, v68, v70
v_sub_f32 v84, v72, v74
v_add_f32 v86, v72, v74
v_and_b32 v76, 0xffff0000, v52
v_and_b32 v77, 0xffff0000, v56
v_and_b32 v78, 0xffff0000, v60
v_and_b32 v79, 0xffff0000, v64
v_dot2_f32_bf16 v69, v47, s71, v77
v_dot2_f32_bf16 v73, v47, s71, v77 neg_lo:[0,0,1]
v_dot2_f32_bf16 v71, v51, s71, v79
v_dot2_f32_bf16 v75, v51, s71, v79 neg_lo:[0,0,1]
v_dot2_f32_bf16 v68, v45, s71, v76
v_dot2_f32_bf16 v72, v45, s71, v76 neg_lo:[0,0,1]
v_dot2_f32_bf16 v70, v49, s71, v78
v_dot2_f32_bf16 v74, v49, s71, v78 neg_lo:[0,0,1]
v_fma_f32 v68, v35, v69, v68
v_fma_f32 v72, -v35, v73, v72
v_fma_f32 v70, v35, v71, v70
v_fma_f32 v74, -v35, v75, v74
v_add_f32 v81, v68, v70
v_sub_f32 v83, v68, v70
v_sub_f32 v85, v72, v74
v_add_f32 v87, v72, v74
v_cvt_pk_bf16_f32 v89, v80, v81
v_and_b32 v89, v89, v38
v_cvt_pk_bf16_f32 v91, v82, v83
v_and_b32 v91, v91, v38
v_cvt_pk_bf16_f32 v93, v84, v85
v_and_b32 v93, v93, v38
v_cvt_pk_bf16_f32 v95, v86, v87
v_and_b32 v95, v95, v38
buffer_store_dwordx2 v[88:89], v39, s[32:35], 0 offen sc1
buffer_store_dwordx2 v[90:91], v39, s[32:35], s76 offen sc1
buffer_store_dwordx2 v[92:93], v40, s[32:35], 0 offen sc1
buffer_store_dwordx2 v[94:95], v41, s[32:35], 0 offen sc1
s_sub_u32 s80, s80, 1
s_cmp_lg_u32 s80, 0
s_cbranch_scc1 L_fold_45
s_mul_i32 s68, s68, 2654435761
s_add_u32 s68, s68, 2135587861
s_lshl_b32 s73, s69, 2
s_add_u32 s73, s73, s60
s_lshl_b32 s73, s73, 2
s_add_u32 s73, s73, 4096
v_mov_b32 v21, 2147483392
v_mov_b32 v2, s73
v_cmp_eq_u32 vcc, 0, v1
v_mov_b32 v23, s68
s_nop 0
v_cndmask_b32 v21, v21, v2, vcc
s_barrier
v_mov_b32 v8, v26
s_branch L_ffn
L_aux:
s_add_u32 s69, s61, 48
v_mov_b32 v26, v5
v_mov_b32 v27, v6
s_lshr_b32 s73, s60, 1
s_lshl_b32 s74, s69, 3
s_add_u32 s73, s73, s74
s_and_b32 s74, s60, 1
v_lshrrev_b32 v2, 5, v1
v_xor_b32 v3, s74, v2
v_lshlrev_b32 v4, 1, v3
v_sub_u32 v4, 1, v4
s_lshl_b32 s75, s74, 10
v_lshlrev_b32 v7, 11, v2
v_mov_b32 v8, s75
s_cmp_eq_u32 s74, 0
s_cselect_b64 vcc, -1, 0
v_cndmask_b32 v7, v8, v7, vcc
v_mad_i32_i24 v7, v4, s73, v7
v_and_b32 v3, 31, v1
v_lshlrev_b32 v3, 2, v3
v_mul_i32_i24 v4, 2304, v4
s_add_u32 s75, s75, 512
v_mov_b32 v8, s75
s_cmp_eq_u32 s73, 0
s_cselect_b32 vcc_hi, -1, 0
s_mov_b32 vcc_lo, 0
v_cndmask_b32 v8, v7, v8, vcc
s_mov_b32 s79, 1152
v_mad_u32_u24 v8, v8, s79, v3
v_mad_u32_u24 v7, v7, s79, v3
buffer_load_dword v28, v8, s[28:31], 0 offen offset:0
buffer_load_dword v29, v8, s[28:31], 0 offen offset:128
buffer_load_dword v30, v8, s[28:31], 0 offen offset:256
buffer_load_dword v31, v8, s[28:31], 0 offen offset:384
buffer_load_dword v32, v8, s[28:31], 0 offen offset:512
buffer_load_dword v33, v8, s[28:31], 0 offen offset:640
buffer_load_dword v34, v8, s[28:31], 0 offen offset:768
buffer_load_dword v35, v8, s[28:31], 0 offen offset:896
buffer_load_dword v36, v8, s[28:31], 0 offen offset:1024
v_add_u32 v7, v7, v4
buffer_load_dword v37, v7, s[28:31], 0 offen offset:0
buffer_load_dword v38, v7, s[28:31], 0 offen offset:128
buffer_load_dword v39, v7, s[28:31], 0 offen offset:256
buffer_load_dword v40, v7, s[28:31], 0 offen offset:384
buffer_load_dword v41, v7, s[28:31], 0 offen offset:512
buffer_load_dword v42, v7, s[28:31], 0 offen offset:640
buffer_load_dword v43, v7, s[28:31], 0 offen offset:768
buffer_load_dword v44, v7, s[28:31], 0 offen offset:896
buffer_load_dword v45, v7, s[28:31], 0 offen offset:1024
v_add_u32 v7, v7, v4
buffer_load_dword v46, v7, s[28:31], 0 offen offset:0
buffer_load_dword v47, v7, s[28:31], 0 offen offset:128
buffer_load_dword v48, v7, s[28:31], 0 offen offset:256
buffer_load_dword v49, v7, s[28:31], 0 offen offset:384
buffer_load_dword v50, v7, s[28:31], 0 offen offset:512
buffer_load_dword v51, v7, s[28:31], 0 offen offset:640
buffer_load_dword v52, v7, s[28:31], 0 offen offset:768
buffer_load_dword v53, v7, s[28:31], 0 offen offset:896
buffer_load_dword v54, v7, s[28:31], 0 offen offset:1024
v_add_u32 v7, v7, v4
buffer_load_dword v55, v7, s[28:31], 0 offen offset:0
buffer_load_dword v56, v7, s[28:31], 0 offen offset:128
buffer_load_dword v57, v7, s[28:31], 0 offen offset:256
buffer_load_dword v58, v7, s[28:31], 0 offen offset:384
buffer_load_dword v59, v7, s[28:31], 0 offen offset:512
buffer_load_dword v60, v7, s[28:31], 0 offen offset:640
buffer_load_dword v61, v7, s[28:31], 0 offen offset:768
buffer_load_dword v62, v7, s[28:31], 0 offen offset:896
buffer_load_dword v63, v7, s[28:31], 0 offen offset:1024
s_lshl_b32 s73, s69, 2
s_add_u32 s73, s73, s60
s_mul_i32 s73, s73, 27
v_lshrrev_b32 v4, 0, v1
v_add_u32 v2, s73, v4
v_mul_u32_u24 v3, 7282, v2
v_lshrrev_b32 v3, 22, v3
v_mul_u32_u24 v7, 576, v3
v_sub_u32 v2, v2, v7
v_mul_u32_u24 v2, 9216, v2
v_mul_u32_u24 v7, 640, v3
v_add_u32 v2, v2, v7
v_cmp_le_u32 vcc, 6, v3
s_nop 1
v_cndmask_b32 v7, 0, 4, vcc
v_cmp_le_u32 vcc, 9, v3
s_nop 1
v_cndmask_b32 v7, v7, 8, vcc
v_mad_u32_u24 v8, v3, 5, v7
v_and_b32 v3, 0, v1
v_add_u32 v7, v7, v3
v_lshl_add_u32 v2, v7, 7, v2
v_cmp_gt_u32 vcc, 27, v4
v_mov_b32 v7, 2147483392
s_nop 0
v_cndmask_b32 v2, v7, v2, vcc
s_mov_b32 s94, 5308416
s_mov_b32 s95, 0x20000
s_mov_b32 s92, s16
s_mov_b32 s93, s17
buffer_load_dword a252, v2, s[92:95], 0 offen
s_mov_b32 s92, s18
s_mov_b32 s93, s19
buffer_load_dword a252, v2, s[92:95], 0 offen
s_and_b32 s24, s61, 3
s_lshr_b32 s25, s61, 1
s_andn2_b32 s25, s25, 1
s_lshr_b32 s25, 0x18, s25
s_and_b32 s25, s25, 3
s_cmp_ge_u32 s24, 2
s_cselect_b32 s48, s8, s6
s_cselect_b32 s49, s9, s7
s_cselect_b32 s44, s12, s10
s_cselect_b32 s45, s13, s11
s_mov_b32 s50, 8388608
s_mov_b32 s51, 0x20000
s_mov_b32 s46, 663552
s_mov_b32 s47, 0x20000
s_mul_i32 s25, s25, 192
s_mul_i32 s73, s60, 48
s_add_u32 s25, s25, s73
s_lshl_b32 s65, s25, 1
s_and_b32 s73, s24, 1
s_add_u32 s65, s65, s73
v_lshlrev_b32 v26, 13, v26
v_add_u32 v26, v26, v27
s_lshl_b32 s65, s65, 12
s_cmp_gt_u32 s25, 512
s_cselect_b32 s65, 2130706432, s65
v_lshlrev_b32 v20, 4, v1
s_mov_b32 s32, s26
s_mov_b32 s33, s27
s_mov_b32 s34, 36962304
s_mov_b32 s35, 0x20000
s_mov_b32 s52, s22
s_mov_b32 s53, s23
s_mov_b32 s54, 2359296
s_mov_b32 s55, 0x20000
s_mov_b32 s70, 0x00003f80
s_mov_b32 s71, 0x3f800000
s_mov_b32 s72, 0x3f803f80
v_lshlrev_b32 v20, 4, v1
v_and_b32 v2, 15, v1
v_lshrrev_b32 v3, 4, v1
v_bfe_u32 v4, v1, 3, 1
v_lshlrev_b32 v7, 1, v4
v_xor_b32 v7, v7, v3
v_lshlrev_b32 v7, 4, v7
v_lshl_add_u32 v7, v2, 6, v7
v_add_u32 v9, s64, v7
v_mul_u32_u24 v7, 40960, v3
v_bfe_u32 v5, v1, 2, 2
v_lshl_add_u32 v7, v5, 7, v7
v_and_b32 v6, 3, v1
v_lshl_add_u32 v7, v6, 3, v7
v_cmp_eq_u32 vcc, v5, v3
v_and_b32 v3, 1, v3
v_lshl_or_b32 v4, v3, 1, v4
v_xor_b32 v3, 0, v4
v_lshl_add_u32 v11, v3, 5, v7
v_xor_b32 v3, 1, v4
v_lshl_add_u32 v12, v3, 5, v7
v_xor_b32 v3, 2, v4
v_lshl_add_u32 v13, v3, 5, v7
v_xor_b32 v3, 3, v4
v_lshl_add_u32 v14, v3, 5, v7
v_and_b32 v3, 1, v6
v_lshlrev_b32 v3, 4, v3
v_lshlrev_b32 v3, v3, s70
v_cndmask_b32 v3, 0, v3, vcc
v_cmp_gt_u32 vcc, 2, v6
v_mov_b32 v244, 0
v_mov_b32 v245, 0
v_cndmask_b32 v246, 0, v3, vcc
v_cndmask_b32 v247, v3, 0, vcc
v_mov_b32 v248, 0
v_mov_b32 v249, 0
v_lshrrev_b32 v2, 3, v1
v_bfe_u32 v3, v1, 4, 1
s_and_b32 s80, s60, 1
s_lshl_b32 s80, s80, 1
v_or_b32 v3, s80, v3
v_lshlrev_b32 v3, 1, v3
v_and_b32 v4, 7, v1
v_xor_b32 v3, v3, v4
v_lshlrev_b32 v3, 4, v3
s_lshl_b32 s80, s60, 3
v_add_u32 v4, s80, v2
s_lshl_b32 s80, s60, 2
v_lshrrev_b32 v7, 2, v2
v_lshlrev_b32 v7, 4, v7
v_and_b32 v5, 3, v2
v_add3_u32 v7, v7, v5, s80
v_mul_u32_u24 v7, 1152, v7
v_add_u32 v15, v7, v3
s_lshl_b32 s15, s61, 15
s_add_u32 s15, s15, 3145728
v_mul_u32_u24 v4, 640, v4
v_add_u32 v10, v4, v3
s_mul_i32 s73, s24, 331776
s_add_u32 s73, s73, 65536
s_add_u32 s36, s26, s73
s_addc_u32 s37, s27, 0
s_mov_b32 s38, 328320
s_mov_b32 s39, 0x20000
s_add_u32 s40, s36, 19456
s_addc_u32 s41, s37, 0
s_mov_b32 s42, 308864
s_mov_b32 s43, 0x20000
v_lshlrev_b32 v25, 2, v1
buffer_load_dword v25, v25, s[32:35], 0 offen
v_and_b32 v24, 15, v1
v_mul_u32_u24 v24, 1040, v24
v_lshrrev_b32 v2, 4, v1
v_lshl_add_u32 v24, v2, 4, v24
v_add_u32 v24, s64, v24
v_and_b32 v27, 15, v1
v_lshlrev_b32 v27, 13, v27
v_lshrrev_b32 v2, 4, v1
v_lshl_add_u32 v27, v2, 4, v27
s_lshl_b32 s73, s60, 1
v_lshrrev_b32 v70, 5, v1
v_add_u32 v70, s73, v70
v_mul_u32_u24 v70, 1280, v70
v_and_b32 v69, 31, v1
v_lshl_add_u32 v70, v69, 2, v70
v_add_u32 v70, 30720, v70
v_mov_b32 v71, 0
s_waitcnt vmcnt(30)
v_dot2_f32_bf16 v64, v28, s72, 0
v_dot2_f32_bf16 v65, v28, v28, 0
v_dot2_f32_bf16 v64, v29, s72, v64
v_dot2_f32_bf16 v65, v29, v29, v65
v_dot2_f32_bf16 v64, v30, s72, v64
v_dot2_f32_bf16 v65, v30, v30, v65
v_dot2_f32_bf16 v64, v31, s72, v64
v_dot2_f32_bf16 v65, v31, v31, v65
v_dot2_f32_bf16 v64, v32, s72, v64
v_dot2_f32_bf16 v65, v32, v32, v65
v_dot2_f32_bf16 v64, v33, s72, v64
v_dot2_f32_bf16 v65, v33, v33, v65
v_dot2_f32_bf16 v64, v34, s72, v64
v_dot2_f32_bf16 v65, v34, v34, v65
v_dot2_f32_bf16 v64, v35, s72, v64
v_dot2_f32_bf16 v65, v35, v35, v65
v_dot2_f32_bf16 v64, v36, s72, v64
v_dot2_f32_bf16 v65, v36, v36, v65
ds_write_b32 v70, v71 offset:1152
s_nop 0
v_add_f32_dpp v64, v64, v64 row_ror:8 row_mask:0xf bank_mask:0xf
v_add_f32_dpp v65, v65, v65 row_ror:8 row_mask:0xf bank_mask:0xf
s_nop 0
v_add_f32_dpp v64, v64, v64 row_ror:4 row_mask:0xf bank_mask:0xf
v_add_f32_dpp v65, v65, v65 row_ror:4 row_mask:0xf bank_mask:0xf
s_nop 0
v_add_f32_dpp v64, v64, v64 row_ror:2 row_mask:0xf bank_mask:0xf
v_add_f32_dpp v65, v65, v65 row_ror:2 row_mask:0xf bank_mask:0xf
s_nop 0
v_add_f32_dpp v64, v64, v64 row_ror:1 row_mask:0xf bank_mask:0xf
v_add_f32_dpp v65, v65, v65 row_ror:1 row_mask:0xf bank_mask:0xf
v_mov_b32 v68, v64
v_mov_b32 v69, v65
s_nop 0
v_permlane16_swap_b32 v68, v64
v_permlane16_swap_b32 v69, v65
v_add_f32 v64, v64, v68
v_add_f32 v65, v65, v69
v_mul_f32 v64, 0x3ae38e39, v64
v_cvt_pk_bf16_f32 v66, v64, v64
v_lshlrev_b32 v66, 16, v66
v_mul_f32 v68, v64, v64
v_dot2_f32_bf16 v72, v28, s70, v66 neg_lo:[0,0,1]
v_mov_b32 v67, 0x3ae38e39
v_dot2_f32_bf16 v73, v28, s71, v66 neg_lo:[0,0,1]
v_fma_f32 v65, v65, v67, -v68
v_dot2_f32_bf16 v74, v29, s70, v66 neg_lo:[0,0,1]
v_max_f32 v65, 0, v65
v_dot2_f32_bf16 v75, v29, s71, v66 neg_lo:[0,0,1]
v_cvt_pk_bf16_f32 v65, v65, v65
v_dot2_f32_bf16 v76, v30, s70, v66 neg_lo:[0,0,1]
v_lshlrev_b32 v65, 16, v65
v_dot2_f32_bf16 v77, v30, s71, v66 neg_lo:[0,0,1]
v_add_f32 v65, 0x3727c5ac, v65
v_dot2_f32_bf16 v78, v31, s70, v66 neg_lo:[0,0,1]
v_cvt_pk_bf16_f32 v65, v65, v65
v_dot2_f32_bf16 v79, v31, s71, v66 neg_lo:[0,0,1]
v_lshlrev_b32 v65, 16, v65
v_dot2_f32_bf16 v80, v32, s70, v66 neg_lo:[0,0,1]
v_sqrt_f32 v65, v65
v_dot2_f32_bf16 v81, v32, s71, v66 neg_lo:[0,0,1]
v_cvt_pk_bf16_f32 v65, v65, v65
v_dot2_f32_bf16 v82, v33, s70, v66 neg_lo:[0,0,1]
v_lshlrev_b32 v65, 16, v65
v_dot2_f32_bf16 v83, v33, s71, v66 neg_lo:[0,0,1]
v_rcp_f32 v67, v65
v_dot2_f32_bf16 v84, v34, s70, v66 neg_lo:[0,0,1]
v_dot2_f32_bf16 v85, v34, s71, v66 neg_lo:[0,0,1]
v_dot2_f32_bf16 v86, v35, s70, v66 neg_lo:[0,0,1]
v_dot2_f32_bf16 v87, v35, s71, v66 neg_lo:[0,0,1]
v_dot2_f32_bf16 v88, v36, s70, v66 neg_lo:[0,0,1]
v_dot2_f32_bf16 v89, v36, s71, v66 neg_lo:[0,0,1]
v_cvt_pk_bf16_f32 v28, v72, v73
v_cvt_pk_bf16_f32 v29, v74, v75
v_cvt_pk_bf16_f32 v30, v76, v77
v_cvt_pk_bf16_f32 v31, v78, v79
v_cvt_pk_bf16_f32 v32, v80, v81
v_cvt_pk_bf16_f32 v33, v82, v83
v_cvt_pk_bf16_f32 v34, v84, v85
v_cvt_pk_bf16_f32 v35, v86, v87
v_cvt_pk_bf16_f32 v36, v88, v89
v_lshlrev_b32 v72, 16, v28
v_and_b32 v73, 0xffff0000, v28
v_mul_f32 v72, v72, v67
v_mul_f32 v73, v73, v67
v_cvt_pk_bf16_f32 v28, v72, v73
ds_write_b32 v70, v28 offset:0
v_lshlrev_b32 v74, 16, v29
v_and_b32 v75, 0xffff0000, v29
v_mul_f32 v74, v74, v67
v_mul_f32 v75, v75, v67
v_cvt_pk_bf16_f32 v29, v74, v75
ds_write_b32 v70, v29 offset:128
v_lshlrev_b32 v76, 16, v30
v_and_b32 v77, 0xffff0000, v30
v_mul_f32 v76, v76, v67
v_mul_f32 v77, v77, v67
v_cvt_pk_bf16_f32 v30, v76, v77
ds_write_b32 v70, v30 offset:256
v_lshlrev_b32 v78, 16, v31
v_and_b32 v79, 0xffff0000, v31
v_mul_f32 v78, v78, v67
v_mul_f32 v79, v79, v67
v_cvt_pk_bf16_f32 v31, v78, v79
ds_write_b32 v70, v31 offset:384
v_lshlrev_b32 v80, 16, v32
v_and_b32 v81, 0xffff0000, v32
v_mul_f32 v80, v80, v67
v_mul_f32 v81, v81, v67
v_cvt_pk_bf16_f32 v32, v80, v81
ds_write_b32 v70, v32 offset:512
v_lshlrev_b32 v82, 16, v33
v_and_b32 v83, 0xffff0000, v33
v_mul_f32 v82, v82, v67
v_mul_f32 v83, v83, v67
v_cvt_pk_bf16_f32 v33, v82, v83
ds_write_b32 v70, v33 offset:640
v_lshlrev_b32 v84, 16, v34
v_and_b32 v85, 0xffff0000, v34
v_mul_f32 v84, v84, v67
v_mul_f32 v85, v85, v67
v_cvt_pk_bf16_f32 v34, v84, v85
ds_write_b32 v70, v34 offset:768
v_lshlrev_b32 v86, 16, v35
v_and_b32 v87, 0xffff0000, v35
v_mul_f32 v86, v86, v67
v_mul_f32 v87, v87, v67
v_cvt_pk_bf16_f32 v35, v86, v87
ds_write_b32 v70, v35 offset:896
v_lshlrev_b32 v88, 16, v36
v_and_b32 v89, 0xffff0000, v36
v_mul_f32 v88, v88, v67
v_mul_f32 v89, v89, v67
v_cvt_pk_bf16_f32 v36, v88, v89
ds_write_b32 v70, v36 offset:1024
v_add_u32 v70, 40960, v70
s_add_u32 m0, s64, 0
s_add_u32 s67, s65, 0
buffer_load_dwordx4 v20, s[48:51], s67 offen nt lds
s_add_u32 m0, s64, 1040
s_add_u32 s67, s65, 8192
buffer_load_dwordx4 v20, s[48:51], s67 offen nt lds
s_add_u32 m0, s64, 2080
s_add_u32 s67, s65, 16384
buffer_load_dwordx4 v20, s[48:51], s67 offen nt lds
s_add_u32 m0, s64, 3120
s_add_u32 s67, s65, 24576
buffer_load_dwordx4 v20, s[48:51], s67 offen nt lds
s_add_u32 m0, s64, 4160
s_add_u32 s67, s65, 32768
buffer_load_dwordx4 v20, s[48:51], s67 offen nt lds
s_add_u32 m0, s64, 5200
s_add_u32 s67, s65, 40960
buffer_load_dwordx4 v20, s[48:51], s67 offen nt lds
s_add_u32 m0, s64, 6240
s_add_u32 s67, s65, 49152
buffer_load_dwordx4 v20, s[48:51], s67 offen nt lds
s_waitcnt vmcnt(28)
v_dot2_f32_bf16 v64, v37, s72, 0
v_dot2_f32_bf16 v65, v37, v37, 0
v_dot2_f32_bf16 v64, v38, s72, v64
v_dot2_f32_bf16 v65, v38, v38, v65
v_dot2_f32_bf16 v64, v39, s72, v64
v_dot2_f32_bf16 v65, v39, v39, v65
v_dot2_f32_bf16 v64, v40, s72, v64
v_dot2_f32_bf16 v65, v40, v40, v65
v_dot2_f32_bf16 v64, v41, s72, v64
v_dot2_f32_bf16 v65, v41, v41, v65
v_dot2_f32_bf16 v64, v42, s72, v64
v_dot2_f32_bf16 v65, v42, v42, v65
v_dot2_f32_bf16 v64, v43, s72, v64
v_dot2_f32_bf16 v65, v43, v43, v65
v_dot2_f32_bf16 v64, v44, s72, v64
v_dot2_f32_bf16 v65, v44, v44, v65
v_dot2_f32_bf16 v64, v45, s72, v64
v_dot2_f32_bf16 v65, v45, v45, v65
ds_write_b32 v70, v71 offset:1152
s_nop 0
v_add_f32_dpp v64, v64, v64 row_ror:8 row_mask:0xf bank_mask:0xf
v_add_f32_dpp v65, v65, v65 row_ror:8 row_mask:0xf bank_mask:0xf
s_nop 0
v_add_f32_dpp v64, v64, v64 row_ror:4 row_mask:0xf bank_mask:0xf
v_add_f32_dpp v65, v65, v65 row_ror:4 row_mask:0xf bank_mask:0xf
s_nop 0
v_add_f32_dpp v64, v64, v64 row_ror:2 row_mask:0xf bank_mask:0xf
v_add_f32_dpp v65, v65, v65 row_ror:2 row_mask:0xf bank_mask:0xf
s_nop 0
v_add_f32_dpp v64, v64, v64 row_ror:1 row_mask:0xf bank_mask:0xf
v_add_f32_dpp v65, v65, v65 row_ror:1 row_mask:0xf bank_mask:0xf
v_mov_b32 v68, v64
v_mov_b32 v69, v65
s_nop 0
v_permlane16_swap_b32 v68, v64
v_permlane16_swap_b32 v69, v65
v_add_f32 v64, v64, v68
v_add_f32 v65, v65, v69
v_mul_f32 v64, 0x3ae38e39, v64
v_cvt_pk_bf16_f32 v66, v64, v64
v_lshlrev_b32 v66, 16, v66
v_mul_f32 v68, v64, v64
v_dot2_f32_bf16 v72, v37, s70, v66 neg_lo:[0,0,1]
v_mov_b32 v67, 0x3ae38e39
v_dot2_f32_bf16 v73, v37, s71, v66 neg_lo:[0,0,1]
v_fma_f32 v65, v65, v67, -v68
v_dot2_f32_bf16 v74, v38, s70, v66 neg_lo:[0,0,1]
v_max_f32 v65, 0, v65
v_dot2_f32_bf16 v75, v38, s71, v66 neg_lo:[0,0,1]
v_cvt_pk_bf16_f32 v65, v65, v65
v_dot2_f32_bf16 v76, v39, s70, v66 neg_lo:[0,0,1]
v_lshlrev_b32 v65, 16, v65
v_dot2_f32_bf16 v77, v39, s71, v66 neg_lo:[0,0,1]
v_add_f32 v65, 0x3727c5ac, v65
v_dot2_f32_bf16 v78, v40, s70, v66 neg_lo:[0,0,1]
v_cvt_pk_bf16_f32 v65, v65, v65
v_dot2_f32_bf16 v79, v40, s71, v66 neg_lo:[0,0,1]
v_lshlrev_b32 v65, 16, v65
v_dot2_f32_bf16 v80, v41, s70, v66 neg_lo:[0,0,1]
v_sqrt_f32 v65, v65
v_dot2_f32_bf16 v81, v41, s71, v66 neg_lo:[0,0,1]
v_cvt_pk_bf16_f32 v65, v65, v65
v_dot2_f32_bf16 v82, v42, s70, v66 neg_lo:[0,0,1]
v_lshlrev_b32 v65, 16, v65
v_dot2_f32_bf16 v83, v42, s71, v66 neg_lo:[0,0,1]
v_rcp_f32 v67, v65
v_dot2_f32_bf16 v84, v43, s70, v66 neg_lo:[0,0,1]
v_dot2_f32_bf16 v85, v43, s71, v66 neg_lo:[0,0,1]
v_dot2_f32_bf16 v86, v44, s70, v66 neg_lo:[0,0,1]
v_dot2_f32_bf16 v87, v44, s71, v66 neg_lo:[0,0,1]
v_dot2_f32_bf16 v88, v45, s70, v66 neg_lo:[0,0,1]
v_dot2_f32_bf16 v89, v45, s71, v66 neg_lo:[0,0,1]
v_cvt_pk_bf16_f32 v37, v72, v73
v_cvt_pk_bf16_f32 v38, v74, v75
v_cvt_pk_bf16_f32 v39, v76, v77
v_cvt_pk_bf16_f32 v40, v78, v79
v_cvt_pk_bf16_f32 v41, v80, v81
v_cvt_pk_bf16_f32 v42, v82, v83
v_cvt_pk_bf16_f32 v43, v84, v85
v_cvt_pk_bf16_f32 v44, v86, v87
v_cvt_pk_bf16_f32 v45, v88, v89
v_lshlrev_b32 v72, 16, v37
v_and_b32 v73, 0xffff0000, v37
v_mul_f32 v72, v72, v67
v_mul_f32 v73, v73, v67
v_cvt_pk_bf16_f32 v37, v72, v73
ds_write_b32 v70, v37 offset:0
v_lshlrev_b32 v74, 16, v38
v_and_b32 v75, 0xffff0000, v38
v_mul_f32 v74, v74, v67
v_mul_f32 v75, v75, v67
v_cvt_pk_bf16_f32 v38, v74, v75
ds_write_b32 v70, v38 offset:128
v_lshlrev_b32 v76, 16, v39
v_and_b32 v77, 0xffff0000, v39
v_mul_f32 v76, v76, v67
v_mul_f32 v77, v77, v67
v_cvt_pk_bf16_f32 v39, v76, v77
ds_write_b32 v70, v39 offset:256
v_lshlrev_b32 v78, 16, v40
v_and_b32 v79, 0xffff0000, v40
v_mul_f32 v78, v78, v67
v_mul_f32 v79, v79, v67
v_cvt_pk_bf16_f32 v40, v78, v79
ds_write_b32 v70, v40 offset:384
v_lshlrev_b32 v80, 16, v41
v_and_b32 v81, 0xffff0000, v41
v_mul_f32 v80, v80, v67
v_mul_f32 v81, v81, v67
v_cvt_pk_bf16_f32 v41, v80, v81
ds_write_b32 v70, v41 offset:512
v_lshlrev_b32 v82, 16, v42
v_and_b32 v83, 0xffff0000, v42
v_mul_f32 v82, v82, v67
v_mul_f32 v83, v83, v67
v_cvt_pk_bf16_f32 v42, v82, v83
ds_write_b32 v70, v42 offset:640
v_lshlrev_b32 v84, 16, v43
v_and_b32 v85, 0xffff0000, v43
v_mul_f32 v84, v84, v67
v_mul_f32 v85, v85, v67
v_cvt_pk_bf16_f32 v43, v84, v85
ds_write_b32 v70, v43 offset:768
v_lshlrev_b32 v86, 16, v44
v_and_b32 v87, 0xffff0000, v44
v_mul_f32 v86, v86, v67
v_mul_f32 v87, v87, v67
v_cvt_pk_bf16_f32 v44, v86, v87
ds_write_b32 v70, v44 offset:896
v_lshlrev_b32 v88, 16, v45
v_and_b32 v89, 0xffff0000, v45
v_mul_f32 v88, v88, v67
v_mul_f32 v89, v89, v67
v_cvt_pk_bf16_f32 v45, v88, v89
ds_write_b32 v70, v45 offset:1024
v_add_u32 v70, 40960, v70
s_add_u32 m0, s64, 7280
s_add_u32 s67, s65, 57344
buffer_load_dwordx4 v20, s[48:51], s67 offen nt lds
s_add_u32 m0, s64, 8320
s_add_u32 s67, s65, 65536
buffer_load_dwordx4 v20, s[48:51], s67 offen nt lds
s_add_u32 m0, s64, 9360
s_add_u32 s67, s65, 73728
buffer_load_dwordx4 v20, s[48:51], s67 offen nt lds
s_add_u32 m0, s64, 10400
s_add_u32 s67, s65, 81920
buffer_load_dwordx4 v20, s[48:51], s67 offen nt lds
s_add_u32 m0, s64, 11440
s_add_u32 s67, s65, 90112
buffer_load_dwordx4 v20, s[48:51], s67 offen nt lds
s_add_u32 m0, s64, 12480
s_add_u32 s67, s65, 98304
buffer_load_dwordx4 v20, s[48:51], s67 offen nt lds
s_add_u32 m0, s64, 13520
s_add_u32 s67, s65, 106496
buffer_load_dwordx4 v20, s[48:51], s67 offen nt lds
s_waitcnt vmcnt(26)
v_dot2_f32_bf16 v64, v46, s72, 0
v_dot2_f32_bf16 v65, v46, v46, 0
v_dot2_f32_bf16 v64, v47, s72, v64
v_dot2_f32_bf16 v65, v47, v47, v65
v_dot2_f32_bf16 v64, v48, s72, v64
v_dot2_f32_bf16 v65, v48, v48, v65
v_dot2_f32_bf16 v64, v49, s72, v64
v_dot2_f32_bf16 v65, v49, v49, v65
v_dot2_f32_bf16 v64, v50, s72, v64
v_dot2_f32_bf16 v65, v50, v50, v65
v_dot2_f32_bf16 v64, v51, s72, v64
v_dot2_f32_bf16 v65, v51, v51, v65
v_dot2_f32_bf16 v64, v52, s72, v64
v_dot2_f32_bf16 v65, v52, v52, v65
v_dot2_f32_bf16 v64, v53, s72, v64
v_dot2_f32_bf16 v65, v53, v53, v65
v_dot2_f32_bf16 v64, v54, s72, v64
v_dot2_f32_bf16 v65, v54, v54, v65
ds_write_b32 v70, v71 offset:1152
s_nop 0
v_add_f32_dpp v64, v64, v64 row_ror:8 row_mask:0xf bank_mask:0xf
v_add_f32_dpp v65, v65, v65 row_ror:8 row_mask:0xf bank_mask:0xf
s_nop 0
v_add_f32_dpp v64, v64, v64 row_ror:4 row_mask:0xf bank_mask:0xf
v_add_f32_dpp v65, v65, v65 row_ror:4 row_mask:0xf bank_mask:0xf
s_nop 0
v_add_f32_dpp v64, v64, v64 row_ror:2 row_mask:0xf bank_mask:0xf
v_add_f32_dpp v65, v65, v65 row_ror:2 row_mask:0xf bank_mask:0xf
s_nop 0
v_add_f32_dpp v64, v64, v64 row_ror:1 row_mask:0xf bank_mask:0xf
v_add_f32_dpp v65, v65, v65 row_ror:1 row_mask:0xf bank_mask:0xf
v_mov_b32 v68, v64
v_mov_b32 v69, v65
s_nop 0
v_permlane16_swap_b32 v68, v64
v_permlane16_swap_b32 v69, v65
v_add_f32 v64, v64, v68
v_add_f32 v65, v65, v69
v_mul_f32 v64, 0x3ae38e39, v64
v_cvt_pk_bf16_f32 v66, v64, v64
v_lshlrev_b32 v66, 16, v66
v_mul_f32 v68, v64, v64
v_dot2_f32_bf16 v72, v46, s70, v66 neg_lo:[0,0,1]
v_mov_b32 v67, 0x3ae38e39
v_dot2_f32_bf16 v73, v46, s71, v66 neg_lo:[0,0,1]
v_fma_f32 v65, v65, v67, -v68
v_dot2_f32_bf16 v74, v47, s70, v66 neg_lo:[0,0,1]
v_max_f32 v65, 0, v65
v_dot2_f32_bf16 v75, v47, s71, v66 neg_lo:[0,0,1]
v_cvt_pk_bf16_f32 v65, v65, v65
v_dot2_f32_bf16 v76, v48, s70, v66 neg_lo:[0,0,1]
v_lshlrev_b32 v65, 16, v65
v_dot2_f32_bf16 v77, v48, s71, v66 neg_lo:[0,0,1]
v_add_f32 v65, 0x3727c5ac, v65
v_dot2_f32_bf16 v78, v49, s70, v66 neg_lo:[0,0,1]
v_cvt_pk_bf16_f32 v65, v65, v65
v_dot2_f32_bf16 v79, v49, s71, v66 neg_lo:[0,0,1]
v_lshlrev_b32 v65, 16, v65
v_dot2_f32_bf16 v80, v50, s70, v66 neg_lo:[0,0,1]
v_sqrt_f32 v65, v65
v_dot2_f32_bf16 v81, v50, s71, v66 neg_lo:[0,0,1]
v_cvt_pk_bf16_f32 v65, v65, v65
v_dot2_f32_bf16 v82, v51, s70, v66 neg_lo:[0,0,1]
v_lshlrev_b32 v65, 16, v65
v_dot2_f32_bf16 v83, v51, s71, v66 neg_lo:[0,0,1]
v_rcp_f32 v67, v65
v_dot2_f32_bf16 v84, v52, s70, v66 neg_lo:[0,0,1]
v_dot2_f32_bf16 v85, v52, s71, v66 neg_lo:[0,0,1]
v_dot2_f32_bf16 v86, v53, s70, v66 neg_lo:[0,0,1]
v_dot2_f32_bf16 v87, v53, s71, v66 neg_lo:[0,0,1]
v_dot2_f32_bf16 v88, v54, s70, v66 neg_lo:[0,0,1]
v_dot2_f32_bf16 v89, v54, s71, v66 neg_lo:[0,0,1]
v_cvt_pk_bf16_f32 v46, v72, v73
v_cvt_pk_bf16_f32 v47, v74, v75
v_cvt_pk_bf16_f32 v48, v76, v77
v_cvt_pk_bf16_f32 v49, v78, v79
v_cvt_pk_bf16_f32 v50, v80, v81
v_cvt_pk_bf16_f32 v51, v82, v83
v_cvt_pk_bf16_f32 v52, v84, v85
v_cvt_pk_bf16_f32 v53, v86, v87
v_cvt_pk_bf16_f32 v54, v88, v89
v_lshlrev_b32 v72, 16, v46
v_and_b32 v73, 0xffff0000, v46
v_mul_f32 v72, v72, v67
v_mul_f32 v73, v73, v67
v_cvt_pk_bf16_f32 v46, v72, v73
ds_write_b32 v70, v46 offset:0
v_lshlrev_b32 v74, 16, v47
v_and_b32 v75, 0xffff0000, v47
v_mul_f32 v74, v74, v67
v_mul_f32 v75, v75, v67
v_cvt_pk_bf16_f32 v47, v74, v75
ds_write_b32 v70, v47 offset:128
v_lshlrev_b32 v76, 16, v48
v_and_b32 v77, 0xffff0000, v48
v_mul_f32 v76, v76, v67
v_mul_f32 v77, v77, v67
v_cvt_pk_bf16_f32 v48, v76, v77
ds_write_b32 v70, v48 offset:256
v_lshlrev_b32 v78, 16, v49
v_and_b32 v79, 0xffff0000, v49
v_mul_f32 v78, v78, v67
v_mul_f32 v79, v79, v67
v_cvt_pk_bf16_f32 v49, v78, v79
ds_write_b32 v70, v49 offset:384
v_lshlrev_b32 v80, 16, v50
v_and_b32 v81, 0xffff0000, v50
v_mul_f32 v80, v80, v67
v_mul_f32 v81, v81, v67
v_cvt_pk_bf16_f32 v50, v80, v81
ds_write_b32 v70, v50 offset:512
v_lshlrev_b32 v82, 16, v51
v_and_b32 v83, 0xffff0000, v51
v_mul_f32 v82, v82, v67
v_mul_f32 v83, v83, v67
v_cvt_pk_bf16_f32 v51, v82, v83
ds_write_b32 v70, v51 offset:640
v_lshlrev_b32 v84, 16, v52
v_and_b32 v85, 0xffff0000, v52
v_mul_f32 v84, v84, v67
v_mul_f32 v85, v85, v67
v_cvt_pk_bf16_f32 v52, v84, v85
ds_write_b32 v70, v52 offset:768
v_lshlrev_b32 v86, 16, v53
v_and_b32 v87, 0xffff0000, v53
v_mul_f32 v86, v86, v67
v_mul_f32 v87, v87, v67
v_cvt_pk_bf16_f32 v53, v86, v87
ds_write_b32 v70, v53 offset:896
v_lshlrev_b32 v88, 16, v54
v_and_b32 v89, 0xffff0000, v54
v_mul_f32 v88, v88, v67
v_mul_f32 v89, v89, v67
v_cvt_pk_bf16_f32 v54, v88, v89
ds_write_b32 v70, v54 offset:1024
v_add_u32 v70, 40960, v70
s_add_u32 m0, s64, 14560
s_add_u32 s67, s65, 114688
buffer_load_dwordx4 v20, s[48:51], s67 offen nt lds
s_add_u32 m0, s64, 15600
s_add_u32 s67, s65, 122880
buffer_load_dwordx4 v20, s[48:51], s67 offen nt lds
s_add_u32 m0, s64, 16640
s_add_u32 s67, s65, 1024
buffer_load_dwordx4 v26, s[48:51], s67 offen nt lds
s_add_u32 m0, s64, 17664
s_add_u32 s67, s65, 131072
buffer_load_dwordx4 v20, s[48:51], s67 offen nt lds
s_add_u32 m0, s64, 18704
s_add_u32 s67, s65, 139264
buffer_load_dwordx4 v20, s[48:51], s67 offen nt lds
s_add_u32 m0, s64, 19744
s_add_u32 s67, s65, 147456
buffer_load_dwordx4 v20, s[48:51], s67 offen nt lds
s_add_u32 m0, s64, 20784
s_add_u32 s67, s65, 155648
buffer_load_dwordx4 v20, s[48:51], s67 offen nt lds
s_waitcnt vmcnt(24)
v_dot2_f32_bf16 v64, v55, s72, 0
v_dot2_f32_bf16 v65, v55, v55, 0
v_dot2_f32_bf16 v64, v56, s72, v64
v_dot2_f32_bf16 v65, v56, v56, v65
v_dot2_f32_bf16 v64, v57, s72, v64
v_dot2_f32_bf16 v65, v57, v57, v65
v_dot2_f32_bf16 v64, v58, s72, v64
v_dot2_f32_bf16 v65, v58, v58, v65
v_dot2_f32_bf16 v64, v59, s72, v64
v_dot2_f32_bf16 v65, v59, v59, v65
v_dot2_f32_bf16 v64, v60, s72, v64
v_dot2_f32_bf16 v65, v60, v60, v65
v_dot2_f32_bf16 v64, v61, s72, v64
v_dot2_f32_bf16 v65, v61, v61, v65
v_dot2_f32_bf16 v64, v62, s72, v64
v_dot2_f32_bf16 v65, v62, v62, v65
v_dot2_f32_bf16 v64, v63, s72, v64
v_dot2_f32_bf16 v65, v63, v63, v65
ds_write_b32 v70, v71 offset:1152
s_nop 0
v_add_f32_dpp v64, v64, v64 row_ror:8 row_mask:0xf bank_mask:0xf
v_add_f32_dpp v65, v65, v65 row_ror:8 row_mask:0xf bank_mask:0xf
s_nop 0
v_add_f32_dpp v64, v64, v64 row_ror:4 row_mask:0xf bank_mask:0xf
v_add_f32_dpp v65, v65, v65 row_ror:4 row_mask:0xf bank_mask:0xf
s_nop 0
v_add_f32_dpp v64, v64, v64 row_ror:2 row_mask:0xf bank_mask:0xf
v_add_f32_dpp v65, v65, v65 row_ror:2 row_mask:0xf bank_mask:0xf
s_nop 0
v_add_f32_dpp v64, v64, v64 row_ror:1 row_mask:0xf bank_mask:0xf
v_add_f32_dpp v65, v65, v65 row_ror:1 row_mask:0xf bank_mask:0xf
v_mov_b32 v68, v64
v_mov_b32 v69, v65
s_nop 0
v_permlane16_swap_b32 v68, v64
v_permlane16_swap_b32 v69, v65
v_add_f32 v64, v64, v68
v_add_f32 v65, v65, v69
v_mul_f32 v64, 0x3ae38e39, v64
v_cvt_pk_bf16_f32 v66, v64, v64
v_lshlrev_b32 v66, 16, v66
v_mul_f32 v68, v64, v64
v_dot2_f32_bf16 v72, v55, s70, v66 neg_lo:[0,0,1]
v_mov_b32 v67, 0x3ae38e39
v_dot2_f32_bf16 v73, v55, s71, v66 neg_lo:[0,0,1]
v_fma_f32 v65, v65, v67, -v68
v_dot2_f32_bf16 v74, v56, s70, v66 neg_lo:[0,0,1]
v_max_f32 v65, 0, v65
v_dot2_f32_bf16 v75, v56, s71, v66 neg_lo:[0,0,1]
v_cvt_pk_bf16_f32 v65, v65, v65
v_dot2_f32_bf16 v76, v57, s70, v66 neg_lo:[0,0,1]
v_lshlrev_b32 v65, 16, v65
v_dot2_f32_bf16 v77, v57, s71, v66 neg_lo:[0,0,1]
v_add_f32 v65, 0x3727c5ac, v65
v_dot2_f32_bf16 v78, v58, s70, v66 neg_lo:[0,0,1]
v_cvt_pk_bf16_f32 v65, v65, v65
v_dot2_f32_bf16 v79, v58, s71, v66 neg_lo:[0,0,1]
v_lshlrev_b32 v65, 16, v65
v_dot2_f32_bf16 v80, v59, s70, v66 neg_lo:[0,0,1]
v_sqrt_f32 v65, v65
v_dot2_f32_bf16 v81, v59, s71, v66 neg_lo:[0,0,1]
v_cvt_pk_bf16_f32 v65, v65, v65
v_dot2_f32_bf16 v82, v60, s70, v66 neg_lo:[0,0,1]
v_lshlrev_b32 v65, 16, v65
v_dot2_f32_bf16 v83, v60, s71, v66 neg_lo:[0,0,1]
v_rcp_f32 v67, v65
v_dot2_f32_bf16 v84, v61, s70, v66 neg_lo:[0,0,1]
v_dot2_f32_bf16 v85, v61, s71, v66 neg_lo:[0,0,1]
v_dot2_f32_bf16 v86, v62, s70, v66 neg_lo:[0,0,1]
v_dot2_f32_bf16 v87, v62, s71, v66 neg_lo:[0,0,1]
v_dot2_f32_bf16 v88, v63, s70, v66 neg_lo:[0,0,1]
v_dot2_f32_bf16 v89, v63, s71, v66 neg_lo:[0,0,1]
v_cvt_pk_bf16_f32 v55, v72, v73
v_cvt_pk_bf16_f32 v56, v74, v75
v_cvt_pk_bf16_f32 v57, v76, v77
v_cvt_pk_bf16_f32 v58, v78, v79
v_cvt_pk_bf16_f32 v59, v80, v81
v_cvt_pk_bf16_f32 v60, v82, v83
v_cvt_pk_bf16_f32 v61, v84, v85
v_cvt_pk_bf16_f32 v62, v86, v87
v_cvt_pk_bf16_f32 v63, v88, v89
v_lshlrev_b32 v72, 16, v55
v_and_b32 v73, 0xffff0000, v55
v_mul_f32 v72, v72, v67
v_mul_f32 v73, v73, v67
v_cvt_pk_bf16_f32 v55, v72, v73
ds_write_b32 v70, v55 offset:0
v_lshlrev_b32 v74, 16, v56
v_and_b32 v75, 0xffff0000, v56
v_mul_f32 v74, v74, v67
v_mul_f32 v75, v75, v67
v_cvt_pk_bf16_f32 v56, v74, v75
ds_write_b32 v70, v56 offset:128
v_lshlrev_b32 v76, 16, v57
v_and_b32 v77, 0xffff0000, v57
v_mul_f32 v76, v76, v67
v_mul_f32 v77, v77, v67
v_cvt_pk_bf16_f32 v57, v76, v77
ds_write_b32 v70, v57 offset:256
v_lshlrev_b32 v78, 16, v58
v_and_b32 v79, 0xffff0000, v58
v_mul_f32 v78, v78, v67
v_mul_f32 v79, v79, v67
v_cvt_pk_bf16_f32 v58, v78, v79
ds_write_b32 v70, v58 offset:384
v_lshlrev_b32 v80, 16, v59
v_and_b32 v81, 0xffff0000, v59
v_mul_f32 v80, v80, v67
v_mul_f32 v81, v81, v67
v_cvt_pk_bf16_f32 v59, v80, v81
ds_write_b32 v70, v59 offset:512
v_lshlrev_b32 v82, 16, v60
v_and_b32 v83, 0xffff0000, v60
v_mul_f32 v82, v82, v67
v_mul_f32 v83, v83, v67
v_cvt_pk_bf16_f32 v60, v82, v83
ds_write_b32 v70, v60 offset:640
v_lshlrev_b32 v84, 16, v61
v_and_b32 v85, 0xffff0000, v61
v_mul_f32 v84, v84, v67
v_mul_f32 v85, v85, v67
v_cvt_pk_bf16_f32 v61, v84, v85
ds_write_b32 v70, v61 offset:768
v_lshlrev_b32 v86, 16, v62
v_and_b32 v87, 0xffff0000, v62
v_mul_f32 v86, v86, v67
v_mul_f32 v87, v87, v67
v_cvt_pk_bf16_f32 v62, v86, v87
ds_write_b32 v70, v62 offset:896
v_lshlrev_b32 v88, 16, v63
v_and_b32 v89, 0xffff0000, v63
v_mul_f32 v88, v88, v67
v_mul_f32 v89, v89, v67
v_cvt_pk_bf16_f32 v63, v88, v89
ds_write_b32 v70, v63 offset:1024
s_add_u32 m0, s64, 21824
s_add_u32 s67, s65, 163840
buffer_load_dwordx4 v20, s[48:51], s67 offen nt lds
s_add_u32 m0, s64, 22864
s_add_u32 s67, s65, 172032
buffer_load_dwordx4 v20, s[48:51], s67 offen nt lds
s_add_u32 m0, s64, 23904
s_add_u32 s67, s65, 180224
buffer_load_dwordx4 v20, s[48:51], s67 offen nt lds
s_add_u32 m0, s64, 24944
s_add_u32 s67, s65, 188416
buffer_load_dwordx4 v20, s[48:51], s67 offen nt lds
s_add_u32 m0, s64, 25984
s_add_u32 s67, s65, 196608
buffer_load_dwordx4 v20, s[48:51], s67 offen nt lds
s_add_u32 m0, s64, 27024
s_add_u32 s67, s65, 204800
buffer_load_dwordx4 v20, s[48:51], s67 offen nt lds
s_add_u32 m0, s64, 28064
s_add_u32 s67, s65, 212992
buffer_load_dwordx4 v20, s[48:51], s67 offen nt lds
s_waitcnt lgkmcnt(0)
s_barrier
v_mov_b32 v28, v0
s_mov_b32 s80, 3
s_cmp_eq_u32 s69, 0
s_cselect_b32 s81, 80, 0
s_add_u32 s81, s81, 640
s_lshl_b32 s73, s69, 3
s_mov_b32 s76, 331776
L_fold_46:
v_mul_u32_u24 v30, 52429, v28
v_lshrrev_b32 v30, 22, v30
v_mul_u32_u24 v29, 80, v30
v_sub_u32 v29, v28, v29
v_cmp_le_u32 vcc, 8, v30
s_nop 1
v_cndmask_b32 v31, v30, 0, vcc
v_lshrrev_b32 v32, 1, v31
v_mul_u32_u24 v32, 40960, v32
v_and_b32 v31, 1, v31
v_mul_u32_u24 v31, 5120, v31
v_add3_u32 v32, v32, v31, s76
v_subrev_u32 v32, 299776, v32
v_subrev_u32 v31, 1280, v32
v_cndmask_b32 v31, v31, v32, vcc
v_lshlrev_b32 v37, 3, v29
v_sub_u32 v33, v31, v37
v_sub_u32 v34, v32, v37
v_add_u32 v31, v31, v37
v_add_u32 v32, v32, v37
ds_read_b64 v[44:45], v31 offset:0
ds_read_b64 v[52:53], v33 offset:1144
ds_read_b32 v54, v33 offset:1152
ds_read_b64 v[46:47], v32 offset:0
ds_read_b64 v[56:57], v34 offset:1144
ds_read_b32 v58, v34 offset:1152
ds_read_b64 v[48:49], v31 offset:2560
ds_read_b64 v[60:61], v33 offset:3704
ds_read_b32 v62, v33 offset:3712
ds_read_b64 v[50:51], v32 offset:2560
ds_read_b64 v[64:65], v34 offset:3704
ds_read_b32 v66, v34 offset:3712
v_add_u32 v39, s73, v30
v_cmp_eq_u32 s[74:75], 0, v39
v_mov_b32 v35, 512
s_or_b64 s[74:75], s[74:75], vcc
v_cndmask_b32 v39, v39, v35, vcc
v_cndmask_b32 v35, 1.0, 0, s[74:75]
v_mul_u32_u24 v39, 640, v39
v_add_u32 v39, v39, v37
v_add_u32 v39, 65536, v39
v_add_u32 v40, 663552, v39
v_add_u32 v41, 995328, v39
v_cndmask_b32 v36, v40, v41, vcc
v_cndmask_b32 v41, v41, v40, vcc
v_mov_b32 v40, v36
v_cmp_le_u32 vcc, s81, v28
v_mov_b32 v36, 2147483392
s_nop 0
v_cndmask_b32 v39, v39, v36, vcc
v_cndmask_b32 v40, v40, v36, vcc
v_cndmask_b32 v41, v41, v36, vcc
v_cmp_eq_u32 vcc, 72, v29
v_mov_b32 v38, 0xffff
v_add_u32 v28, 256, v28
v_cndmask_b32 v36, 1.0, 0.5, vcc
v_cndmask_b32 v37, 0, v38, vcc
v_cmp_gt_u32 vcc, 72, v29
s_waitcnt lgkmcnt(0)
s_nop 0
v_cndmask_b32 v37, v37, -1, vcc
v_cndmask_b32 v38, 0, -1, vcc
v_lshlrev_b32 v76, 16, v54
v_lshlrev_b32 v77, 16, v58
v_lshlrev_b32 v78, 16, v62
v_lshlrev_b32 v79, 16, v66
v_dot2_f32_bf16 v69, v46, s70, v77
v_dot2_f32_bf16 v73, v46, s70, v77 neg_lo:[0,0,1]
v_dot2_f32_bf16 v71, v50, s70, v79
v_dot2_f32_bf16 v75, v50, s70, v79 neg_lo:[0,0,1]
v_dot2_f32_bf16 v68, v44, s70, v76
v_dot2_f32_bf16 v72, v44, s70, v76 neg_lo:[0,0,1]
v_dot2_f32_bf16 v70, v48, s70, v78
v_dot2_f32_bf16 v74, v48, s70, v78 neg_lo:[0,0,1]
v_fma_f32 v68, v35, v69, v68
v_fma_f32 v72, -v35, v73, v72
v_fma_f32 v70, v35, v71, v70
v_fma_f32 v74, -v35, v75, v74
v_add_f32 v80, v68, v70
v_sub_f32 v82, v68, v70
v_sub_f32 v84, v72, v74
v_add_f32 v86, v72, v74
v_mul_f32 v80, v80, v36
v_mul_f32 v82, v82, v36
v_and_b32 v76, 0xffff0000, v53
v_and_b32 v77, 0xffff0000, v57
v_and_b32 v78, 0xffff0000, v61
v_and_b32 v79, 0xffff0000, v65
v_dot2_f32_bf16 v69, v46, s71, v77
v_dot2_f32_bf16 v73, v46, s71, v77 neg_lo:[0,0,1]
v_dot2_f32_bf16 v71, v50, s71, v79
v_dot2_f32_bf16 v75, v50, s71, v79 neg_lo:[0,0,1]
v_dot2_f32_bf16 v68, v44, s71, v76
v_dot2_f32_bf16 v72, v44, s71, v76 neg_lo:[0,0,1]
v_dot2_f32_bf16 v70, v48, s71, v78
v_dot2_f32_bf16 v74, v48, s71, v78 neg_lo:[0,0,1]
v_fma_f32 v68, v35, v69, v68
v_fma_f32 v72, -v35, v73, v72
v_fma_f32 v70, v35, v71, v70
v_fma_f32 v74, -v35, v75, v74
v_add_f32 v81, v68, v70
v_sub_f32 v83, v68, v70
v_sub_f32 v85, v72, v74
v_add_f32 v87, v72, v74
v_cvt_pk_bf16_f32 v88, v80, v81
v_and_b32 v88, v88, v37
v_cvt_pk_bf16_f32 v90, v82, v83
v_and_b32 v90, v90, v37
v_cvt_pk_bf16_f32 v92, v84, v85
v_and_b32 v92, v92, v37
v_cvt_pk_bf16_f32 v94, v86, v87
v_and_b32 v94, v94, v37
v_lshlrev_b32 v76, 16, v53
v_lshlrev_b32 v77, 16, v57
v_lshlrev_b32 v78, 16, v61
v_lshlrev_b32 v79, 16, v65
v_dot2_f32_bf16 v69, v47, s70, v77
v_dot2_f32_bf16 v73, v47, s70, v77 neg_lo:[0,0,1]
v_dot2_f32_bf16 v71, v51, s70, v79
v_dot2_f32_bf16 v75, v51, s70, v79 neg_lo:[0,0,1]
v_dot2_f32_bf16 v68, v45, s70, v76
v_dot2_f32_bf16 v72, v45, s70, v76 neg_lo:[0,0,1]
v_dot2_f32_bf16 v70, v49, s70, v78
v_dot2_f32_bf16 v74, v49, s70, v78 neg_lo:[0,0,1]
v_fma_f32 v68, v35, v69, v68
v_fma_f32 v72, -v35, v73, v72
v_fma_f32 v70, v35, v71, v70
v_fma_f32 v74, -v35, v75, v74
v_add_f32 v80, v68, v70
v_sub_f32 v82, v68, v70
v_sub_f32 v84, v72, v74
v_add_f32 v86, v72, v74
v_and_b32 v76, 0xffff0000, v52
v_and_b32 v77, 0xffff0000, v56
v_and_b32 v78, 0xffff0000, v60
v_and_b32 v79, 0xffff0000, v64
v_dot2_f32_bf16 v69, v47, s71, v77
v_dot2_f32_bf16 v73, v47, s71, v77 neg_lo:[0,0,1]
v_dot2_f32_bf16 v71, v51, s71, v79
v_dot2_f32_bf16 v75, v51, s71, v79 neg_lo:[0,0,1]
v_dot2_f32_bf16 v68, v45, s71, v76
v_dot2_f32_bf16 v72, v45, s71, v76 neg_lo:[0,0,1]
v_dot2_f32_bf16 v70, v49, s71, v78
v_dot2_f32_bf16 v74, v49, s71, v78 neg_lo:[0,0,1]
v_fma_f32 v68, v35, v69, v68
v_fma_f32 v72, -v35, v73, v72
v_fma_f32 v70, v35, v71, v70
v_fma_f32 v74, -v35, v75, v74
v_add_f32 v81, v68, v70
v_sub_f32 v83, v68, v70
v_sub_f32 v85, v72, v74
v_add_f32 v87, v72, v74
v_cvt_pk_bf16_f32 v89, v80, v81
v_and_b32 v89, v89, v38
v_cvt_pk_bf16_f32 v91, v82, v83
v_and_b32 v91, v91, v38
v_cvt_pk_bf16_f32 v93, v84, v85
v_and_b32 v93, v93, v38
v_cvt_pk_bf16_f32 v95, v86, v87
v_and_b32 v95, v95, v38
buffer_store_dwordx2 v[88:89], v39, s[32:35], 0 offen sc1
buffer_store_dwordx2 v[90:91], v39, s[32:35], s76 offen sc1
buffer_store_dwordx2 v[92:93], v40, s[32:35], 0 offen sc1
buffer_store_dwordx2 v[94:95], v41, s[32:35], 0 offen sc1
s_sub_u32 s80, s80, 1
s_cmp_lg_u32 s80, 0
s_cbranch_scc1 L_fold_46
s_waitcnt vmcnt(23)
ds_read_b128 a[0:3], v24 offset:0
ds_read_b128 a[12:15], v24 offset:64
ds_read_b128 a[24:27], v24 offset:128
ds_read_b128 a[36:39], v24 offset:192
ds_read_b128 a[48:51], v24 offset:256
ds_read_b128 a[60:63], v24 offset:320
ds_read_b128 a[72:75], v24 offset:384
ds_read_b128 a[84:87], v24 offset:448
ds_read_b128 a[96:99], v24 offset:512
ds_read_b128 a[108:111], v24 offset:576
ds_read_b128 a[120:123], v24 offset:640
ds_read_b128 a[132:135], v24 offset:704
ds_read_b128 a[144:147], v24 offset:768
ds_read_b128 a[156:159], v24 offset:832
ds_read_b128 a[168:171], v24 offset:896
ds_read_b128 a[180:183], v24 offset:960
ds_read_b128 a[192:195], v9 offset:16640
s_mul_i32 s68, s68, 2654435761
s_add_u32 s68, s68, 2135587861
s_lshl_b32 s73, s69, 2
s_add_u32 s73, s73, s60
s_lshl_b32 s73, s73, 2
s_add_u32 s73, s73, 4096
v_mov_b32 v21, 2147483392
v_mov_b32 v2, s73
v_cmp_eq_u32 vcc, 0, v1
v_mov_b32 v23, s68
s_nop 0
v_cndmask_b32 v21, v21, v2, vcc
s_waitcnt vmcnt(0)
buffer_store_dword v23, v21, s[32:35], 0 offen sc1
s_barrier
s_mul_i32 s63, s63, 2654435761
s_add_u32 s63, s63, 2135587861
v_mov_b32 v22, s63
s_cmp_ge_u32 s61, 12
s_cbranch_scc1 L_aux_help
s_add_u32 m0, s64, 29104
s_add_u32 s67, s65, 221184
buffer_load_dwordx4 v20, s[48:51], s67 offen nt lds
s_add_u32 m0, s64, 30144
s_add_u32 s67, s65, 229376
buffer_load_dwordx4 v20, s[48:51], s67 offen nt lds
s_add_u32 m0, s64, 31184
s_add_u32 s67, s65, 237568
buffer_load_dwordx4 v20, s[48:51], s67 offen nt lds
s_add_u32 m0, s64, 32224
s_add_u32 s67, s65, 245760
buffer_load_dwordx4 v20, s[48:51], s67 offen nt lds
s_add_u32 m0, s64, 33264
s_add_u32 s67, s65, 253952
buffer_load_dwordx4 v20, s[48:51], s67 offen nt lds
s_add_u32 m0, s64, 34304
s_add_u32 s67, s65, 132096
buffer_load_dwordx4 v26, s[48:51], s67 offen nt lds
s_waitcnt lgkmcnt(0)
s_add_u32 m0, s64, 0
s_add_u32 s67, s65, 262144
buffer_load_dwordx4 v20, s[48:51], s67 offen nt lds
s_add_u32 m0, s64, 1040
s_add_u32 s67, s65, 270336
buffer_load_dwordx4 v20, s[48:51], s67 offen nt lds
s_add_u32 m0, s64, 2080
s_add_u32 s67, s65, 278528
buffer_load_dwordx4 v20, s[48:51], s67 offen nt lds
s_add_u32 m0, s64, 3120
s_add_u32 s67, s65, 286720
buffer_load_dwordx4 v20, s[48:51], s67 offen nt lds
s_add_u32 m0, s64, 4160
s_add_u32 s67, s65, 294912
buffer_load_dwordx4 v20, s[48:51], s67 offen nt lds
s_add_u32 m0, s64, 5200
s_add_u32 s67, s65, 303104
buffer_load_dwordx4 v20, s[48:51], s67 offen nt lds
s_add_u32 m0, s64, 6240
s_add_u32 s67, s65, 311296
buffer_load_dwordx4 v20, s[48:51], s67 offen nt lds
s_add_u32 m0, s64, 7280
s_add_u32 s67, s65, 319488
buffer_load_dwordx4 v20, s[48:51], s67 offen nt lds
s_add_u32 m0, s64, 8320
s_add_u32 s67, s65, 327680
buffer_load_dwordx4 v20, s[48:51], s67 offen nt lds
s_add_u32 m0, s64, 9360
s_add_u32 s67, s65, 335872
buffer_load_dwordx4 v20, s[48:51], s67 offen nt lds
s_add_u32 m0, s64, 10400
s_add_u32 s67, s65, 344064
buffer_load_dwordx4 v20, s[48:51], s67 offen nt lds
s_add_u32 m0, s64, 11440
s_add_u32 s67, s65, 352256
buffer_load_dwordx4 v20, s[48:51], s67 offen nt lds
s_add_u32 m0, s64, 12480
s_add_u32 s67, s65, 360448
buffer_load_dwordx4 v20, s[48:51], s67 offen nt lds
s_add_u32 m0, s64, 13520
s_add_u32 s67, s65, 368640
buffer_load_dwordx4 v20, s[48:51], s67 offen nt lds
s_add_u32 m0, s64, 14560
s_add_u32 s67, s65, 376832
buffer_load_dwordx4 v20, s[48:51], s67 offen nt lds
s_add_u32 m0, s64, 15600
s_add_u32 s67, s65, 385024
buffer_load_dwordx4 v20, s[48:51], s67 offen nt lds
s_add_u32 m0, s64, 16640
s_add_u32 s67, s65, 263168
buffer_load_dwordx4 v26, s[48:51], s67 offen nt lds
s_mov_b32 s73, 2654435761
v_mul_lo_u32 v25, v25, s73
v_add_u32 v25, 2135587861, v25
s_mov_b32 s65, 0
s_mov_b32 s66, 0
s_waitcnt vmcnt(17)
ds_read_b128 a[4:7], v24 offset:17664
ds_read_b128 a[16:19], v24 offset:17728
ds_read_b128 a[28:31], v24 offset:17792
ds_read_b128 a[40:43], v24 offset:17856
ds_read_b128 a[52:55], v24 offset:17920
ds_read_b128 a[64:67], v24 offset:17984
ds_read_b128 a[76:79], v24 offset:18048
ds_read_b128 a[88:91], v24 offset:18112
ds_read_b128 a[100:103], v24 offset:18176
ds_read_b128 a[112:115], v24 offset:18240
ds_read_b128 a[124:127], v24 offset:18304
ds_read_b128 a[136:139], v24 offset:18368
ds_read_b128 a[148:151], v24 offset:18432
ds_read_b128 a[160:163], v24 offset:18496
ds_read_b128 a[172:175], v24 offset:18560
ds_read_b128 a[184:187], v24 offset:18624
ds_read_b128 a[196:199], v9 offset:34304
s_cmp_lg_u32 s60, 3
s_cbranch_scc1 L_aux_np
s_mov_b32 s73, 4096
v_lshl_add_u32 v2, v1, 4, s73
s_mov_b32 s74, 200000
s_mov_b32 exec_lo, 0xffffffff
s_mov_b32 exec_hi, 0xffffffff
L_poll_47:
buffer_load_dwordx4 v[4:7], v2, s[32:35], 0 offen sc1
s_sub_u32 s74, s74, 1
s_waitcnt vmcnt(0)
v_xor_b32 v5, v4, v5
v_xor_b32 v6, v4, v6
v_xor_b32 v7, v4, v7
v_or3_b32 v5, v5, v6, v7
v_xor_b32 v4, v4, v5
v_cmp_eq_u32 s[80:81], 0, v5
v_cmp_eq_u32 vcc, s68, v4
s_nop 0
s_and_b64 vcc, vcc, s[80:81]
s_cmp_eq_u32 s74, 0
s_cbranch_scc1 L_polld_48
s_cmp_eq_u64 vcc, exec
s_cbranch_scc0 L_poll_47
L_polld_48:
s_mov_b64 exec, -1
s_cmp_lg_u32 s61, 0
s_cbranch_scc1 L_aux_nn
v_mov_b32 v2, 2147483392
v_mov_b32 v3, 64
v_cmp_eq_u32 vcc, 0, v1
s_nop 1
v_cndmask_b32 v2, v2, v3, vcc
v_mov_b32 v3, s68
buffer_store_dword v3, v2, s[32:35], 0 offen sc1
L_aux_nn:
buffer_inv sc1
s_waitcnt vmcnt(0)
L_aux_np:
s_waitcnt lgkmcnt(0)
s_barrier
s_add_u32 m0, s64, 18432
s_add_u32 s67, s65, 0
buffer_load_dwordx4 v10, s[36:39], s67 offen sc1 lds
buffer_load_dwordx4 v10, s[40:43], s67 offen offset:1024 sc1 lds
s_add_u32 m0, s64, 20480
s_add_u32 s67, s65, 40960
buffer_load_dwordx4 v10, s[36:39], s67 offen sc1 lds
buffer_load_dwordx4 v10, s[40:43], s67 offen offset:1024 sc1 lds
s_add_u32 m0, s64, 22528
s_add_u32 s67, s65, 81920
buffer_load_dwordx4 v10, s[36:39], s67 offen sc1 lds
buffer_load_dwordx4 v10, s[40:43], s67 offen offset:1024 sc1 lds
s_add_u32 m0, s64, 24576
s_add_u32 s67, s65, 122880
buffer_load_dwordx4 v10, s[36:39], s67 offen sc1 lds
buffer_load_dwordx4 v10, s[40:43], s67 offen offset:1024 sc1 lds
s_add_u32 m0, s64, 26624
s_add_u32 s67, s65, 163840
buffer_load_dwordx4 v10, s[36:39], s67 offen sc1 lds
buffer_load_dwordx4 v10, s[40:43], s67 offen offset:1024 sc1 lds
s_add_u32 m0, s64, 28672
s_add_u32 s67, s65, 204800
buffer_load_dwordx4 v10, s[36:39], s67 offen sc1 lds
buffer_load_dwordx4 v10, s[40:43], s67 offen offset:1024 sc1 lds
s_add_u32 m0, s64, 30720
s_add_u32 s67, s65, 245760
buffer_load_dwordx4 v10, s[36:39], s67 offen sc1 lds
buffer_load_dwordx4 v10, s[40:43], s67 offen offset:1024 sc1 lds
s_add_u32 m0, s64, 32768
s_add_u32 s67, s65, 286720
buffer_load_dwordx4 v10, s[36:39], s67 offen sc1 lds
buffer_load_dwordx4 v10, s[40:43], s67 offen offset:1024 sc1 lds
s_add_u32 m0, s64, 34816
s_add_u32 s67, s65, 327680
buffer_load_dwordx4 v10, s[36:39], s67 offen sc1 lds
s_add_u32 m0, s64, 36864
s_add_u32 s67, s65, 128
buffer_load_dwordx4 v10, s[36:39], s67 offen sc1 lds
buffer_load_dwordx4 v10, s[40:43], s67 offen offset:1024 sc1 lds
s_add_u32 m0, s64, 38912
s_add_u32 s67, s65, 41088
buffer_load_dwordx4 v10, s[36:39], s67 offen sc1 lds
buffer_load_dwordx4 v10, s[40:43], s67 offen offset:1024 sc1 lds
s_waitcnt vmcnt(21)
ds_read_b128 a[8:11], v24 offset:0
ds_read_b128 a[20:23], v24 offset:64
ds_read_b128 a[32:35], v24 offset:128
ds_read_b128 a[44:47], v24 offset:192
ds_read_b128 a[56:59], v24 offset:256
ds_read_b128 a[68:71], v24 offset:320
ds_read_b128 a[80:83], v24 offset:384
ds_read_b128 a[92:95], v24 offset:448
ds_read_b128 a[104:107], v24 offset:512
ds_read_b128 a[116:119], v24 offset:576
ds_read_b128 a[128:131], v24 offset:640
ds_read_b128 a[140:143], v24 offset:704
ds_read_b128 a[152:155], v24 offset:768
ds_read_b128 a[164:167], v24 offset:832
ds_read_b128 a[176:179], v24 offset:896
ds_read_b128 a[188:191], v24 offset:960
ds_read_b128 a[200:203], v9 offset:16640
s_add_u32 s48, s44, 35840
s_addc_u32 s49, s45, 0
s_mov_b32 s50, 627712
s_mov_b32 s51, 0x20000
v_mov_b32 v234, 0
v_mov_b32 v235, 0
v_mov_b32 v238, 0
v_mov_b32 v239, 0
v_mov_b32 v242, 0
v_mov_b32 v243, 0
v_and_b32 v2, 15, v1
v_add_u32 v2, s25, v2
v_lshrrev_b32 v3, 4, v1
v_mul_u32_u24 v3, 9216, v3
v_lshl_add_u32 v16, v2, 4, v3
s_mul_i32 s14, s24, 377856
s_add_u32 s14, s14, 1441792
v_lshlrev_b32 v2, 15, v1
s_lshl_b32 s73, s61, 7
s_add_u32 s73, s73, 3153920
v_add_u32 v2, s73, v2
v_mov_b32 v3, 2147483392
v_cmp_gt_u32 vcc, 16, v0
s_nop 1
v_cndmask_b32 v21, v3, v2, vcc
s_waitcnt lgkmcnt(0)
s_waitcnt vmcnt(11)
s_barrier
ds_read_b64_tr_b16 a[204:205], v11 offset:18432
ds_read_b64_tr_b16 a[206:207], v11 offset:18944
ds_read_b64_tr_b16 a[208:209], v12 offset:18432
ds_read_b64_tr_b16 a[210:211], v12 offset:18944
ds_read_b64_tr_b16 a[212:213], v13 offset:18432
ds_read_b64_tr_b16 a[214:215], v13 offset:18944
ds_read_b64_tr_b16 a[216:217], v14 offset:18432
ds_read_b64_tr_b16 a[218:219], v14 offset:18944
ds_read_b64_tr_b16 a[220:221], v11 offset:19456
ds_read_b64_tr_b16 a[222:223], v11 offset:19968
ds_read_b64_tr_b16 a[224:225], v12 offset:19456
ds_read_b64_tr_b16 a[226:227], v12 offset:19968
ds_read_b64_tr_b16 a[228:229], v13 offset:19456
ds_read_b64_tr_b16 a[230:231], v13 offset:19968
ds_read_b64_tr_b16 a[232:233], v14 offset:19456
ds_read_b64_tr_b16 a[234:235], v14 offset:19968
s_waitcnt lgkmcnt(8)
v_mfma_f32_16x16x32_bf16 v[28:31], a[204:207], a[0:3], 0
ds_read_b64_tr_b16 a[236:237], v11 offset:20480
s_add_u32 m0, s64, 0
v_mfma_f32_16x16x32_bf16 v[32:35], a[204:207], a[4:7], 0
ds_read_b64_tr_b16 a[238:239], v11 offset:20992
s_add_u32 s67, s65, 82048
v_mfma_f32_16x16x32_bf16 v[36:39], a[204:207], a[8:11], 0
buffer_load_dwordx4 v10, s[36:39], s67 offen sc1 lds
v_mfma_f32_16x16x32_bf16 v[40:43], a[208:211], a[0:3], 0
ds_read_b64_tr_b16 a[240:241], v12 offset:20480
v_mfma_f32_16x16x32_bf16 v[44:47], a[208:211], a[4:7], 0
ds_read_b64_tr_b16 a[242:243], v12 offset:20992
v_mfma_f32_16x16x32_bf16 v[48:51], a[208:211], a[8:11], 0
buffer_load_dwordx4 v10, s[40:43], s67 offen offset:1024 sc1 lds
v_mfma_f32_16x16x32_bf16 v[52:55], a[212:215], a[0:3], 0
ds_read_b64_tr_b16 a[204:205], v13 offset:20480
s_add_u32 m0, s64, 2048
v_mfma_f32_16x16x32_bf16 v[56:59], a[212:215], a[4:7], 0
ds_read_b64_tr_b16 a[206:207], v13 offset:20992
s_add_u32 s67, s65, 123008
v_mfma_f32_16x16x32_bf16 v[60:63], a[212:215], a[8:11], 0
buffer_load_dwordx4 v10, s[36:39], s67 offen sc1 lds
v_mfma_f32_16x16x32_bf16 v[64:67], a[216:219], a[0:3], 0
ds_read_b64_tr_b16 a[208:209], v14 offset:20480
v_mfma_f32_16x16x32_bf16 v[68:71], a[216:219], a[4:7], 0
ds_read_b64_tr_b16 a[210:211], v14 offset:20992
v_mfma_f32_16x16x32_bf16 v[72:75], a[216:219], a[8:11], 0
buffer_load_dwordx4 v10, s[40:43], s67 offen offset:1024 sc1 lds
s_waitcnt lgkmcnt(8)
v_mfma_f32_16x16x32_bf16 v[28:31], a[220:223], a[12:15], v[28:31]
ds_read_b64_tr_b16 a[212:213], v11 offset:21504
v_mfma_f32_16x16x32_bf16 v[32:35], a[220:223], a[16:19], v[32:35]
ds_read_b64_tr_b16 a[214:215], v11 offset:22016
v_mfma_f32_16x16x32_bf16 v[36:39], a[220:223], a[20:23], v[36:39]
v_mfma_f32_16x16x32_bf16 v[40:43], a[224:227], a[12:15], v[40:43]
ds_read_b64_tr_b16 a[216:217], v12 offset:21504
v_mfma_f32_16x16x32_bf16 v[44:47], a[224:227], a[16:19], v[44:47]
ds_read_b64_tr_b16 a[218:219], v12 offset:22016
v_mfma_f32_16x16x32_bf16 v[48:51], a[224:227], a[20:23], v[48:51]
v_mfma_f32_16x16x32_bf16 v[52:55], a[228:231], a[12:15], v[52:55]
ds_read_b64_tr_b16 a[220:221], v13 offset:21504
v_mfma_f32_16x16x32_bf16 v[56:59], a[228:231], a[16:19], v[56:59]
ds_read_b64_tr_b16 a[222:223], v13 offset:22016
v_mfma_f32_16x16x32_bf16 v[60:63], a[228:231], a[20:23], v[60:63]
v_mfma_f32_16x16x32_bf16 v[64:67], a[232:235], a[12:15], v[64:67]
ds_read_b64_tr_b16 a[224:225], v14 offset:21504
v_mfma_f32_16x16x32_bf16 v[68:71], a[232:235], a[16:19], v[68:71]
ds_read_b64_tr_b16 a[226:227], v14 offset:22016
v_mfma_f32_16x16x32_bf16 v[72:75], a[232:235], a[20:23], v[72:75]
s_waitcnt lgkmcnt(8)
v_mfma_f32_16x16x32_bf16 v[28:31], a[236:239], a[24:27], v[28:31]
ds_read_b64_tr_b16 a[228:229], v11 offset:22528
s_add_u32 m0, s64, 4096
v_mfma_f32_16x16x32_bf16 v[32:35], a[236:239], a[28:31], v[32:35]
ds_read_b64_tr_b16 a[230:231], v11 offset:23040
s_add_u32 s67, s65, 163968
v_mfma_f32_16x16x32_bf16 v[36:39], a[236:239], a[32:35], v[36:39]
buffer_load_dwordx4 v10, s[36:39], s67 offen sc1 lds
v_mfma_f32_16x16x32_bf16 v[40:43], a[240:243], a[24:27], v[40:43]
ds_read_b64_tr_b16 a[232:233], v12 offset:22528
v_mfma_f32_16x16x32_bf16 v[44:47], a[240:243], a[28:31], v[44:47]
ds_read_b64_tr_b16 a[234:235], v12 offset:23040
v_mfma_f32_16x16x32_bf16 v[48:51], a[240:243], a[32:35], v[48:51]
buffer_load_dwordx4 v10, s[40:43], s67 offen offset:1024 sc1 lds
v_mfma_f32_16x16x32_bf16 v[52:55], a[204:207], a[24:27], v[52:55]
ds_read_b64_tr_b16 a[236:237], v13 offset:22528
s_add_u32 m0, s64, 6144
v_mfma_f32_16x16x32_bf16 v[56:59], a[204:207], a[28:31], v[56:59]
ds_read_b64_tr_b16 a[238:239], v13 offset:23040
s_add_u32 s67, s65, 204928
v_mfma_f32_16x16x32_bf16 v[60:63], a[204:207], a[32:35], v[60:63]
buffer_load_dwordx4 v10, s[36:39], s67 offen sc1 lds
v_mfma_f32_16x16x32_bf16 v[64:67], a[208:211], a[24:27], v[64:67]
ds_read_b64_tr_b16 a[240:241], v14 offset:22528
v_mfma_f32_16x16x32_bf16 v[68:71], a[208:211], a[28:31], v[68:71]
ds_read_b64_tr_b16 a[242:243], v14 offset:23040
v_mfma_f32_16x16x32_bf16 v[72:75], a[208:211], a[32:35], v[72:75]
buffer_load_dwordx4 v10, s[40:43], s67 offen offset:1024 sc1 lds
s_waitcnt lgkmcnt(8)
v_mfma_f32_16x16x32_bf16 v[28:31], a[212:215], a[36:39], v[28:31]
ds_read_b64_tr_b16 a[204:205], v11 offset:23552
v_mfma_f32_16x16x32_bf16 v[32:35], a[212:215], a[40:43], v[32:35]
ds_read_b64_tr_b16 a[206:207], v11 offset:24064
v_mfma_f32_16x16x32_bf16 v[36:39], a[212:215], a[44:47], v[36:39]
v_mfma_f32_16x16x32_bf16 v[40:43], a[216:219], a[36:39], v[40:43]
ds_read_b64_tr_b16 a[208:209], v12 offset:23552
v_mfma_f32_16x16x32_bf16 v[44:47], a[216:219], a[40:43], v[44:47]
ds_read_b64_tr_b16 a[210:211], v12 offset:24064
v_mfma_f32_16x16x32_bf16 v[48:51], a[216:219], a[44:47], v[48:51]
v_mfma_f32_16x16x32_bf16 v[52:55], a[220:223], a[36:39], v[52:55]
ds_read_b64_tr_b16 a[212:213], v13 offset:23552
v_mfma_f32_16x16x32_bf16 v[56:59], a[220:223], a[40:43], v[56:59]
ds_read_b64_tr_b16 a[214:215], v13 offset:24064
v_mfma_f32_16x16x32_bf16 v[60:63], a[220:223], a[44:47], v[60:63]
v_mfma_f32_16x16x32_bf16 v[64:67], a[224:227], a[36:39], v[64:67]
ds_read_b64_tr_b16 a[216:217], v14 offset:23552
v_mfma_f32_16x16x32_bf16 v[68:71], a[224:227], a[40:43], v[68:71]
ds_read_b64_tr_b16 a[218:219], v14 offset:24064
v_mfma_f32_16x16x32_bf16 v[72:75], a[224:227], a[44:47], v[72:75]
s_waitcnt lgkmcnt(8)
v_mfma_f32_16x16x32_bf16 v[28:31], a[228:231], a[48:51], v[28:31]
ds_read_b64_tr_b16 a[220:221], v11 offset:24576
s_add_u32 m0, s64, 8192
v_mfma_f32_16x16x32_bf16 v[32:35], a[228:231], a[52:55], v[32:35]
ds_read_b64_tr_b16 a[222:223], v11 offset:25088
s_add_u32 s67, s65, 245888
v_mfma_f32_16x16x32_bf16 v[36:39], a[228:231], a[56:59], v[36:39]
buffer_load_dwordx4 v10, s[36:39], s67 offen sc1 lds
v_mfma_f32_16x16x32_bf16 v[40:43], a[232:235], a[48:51], v[40:43]
ds_read_b64_tr_b16 a[224:225], v12 offset:24576
v_mfma_f32_16x16x32_bf16 v[44:47], a[232:235], a[52:55], v[44:47]
ds_read_b64_tr_b16 a[226:227], v12 offset:25088
v_mfma_f32_16x16x32_bf16 v[48:51], a[232:235], a[56:59], v[48:51]
buffer_load_dwordx4 v10, s[40:43], s67 offen offset:1024 sc1 lds
v_mfma_f32_16x16x32_bf16 v[52:55], a[236:239], a[48:51], v[52:55]
ds_read_b64_tr_b16 a[228:229], v13 offset:24576
s_add_u32 m0, s64, 10240
v_mfma_f32_16x16x32_bf16 v[56:59], a[236:239], a[52:55], v[56:59]
ds_read_b64_tr_b16 a[230:231], v13 offset:25088
s_add_u32 s67, s65, 286848
v_mfma_f32_16x16x32_bf16 v[60:63], a[236:239], a[56:59], v[60:63]
buffer_load_dwordx4 v10, s[36:39], s67 offen sc1 lds
v_mfma_f32_16x16x32_bf16 v[64:67], a[240:243], a[48:51], v[64:67]
ds_read_b64_tr_b16 a[232:233], v14 offset:24576
v_mfma_f32_16x16x32_bf16 v[68:71], a[240:243], a[52:55], v[68:71]
ds_read_b64_tr_b16 a[234:235], v14 offset:25088
v_mfma_f32_16x16x32_bf16 v[72:75], a[240:243], a[56:59], v[72:75]
buffer_load_dwordx4 v10, s[40:43], s67 offen offset:1024 sc1 lds
s_waitcnt lgkmcnt(8)
v_mfma_f32_16x16x32_bf16 v[28:31], a[204:207], a[60:63], v[28:31]
ds_read_b64_tr_b16 a[236:237], v11 offset:25600
v_mfma_f32_16x16x32_bf16 v[32:35], a[204:207], a[64:67], v[32:35]
ds_read_b64_tr_b16 a[238:239], v11 offset:26112
v_mfma_f32_16x16x32_bf16 v[36:39], a[204:207], a[68:71], v[36:39]
v_mfma_f32_16x16x32_bf16 v[40:43], a[208:211], a[60:63], v[40:43]
ds_read_b64_tr_b16 a[240:241], v12 offset:25600
v_mfma_f32_16x16x32_bf16 v[44:47], a[208:211], a[64:67], v[44:47]
ds_read_b64_tr_b16 a[242:243], v12 offset:26112
v_mfma_f32_16x16x32_bf16 v[48:51], a[208:211], a[68:71], v[48:51]
v_mfma_f32_16x16x32_bf16 v[52:55], a[212:215], a[60:63], v[52:55]
ds_read_b64_tr_b16 a[204:205], v13 offset:25600
v_mfma_f32_16x16x32_bf16 v[56:59], a[212:215], a[64:67], v[56:59]
ds_read_b64_tr_b16 a[206:207], v13 offset:26112
v_mfma_f32_16x16x32_bf16 v[60:63], a[212:215], a[68:71], v[60:63]
v_mfma_f32_16x16x32_bf16 v[64:67], a[216:219], a[60:63], v[64:67]
ds_read_b64_tr_b16 a[208:209], v14 offset:25600
v_mfma_f32_16x16x32_bf16 v[68:71], a[216:219], a[64:67], v[68:71]
ds_read_b64_tr_b16 a[210:211], v14 offset:26112
v_mfma_f32_16x16x32_bf16 v[72:75], a[216:219], a[68:71], v[72:75]
s_waitcnt lgkmcnt(8)
v_mfma_f32_16x16x32_bf16 v[28:31], a[220:223], a[72:75], v[28:31]
ds_read_b64_tr_b16 a[212:213], v11 offset:26624
s_add_u32 m0, s64, 12288
v_mfma_f32_16x16x32_bf16 v[32:35], a[220:223], a[76:79], v[32:35]
ds_read_b64_tr_b16 a[214:215], v11 offset:27136
s_add_u32 s67, s65, 327808
v_mfma_f32_16x16x32_bf16 v[36:39], a[220:223], a[80:83], v[36:39]
buffer_load_dwordx4 v10, s[36:39], s67 offen sc1 lds
v_mfma_f32_16x16x32_bf16 v[40:43], a[224:227], a[72:75], v[40:43]
ds_read_b64_tr_b16 a[216:217], v12 offset:26624
s_add_u32 m0, s64, 14336
v_mfma_f32_16x16x32_bf16 v[44:47], a[224:227], a[76:79], v[44:47]
ds_read_b64_tr_b16 a[218:219], v12 offset:27136
s_add_u32 s67, s65, 256
v_mfma_f32_16x16x32_bf16 v[48:51], a[224:227], a[80:83], v[48:51]
buffer_load_dwordx4 v10, s[36:39], s67 offen sc1 lds
v_mfma_f32_16x16x32_bf16 v[52:55], a[228:231], a[72:75], v[52:55]
ds_read_b64_tr_b16 a[220:221], v13 offset:26624
v_mfma_f32_16x16x32_bf16 v[56:59], a[228:231], a[76:79], v[56:59]
ds_read_b64_tr_b16 a[222:223], v13 offset:27136
v_mfma_f32_16x16x32_bf16 v[60:63], a[228:231], a[80:83], v[60:63]
buffer_load_dwordx4 v10, s[40:43], s67 offen offset:1024 sc1 lds
v_mfma_f32_16x16x32_bf16 v[64:67], a[232:235], a[72:75], v[64:67]
ds_read_b64_tr_b16 a[224:225], v14 offset:26624
v_mfma_f32_16x16x32_bf16 v[68:71], a[232:235], a[76:79], v[68:71]
ds_read_b64_tr_b16 a[226:227], v14 offset:27136
v_mfma_f32_16x16x32_bf16 v[72:75], a[232:235], a[80:83], v[72:75]
s_waitcnt lgkmcnt(8)
v_mfma_f32_16x16x32_bf16 v[28:31], a[236:239], a[84:87], v[28:31]
ds_read_b64_tr_b16 a[228:229], v11 offset:27648
v_mfma_f32_16x16x32_bf16 v[32:35], a[236:239], a[88:91], v[32:35]
ds_read_b64_tr_b16 a[230:231], v11 offset:28160
v_mfma_f32_16x16x32_bf16 v[36:39], a[236:239], a[92:95], v[36:39]
v_mfma_f32_16x16x32_bf16 v[40:43], a[240:243], a[84:87], v[40:43]
ds_read_b64_tr_b16 a[232:233], v12 offset:27648
v_mfma_f32_16x16x32_bf16 v[44:47], a[240:243], a[88:91], v[44:47]
ds_read_b64_tr_b16 a[234:235], v12 offset:28160
v_mfma_f32_16x16x32_bf16 v[48:51], a[240:243], a[92:95], v[48:51]
v_mfma_f32_16x16x32_bf16 v[52:55], a[204:207], a[84:87], v[52:55]
ds_read_b64_tr_b16 a[236:237], v13 offset:27648
v_mfma_f32_16x16x32_bf16 v[56:59], a[204:207], a[88:91], v[56:59]
ds_read_b64_tr_b16 a[238:239], v13 offset:28160
v_mfma_f32_16x16x32_bf16 v[60:63], a[204:207], a[92:95], v[60:63]
v_mfma_f32_16x16x32_bf16 v[64:67], a[208:211], a[84:87], v[64:67]
ds_read_b64_tr_b16 a[240:241], v14 offset:27648
v_mfma_f32_16x16x32_bf16 v[68:71], a[208:211], a[88:91], v[68:71]
ds_read_b64_tr_b16 a[242:243], v14 offset:28160
v_mfma_f32_16x16x32_bf16 v[72:75], a[208:211], a[92:95], v[72:75]
s_waitcnt lgkmcnt(8)
v_mfma_f32_16x16x32_bf16 v[28:31], a[212:215], a[96:99], v[28:31]
s_waitcnt vmcnt(17)
s_barrier
ds_read_b64_tr_b16 a[204:205], v11 offset:28672
v_mfma_f32_16x16x32_bf16 v[32:35], a[212:215], a[100:103], v[32:35]
ds_read_b64_tr_b16 a[206:207], v11 offset:29184
s_add_u32 m0, s64, 16384
v_mfma_f32_16x16x32_bf16 v[36:39], a[212:215], a[104:107], v[36:39]
s_add_u32 s67, s65, 41216
buffer_load_dwordx4 v10, s[36:39], s67 offen sc1 lds
v_mfma_f32_16x16x32_bf16 v[40:43], a[216:219], a[96:99], v[40:43]
ds_read_b64_tr_b16 a[208:209], v12 offset:28672
v_mfma_f32_16x16x32_bf16 v[44:47], a[216:219], a[100:103], v[44:47]
ds_read_b64_tr_b16 a[210:211], v12 offset:29184
v_mfma_f32_16x16x32_bf16 v[48:51], a[216:219], a[104:107], v[48:51]
buffer_load_dwordx4 v10, s[40:43], s67 offen offset:1024 sc1 lds
v_mfma_f32_16x16x32_bf16 v[52:55], a[220:223], a[96:99], v[52:55]
ds_read_b64_tr_b16 a[212:213], v13 offset:28672
s_add_u32 m0, s64, 18432
v_mfma_f32_16x16x32_bf16 v[56:59], a[220:223], a[100:103], v[56:59]
ds_read_b64_tr_b16 a[214:215], v13 offset:29184
s_add_u32 s67, s65, 82176
v_mfma_f32_16x16x32_bf16 v[60:63], a[220:223], a[104:107], v[60:63]
buffer_load_dwordx4 v10, s[36:39], s67 offen sc1 lds
v_mfma_f32_16x16x32_bf16 v[64:67], a[224:227], a[96:99], v[64:67]
ds_read_b64_tr_b16 a[216:217], v14 offset:28672
v_mfma_f32_16x16x32_bf16 v[68:71], a[224:227], a[100:103], v[68:71]
ds_read_b64_tr_b16 a[218:219], v14 offset:29184
v_mfma_f32_16x16x32_bf16 v[72:75], a[224:227], a[104:107], v[72:75]
buffer_load_dwordx4 v10, s[40:43], s67 offen offset:1024 sc1 lds
s_waitcnt lgkmcnt(8)
v_mfma_f32_16x16x32_bf16 v[28:31], a[228:231], a[108:111], v[28:31]
ds_read_b64_tr_b16 a[220:221], v11 offset:29696
v_mfma_f32_16x16x32_bf16 v[32:35], a[228:231], a[112:115], v[32:35]
ds_read_b64_tr_b16 a[222:223], v11 offset:30208
v_mfma_f32_16x16x32_bf16 v[36:39], a[228:231], a[116:119], v[36:39]
v_mfma_f32_16x16x32_bf16 v[40:43], a[232:235], a[108:111], v[40:43]
ds_read_b64_tr_b16 a[224:225], v12 offset:29696
v_mfma_f32_16x16x32_bf16 v[44:47], a[232:235], a[112:115], v[44:47]
ds_read_b64_tr_b16 a[226:227], v12 offset:30208
v_mfma_f32_16x16x32_bf16 v[48:51], a[232:235], a[116:119], v[48:51]
v_mfma_f32_16x16x32_bf16 v[52:55], a[236:239], a[108:111], v[52:55]
ds_read_b64_tr_b16 a[228:229], v13 offset:29696
v_mfma_f32_16x16x32_bf16 v[56:59], a[236:239], a[112:115], v[56:59]
ds_read_b64_tr_b16 a[230:231], v13 offset:30208
v_mfma_f32_16x16x32_bf16 v[60:63], a[236:239], a[116:119], v[60:63]
v_mfma_f32_16x16x32_bf16 v[64:67], a[240:243], a[108:111], v[64:67]
ds_read_b64_tr_b16 a[232:233], v14 offset:29696
v_mfma_f32_16x16x32_bf16 v[68:71], a[240:243], a[112:115], v[68:71]
ds_read_b64_tr_b16 a[234:235], v14 offset:30208
v_mfma_f32_16x16x32_bf16 v[72:75], a[240:243], a[116:119], v[72:75]
s_waitcnt lgkmcnt(8)
v_mfma_f32_16x16x32_bf16 v[28:31], a[204:207], a[120:123], v[28:31]
ds_read_b64_tr_b16 a[236:237], v11 offset:30720
s_add_u32 m0, s64, 20480
v_mfma_f32_16x16x32_bf16 v[32:35], a[204:207], a[124:127], v[32:35]
ds_read_b64_tr_b16 a[238:239], v11 offset:31232
s_add_u32 s67, s65, 123136
v_mfma_f32_16x16x32_bf16 v[36:39], a[204:207], a[128:131], v[36:39]
buffer_load_dwordx4 v10, s[36:39], s67 offen sc1 lds
v_mfma_f32_16x16x32_bf16 v[40:43], a[208:211], a[120:123], v[40:43]
ds_read_b64_tr_b16 a[240:241], v12 offset:30720
v_mfma_f32_16x16x32_bf16 v[44:47], a[208:211], a[124:127], v[44:47]
ds_read_b64_tr_b16 a[242:243], v12 offset:31232
v_mfma_f32_16x16x32_bf16 v[48:51], a[208:211], a[128:131], v[48:51]
buffer_load_dwordx4 v10, s[40:43], s67 offen offset:1024 sc1 lds
v_mfma_f32_16x16x32_bf16 v[52:55], a[212:215], a[120:123], v[52:55]
ds_read_b64_tr_b16 a[204:205], v13 offset:30720
s_add_u32 m0, s64, 22528
v_mfma_f32_16x16x32_bf16 v[56:59], a[212:215], a[124:127], v[56:59]
ds_read_b64_tr_b16 a[206:207], v13 offset:31232
s_add_u32 s67, s65, 164096
v_mfma_f32_16x16x32_bf16 v[60:63], a[212:215], a[128:131], v[60:63]
buffer_load_dwordx4 v10, s[36:39], s67 offen sc1 lds
v_mfma_f32_16x16x32_bf16 v[64:67], a[216:219], a[120:123], v[64:67]
ds_read_b64_tr_b16 a[208:209], v14 offset:30720
v_mfma_f32_16x16x32_bf16 v[68:71], a[216:219], a[124:127], v[68:71]
ds_read_b64_tr_b16 a[210:211], v14 offset:31232
v_mfma_f32_16x16x32_bf16 v[72:75], a[216:219], a[128:131], v[72:75]
buffer_load_dwordx4 v10, s[40:43], s67 offen offset:1024 sc1 lds
s_waitcnt lgkmcnt(8)
v_mfma_f32_16x16x32_bf16 v[28:31], a[220:223], a[132:135], v[28:31]
ds_read_b64_tr_b16 a[212:213], v11 offset:31744
v_mfma_f32_16x16x32_bf16 v[32:35], a[220:223], a[136:139], v[32:35]
ds_read_b64_tr_b16 a[214:215], v11 offset:32256
v_mfma_f32_16x16x32_bf16 v[36:39], a[220:223], a[140:143], v[36:39]
v_mfma_f32_16x16x32_bf16 v[40:43], a[224:227], a[132:135], v[40:43]
ds_read_b64_tr_b16 a[216:217], v12 offset:31744
v_mfma_f32_16x16x32_bf16 v[44:47], a[224:227], a[136:139], v[44:47]
ds_read_b64_tr_b16 a[218:219], v12 offset:32256
v_mfma_f32_16x16x32_bf16 v[48:51], a[224:227], a[140:143], v[48:51]
v_mfma_f32_16x16x32_bf16 v[52:55], a[228:231], a[132:135], v[52:55]
ds_read_b64_tr_b16 a[220:221], v13 offset:31744
v_mfma_f32_16x16x32_bf16 v[56:59], a[228:231], a[136:139], v[56:59]
ds_read_b64_tr_b16 a[222:223], v13 offset:32256
v_mfma_f32_16x16x32_bf16 v[60:63], a[228:231], a[140:143], v[60:63]
v_mfma_f32_16x16x32_bf16 v[64:67], a[232:235], a[132:135], v[64:67]
ds_read_b64_tr_b16 a[224:225], v14 offset:31744
v_mfma_f32_16x16x32_bf16 v[68:71], a[232:235], a[136:139], v[68:71]
ds_read_b64_tr_b16 a[226:227], v14 offset:32256
v_mfma_f32_16x16x32_bf16 v[72:75], a[232:235], a[140:143], v[72:75]
s_waitcnt lgkmcnt(8)
v_mfma_f32_16x16x32_bf16 v[28:31], a[236:239], a[144:147], v[28:31]
ds_read_b64_tr_b16 a[228:229], v11 offset:32768
s_add_u32 m0, s64, 24576
v_mfma_f32_16x16x32_bf16 v[32:35], a[236:239], a[148:151], v[32:35]
ds_read_b64_tr_b16 a[230:231], v11 offset:33280
s_add_u32 s67, s65, 205056
v_mfma_f32_16x16x32_bf16 v[36:39], a[236:239], a[152:155], v[36:39]
buffer_load_dwordx4 v10, s[36:39], s67 offen sc1 lds
v_mfma_f32_16x16x32_bf16 v[40:43], a[240:243], a[144:147], v[40:43]
ds_read_b64_tr_b16 a[232:233], v12 offset:32768
v_mfma_f32_16x16x32_bf16 v[44:47], a[240:243], a[148:151], v[44:47]
ds_read_b64_tr_b16 a[234:235], v12 offset:33280
v_mfma_f32_16x16x32_bf16 v[48:51], a[240:243], a[152:155], v[48:51]
buffer_load_dwordx4 v10, s[40:43], s67 offen offset:1024 sc1 lds
v_mfma_f32_16x16x32_bf16 v[52:55], a[204:207], a[144:147], v[52:55]
ds_read_b64_tr_b16 a[236:237], v13 offset:32768
v_mfma_f32_16x16x32_bf16 v[56:59], a[204:207], a[148:151], v[56:59]
ds_read_b64_tr_b16 a[238:239], v13 offset:33280
v_mfma_f32_16x16x32_bf16 v[60:63], a[204:207], a[152:155], v[60:63]
v_mfma_f32_16x16x32_bf16 v[64:67], a[208:211], a[144:147], v[64:67]
ds_read_b64_tr_b16 a[240:241], v14 offset:32768
v_mfma_f32_16x16x32_bf16 v[68:71], a[208:211], a[148:151], v[68:71]
ds_read_b64_tr_b16 a[242:243], v14 offset:33280
v_mfma_f32_16x16x32_bf16 v[72:75], a[208:211], a[152:155], v[72:75]
s_waitcnt lgkmcnt(8)
v_mfma_f32_16x16x32_bf16 v[28:31], a[212:215], a[156:159], v[28:31]
ds_read_b64_tr_b16 a[204:205], v11 offset:33792
v_mfma_f32_16x16x32_bf16 v[32:35], a[212:215], a[160:163], v[32:35]
ds_read_b64_tr_b16 a[206:207], v11 offset:34304
v_mfma_f32_16x16x32_bf16 v[36:39], a[212:215], a[164:167], v[36:39]
v_mfma_f32_16x16x32_bf16 v[40:43], a[216:219], a[156:159], v[40:43]
ds_read_b64_tr_b16 a[208:209], v12 offset:33792
v_mfma_f32_16x16x32_bf16 v[44:47], a[216:219], a[160:163], v[44:47]
ds_read_b64_tr_b16 a[210:211], v12 offset:34304
v_mfma_f32_16x16x32_bf16 v[48:51], a[216:219], a[164:167], v[48:51]
v_mfma_f32_16x16x32_bf16 v[52:55], a[220:223], a[156:159], v[52:55]
ds_read_b64_tr_b16 a[212:213], v13 offset:33792
v_mfma_f32_16x16x32_bf16 v[56:59], a[220:223], a[160:163], v[56:59]
ds_read_b64_tr_b16 a[214:215], v13 offset:34304
v_mfma_f32_16x16x32_bf16 v[60:63], a[220:223], a[164:167], v[60:63]
v_mfma_f32_16x16x32_bf16 v[64:67], a[224:227], a[156:159], v[64:67]
ds_read_b64_tr_b16 a[216:217], v14 offset:33792
v_mfma_f32_16x16x32_bf16 v[68:71], a[224:227], a[160:163], v[68:71]
ds_read_b64_tr_b16 a[218:219], v14 offset:34304
v_mfma_f32_16x16x32_bf16 v[72:75], a[224:227], a[164:167], v[72:75]
s_waitcnt lgkmcnt(8)
v_mfma_f32_16x16x32_bf16 v[28:31], a[228:231], a[168:171], v[28:31]
ds_read_b64_tr_b16 a[220:221], v11 offset:34816
v_mfma_f32_16x16x32_bf16 v[32:35], a[228:231], a[172:175], v[32:35]
ds_read_b64_tr_b16 a[222:223], v11 offset:35328
v_mfma_f32_16x16x32_bf16 v[36:39], a[228:231], a[176:179], v[36:39]
v_mfma_f32_16x16x32_bf16 v[40:43], a[232:235], a[168:171], v[40:43]
ds_read_b64_tr_b16 a[224:225], v12 offset:34816
v_mfma_f32_16x16x32_bf16 v[44:47], a[232:235], a[172:175], v[44:47]
ds_read_b64_tr_b16 a[226:227], v12 offset:35328
v_mfma_f32_16x16x32_bf16 v[48:51], a[232:235], a[176:179], v[48:51]
v_mfma_f32_16x16x32_bf16 v[52:55], a[236:239], a[168:171], v[52:55]
ds_read_b64_tr_b16 a[228:229], v13 offset:34816
v_mfma_f32_16x16x32_bf16 v[56:59], a[236:239], a[172:175], v[56:59]
ds_read_b64_tr_b16 a[230:231], v13 offset:35328
v_mfma_f32_16x16x32_bf16 v[60:63], a[236:239], a[176:179], v[60:63]
v_mfma_f32_16x16x32_bf16 v[64:67], a[240:243], a[168:171], v[64:67]
ds_read_b64_tr_b16 a[232:233], v14 offset:34816
v_mfma_f32_16x16x32_bf16 v[68:71], a[240:243], a[172:175], v[68:71]
ds_read_b64_tr_b16 a[234:235], v14 offset:35328
v_mfma_f32_16x16x32_bf16 v[72:75], a[240:243], a[176:179], v[72:75]
s_waitcnt lgkmcnt(8)
v_mfma_f32_16x16x32_bf16 v[28:31], a[204:207], a[180:183], v[28:31]
ds_read_b64_tr_b16 a[236:237], v11 offset:36864
v_mfma_f32_16x16x32_bf16 v[32:35], a[204:207], a[184:187], v[32:35]
ds_read_b64_tr_b16 a[238:239], v11 offset:37376
v_mfma_f32_16x16x32_bf16 v[36:39], a[204:207], a[188:191], v[36:39]
v_mfma_f32_16x16x32_bf16 v[40:43], a[208:211], a[180:183], v[40:43]
ds_read_b64_tr_b16 a[240:241], v12 offset:36864
v_mfma_f32_16x16x32_bf16 v[44:47], a[208:211], a[184:187], v[44:47]
ds_read_b64_tr_b16 a[242:243], v12 offset:37376
v_mfma_f32_16x16x32_bf16 v[48:51], a[208:211], a[188:191], v[48:51]
v_mfma_f32_16x16x32_bf16 v[52:55], a[212:215], a[180:183], v[52:55]
ds_read_b64_tr_b16 a[204:205], v13 offset:36864
v_mfma_f32_16x16x32_bf16 v[56:59], a[212:215], a[184:187], v[56:59]
ds_read_b64_tr_b16 a[206:207], v13 offset:37376
v_mfma_f32_16x16x32_bf16 v[60:63], a[212:215], a[188:191], v[60:63]
v_mfma_f32_16x16x32_bf16 v[64:67], a[216:219], a[180:183], v[64:67]
ds_read_b64_tr_b16 a[208:209], v14 offset:36864
v_mfma_f32_16x16x32_bf16 v[68:71], a[216:219], a[184:187], v[68:71]
ds_read_b64_tr_b16 a[210:211], v14 offset:37376
v_mfma_f32_16x16x32_bf16 v[72:75], a[216:219], a[188:191], v[72:75]
s_waitcnt lgkmcnt(8)
v_mfma_f32_16x16x32_bf16 v[28:31], a[220:223], a[192:195], v[28:31]
ds_read_b64_tr_b16 a[212:213], v11 offset:37888
v_mfma_f32_16x16x32_bf16 v[32:35], a[220:223], a[196:199], v[32:35]
ds_read_b64_tr_b16 a[214:215], v11 offset:38400
v_mfma_f32_16x16x32_bf16 v[36:39], a[220:223], a[200:203], v[36:39]
v_mfma_f32_16x16x32_bf16 v[40:43], a[224:227], a[192:195], v[40:43]
ds_read_b64_tr_b16 a[216:217], v12 offset:37888
v_mfma_f32_16x16x32_bf16 v[44:47], a[224:227], a[196:199], v[44:47]
ds_read_b64_tr_b16 a[218:219], v12 offset:38400
v_mfma_f32_16x16x32_bf16 v[48:51], a[224:227], a[200:203], v[48:51]
v_mfma_f32_16x16x32_bf16 v[52:55], a[228:231], a[192:195], v[52:55]
ds_read_b64_tr_b16 a[220:221], v13 offset:37888
v_mfma_f32_16x16x32_bf16 v[56:59], a[228:231], a[196:199], v[56:59]
ds_read_b64_tr_b16 a[222:223], v13 offset:38400
v_mfma_f32_16x16x32_bf16 v[60:63], a[228:231], a[200:203], v[60:63]
v_mfma_f32_16x16x32_bf16 v[64:67], a[232:235], a[192:195], v[64:67]
ds_read_b64_tr_b16 a[224:225], v14 offset:37888
v_mfma_f32_16x16x32_bf16 v[68:71], a[232:235], a[196:199], v[68:71]
ds_read_b64_tr_b16 a[226:227], v14 offset:38400
v_mfma_f32_16x16x32_bf16 v[72:75], a[232:235], a[200:203], v[72:75]
s_waitcnt lgkmcnt(8)
v_mfma_f32_16x16x32_bf16 v[76:79], a[236:239], a[0:3], 0
s_waitcnt vmcnt(17)
s_barrier
ds_read_b64_tr_b16 a[228:229], v11 offset:38912
v_mfma_f32_16x16x32_bf16 v[80:83], a[236:239], a[4:7], 0
ds_read_b64_tr_b16 a[230:231], v11 offset:39424
s_add_u32 m0, s64, 26624
v_mfma_f32_16x16x32_bf16 v[84:87], a[236:239], a[8:11], 0
s_add_u32 s67, s65, 246016
buffer_load_dwordx4 v10, s[36:39], s67 offen sc1 lds
v_mfma_f32_16x16x32_bf16 v[88:91], a[240:243], a[0:3], 0
ds_read_b64_tr_b16 a[232:233], v12 offset:38912
v_cvt_pk_bf16_f32 v124, v28, v29
v_mfma_f32_16x16x32_bf16 v[92:95], a[240:243], a[4:7], 0
ds_read_b64_tr_b16 a[234:235], v12 offset:39424
v_cvt_pk_bf16_f32 v125, v30, v31
v_mfma_f32_16x16x32_bf16 v[96:99], a[240:243], a[8:11], 0
buffer_load_dwordx4 v10, s[40:43], s67 offen offset:1024 sc1 lds
v_cvt_pk_bf16_f32 v128, v32, v33
v_mfma_f32_16x16x32_bf16 v[100:103], a[204:207], a[0:3], 0
ds_read_b64_tr_b16 a[236:237], v13 offset:38912
s_add_u32 m0, s64, 28672
v_mfma_f32_16x16x32_bf16 v[104:107], a[204:207], a[4:7], 0
ds_read_b64_tr_b16 a[238:239], v13 offset:39424
s_add_u32 s67, s65, 286976
v_mfma_f32_16x16x32_bf16 v[108:111], a[204:207], a[8:11], 0
buffer_load_dwordx4 v10, s[36:39], s67 offen sc1 lds
v_cvt_pk_bf16_f32 v129, v34, v35
v_mfma_f32_16x16x32_bf16 v[112:115], a[208:211], a[0:3], 0
ds_read_b64_tr_b16 a[240:241], v14 offset:38912
v_cvt_pk_bf16_f32 v132, v36, v37
v_mfma_f32_16x16x32_bf16 v[116:119], a[208:211], a[4:7], 0
ds_read_b64_tr_b16 a[242:243], v14 offset:39424
v_cvt_pk_bf16_f32 v133, v38, v39
v_mfma_f32_16x16x32_bf16 v[120:123], a[208:211], a[8:11], 0
buffer_load_dwordx4 v10, s[40:43], s67 offen offset:1024 sc1 lds
s_waitcnt lgkmcnt(8)
v_mfma_f32_16x16x32_bf16 v[76:79], a[212:215], a[12:15], v[76:79]
ds_read_b64_tr_b16 a[204:205], v11 offset:39936
v_cvt_pk_bf16_f32 v126, v40, v41
v_mfma_f32_16x16x32_bf16 v[80:83], a[212:215], a[16:19], v[80:83]
ds_read_b64_tr_b16 a[206:207], v11 offset:40448
v_cvt_pk_bf16_f32 v127, v42, v43
v_mfma_f32_16x16x32_bf16 v[84:87], a[212:215], a[20:23], v[84:87]
v_mfma_f32_16x16x32_bf16 v[88:91], a[216:219], a[12:15], v[88:91]
ds_read_b64_tr_b16 a[208:209], v12 offset:39936
v_mfma_f32_16x16x32_bf16 v[92:95], a[216:219], a[16:19], v[92:95]
ds_read_b64_tr_b16 a[210:211], v12 offset:40448
v_mfma_f32_16x16x32_bf16 v[96:99], a[216:219], a[20:23], v[96:99]
v_mfma_f32_16x16x32_bf16 v[100:103], a[220:223], a[12:15], v[100:103]
ds_read_b64_tr_b16 a[212:213], v13 offset:39936
v_mfma_f32_16x16x32_bf16 v[104:107], a[220:223], a[16:19], v[104:107]
ds_read_b64_tr_b16 a[214:215], v13 offset:40448
v_mfma_f32_16x16x32_bf16 v[108:111], a[220:223], a[20:23], v[108:111]
v_mfma_f32_16x16x32_bf16 v[112:115], a[224:227], a[12:15], v[112:115]
ds_read_b64_tr_b16 a[216:217], v14 offset:39936
v_mfma_f32_16x16x32_bf16 v[116:119], a[224:227], a[16:19], v[116:119]
ds_read_b64_tr_b16 a[218:219], v14 offset:40448
v_mfma_f32_16x16x32_bf16 v[120:123], a[224:227], a[20:23], v[120:123]
s_waitcnt lgkmcnt(8)
v_mfma_f32_16x16x32_bf16 v[76:79], a[228:231], a[24:27], v[76:79]
ds_read_b64_tr_b16 a[220:221], v11 offset:0
s_add_u32 m0, s64, 30720
v_mfma_f32_16x16x32_bf16 v[80:83], a[228:231], a[28:31], v[80:83]
ds_read_b64_tr_b16 a[222:223], v11 offset:512
s_add_u32 s67, s65, 327936
v_mfma_f32_16x16x32_bf16 v[84:87], a[228:231], a[32:35], v[84:87]
buffer_load_dwordx4 v10, s[36:39], s67 offen sc1 lds
v_cvt_pk_bf16_f32 v130, v44, v45
v_mfma_f32_16x16x32_bf16 v[88:91], a[232:235], a[24:27], v[88:91]
ds_read_b64_tr_b16 a[224:225], v12 offset:0
s_add_u32 m0, s64, 32768
v_mfma_f32_16x16x32_bf16 v[92:95], a[232:235], a[28:31], v[92:95]
ds_read_b64_tr_b16 a[226:227], v12 offset:512
s_add_u32 s67, s65, 384
v_mfma_f32_16x16x32_bf16 v[96:99], a[232:235], a[32:35], v[96:99]
buffer_load_dwordx4 v10, s[36:39], s67 offen sc1 lds
v_cvt_pk_bf16_f32 v131, v46, v47
v_mfma_f32_16x16x32_bf16 v[100:103], a[236:239], a[24:27], v[100:103]
ds_read_b64_tr_b16 a[228:229], v13 offset:0
v_cvt_pk_bf16_f32 v134, v48, v49
v_mfma_f32_16x16x32_bf16 v[104:107], a[236:239], a[28:31], v[104:107]
ds_read_b64_tr_b16 a[230:231], v13 offset:512
v_cvt_pk_bf16_f32 v135, v50, v51
v_mfma_f32_16x16x32_bf16 v[108:111], a[236:239], a[32:35], v[108:111]
buffer_load_dwordx4 v10, s[40:43], s67 offen offset:1024 sc1 lds
v_cvt_pk_bf16_f32 v136, v52, v53
v_mfma_f32_16x16x32_bf16 v[112:115], a[240:243], a[24:27], v[112:115]
ds_read_b64_tr_b16 a[232:233], v14 offset:0
v_cvt_pk_bf16_f32 v137, v54, v55
v_mfma_f32_16x16x32_bf16 v[116:119], a[240:243], a[28:31], v[116:119]
ds_read_b64_tr_b16 a[234:235], v14 offset:512
v_cvt_pk_bf16_f32 v140, v56, v57
v_mfma_f32_16x16x32_bf16 v[120:123], a[240:243], a[32:35], v[120:123]
v_cvt_pk_bf16_f32 v141, v58, v59
s_waitcnt lgkmcnt(8)
v_mfma_f32_16x16x32_bf16 v[76:79], a[204:207], a[36:39], v[76:79]
ds_read_b64_tr_b16 a[236:237], v11 offset:1024
v_mfma_f32_16x16x32_bf16 v[80:83], a[204:207], a[40:43], v[80:83]
ds_read_b64_tr_b16 a[238:239], v11 offset:1536
v_mfma_f32_16x16x32_bf16 v[84:87], a[204:207], a[44:47], v[84:87]
v_mfma_f32_16x16x32_bf16 v[88:91], a[208:211], a[36:39], v[88:91]
ds_read_b64_tr_b16 a[240:241], v12 offset:1024
v_mfma_f32_16x16x32_bf16 v[92:95], a[208:211], a[40:43], v[92:95]
ds_read_b64_tr_b16 a[242:243], v12 offset:1536
v_mfma_f32_16x16x32_bf16 v[96:99], a[208:211], a[44:47], v[96:99]
v_mfma_f32_16x16x32_bf16 v[100:103], a[212:215], a[36:39], v[100:103]
ds_read_b64_tr_b16 a[204:205], v13 offset:1024
v_mfma_f32_16x16x32_bf16 v[104:107], a[212:215], a[40:43], v[104:107]
ds_read_b64_tr_b16 a[206:207], v13 offset:1536
v_mfma_f32_16x16x32_bf16 v[108:111], a[212:215], a[44:47], v[108:111]
v_mfma_f32_16x16x32_bf16 v[112:115], a[216:219], a[36:39], v[112:115]
ds_read_b64_tr_b16 a[208:209], v14 offset:1024
v_mfma_f32_16x16x32_bf16 v[116:119], a[216:219], a[40:43], v[116:119]
ds_read_b64_tr_b16 a[210:211], v14 offset:1536
v_mfma_f32_16x16x32_bf16 v[120:123], a[216:219], a[44:47], v[120:123]
s_waitcnt lgkmcnt(8)
v_mfma_f32_16x16x32_bf16 v[76:79], a[220:223], a[48:51], v[76:79]
ds_read_b64_tr_b16 a[212:213], v11 offset:2048
s_add_u32 m0, s64, 34816
v_mfma_f32_16x16x32_bf16 v[80:83], a[220:223], a[52:55], v[80:83]
ds_read_b64_tr_b16 a[214:215], v11 offset:2560
s_add_u32 s67, s65, 41344
v_mfma_f32_16x16x32_bf16 v[84:87], a[220:223], a[56:59], v[84:87]
buffer_load_dwordx4 v10, s[36:39], s67 offen sc1 lds
v_cvt_pk_bf16_f32 v144, v60, v61
v_mfma_f32_16x16x32_bf16 v[88:91], a[224:227], a[48:51], v[88:91]
ds_read_b64_tr_b16 a[216:217], v12 offset:2048
v_cvt_pk_bf16_f32 v145, v62, v63
v_mfma_f32_16x16x32_bf16 v[92:95], a[224:227], a[52:55], v[92:95]
ds_read_b64_tr_b16 a[218:219], v12 offset:2560
v_cvt_pk_bf16_f32 v138, v64, v65
v_mfma_f32_16x16x32_bf16 v[96:99], a[224:227], a[56:59], v[96:99]
buffer_load_dwordx4 v10, s[40:43], s67 offen offset:1024 sc1 lds
v_cvt_pk_bf16_f32 v139, v66, v67
v_mfma_f32_16x16x32_bf16 v[100:103], a[228:231], a[48:51], v[100:103]
ds_read_b64_tr_b16 a[220:221], v13 offset:2048
v_cvt_pk_bf16_f32 v142, v68, v69
v_mfma_f32_16x16x32_bf16 v[104:107], a[228:231], a[52:55], v[104:107]
ds_read_b64_tr_b16 a[222:223], v13 offset:2560
v_cvt_pk_bf16_f32 v143, v70, v71
v_mfma_f32_16x16x32_bf16 v[108:111], a[228:231], a[56:59], v[108:111]
v_cvt_pk_bf16_f32 v146, v72, v73
v_cvt_pk_bf16_f32 v147, v74, v75
v_mfma_f32_16x16x32_bf16 v[112:115], a[232:235], a[48:51], v[112:115]
ds_read_b64_tr_b16 a[224:225], v14 offset:2048
v_mfma_f32_16x16x32_bf16 v[116:119], a[232:235], a[52:55], v[116:119]
ds_read_b64_tr_b16 a[226:227], v14 offset:2560
v_mfma_f32_16x16x32_bf16 v[120:123], a[232:235], a[56:59], v[120:123]
s_waitcnt lgkmcnt(8)
v_mfma_f32_16x16x32_bf16 v[76:79], a[236:239], a[60:63], v[76:79]
ds_read_b64_tr_b16 a[228:229], v11 offset:3072
v_mfma_f32_16x16x32_bf16 v[80:83], a[236:239], a[64:67], v[80:83]
ds_read_b64_tr_b16 a[230:231], v11 offset:3584
v_mfma_f32_16x16x32_bf16 v[84:87], a[236:239], a[68:71], v[84:87]
v_mfma_f32_16x16x32_bf16 v[88:91], a[240:243], a[60:63], v[88:91]
ds_read_b64_tr_b16 a[232:233], v12 offset:3072
v_mfma_f32_16x16x32_bf16 v[92:95], a[240:243], a[64:67], v[92:95]
ds_read_b64_tr_b16 a[234:235], v12 offset:3584
v_mfma_f32_16x16x32_bf16 v[96:99], a[240:243], a[68:71], v[96:99]
v_mfma_f32_16x16x32_bf16 v[100:103], a[204:207], a[60:63], v[100:103]
ds_read_b64_tr_b16 a[236:237], v13 offset:3072
v_mfma_f32_16x16x32_bf16 v[104:107], a[204:207], a[64:67], v[104:107]
ds_read_b64_tr_b16 a[238:239], v13 offset:3584
v_mfma_f32_16x16x32_bf16 v[108:111], a[204:207], a[68:71], v[108:111]
v_mfma_f32_16x16x32_bf16 v[112:115], a[208:211], a[60:63], v[112:115]
ds_read_b64_tr_b16 a[240:241], v14 offset:3072
v_mfma_f32_16x16x32_bf16 v[116:119], a[208:211], a[64:67], v[116:119]
ds_read_b64_tr_b16 a[242:243], v14 offset:3584
v_mfma_f32_16x16x32_bf16 v[120:123], a[208:211], a[68:71], v[120:123]
s_waitcnt lgkmcnt(8)
v_mfma_f32_16x16x32_bf16 v[76:79], a[212:215], a[72:75], v[76:79]
ds_read_b64_tr_b16 a[204:205], v11 offset:4096
v_mfma_f32_16x16x32_bf16 v[80:83], a[212:215], a[76:79], v[80:83]
ds_read_b64_tr_b16 a[206:207], v11 offset:4608
v_mfma_f32_16x16x32_bf16 v[84:87], a[212:215], a[80:83], v[84:87]
buffer_load_dwordx4 a[252:255], v255, s[56:59], s3 offen
v_mfma_f32_16x16x32_bf16 v[88:91], a[216:219], a[72:75], v[88:91]
ds_read_b64_tr_b16 a[208:209], v12 offset:4096
v_mfma_f32_16x16x32_bf16 v[92:95], a[216:219], a[76:79], v[92:95]
ds_read_b64_tr_b16 a[210:211], v12 offset:4608
v_mfma_f32_16x16x32_bf16 v[96:99], a[216:219], a[80:83], v[96:99]
v_mfma_f32_16x16x32_bf16 v[100:103], a[220:223], a[72:75], v[100:103]
ds_read_b64_tr_b16 a[212:213], v13 offset:4096
v_mfma_f32_16x16x32_bf16 v[104:107], a[220:223], a[76:79], v[104:107]
ds_read_b64_tr_b16 a[214:215], v13 offset:4608
v_mfma_f32_16x16x32_bf16 v[108:111], a[220:223], a[80:83], v[108:111]
v_mfma_f32_16x16x32_bf16 v[112:115], a[224:227], a[72:75], v[112:115]
ds_read_b64_tr_b16 a[216:217], v14 offset:4096
v_mfma_f32_16x16x32_bf16 v[116:119], a[224:227], a[76:79], v[116:119]
ds_read_b64_tr_b16 a[218:219], v14 offset:4608
v_mfma_f32_16x16x32_bf16 v[120:123], a[224:227], a[80:83], v[120:123]
s_waitcnt lgkmcnt(8)
v_mfma_f32_16x16x32_bf16 v[76:79], a[228:231], a[84:87], v[76:79]
ds_read_b64_tr_b16 a[220:221], v11 offset:5120
v_mfma_f32_16x16x32_bf16 v[80:83], a[228:231], a[88:91], v[80:83]
ds_read_b64_tr_b16 a[222:223], v11 offset:5632
v_mfma_f32_16x16x32_bf16 v[84:87], a[228:231], a[92:95], v[84:87]
v_mfma_f32_16x16x32_bf16 v[88:91], a[232:235], a[84:87], v[88:91]
ds_read_b64_tr_b16 a[224:225], v12 offset:5120
v_mfma_f32_16x16x32_bf16 v[92:95], a[232:235], a[88:91], v[92:95]
ds_read_b64_tr_b16 a[226:227], v12 offset:5632
v_mfma_f32_16x16x32_bf16 v[96:99], a[232:235], a[92:95], v[96:99]
v_mfma_f32_16x16x32_bf16 v[100:103], a[236:239], a[84:87], v[100:103]
ds_read_b64_tr_b16 a[228:229], v13 offset:5120
v_mfma_f32_16x16x32_bf16 v[104:107], a[236:239], a[88:91], v[104:107]
ds_read_b64_tr_b16 a[230:231], v13 offset:5632
v_mfma_f32_16x16x32_bf16 v[108:111], a[236:239], a[92:95], v[108:111]
v_mfma_f32_16x16x32_bf16 v[112:115], a[240:243], a[84:87], v[112:115]
ds_read_b64_tr_b16 a[232:233], v14 offset:5120
v_mfma_f32_16x16x32_bf16 v[116:119], a[240:243], a[88:91], v[116:119]
ds_read_b64_tr_b16 a[234:235], v14 offset:5632
v_mfma_f32_16x16x32_bf16 v[120:123], a[240:243], a[92:95], v[120:123]
s_waitcnt lgkmcnt(8)
v_mfma_f32_16x16x32_bf16 v[76:79], a[204:207], a[96:99], v[76:79]
ds_read_b64_tr_b16 a[236:237], v11 offset:6144
v_mfma_f32_16x16x32_bf16 v[80:83], a[204:207], a[100:103], v[80:83]
ds_read_b64_tr_b16 a[238:239], v11 offset:6656
v_mfma_f32_16x16x32_bf16 v[84:87], a[204:207], a[104:107], v[84:87]
v_mfma_f32_16x16x32_bf16 v[88:91], a[208:211], a[96:99], v[88:91]
ds_read_b64_tr_b16 a[240:241], v12 offset:6144
v_mfma_f32_16x16x32_bf16 v[92:95], a[208:211], a[100:103], v[92:95]
ds_read_b64_tr_b16 a[242:243], v12 offset:6656
v_mfma_f32_16x16x32_bf16 v[96:99], a[208:211], a[104:107], v[96:99]
v_mfma_f32_16x16x32_bf16 v[100:103], a[212:215], a[96:99], v[100:103]
ds_read_b64_tr_b16 a[204:205], v13 offset:6144
v_mfma_f32_16x16x32_bf16 v[104:107], a[212:215], a[100:103], v[104:107]
ds_read_b64_tr_b16 a[206:207], v13 offset:6656
v_mfma_f32_16x16x32_bf16 v[108:111], a[212:215], a[104:107], v[108:111]
v_mfma_f32_16x16x32_bf16 v[112:115], a[216:219], a[96:99], v[112:115]
ds_read_b64_tr_b16 a[208:209], v14 offset:6144
v_mfma_f32_16x16x32_bf16 v[116:119], a[216:219], a[100:103], v[116:119]
ds_read_b64_tr_b16 a[210:211], v14 offset:6656
v_mfma_f32_16x16x32_bf16 v[120:123], a[216:219], a[104:107], v[120:123]
s_waitcnt lgkmcnt(8)
v_mfma_f32_16x16x32_bf16 v[76:79], a[220:223], a[108:111], v[76:79]
ds_read_b64_tr_b16 a[212:213], v11 offset:7168
v_mfma_f32_16x16x32_bf16 v[80:83], a[220:223], a[112:115], v[80:83]
ds_read_b64_tr_b16 a[214:215], v11 offset:7680
v_mfma_f32_16x16x32_bf16 v[84:87], a[220:223], a[116:119], v[84:87]
v_mfma_f32_16x16x32_bf16 v[88:91], a[224:227], a[108:111], v[88:91]
ds_read_b64_tr_b16 a[216:217], v12 offset:7168
v_mfma_f32_16x16x32_bf16 v[92:95], a[224:227], a[112:115], v[92:95]
ds_read_b64_tr_b16 a[218:219], v12 offset:7680
v_mfma_f32_16x16x32_bf16 v[96:99], a[224:227], a[116:119], v[96:99]
v_mfma_f32_16x16x32_bf16 v[100:103], a[228:231], a[108:111], v[100:103]
ds_read_b64_tr_b16 a[220:221], v13 offset:7168
v_mfma_f32_16x16x32_bf16 v[104:107], a[228:231], a[112:115], v[104:107]
ds_read_b64_tr_b16 a[222:223], v13 offset:7680
v_mfma_f32_16x16x32_bf16 v[108:111], a[228:231], a[116:119], v[108:111]
v_mfma_f32_16x16x32_bf16 v[112:115], a[232:235], a[108:111], v[112:115]
ds_read_b64_tr_b16 a[224:225], v14 offset:7168
v_mfma_f32_16x16x32_bf16 v[116:119], a[232:235], a[112:115], v[116:119]
ds_read_b64_tr_b16 a[226:227], v14 offset:7680
v_mfma_f32_16x16x32_bf16 v[120:123], a[232:235], a[116:119], v[120:123]
s_waitcnt lgkmcnt(8)
v_mfma_f32_16x16x32_bf16 v[76:79], a[236:239], a[120:123], v[76:79]
s_waitcnt vmcnt(18)
s_barrier
ds_read_b64_tr_b16 a[228:229], v11 offset:8192
v_mfma_f32_16x16x32_bf16 v[80:83], a[236:239], a[124:127], v[80:83]
ds_read_b64_tr_b16 a[230:231], v11 offset:8704
s_add_u32 m0, s64, 36864
v_mfma_f32_16x16x32_bf16 v[84:87], a[236:239], a[128:131], v[84:87]
s_add_u32 s67, s65, 82304
buffer_load_dwordx4 v10, s[36:39], s67 offen sc1 lds
v_mfma_f32_16x16x32_bf16 v[88:91], a[240:243], a[120:123], v[88:91]
ds_read_b64_tr_b16 a[232:233], v12 offset:8192
v_mfma_f32_16x16x32_bf16 v[92:95], a[240:243], a[124:127], v[92:95]
ds_read_b64_tr_b16 a[234:235], v12 offset:8704
v_mfma_f32_16x16x32_bf16 v[96:99], a[240:243], a[128:131], v[96:99]
buffer_load_dwordx4 v10, s[40:43], s67 offen offset:1024 sc1 lds
v_mfma_f32_16x16x32_bf16 v[100:103], a[204:207], a[120:123], v[100:103]
ds_read_b64_tr_b16 a[236:237], v13 offset:8192
s_add_u32 m0, s64, 38912
v_mfma_f32_16x16x32_bf16 v[104:107], a[204:207], a[124:127], v[104:107]
ds_read_b64_tr_b16 a[238:239], v13 offset:8704
s_add_u32 s67, s65, 123264
v_mfma_f32_16x16x32_bf16 v[108:111], a[204:207], a[128:131], v[108:111]
buffer_load_dwordx4 v10, s[36:39], s67 offen sc1 lds
v_mfma_f32_16x16x32_bf16 v[112:115], a[208:211], a[120:123], v[112:115]
ds_read_b64_tr_b16 a[240:241], v14 offset:8192
v_mfma_f32_16x16x32_bf16 v[116:119], a[208:211], a[124:127], v[116:119]
ds_read_b64_tr_b16 a[242:243], v14 offset:8704
v_mfma_f32_16x16x32_bf16 v[120:123], a[208:211], a[128:131], v[120:123]
buffer_load_dwordx4 v10, s[40:43], s67 offen offset:1024 sc1 lds
s_waitcnt lgkmcnt(8)
v_mfma_f32_16x16x32_bf16 v[76:79], a[212:215], a[132:135], v[76:79]
ds_read_b64_tr_b16 a[204:205], v11 offset:9216
v_mfma_f32_16x16x32_bf16 v[80:83], a[212:215], a[136:139], v[80:83]
ds_read_b64_tr_b16 a[206:207], v11 offset:9728
v_mfma_f32_16x16x32_bf16 v[84:87], a[212:215], a[140:143], v[84:87]
v_mfma_f32_16x16x32_bf16 v[88:91], a[216:219], a[132:135], v[88:91]
ds_read_b64_tr_b16 a[208:209], v12 offset:9216
v_mfma_f32_16x16x32_bf16 v[92:95], a[216:219], a[136:139], v[92:95]
ds_read_b64_tr_b16 a[210:211], v12 offset:9728
v_mfma_f32_16x16x32_bf16 v[96:99], a[216:219], a[140:143], v[96:99]
v_mfma_f32_16x16x32_bf16 v[100:103], a[220:223], a[132:135], v[100:103]
ds_read_b64_tr_b16 a[212:213], v13 offset:9216
v_mfma_f32_16x16x32_bf16 v[104:107], a[220:223], a[136:139], v[104:107]
ds_read_b64_tr_b16 a[214:215], v13 offset:9728
v_mfma_f32_16x16x32_bf16 v[108:111], a[220:223], a[140:143], v[108:111]
v_mfma_f32_16x16x32_bf16 v[112:115], a[224:227], a[132:135], v[112:115]
ds_read_b64_tr_b16 a[216:217], v14 offset:9216
v_mfma_f32_16x16x32_bf16 v[116:119], a[224:227], a[136:139], v[116:119]
ds_read_b64_tr_b16 a[218:219], v14 offset:9728
v_mfma_f32_16x16x32_bf16 v[120:123], a[224:227], a[140:143], v[120:123]
s_waitcnt lgkmcnt(8)
v_mfma_f32_16x16x32_bf16 v[76:79], a[228:231], a[144:147], v[76:79]
ds_read_b64_tr_b16 a[220:221], v11 offset:10240
s_add_u32 m0, s64, 0
v_mfma_f32_16x16x32_bf16 v[80:83], a[228:231], a[148:151], v[80:83]
ds_read_b64_tr_b16 a[222:223], v11 offset:10752
s_add_u32 s67, s65, 164224
v_mfma_f32_16x16x32_bf16 v[84:87], a[228:231], a[152:155], v[84:87]
buffer_load_dwordx4 v10, s[36:39], s67 offen sc1 lds
v_mfma_f32_16x16x32_bf16 v[88:91], a[232:235], a[144:147], v[88:91]
ds_read_b64_tr_b16 a[224:225], v12 offset:10240
v_mfma_f32_16x16x32_bf16 v[92:95], a[232:235], a[148:151], v[92:95]
ds_read_b64_tr_b16 a[226:227], v12 offset:10752
v_mfma_f32_16x16x32_bf16 v[96:99], a[232:235], a[152:155], v[96:99]
buffer_load_dwordx4 v10, s[40:43], s67 offen offset:1024 sc1 lds
v_mfma_f32_16x16x32_bf16 v[100:103], a[236:239], a[144:147], v[100:103]
ds_read_b64_tr_b16 a[228:229], v13 offset:10240
s_add_u32 m0, s64, 2048
v_mfma_f32_16x16x32_bf16 v[104:107], a[236:239], a[148:151], v[104:107]
ds_read_b64_tr_b16 a[230:231], v13 offset:10752
s_add_u32 s67, s65, 205184
v_mfma_f32_16x16x32_bf16 v[108:111], a[236:239], a[152:155], v[108:111]
buffer_load_dwordx4 v10, s[36:39], s67 offen sc1 lds
v_mfma_f32_16x16x32_bf16 v[112:115], a[240:243], a[144:147], v[112:115]
ds_read_b64_tr_b16 a[232:233], v14 offset:10240
v_mfma_f32_16x16x32_bf16 v[116:119], a[240:243], a[148:151], v[116:119]
ds_read_b64_tr_b16 a[234:235], v14 offset:10752
v_mfma_f32_16x16x32_bf16 v[120:123], a[240:243], a[152:155], v[120:123]
buffer_load_dwordx4 v10, s[40:43], s67 offen offset:1024 sc1 lds
s_waitcnt lgkmcnt(8)
v_mfma_f32_16x16x32_bf16 v[76:79], a[204:207], a[156:159], v[76:79]
ds_read_b64_tr_b16 a[236:237], v11 offset:11264
v_mfma_f32_16x16x32_bf16 v[80:83], a[204:207], a[160:163], v[80:83]
ds_read_b64_tr_b16 a[238:239], v11 offset:11776
v_mfma_f32_16x16x32_bf16 v[84:87], a[204:207], a[164:167], v[84:87]
v_mfma_f32_16x16x32_bf16 v[88:91], a[208:211], a[156:159], v[88:91]
ds_read_b64_tr_b16 a[240:241], v12 offset:11264
v_mfma_f32_16x16x32_bf16 v[92:95], a[208:211], a[160:163], v[92:95]
ds_read_b64_tr_b16 a[242:243], v12 offset:11776
v_mfma_f32_16x16x32_bf16 v[96:99], a[208:211], a[164:167], v[96:99]
v_mfma_f32_16x16x32_bf16 v[100:103], a[212:215], a[156:159], v[100:103]
ds_read_b64_tr_b16 a[204:205], v13 offset:11264
v_mfma_f32_16x16x32_bf16 v[104:107], a[212:215], a[160:163], v[104:107]
ds_read_b64_tr_b16 a[206:207], v13 offset:11776
v_mfma_f32_16x16x32_bf16 v[108:111], a[212:215], a[164:167], v[108:111]
v_mfma_f32_16x16x32_bf16 v[112:115], a[216:219], a[156:159], v[112:115]
ds_read_b64_tr_b16 a[208:209], v14 offset:11264
v_mfma_f32_16x16x32_bf16 v[116:119], a[216:219], a[160:163], v[116:119]
ds_read_b64_tr_b16 a[210:211], v14 offset:11776
v_mfma_f32_16x16x32_bf16 v[120:123], a[216:219], a[164:167], v[120:123]
s_waitcnt lgkmcnt(8)
v_mfma_f32_16x16x32_bf16 v[76:79], a[220:223], a[168:171], v[76:79]
ds_read_b64_tr_b16 a[212:213], v11 offset:12288
s_add_u32 m0, s64, 4096
v_mfma_f32_16x16x32_bf16 v[80:83], a[220:223], a[172:175], v[80:83]
ds_read_b64_tr_b16 a[214:215], v11 offset:12800
s_add_u32 s67, s65, 246144
v_mfma_f32_16x16x32_bf16 v[84:87], a[220:223], a[176:179], v[84:87]
buffer_load_dwordx4 v10, s[36:39], s67 offen sc1 lds
v_mfma_f32_16x16x32_bf16 v[88:91], a[224:227], a[168:171], v[88:91]
ds_read_b64_tr_b16 a[216:217], v12 offset:12288
v_mfma_f32_16x16x32_bf16 v[92:95], a[224:227], a[172:175], v[92:95]
ds_read_b64_tr_b16 a[218:219], v12 offset:12800
v_mfma_f32_16x16x32_bf16 v[96:99], a[224:227], a[176:179], v[96:99]
buffer_load_dwordx4 v10, s[40:43], s67 offen offset:1024 sc1 lds
v_mfma_f32_16x16x32_bf16 v[100:103], a[228:231], a[168:171], v[100:103]
ds_read_b64_tr_b16 a[220:221], v13 offset:12288
v_mfma_f32_16x16x32_bf16 v[104:107], a[228:231], a[172:175], v[104:107]
ds_read_b64_tr_b16 a[222:223], v13 offset:12800
v_mfma_f32_16x16x32_bf16 v[108:111], a[228:231], a[176:179], v[108:111]
v_mfma_f32_16x16x32_bf16 v[112:115], a[232:235], a[168:171], v[112:115]
ds_read_b64_tr_b16 a[224:225], v14 offset:12288
v_mfma_f32_16x16x32_bf16 v[116:119], a[232:235], a[172:175], v[116:119]
ds_read_b64_tr_b16 a[226:227], v14 offset:12800
v_mfma_f32_16x16x32_bf16 v[120:123], a[232:235], a[176:179], v[120:123]
s_waitcnt lgkmcnt(8)
v_mfma_f32_16x16x32_bf16 v[76:79], a[236:239], a[180:183], v[76:79]
ds_read_b64_tr_b16 a[228:229], v11 offset:14336
v_mfma_f32_16x16x32_bf16 v[80:83], a[236:239], a[184:187], v[80:83]
ds_read_b64_tr_b16 a[230:231], v11 offset:14848
v_mfma_f32_16x16x32_bf16 v[84:87], a[236:239], a[188:191], v[84:87]
v_mfma_f32_16x16x32_bf16 v[88:91], a[240:243], a[180:183], v[88:91]
ds_read_b64_tr_b16 a[232:233], v12 offset:14336
v_mfma_f32_16x16x32_bf16 v[92:95], a[240:243], a[184:187], v[92:95]
ds_read_b64_tr_b16 a[234:235], v12 offset:14848
v_mfma_f32_16x16x32_bf16 v[96:99], a[240:243], a[188:191], v[96:99]
v_mfma_f32_16x16x32_bf16 v[100:103], a[204:207], a[180:183], v[100:103]
ds_read_b64_tr_b16 a[236:237], v13 offset:14336
v_mfma_f32_16x16x32_bf16 v[104:107], a[204:207], a[184:187], v[104:107]
ds_read_b64_tr_b16 a[238:239], v13 offset:14848
v_mfma_f32_16x16x32_bf16 v[108:111], a[204:207], a[188:191], v[108:111]
v_mfma_f32_16x16x32_bf16 v[112:115], a[208:211], a[180:183], v[112:115]
ds_read_b64_tr_b16 a[240:241], v14 offset:14336
v_mfma_f32_16x16x32_bf16 v[116:119], a[208:211], a[184:187], v[116:119]
ds_read_b64_tr_b16 a[242:243], v14 offset:14848
v_mfma_f32_16x16x32_bf16 v[120:123], a[208:211], a[188:191], v[120:123]
s_waitcnt lgkmcnt(8)
v_mfma_f32_16x16x32_bf16 v[76:79], a[212:215], a[192:195], v[76:79]
ds_read_b64_tr_b16 a[204:205], v11 offset:15360
v_mfma_f32_16x16x32_bf16 v[80:83], a[212:215], a[196:199], v[80:83]
ds_read_b64_tr_b16 a[206:207], v11 offset:15872
v_mfma_f32_16x16x32_bf16 v[84:87], a[212:215], a[200:203], v[84:87]
v_mfma_f32_16x16x32_bf16 v[88:91], a[216:219], a[192:195], v[88:91]
ds_read_b64_tr_b16 a[208:209], v12 offset:15360
v_mfma_f32_16x16x32_bf16 v[92:95], a[216:219], a[196:199], v[92:95]
ds_read_b64_tr_b16 a[210:211], v12 offset:15872
v_mfma_f32_16x16x32_bf16 v[96:99], a[216:219], a[200:203], v[96:99]
v_mfma_f32_16x16x32_bf16 v[100:103], a[220:223], a[192:195], v[100:103]
ds_read_b64_tr_b16 a[212:213], v13 offset:15360
v_mfma_f32_16x16x32_bf16 v[104:107], a[220:223], a[196:199], v[104:107]
ds_read_b64_tr_b16 a[214:215], v13 offset:15872
v_mfma_f32_16x16x32_bf16 v[108:111], a[220:223], a[200:203], v[108:111]
v_mfma_f32_16x16x32_bf16 v[112:115], a[224:227], a[192:195], v[112:115]
ds_read_b64_tr_b16 a[216:217], v14 offset:15360
v_mfma_f32_16x16x32_bf16 v[116:119], a[224:227], a[196:199], v[116:119]
ds_read_b64_tr_b16 a[218:219], v14 offset:15872
v_mfma_f32_16x16x32_bf16 v[120:123], a[224:227], a[200:203], v[120:123]
s_waitcnt lgkmcnt(8)
v_mfma_f32_16x16x32_bf16 v[28:31], a[228:231], a[0:3], 0
ds_read_b64_tr_b16 a[220:221], v11 offset:16384
v_mfma_f32_16x16x32_bf16 v[32:35], a[228:231], a[4:7], 0
ds_read_b64_tr_b16 a[222:223], v11 offset:16896
v_mfma_f32_16x16x32_bf16 v[36:39], a[228:231], a[8:11], 0
v_cvt_pk_bf16_f32 v148, v76, v77
v_cvt_pk_bf16_f32 v149, v78, v79
v_mfma_f32_16x16x32_bf16 v[40:43], a[232:235], a[0:3], 0
ds_read_b64_tr_b16 a[224:225], v12 offset:16384
v_cvt_pk_bf16_f32 v152, v80, v81
v_mfma_f32_16x16x32_bf16 v[44:47], a[232:235], a[4:7], 0
ds_read_b64_tr_b16 a[226:227], v12 offset:16896
v_cvt_pk_bf16_f32 v153, v82, v83
v_mfma_f32_16x16x32_bf16 v[48:51], a[232:235], a[8:11], 0
v_cvt_pk_bf16_f32 v156, v84, v85
v_cvt_pk_bf16_f32 v157, v86, v87
v_mfma_f32_16x16x32_bf16 v[52:55], a[236:239], a[0:3], 0
ds_read_b64_tr_b16 a[228:229], v13 offset:16384
v_cvt_pk_bf16_f32 v150, v88, v89
v_mfma_f32_16x16x32_bf16 v[56:59], a[236:239], a[4:7], 0
ds_read_b64_tr_b16 a[230:231], v13 offset:16896
v_cvt_pk_bf16_f32 v151, v90, v91
v_mfma_f32_16x16x32_bf16 v[60:63], a[236:239], a[8:11], 0
v_mfma_f32_16x16x32_bf16 v[64:67], a[240:243], a[0:3], 0
ds_read_b64_tr_b16 a[232:233], v14 offset:16384
v_mfma_f32_16x16x32_bf16 v[68:71], a[240:243], a[4:7], 0
ds_read_b64_tr_b16 a[234:235], v14 offset:16896
v_mfma_f32_16x16x32_bf16 v[72:75], a[240:243], a[8:11], 0
s_waitcnt lgkmcnt(8)
v_mfma_f32_16x16x32_bf16 v[28:31], a[204:207], a[12:15], v[28:31]
ds_read_b64_tr_b16 a[236:237], v11 offset:17408
v_mfma_f32_16x16x32_bf16 v[32:35], a[204:207], a[16:19], v[32:35]
ds_read_b64_tr_b16 a[238:239], v11 offset:17920
v_mfma_f32_16x16x32_bf16 v[36:39], a[204:207], a[20:23], v[36:39]
v_mfma_f32_16x16x32_bf16 v[40:43], a[208:211], a[12:15], v[40:43]
ds_read_b64_tr_b16 a[240:241], v12 offset:17408
v_mfma_f32_16x16x32_bf16 v[44:47], a[208:211], a[16:19], v[44:47]
ds_read_b64_tr_b16 a[242:243], v12 offset:17920
v_mfma_f32_16x16x32_bf16 v[48:51], a[208:211], a[20:23], v[48:51]
v_mfma_f32_16x16x32_bf16 v[52:55], a[212:215], a[12:15], v[52:55]
ds_read_b64_tr_b16 a[204:205], v13 offset:17408
v_mfma_f32_16x16x32_bf16 v[56:59], a[212:215], a[16:19], v[56:59]
ds_read_b64_tr_b16 a[206:207], v13 offset:17920
v_mfma_f32_16x16x32_bf16 v[60:63], a[212:215], a[20:23], v[60:63]
v_mfma_f32_16x16x32_bf16 v[64:67], a[216:219], a[12:15], v[64:67]
ds_read_b64_tr_b16 a[208:209], v14 offset:17408
v_mfma_f32_16x16x32_bf16 v[68:71], a[216:219], a[16:19], v[68:71]
ds_read_b64_tr_b16 a[210:211], v14 offset:17920
v_mfma_f32_16x16x32_bf16 v[72:75], a[216:219], a[20:23], v[72:75]
s_waitcnt lgkmcnt(8)
v_mfma_f32_16x16x32_bf16 v[28:31], a[220:223], a[24:27], v[28:31]
s_waitcnt vmcnt(18)
s_barrier
ds_read_b64_tr_b16 a[212:213], v11 offset:18432
v_mfma_f32_16x16x32_bf16 v[32:35], a[220:223], a[28:31], v[32:35]
ds_read_b64_tr_b16 a[214:215], v11 offset:18944
s_add_u32 m0, s64, 6144
v_mfma_f32_16x16x32_bf16 v[36:39], a[220:223], a[32:35], v[36:39]
s_add_u32 s67, s65, 287104
buffer_load_dwordx4 v10, s[36:39], s67 offen sc1 lds
v_mfma_f32_16x16x32_bf16 v[40:43], a[224:227], a[24:27], v[40:43]
ds_read_b64_tr_b16 a[216:217], v12 offset:18432
v_cvt_pk_bf16_f32 v154, v92, v93
v_mfma_f32_16x16x32_bf16 v[44:47], a[224:227], a[28:31], v[44:47]
ds_read_b64_tr_b16 a[218:219], v12 offset:18944
v_cvt_pk_bf16_f32 v155, v94, v95
v_mfma_f32_16x16x32_bf16 v[48:51], a[224:227], a[32:35], v[48:51]
buffer_load_dwordx4 v10, s[40:43], s67 offen offset:1024 sc1 lds
v_cvt_pk_bf16_f32 v158, v96, v97
v_mfma_f32_16x16x32_bf16 v[52:55], a[228:231], a[24:27], v[52:55]
ds_read_b64_tr_b16 a[220:221], v13 offset:18432
s_add_u32 m0, s64, 8192
v_mfma_f32_16x16x32_bf16 v[56:59], a[228:231], a[28:31], v[56:59]
ds_read_b64_tr_b16 a[222:223], v13 offset:18944
s_add_u32 s67, s65, 328064
v_mfma_f32_16x16x32_bf16 v[60:63], a[228:231], a[32:35], v[60:63]
buffer_load_dwordx4 v10, s[36:39], s67 offen sc1 lds
v_cvt_pk_bf16_f32 v159, v98, v99
v_mfma_f32_16x16x32_bf16 v[64:67], a[232:235], a[24:27], v[64:67]
ds_read_b64_tr_b16 a[224:225], v14 offset:18432
v_cvt_pk_bf16_f32 v160, v100, v101
v_mfma_f32_16x16x32_bf16 v[68:71], a[232:235], a[28:31], v[68:71]
ds_read_b64_tr_b16 a[226:227], v14 offset:18944
v_cvt_pk_bf16_f32 v161, v102, v103
v_mfma_f32_16x16x32_bf16 v[72:75], a[232:235], a[32:35], v[72:75]
v_cvt_pk_bf16_f32 v164, v104, v105
s_waitcnt lgkmcnt(8)
v_mfma_f32_16x16x32_bf16 v[28:31], a[236:239], a[36:39], v[28:31]
ds_read_b64_tr_b16 a[228:229], v11 offset:19456
v_cvt_pk_bf16_f32 v165, v106, v107
v_mfma_f32_16x16x32_bf16 v[32:35], a[236:239], a[40:43], v[32:35]
ds_read_b64_tr_b16 a[230:231], v11 offset:19968
v_mfma_f32_16x16x32_bf16 v[36:39], a[236:239], a[44:47], v[36:39]
v_mfma_f32_16x16x32_bf16 v[40:43], a[240:243], a[36:39], v[40:43]
ds_read_b64_tr_b16 a[232:233], v12 offset:19456
v_mfma_f32_16x16x32_bf16 v[44:47], a[240:243], a[40:43], v[44:47]
ds_read_b64_tr_b16 a[234:235], v12 offset:19968
v_mfma_f32_16x16x32_bf16 v[48:51], a[240:243], a[44:47], v[48:51]
v_mfma_f32_16x16x32_bf16 v[52:55], a[204:207], a[36:39], v[52:55]
ds_read_b64_tr_b16 a[236:237], v13 offset:19456
v_mfma_f32_16x16x32_bf16 v[56:59], a[204:207], a[40:43], v[56:59]
ds_read_b64_tr_b16 a[238:239], v13 offset:19968
v_mfma_f32_16x16x32_bf16 v[60:63], a[204:207], a[44:47], v[60:63]
v_mfma_f32_16x16x32_bf16 v[64:67], a[208:211], a[36:39], v[64:67]
ds_read_b64_tr_b16 a[240:241], v14 offset:19456
v_mfma_f32_16x16x32_bf16 v[68:71], a[208:211], a[40:43], v[68:71]
ds_read_b64_tr_b16 a[242:243], v14 offset:19968
v_mfma_f32_16x16x32_bf16 v[72:75], a[208:211], a[44:47], v[72:75]
s_waitcnt lgkmcnt(8)
v_mfma_f32_16x16x32_bf16 v[28:31], a[212:215], a[48:51], v[28:31]
ds_read_b64_tr_b16 a[204:205], v11 offset:20480
s_add_u32 m0, s64, 10240
v_mfma_f32_16x16x32_bf16 v[32:35], a[212:215], a[52:55], v[32:35]
ds_read_b64_tr_b16 a[206:207], v11 offset:20992
s_add_u32 s67, s65, 512
v_mfma_f32_16x16x32_bf16 v[36:39], a[212:215], a[56:59], v[36:39]
buffer_load_dwordx4 v10, s[36:39], s67 offen sc1 lds
v_cvt_pk_bf16_f32 v168, v108, v109
v_mfma_f32_16x16x32_bf16 v[40:43], a[216:219], a[48:51], v[40:43]
ds_read_b64_tr_b16 a[208:209], v12 offset:20480
v_cvt_pk_bf16_f32 v169, v110, v111
v_mfma_f32_16x16x32_bf16 v[44:47], a[216:219], a[52:55], v[44:47]
ds_read_b64_tr_b16 a[210:211], v12 offset:20992
v_cvt_pk_bf16_f32 v162, v112, v113
v_mfma_f32_16x16x32_bf16 v[48:51], a[216:219], a[56:59], v[48:51]
buffer_load_dwordx4 v10, s[40:43], s67 offen offset:1024 sc1 lds
v_cvt_pk_bf16_f32 v163, v114, v115
v_mfma_f32_16x16x32_bf16 v[52:55], a[220:223], a[48:51], v[52:55]
ds_read_b64_tr_b16 a[212:213], v13 offset:20480
s_add_u32 m0, s64, 12288
v_mfma_f32_16x16x32_bf16 v[56:59], a[220:223], a[52:55], v[56:59]
ds_read_b64_tr_b16 a[214:215], v13 offset:20992
s_add_u32 s67, s65, 41472
v_mfma_f32_16x16x32_bf16 v[60:63], a[220:223], a[56:59], v[60:63]
buffer_load_dwordx4 v10, s[36:39], s67 offen sc1 lds
v_cvt_pk_bf16_f32 v166, v116, v117
v_mfma_f32_16x16x32_bf16 v[64:67], a[224:227], a[48:51], v[64:67]
ds_read_b64_tr_b16 a[216:217], v14 offset:20480
v_cvt_pk_bf16_f32 v167, v118, v119
v_mfma_f32_16x16x32_bf16 v[68:71], a[224:227], a[52:55], v[68:71]
ds_read_b64_tr_b16 a[218:219], v14 offset:20992
v_cvt_pk_bf16_f32 v170, v120, v121
v_mfma_f32_16x16x32_bf16 v[72:75], a[224:227], a[56:59], v[72:75]
buffer_load_dwordx4 v10, s[40:43], s67 offen offset:1024 sc1 lds
s_waitcnt lgkmcnt(8)
v_mfma_f32_16x16x32_bf16 v[28:31], a[228:231], a[60:63], v[28:31]
ds_read_b64_tr_b16 a[220:221], v11 offset:21504
v_cvt_pk_bf16_f32 v171, v122, v123
v_mfma_f32_16x16x32_bf16 v[32:35], a[228:231], a[64:67], v[32:35]
ds_read_b64_tr_b16 a[222:223], v11 offset:22016
v_mfma_f32_16x16x32_bf16 v[36:39], a[228:231], a[68:71], v[36:39]
v_mfma_f32_16x16x32_bf16 v[40:43], a[232:235], a[60:63], v[40:43]
ds_read_b64_tr_b16 a[224:225], v12 offset:21504
v_mfma_f32_16x16x32_bf16 v[44:47], a[232:235], a[64:67], v[44:47]
ds_read_b64_tr_b16 a[226:227], v12 offset:22016
v_mfma_f32_16x16x32_bf16 v[48:51], a[232:235], a[68:71], v[48:51]
v_mfma_f32_16x16x32_bf16 v[52:55], a[236:239], a[60:63], v[52:55]
ds_read_b64_tr_b16 a[228:229], v13 offset:21504
v_mfma_f32_16x16x32_bf16 v[56:59], a[236:239], a[64:67], v[56:59]
ds_read_b64_tr_b16 a[230:231], v13 offset:22016
v_mfma_f32_16x16x32_bf16 v[60:63], a[236:239], a[68:71], v[60:63]
v_mfma_f32_16x16x32_bf16 v[64:67], a[240:243], a[60:63], v[64:67]
ds_read_b64_tr_b16 a[232:233], v14 offset:21504
v_mfma_f32_16x16x32_bf16 v[68:71], a[240:243], a[64:67], v[68:71]
ds_read_b64_tr_b16 a[234:235], v14 offset:22016
v_mfma_f32_16x16x32_bf16 v[72:75], a[240:243], a[68:71], v[72:75]
s_waitcnt lgkmcnt(8)
v_mfma_f32_16x16x32_bf16 v[28:31], a[204:207], a[72:75], v[28:31]
ds_read_b64_tr_b16 a[236:237], v11 offset:22528
s_add_u32 m0, s64, 14336
v_mfma_f32_16x16x32_bf16 v[32:35], a[204:207], a[76:79], v[32:35]
ds_read_b64_tr_b16 a[238:239], v11 offset:23040
s_add_u32 s67, s65, 82432
v_mfma_f32_16x16x32_bf16 v[36:39], a[204:207], a[80:83], v[36:39]
buffer_load_dwordx4 v10, s[36:39], s67 offen sc1 lds
v_mfma_f32_16x16x32_bf16 v[40:43], a[208:211], a[72:75], v[40:43]
ds_read_b64_tr_b16 a[240:241], v12 offset:22528
v_mfma_f32_16x16x32_bf16 v[44:47], a[208:211], a[76:79], v[44:47]
ds_read_b64_tr_b16 a[242:243], v12 offset:23040
v_mfma_f32_16x16x32_bf16 v[48:51], a[208:211], a[80:83], v[48:51]
buffer_load_dwordx4 v10, s[40:43], s67 offen offset:1024 sc1 lds
v_mfma_f32_16x16x32_bf16 v[52:55], a[212:215], a[72:75], v[52:55]
ds_read_b64_tr_b16 a[204:205], v13 offset:22528
v_mfma_f32_16x16x32_bf16 v[56:59], a[212:215], a[76:79], v[56:59]
ds_read_b64_tr_b16 a[206:207], v13 offset:23040
v_mfma_f32_16x16x32_bf16 v[60:63], a[212:215], a[80:83], v[60:63]
v_mfma_f32_16x16x32_bf16 v[64:67], a[216:219], a[72:75], v[64:67]
ds_read_b64_tr_b16 a[208:209], v14 offset:22528
v_mfma_f32_16x16x32_bf16 v[68:71], a[216:219], a[76:79], v[68:71]
ds_read_b64_tr_b16 a[210:211], v14 offset:23040
v_mfma_f32_16x16x32_bf16 v[72:75], a[216:219], a[80:83], v[72:75]
s_waitcnt lgkmcnt(8)
v_mfma_f32_16x16x32_bf16 v[28:31], a[220:223], a[84:87], v[28:31]
ds_read_b64_tr_b16 a[212:213], v11 offset:23552
v_mfma_f32_16x16x32_bf16 v[32:35], a[220:223], a[88:91], v[32:35]
ds_read_b64_tr_b16 a[214:215], v11 offset:24064
v_mfma_f32_16x16x32_bf16 v[36:39], a[220:223], a[92:95], v[36:39]
v_mfma_f32_16x16x32_bf16 v[40:43], a[224:227], a[84:87], v[40:43]
ds_read_b64_tr_b16 a[216:217], v12 offset:23552
v_mfma_f32_16x16x32_bf16 v[44:47], a[224:227], a[88:91], v[44:47]
ds_read_b64_tr_b16 a[218:219], v12 offset:24064
v_mfma_f32_16x16x32_bf16 v[48:51], a[224:227], a[92:95], v[48:51]
v_mfma_f32_16x16x32_bf16 v[52:55], a[228:231], a[84:87], v[52:55]
ds_read_b64_tr_b16 a[220:221], v13 offset:23552
v_mfma_f32_16x16x32_bf16 v[56:59], a[228:231], a[88:91], v[56:59]
ds_read_b64_tr_b16 a[222:223], v13 offset:24064
v_mfma_f32_16x16x32_bf16 v[60:63], a[228:231], a[92:95], v[60:63]
v_mfma_f32_16x16x32_bf16 v[64:67], a[232:235], a[84:87], v[64:67]
ds_read_b64_tr_b16 a[224:225], v14 offset:23552
v_mfma_f32_16x16x32_bf16 v[68:71], a[232:235], a[88:91], v[68:71]
ds_read_b64_tr_b16 a[226:227], v14 offset:24064
v_mfma_f32_16x16x32_bf16 v[72:75], a[232:235], a[92:95], v[72:75]
s_waitcnt lgkmcnt(8)
v_mfma_f32_16x16x32_bf16 v[28:31], a[236:239], a[96:99], v[28:31]
ds_read_b64_tr_b16 a[228:229], v11 offset:24576
v_mfma_f32_16x16x32_bf16 v[32:35], a[236:239], a[100:103], v[32:35]
ds_read_b64_tr_b16 a[230:231], v11 offset:25088
v_mfma_f32_16x16x32_bf16 v[36:39], a[236:239], a[104:107], v[36:39]
v_mfma_f32_16x16x32_bf16 v[40:43], a[240:243], a[96:99], v[40:43]
ds_read_b64_tr_b16 a[232:233], v12 offset:24576
v_mfma_f32_16x16x32_bf16 v[44:47], a[240:243], a[100:103], v[44:47]
ds_read_b64_tr_b16 a[234:235], v12 offset:25088
v_mfma_f32_16x16x32_bf16 v[48:51], a[240:243], a[104:107], v[48:51]
v_mfma_f32_16x16x32_bf16 v[52:55], a[204:207], a[96:99], v[52:55]
ds_read_b64_tr_b16 a[236:237], v13 offset:24576
v_mfma_f32_16x16x32_bf16 v[56:59], a[204:207], a[100:103], v[56:59]
ds_read_b64_tr_b16 a[238:239], v13 offset:25088
v_mfma_f32_16x16x32_bf16 v[60:63], a[204:207], a[104:107], v[60:63]
v_mfma_f32_16x16x32_bf16 v[64:67], a[208:211], a[96:99], v[64:67]
ds_read_b64_tr_b16 a[240:241], v14 offset:24576
v_mfma_f32_16x16x32_bf16 v[68:71], a[208:211], a[100:103], v[68:71]
ds_read_b64_tr_b16 a[242:243], v14 offset:25088
v_mfma_f32_16x16x32_bf16 v[72:75], a[208:211], a[104:107], v[72:75]
s_waitcnt lgkmcnt(8)
v_mfma_f32_16x16x32_bf16 v[28:31], a[212:215], a[108:111], v[28:31]
ds_read_b64_tr_b16 a[204:205], v11 offset:25600
v_mfma_f32_16x16x32_bf16 v[32:35], a[212:215], a[112:115], v[32:35]
ds_read_b64_tr_b16 a[206:207], v11 offset:26112
v_mfma_f32_16x16x32_bf16 v[36:39], a[212:215], a[116:119], v[36:39]
v_mfma_f32_16x16x32_bf16 v[40:43], a[216:219], a[108:111], v[40:43]
ds_read_b64_tr_b16 a[208:209], v12 offset:25600
v_mfma_f32_16x16x32_bf16 v[44:47], a[216:219], a[112:115], v[44:47]
ds_read_b64_tr_b16 a[210:211], v12 offset:26112
v_mfma_f32_16x16x32_bf16 v[48:51], a[216:219], a[116:119], v[48:51]
v_mfma_f32_16x16x32_bf16 v[52:55], a[220:223], a[108:111], v[52:55]
ds_read_b64_tr_b16 a[212:213], v13 offset:25600
v_mfma_f32_16x16x32_bf16 v[56:59], a[220:223], a[112:115], v[56:59]
ds_read_b64_tr_b16 a[214:215], v13 offset:26112
v_mfma_f32_16x16x32_bf16 v[60:63], a[220:223], a[116:119], v[60:63]
v_mfma_f32_16x16x32_bf16 v[64:67], a[224:227], a[108:111], v[64:67]
ds_read_b64_tr_b16 a[216:217], v14 offset:25600
v_mfma_f32_16x16x32_bf16 v[68:71], a[224:227], a[112:115], v[68:71]
ds_read_b64_tr_b16 a[218:219], v14 offset:26112
v_mfma_f32_16x16x32_bf16 v[72:75], a[224:227], a[116:119], v[72:75]
s_waitcnt lgkmcnt(8)
v_mfma_f32_16x16x32_bf16 v[28:31], a[228:231], a[120:123], v[28:31]
ds_read_b64_tr_b16 a[220:221], v11 offset:26624
v_mfma_f32_16x16x32_bf16 v[32:35], a[228:231], a[124:127], v[32:35]
ds_read_b64_tr_b16 a[222:223], v11 offset:27136
v_mfma_f32_16x16x32_bf16 v[36:39], a[228:231], a[128:131], v[36:39]
v_mfma_f32_16x16x32_bf16 v[40:43], a[232:235], a[120:123], v[40:43]
ds_read_b64_tr_b16 a[224:225], v12 offset:26624
v_mfma_f32_16x16x32_bf16 v[44:47], a[232:235], a[124:127], v[44:47]
ds_read_b64_tr_b16 a[226:227], v12 offset:27136
v_mfma_f32_16x16x32_bf16 v[48:51], a[232:235], a[128:131], v[48:51]
v_mfma_f32_16x16x32_bf16 v[52:55], a[236:239], a[120:123], v[52:55]
ds_read_b64_tr_b16 a[228:229], v13 offset:26624
v_mfma_f32_16x16x32_bf16 v[56:59], a[236:239], a[124:127], v[56:59]
ds_read_b64_tr_b16 a[230:231], v13 offset:27136
v_mfma_f32_16x16x32_bf16 v[60:63], a[236:239], a[128:131], v[60:63]
v_mfma_f32_16x16x32_bf16 v[64:67], a[240:243], a[120:123], v[64:67]
ds_read_b64_tr_b16 a[232:233], v14 offset:26624
v_mfma_f32_16x16x32_bf16 v[68:71], a[240:243], a[124:127], v[68:71]
ds_read_b64_tr_b16 a[234:235], v14 offset:27136
v_mfma_f32_16x16x32_bf16 v[72:75], a[240:243], a[128:131], v[72:75]
s_waitcnt lgkmcnt(8)
v_mfma_f32_16x16x32_bf16 v[28:31], a[204:207], a[132:135], v[28:31]
ds_read_b64_tr_b16 a[236:237], v11 offset:27648
v_mfma_f32_16x16x32_bf16 v[32:35], a[204:207], a[136:139], v[32:35]
ds_read_b64_tr_b16 a[238:239], v11 offset:28160
v_mfma_f32_16x16x32_bf16 v[36:39], a[204:207], a[140:143], v[36:39]
v_mfma_f32_16x16x32_bf16 v[40:43], a[208:211], a[132:135], v[40:43]
ds_read_b64_tr_b16 a[240:241], v12 offset:27648
v_mfma_f32_16x16x32_bf16 v[44:47], a[208:211], a[136:139], v[44:47]
ds_read_b64_tr_b16 a[242:243], v12 offset:28160
v_mfma_f32_16x16x32_bf16 v[48:51], a[208:211], a[140:143], v[48:51]
v_mfma_f32_16x16x32_bf16 v[52:55], a[212:215], a[132:135], v[52:55]
ds_read_b64_tr_b16 a[204:205], v13 offset:27648
v_mfma_f32_16x16x32_bf16 v[56:59], a[212:215], a[136:139], v[56:59]
ds_read_b64_tr_b16 a[206:207], v13 offset:28160
v_mfma_f32_16x16x32_bf16 v[60:63], a[212:215], a[140:143], v[60:63]
v_mfma_f32_16x16x32_bf16 v[64:67], a[216:219], a[132:135], v[64:67]
ds_read_b64_tr_b16 a[208:209], v14 offset:27648
v_mfma_f32_16x16x32_bf16 v[68:71], a[216:219], a[136:139], v[68:71]
ds_read_b64_tr_b16 a[210:211], v14 offset:28160
v_mfma_f32_16x16x32_bf16 v[72:75], a[216:219], a[140:143], v[72:75]
s_waitcnt lgkmcnt(8)
v_mfma_f32_16x16x32_bf16 v[28:31], a[220:223], a[144:147], v[28:31]
s_waitcnt vmcnt(17)
s_barrier
ds_read_b64_tr_b16 a[212:213], v11 offset:28672
v_mfma_f32_16x16x32_bf16 v[32:35], a[220:223], a[148:151], v[32:35]
ds_read_b64_tr_b16 a[214:215], v11 offset:29184
s_add_u32 m0, s64, 16384
v_mfma_f32_16x16x32_bf16 v[36:39], a[220:223], a[152:155], v[36:39]
s_add_u32 s67, s65, 123392
buffer_load_dwordx4 v10, s[36:39], s67 offen sc1 lds
v_mfma_f32_16x16x32_bf16 v[40:43], a[224:227], a[144:147], v[40:43]
ds_read_b64_tr_b16 a[216:217], v12 offset:28672
v_mfma_f32_16x16x32_bf16 v[44:47], a[224:227], a[148:151], v[44:47]
ds_read_b64_tr_b16 a[218:219], v12 offset:29184
v_mfma_f32_16x16x32_bf16 v[48:51], a[224:227], a[152:155], v[48:51]
buffer_load_dwordx4 v10, s[40:43], s67 offen offset:1024 sc1 lds
v_mfma_f32_16x16x32_bf16 v[52:55], a[228:231], a[144:147], v[52:55]
ds_read_b64_tr_b16 a[220:221], v13 offset:28672
s_add_u32 m0, s64, 18432
v_mfma_f32_16x16x32_bf16 v[56:59], a[228:231], a[148:151], v[56:59]
ds_read_b64_tr_b16 a[222:223], v13 offset:29184
s_add_u32 s67, s65, 164352
v_mfma_f32_16x16x32_bf16 v[60:63], a[228:231], a[152:155], v[60:63]
buffer_load_dwordx4 v10, s[36:39], s67 offen sc1 lds
v_mfma_f32_16x16x32_bf16 v[64:67], a[232:235], a[144:147], v[64:67]
ds_read_b64_tr_b16 a[224:225], v14 offset:28672
v_mfma_f32_16x16x32_bf16 v[68:71], a[232:235], a[148:151], v[68:71]
ds_read_b64_tr_b16 a[226:227], v14 offset:29184
v_mfma_f32_16x16x32_bf16 v[72:75], a[232:235], a[152:155], v[72:75]
buffer_load_dwordx4 v10, s[40:43], s67 offen offset:1024 sc1 lds
s_waitcnt lgkmcnt(8)
v_mfma_f32_16x16x32_bf16 v[28:31], a[236:239], a[156:159], v[28:31]
ds_read_b64_tr_b16 a[228:229], v11 offset:29696
v_mfma_f32_16x16x32_bf16 v[32:35], a[236:239], a[160:163], v[32:35]
ds_read_b64_tr_b16 a[230:231], v11 offset:30208
v_mfma_f32_16x16x32_bf16 v[36:39], a[236:239], a[164:167], v[36:39]
v_mfma_f32_16x16x32_bf16 v[40:43], a[240:243], a[156:159], v[40:43]
ds_read_b64_tr_b16 a[232:233], v12 offset:29696
v_mfma_f32_16x16x32_bf16 v[44:47], a[240:243], a[160:163], v[44:47]
ds_read_b64_tr_b16 a[234:235], v12 offset:30208
v_mfma_f32_16x16x32_bf16 v[48:51], a[240:243], a[164:167], v[48:51]
v_mfma_f32_16x16x32_bf16 v[52:55], a[204:207], a[156:159], v[52:55]
ds_read_b64_tr_b16 a[236:237], v13 offset:29696
v_mfma_f32_16x16x32_bf16 v[56:59], a[204:207], a[160:163], v[56:59]
ds_read_b64_tr_b16 a[238:239], v13 offset:30208
v_mfma_f32_16x16x32_bf16 v[60:63], a[204:207], a[164:167], v[60:63]
v_mfma_f32_16x16x32_bf16 v[64:67], a[208:211], a[156:159], v[64:67]
ds_read_b64_tr_b16 a[240:241], v14 offset:29696
v_mfma_f32_16x16x32_bf16 v[68:71], a[208:211], a[160:163], v[68:71]
ds_read_b64_tr_b16 a[242:243], v14 offset:30208
v_mfma_f32_16x16x32_bf16 v[72:75], a[208:211], a[164:167], v[72:75]
s_waitcnt lgkmcnt(8)
v_mfma_f32_16x16x32_bf16 v[28:31], a[212:215], a[168:171], v[28:31]
ds_read_b64_tr_b16 a[204:205], v11 offset:30720
s_add_u32 m0, s64, 20480
v_mfma_f32_16x16x32_bf16 v[32:35], a[212:215], a[172:175], v[32:35]
ds_read_b64_tr_b16 a[206:207], v11 offset:31232
s_add_u32 s67, s65, 205312
v_mfma_f32_16x16x32_bf16 v[36:39], a[212:215], a[176:179], v[36:39]
buffer_load_dwordx4 v10, s[36:39], s67 offen sc1 lds
v_mfma_f32_16x16x32_bf16 v[40:43], a[216:219], a[168:171], v[40:43]
ds_read_b64_tr_b16 a[208:209], v12 offset:30720
v_mfma_f32_16x16x32_bf16 v[44:47], a[216:219], a[172:175], v[44:47]
ds_read_b64_tr_b16 a[210:211], v12 offset:31232
v_mfma_f32_16x16x32_bf16 v[48:51], a[216:219], a[176:179], v[48:51]
buffer_load_dwordx4 v10, s[40:43], s67 offen offset:1024 sc1 lds
v_mfma_f32_16x16x32_bf16 v[52:55], a[220:223], a[168:171], v[52:55]
ds_read_b64_tr_b16 a[212:213], v13 offset:30720
s_add_u32 m0, s64, 22528
v_mfma_f32_16x16x32_bf16 v[56:59], a[220:223], a[172:175], v[56:59]
ds_read_b64_tr_b16 a[214:215], v13 offset:31232
s_add_u32 s67, s65, 246272
v_mfma_f32_16x16x32_bf16 v[60:63], a[220:223], a[176:179], v[60:63]
buffer_load_dwordx4 v10, s[36:39], s67 offen sc1 lds
v_mfma_f32_16x16x32_bf16 v[64:67], a[224:227], a[168:171], v[64:67]
ds_read_b64_tr_b16 a[216:217], v14 offset:30720
v_mfma_f32_16x16x32_bf16 v[68:71], a[224:227], a[172:175], v[68:71]
ds_read_b64_tr_b16 a[218:219], v14 offset:31232
v_mfma_f32_16x16x32_bf16 v[72:75], a[224:227], a[176:179], v[72:75]
buffer_load_dwordx4 v10, s[40:43], s67 offen offset:1024 sc1 lds
s_waitcnt lgkmcnt(8)
v_mfma_f32_16x16x32_bf16 v[28:31], a[228:231], a[180:183], v[28:31]
ds_read_b64_tr_b16 a[220:221], v11 offset:32768
v_mfma_f32_16x16x32_bf16 v[32:35], a[228:231], a[184:187], v[32:35]
ds_read_b64_tr_b16 a[222:223], v11 offset:33280
v_mfma_f32_16x16x32_bf16 v[36:39], a[228:231], a[188:191], v[36:39]
v_mfma_f32_16x16x32_bf16 v[40:43], a[232:235], a[180:183], v[40:43]
ds_read_b64_tr_b16 a[224:225], v12 offset:32768
v_mfma_f32_16x16x32_bf16 v[44:47], a[232:235], a[184:187], v[44:47]
ds_read_b64_tr_b16 a[226:227], v12 offset:33280
v_mfma_f32_16x16x32_bf16 v[48:51], a[232:235], a[188:191], v[48:51]
v_mfma_f32_16x16x32_bf16 v[52:55], a[236:239], a[180:183], v[52:55]
ds_read_b64_tr_b16 a[228:229], v13 offset:32768
v_mfma_f32_16x16x32_bf16 v[56:59], a[236:239], a[184:187], v[56:59]
ds_read_b64_tr_b16 a[230:231], v13 offset:33280
v_mfma_f32_16x16x32_bf16 v[60:63], a[236:239], a[188:191], v[60:63]
v_mfma_f32_16x16x32_bf16 v[64:67], a[240:243], a[180:183], v[64:67]
ds_read_b64_tr_b16 a[232:233], v14 offset:32768
v_mfma_f32_16x16x32_bf16 v[68:71], a[240:243], a[184:187], v[68:71]
ds_read_b64_tr_b16 a[234:235], v14 offset:33280
v_mfma_f32_16x16x32_bf16 v[72:75], a[240:243], a[188:191], v[72:75]
s_waitcnt lgkmcnt(8)
v_mfma_f32_16x16x32_bf16 v[28:31], a[204:207], a[192:195], v[28:31]
ds_read_b64_tr_b16 a[236:237], v11 offset:33792
s_add_u32 m0, s64, 24576
v_mfma_f32_16x16x32_bf16 v[32:35], a[204:207], a[196:199], v[32:35]
ds_read_b64_tr_b16 a[238:239], v11 offset:34304
s_add_u32 s67, s65, 287232
v_mfma_f32_16x16x32_bf16 v[36:39], a[204:207], a[200:203], v[36:39]
buffer_load_dwordx4 v10, s[36:39], s67 offen sc1 lds
v_mfma_f32_16x16x32_bf16 v[40:43], a[208:211], a[192:195], v[40:43]
ds_read_b64_tr_b16 a[240:241], v12 offset:33792
v_mfma_f32_16x16x32_bf16 v[44:47], a[208:211], a[196:199], v[44:47]
ds_read_b64_tr_b16 a[242:243], v12 offset:34304
v_mfma_f32_16x16x32_bf16 v[48:51], a[208:211], a[200:203], v[48:51]
buffer_load_dwordx4 v10, s[40:43], s67 offen offset:1024 sc1 lds
v_mfma_f32_16x16x32_bf16 v[52:55], a[212:215], a[192:195], v[52:55]
ds_read_b64_tr_b16 a[204:205], v13 offset:33792
v_mfma_f32_16x16x32_bf16 v[56:59], a[212:215], a[196:199], v[56:59]
ds_read_b64_tr_b16 a[206:207], v13 offset:34304
v_mfma_f32_16x16x32_bf16 v[60:63], a[212:215], a[200:203], v[60:63]
v_mfma_f32_16x16x32_bf16 v[64:67], a[216:219], a[192:195], v[64:67]
ds_read_b64_tr_b16 a[208:209], v14 offset:33792
v_mfma_f32_16x16x32_bf16 v[68:71], a[216:219], a[196:199], v[68:71]
ds_read_b64_tr_b16 a[210:211], v14 offset:34304
v_mfma_f32_16x16x32_bf16 v[72:75], a[216:219], a[200:203], v[72:75]
s_waitcnt lgkmcnt(8)
v_mfma_f32_16x16x32_bf16 v[76:79], a[220:223], a[0:3], 0
ds_read_b64_tr_b16 a[212:213], v11 offset:34816
v_mfma_f32_16x16x32_bf16 v[80:83], a[220:223], a[4:7], 0
ds_read_b64_tr_b16 a[214:215], v11 offset:35328
v_mfma_f32_16x16x32_bf16 v[84:87], a[220:223], a[8:11], 0
v_cvt_pk_bf16_f32 v172, v28, v29
v_cvt_pk_bf16_f32 v173, v30, v31
v_mfma_f32_16x16x32_bf16 v[88:91], a[224:227], a[0:3], 0
ds_read_b64_tr_b16 a[216:217], v12 offset:34816
v_cvt_pk_bf16_f32 v176, v32, v33
v_mfma_f32_16x16x32_bf16 v[92:95], a[224:227], a[4:7], 0
ds_read_b64_tr_b16 a[218:219], v12 offset:35328
v_cvt_pk_bf16_f32 v177, v34, v35
v_mfma_f32_16x16x32_bf16 v[96:99], a[224:227], a[8:11], 0
v_cvt_pk_bf16_f32 v180, v36, v37
v_cvt_pk_bf16_f32 v181, v38, v39
v_mfma_f32_16x16x32_bf16 v[100:103], a[228:231], a[0:3], 0
ds_read_b64_tr_b16 a[220:221], v13 offset:34816
v_cvt_pk_bf16_f32 v174, v40, v41
v_mfma_f32_16x16x32_bf16 v[104:107], a[228:231], a[4:7], 0
ds_read_b64_tr_b16 a[222:223], v13 offset:35328
v_cvt_pk_bf16_f32 v175, v42, v43
v_mfma_f32_16x16x32_bf16 v[108:111], a[228:231], a[8:11], 0
v_mfma_f32_16x16x32_bf16 v[112:115], a[232:235], a[0:3], 0
ds_read_b64_tr_b16 a[224:225], v14 offset:34816
v_mfma_f32_16x16x32_bf16 v[116:119], a[232:235], a[4:7], 0
ds_read_b64_tr_b16 a[226:227], v14 offset:35328
v_mfma_f32_16x16x32_bf16 v[120:123], a[232:235], a[8:11], 0
s_waitcnt lgkmcnt(8)
v_mfma_f32_16x16x32_bf16 v[76:79], a[236:239], a[12:15], v[76:79]
ds_read_b64_tr_b16 a[228:229], v11 offset:35840
v_mfma_f32_16x16x32_bf16 v[80:83], a[236:239], a[16:19], v[80:83]
ds_read_b64_tr_b16 a[230:231], v11 offset:36352
v_mfma_f32_16x16x32_bf16 v[84:87], a[236:239], a[20:23], v[84:87]
v_mfma_f32_16x16x32_bf16 v[88:91], a[240:243], a[12:15], v[88:91]
ds_read_b64_tr_b16 a[232:233], v12 offset:35840
v_mfma_f32_16x16x32_bf16 v[92:95], a[240:243], a[16:19], v[92:95]
ds_read_b64_tr_b16 a[234:235], v12 offset:36352
v_mfma_f32_16x16x32_bf16 v[96:99], a[240:243], a[20:23], v[96:99]
v_mfma_f32_16x16x32_bf16 v[100:103], a[204:207], a[12:15], v[100:103]
ds_read_b64_tr_b16 a[236:237], v13 offset:35840
v_mfma_f32_16x16x32_bf16 v[104:107], a[204:207], a[16:19], v[104:107]
ds_read_b64_tr_b16 a[238:239], v13 offset:36352
v_mfma_f32_16x16x32_bf16 v[108:111], a[204:207], a[20:23], v[108:111]
v_mfma_f32_16x16x32_bf16 v[112:115], a[208:211], a[12:15], v[112:115]
ds_read_b64_tr_b16 a[240:241], v14 offset:35840
v_mfma_f32_16x16x32_bf16 v[116:119], a[208:211], a[16:19], v[116:119]
ds_read_b64_tr_b16 a[242:243], v14 offset:36352
v_mfma_f32_16x16x32_bf16 v[120:123], a[208:211], a[20:23], v[120:123]
s_waitcnt lgkmcnt(8)
v_mfma_f32_16x16x32_bf16 v[76:79], a[212:215], a[24:27], v[76:79]
ds_read_b64_tr_b16 a[204:205], v11 offset:36864
v_mfma_f32_16x16x32_bf16 v[80:83], a[212:215], a[28:31], v[80:83]
ds_read_b64_tr_b16 a[206:207], v11 offset:37376
v_mfma_f32_16x16x32_bf16 v[84:87], a[212:215], a[32:35], v[84:87]
v_cvt_pk_bf16_f32 v178, v44, v45
v_cvt_pk_bf16_f32 v179, v46, v47
v_mfma_f32_16x16x32_bf16 v[88:91], a[216:219], a[24:27], v[88:91]
ds_read_b64_tr_b16 a[208:209], v12 offset:36864
v_cvt_pk_bf16_f32 v182, v48, v49
v_mfma_f32_16x16x32_bf16 v[92:95], a[216:219], a[28:31], v[92:95]
ds_read_b64_tr_b16 a[210:211], v12 offset:37376
v_cvt_pk_bf16_f32 v183, v50, v51
v_mfma_f32_16x16x32_bf16 v[96:99], a[216:219], a[32:35], v[96:99]
v_cvt_pk_bf16_f32 v184, v52, v53
v_cvt_pk_bf16_f32 v185, v54, v55
v_mfma_f32_16x16x32_bf16 v[100:103], a[220:223], a[24:27], v[100:103]
ds_read_b64_tr_b16 a[212:213], v13 offset:36864
v_cvt_pk_bf16_f32 v188, v56, v57
v_mfma_f32_16x16x32_bf16 v[104:107], a[220:223], a[28:31], v[104:107]
ds_read_b64_tr_b16 a[214:215], v13 offset:37376
v_cvt_pk_bf16_f32 v189, v58, v59
v_mfma_f32_16x16x32_bf16 v[108:111], a[220:223], a[32:35], v[108:111]
v_mfma_f32_16x16x32_bf16 v[112:115], a[224:227], a[24:27], v[112:115]
ds_read_b64_tr_b16 a[216:217], v14 offset:36864
v_mfma_f32_16x16x32_bf16 v[116:119], a[224:227], a[28:31], v[116:119]
ds_read_b64_tr_b16 a[218:219], v14 offset:37376
v_mfma_f32_16x16x32_bf16 v[120:123], a[224:227], a[32:35], v[120:123]
s_waitcnt lgkmcnt(8)
v_mfma_f32_16x16x32_bf16 v[76:79], a[228:231], a[36:39], v[76:79]
ds_read_b64_tr_b16 a[220:221], v11 offset:37888
v_mfma_f32_16x16x32_bf16 v[80:83], a[228:231], a[40:43], v[80:83]
ds_read_b64_tr_b16 a[222:223], v11 offset:38400
v_mfma_f32_16x16x32_bf16 v[84:87], a[228:231], a[44:47], v[84:87]
v_mfma_f32_16x16x32_bf16 v[88:91], a[232:235], a[36:39], v[88:91]
ds_read_b64_tr_b16 a[224:225], v12 offset:37888
v_mfma_f32_16x16x32_bf16 v[92:95], a[232:235], a[40:43], v[92:95]
ds_read_b64_tr_b16 a[226:227], v12 offset:38400
v_mfma_f32_16x16x32_bf16 v[96:99], a[232:235], a[44:47], v[96:99]
v_mfma_f32_16x16x32_bf16 v[100:103], a[236:239], a[36:39], v[100:103]
ds_read_b64_tr_b16 a[228:229], v13 offset:37888
v_mfma_f32_16x16x32_bf16 v[104:107], a[236:239], a[40:43], v[104:107]
ds_read_b64_tr_b16 a[230:231], v13 offset:38400
v_mfma_f32_16x16x32_bf16 v[108:111], a[236:239], a[44:47], v[108:111]
v_mfma_f32_16x16x32_bf16 v[112:115], a[240:243], a[36:39], v[112:115]
ds_read_b64_tr_b16 a[232:233], v14 offset:37888
v_mfma_f32_16x16x32_bf16 v[116:119], a[240:243], a[40:43], v[116:119]
ds_read_b64_tr_b16 a[234:235], v14 offset:38400
v_mfma_f32_16x16x32_bf16 v[120:123], a[240:243], a[44:47], v[120:123]
s_waitcnt lgkmcnt(8)
v_mfma_f32_16x16x32_bf16 v[76:79], a[204:207], a[48:51], v[76:79]
s_waitcnt vmcnt(17)
s_barrier
ds_read_b64_tr_b16 a[236:237], v11 offset:38912
v_mfma_f32_16x16x32_bf16 v[80:83], a[204:207], a[52:55], v[80:83]
ds_read_b64_tr_b16 a[238:239], v11 offset:39424
s_add_u32 m0, s64, 26624
v_mfma_f32_16x16x32_bf16 v[84:87], a[204:207], a[56:59], v[84:87]
s_add_u32 s67, s65, 328192
buffer_load_dwordx4 v10, s[36:39], s67 offen sc1 lds
v_mfma_f32_16x16x32_bf16 v[88:91], a[208:211], a[48:51], v[88:91]
ds_read_b64_tr_b16 a[240:241], v12 offset:38912
s_add_u32 m0, s64, 28672
v_mfma_f32_16x16x32_bf16 v[92:95], a[208:211], a[52:55], v[92:95]
ds_read_b64_tr_b16 a[242:243], v12 offset:39424
s_add_u32 s67, s66, 0
v_mfma_f32_16x16x32_bf16 v[96:99], a[208:211], a[56:59], v[96:99]
buffer_load_dwordx4 v15, s[44:47], s67 offen lds
v_cvt_pk_bf16_f32 v192, v60, v61
v_mfma_f32_16x16x32_bf16 v[100:103], a[212:215], a[48:51], v[100:103]
ds_read_b64_tr_b16 a[204:205], v13 offset:38912
v_cvt_pk_bf16_f32 v193, v62, v63
v_mfma_f32_16x16x32_bf16 v[104:107], a[212:215], a[52:55], v[104:107]
ds_read_b64_tr_b16 a[206:207], v13 offset:39424
v_cvt_pk_bf16_f32 v186, v64, v65
v_mfma_f32_16x16x32_bf16 v[108:111], a[212:215], a[56:59], v[108:111]
buffer_load_dwordx4 v15, s[48:51], s67 offen offset:1024 lds
v_cvt_pk_bf16_f32 v187, v66, v67
v_mfma_f32_16x16x32_bf16 v[112:115], a[216:219], a[48:51], v[112:115]
ds_read_b64_tr_b16 a[208:209], v14 offset:38912
v_cvt_pk_bf16_f32 v190, v68, v69
v_mfma_f32_16x16x32_bf16 v[116:119], a[216:219], a[52:55], v[116:119]
ds_read_b64_tr_b16 a[210:211], v14 offset:39424
v_cvt_pk_bf16_f32 v191, v70, v71
v_mfma_f32_16x16x32_bf16 v[120:123], a[216:219], a[56:59], v[120:123]
v_cvt_pk_bf16_f32 v194, v72, v73
s_waitcnt lgkmcnt(8)
v_mfma_f32_16x16x32_bf16 v[76:79], a[220:223], a[60:63], v[76:79]
ds_read_b64_tr_b16 a[212:213], v11 offset:39936
v_cvt_pk_bf16_f32 v195, v74, v75
v_mfma_f32_16x16x32_bf16 v[80:83], a[220:223], a[64:67], v[80:83]
ds_read_b64_tr_b16 a[214:215], v11 offset:40448
v_mfma_f32_16x16x32_bf16 v[84:87], a[220:223], a[68:71], v[84:87]
v_mfma_f32_16x16x32_bf16 v[88:91], a[224:227], a[60:63], v[88:91]
ds_read_b64_tr_b16 a[216:217], v12 offset:39936
v_mfma_f32_16x16x32_bf16 v[92:95], a[224:227], a[64:67], v[92:95]
ds_read_b64_tr_b16 a[218:219], v12 offset:40448
v_mfma_f32_16x16x32_bf16 v[96:99], a[224:227], a[68:71], v[96:99]
v_mfma_f32_16x16x32_bf16 v[100:103], a[228:231], a[60:63], v[100:103]
ds_read_b64_tr_b16 a[220:221], v13 offset:39936
v_mfma_f32_16x16x32_bf16 v[104:107], a[228:231], a[64:67], v[104:107]
ds_read_b64_tr_b16 a[222:223], v13 offset:40448
v_mfma_f32_16x16x32_bf16 v[108:111], a[228:231], a[68:71], v[108:111]
v_mfma_f32_16x16x32_bf16 v[112:115], a[232:235], a[60:63], v[112:115]
ds_read_b64_tr_b16 a[224:225], v14 offset:39936
v_mfma_f32_16x16x32_bf16 v[116:119], a[232:235], a[64:67], v[116:119]
ds_read_b64_tr_b16 a[226:227], v14 offset:40448
v_mfma_f32_16x16x32_bf16 v[120:123], a[232:235], a[68:71], v[120:123]
s_waitcnt lgkmcnt(8)
v_mfma_f32_16x16x32_bf16 v[76:79], a[236:239], a[72:75], v[76:79]
ds_read_b64_tr_b16 a[228:229], v11 offset:0
s_add_u32 m0, s64, 30720
v_mfma_f32_16x16x32_bf16 v[80:83], a[236:239], a[76:79], v[80:83]
ds_read_b64_tr_b16 a[230:231], v11 offset:512
s_add_u32 s67, s66, 73728
v_mfma_f32_16x16x32_bf16 v[84:87], a[236:239], a[80:83], v[84:87]
buffer_load_dwordx4 v15, s[44:47], s67 offen lds
buffer_load_dwordx4 a[252:255], v255, s[56:59], s3 offen
v_mfma_f32_16x16x32_bf16 v[88:91], a[240:243], a[72:75], v[88:91]
ds_read_b64_tr_b16 a[232:233], v12 offset:0
v_mfma_f32_16x16x32_bf16 v[92:95], a[240:243], a[76:79], v[92:95]
ds_read_b64_tr_b16 a[234:235], v12 offset:512
v_mfma_f32_16x16x32_bf16 v[96:99], a[240:243], a[80:83], v[96:99]
buffer_load_dwordx4 v15, s[48:51], s67 offen offset:1024 lds
v_mfma_f32_16x16x32_bf16 v[100:103], a[204:207], a[72:75], v[100:103]
ds_read_b64_tr_b16 a[236:237], v13 offset:0
s_add_u32 m0, s64, 32768
v_mfma_f32_16x16x32_bf16 v[104:107], a[204:207], a[76:79], v[104:107]
ds_read_b64_tr_b16 a[238:239], v13 offset:512
s_add_u32 s67, s66, 147456
v_mfma_f32_16x16x32_bf16 v[108:111], a[204:207], a[80:83], v[108:111]
buffer_load_dwordx4 v15, s[44:47], s67 offen lds
v_mfma_f32_16x16x32_bf16 v[112:115], a[208:211], a[72:75], v[112:115]
ds_read_b64_tr_b16 a[240:241], v14 offset:0
v_mfma_f32_16x16x32_bf16 v[116:119], a[208:211], a[76:79], v[116:119]
ds_read_b64_tr_b16 a[242:243], v14 offset:512
v_mfma_f32_16x16x32_bf16 v[120:123], a[208:211], a[80:83], v[120:123]
buffer_load_dwordx4 v15, s[48:51], s67 offen offset:1024 lds
s_waitcnt lgkmcnt(8)
v_mfma_f32_16x16x32_bf16 v[76:79], a[212:215], a[84:87], v[76:79]
ds_read_b64_tr_b16 a[204:205], v11 offset:1024
v_mfma_f32_16x16x32_bf16 v[80:83], a[212:215], a[88:91], v[80:83]
ds_read_b64_tr_b16 a[206:207], v11 offset:1536
v_mfma_f32_16x16x32_bf16 v[84:87], a[212:215], a[92:95], v[84:87]
v_mfma_f32_16x16x32_bf16 v[88:91], a[216:219], a[84:87], v[88:91]
ds_read_b64_tr_b16 a[208:209], v12 offset:1024
v_mfma_f32_16x16x32_bf16 v[92:95], a[216:219], a[88:91], v[92:95]
ds_read_b64_tr_b16 a[210:211], v12 offset:1536
v_mfma_f32_16x16x32_bf16 v[96:99], a[216:219], a[92:95], v[96:99]
v_mfma_f32_16x16x32_bf16 v[100:103], a[220:223], a[84:87], v[100:103]
ds_read_b64_tr_b16 a[212:213], v13 offset:1024
v_mfma_f32_16x16x32_bf16 v[104:107], a[220:223], a[88:91], v[104:107]
ds_read_b64_tr_b16 a[214:215], v13 offset:1536
v_mfma_f32_16x16x32_bf16 v[108:111], a[220:223], a[92:95], v[108:111]
v_mfma_f32_16x16x32_bf16 v[112:115], a[224:227], a[84:87], v[112:115]
ds_read_b64_tr_b16 a[216:217], v14 offset:1024
v_mfma_f32_16x16x32_bf16 v[116:119], a[224:227], a[88:91], v[116:119]
ds_read_b64_tr_b16 a[218:219], v14 offset:1536
v_mfma_f32_16x16x32_bf16 v[120:123], a[224:227], a[92:95], v[120:123]
s_waitcnt lgkmcnt(8)
v_mfma_f32_16x16x32_bf16 v[76:79], a[228:231], a[96:99], v[76:79]
ds_read_b64_tr_b16 a[220:221], v11 offset:2048
s_add_u32 m0, s64, 34816
v_mfma_f32_16x16x32_bf16 v[80:83], a[228:231], a[100:103], v[80:83]
ds_read_b64_tr_b16 a[222:223], v11 offset:2560
s_add_u32 s67, s66, 221184
v_mfma_f32_16x16x32_bf16 v[84:87], a[228:231], a[104:107], v[84:87]
buffer_load_dwordx4 v15, s[44:47], s67 offen lds
v_mfma_f32_16x16x32_bf16 v[88:91], a[232:235], a[96:99], v[88:91]
ds_read_b64_tr_b16 a[224:225], v12 offset:2048
v_mfma_f32_16x16x32_bf16 v[92:95], a[232:235], a[100:103], v[92:95]
ds_read_b64_tr_b16 a[226:227], v12 offset:2560
v_mfma_f32_16x16x32_bf16 v[96:99], a[232:235], a[104:107], v[96:99]
buffer_load_dwordx4 v15, s[48:51], s67 offen offset:1024 lds
v_mfma_f32_16x16x32_bf16 v[100:103], a[236:239], a[96:99], v[100:103]
ds_read_b64_tr_b16 a[228:229], v13 offset:2048
v_mfma_f32_16x16x32_bf16 v[104:107], a[236:239], a[100:103], v[104:107]
ds_read_b64_tr_b16 a[230:231], v13 offset:2560
v_mfma_f32_16x16x32_bf16 v[108:111], a[236:239], a[104:107], v[108:111]
v_mfma_f32_16x16x32_bf16 v[112:115], a[240:243], a[96:99], v[112:115]
ds_read_b64_tr_b16 a[232:233], v14 offset:2048
v_mfma_f32_16x16x32_bf16 v[116:119], a[240:243], a[100:103], v[116:119]
ds_read_b64_tr_b16 a[234:235], v14 offset:2560
v_mfma_f32_16x16x32_bf16 v[120:123], a[240:243], a[104:107], v[120:123]
s_waitcnt lgkmcnt(8)
v_mfma_f32_16x16x32_bf16 v[76:79], a[204:207], a[108:111], v[76:79]
ds_read_b64_tr_b16 a[236:237], v11 offset:3072
v_mfma_f32_16x16x32_bf16 v[80:83], a[204:207], a[112:115], v[80:83]
ds_read_b64_tr_b16 a[238:239], v11 offset:3584
v_mfma_f32_16x16x32_bf16 v[84:87], a[204:207], a[116:119], v[84:87]
v_mfma_f32_16x16x32_bf16 v[88:91], a[208:211], a[108:111], v[88:91]
ds_read_b64_tr_b16 a[240:241], v12 offset:3072
v_mfma_f32_16x16x32_bf16 v[92:95], a[208:211], a[112:115], v[92:95]
ds_read_b64_tr_b16 a[242:243], v12 offset:3584
v_mfma_f32_16x16x32_bf16 v[96:99], a[208:211], a[116:119], v[96:99]
v_mfma_f32_16x16x32_bf16 v[100:103], a[212:215], a[108:111], v[100:103]
ds_read_b64_tr_b16 a[204:205], v13 offset:3072
v_mfma_f32_16x16x32_bf16 v[104:107], a[212:215], a[112:115], v[104:107]
ds_read_b64_tr_b16 a[206:207], v13 offset:3584
v_mfma_f32_16x16x32_bf16 v[108:111], a[212:215], a[116:119], v[108:111]
v_mfma_f32_16x16x32_bf16 v[112:115], a[216:219], a[108:111], v[112:115]
ds_read_b64_tr_b16 a[208:209], v14 offset:3072
v_mfma_f32_16x16x32_bf16 v[116:119], a[216:219], a[112:115], v[116:119]
ds_read_b64_tr_b16 a[210:211], v14 offset:3584
v_mfma_f32_16x16x32_bf16 v[120:123], a[216:219], a[116:119], v[120:123]
s_waitcnt lgkmcnt(8)
v_mfma_f32_16x16x32_bf16 v[76:79], a[220:223], a[120:123], v[76:79]
ds_read_b64_tr_b16 a[212:213], v11 offset:4096
v_mfma_f32_16x16x32_bf16 v[80:83], a[220:223], a[124:127], v[80:83]
ds_read_b64_tr_b16 a[214:215], v11 offset:4608
v_mfma_f32_16x16x32_bf16 v[84:87], a[220:223], a[128:131], v[84:87]
v_mfma_f32_16x16x32_bf16 v[88:91], a[224:227], a[120:123], v[88:91]
ds_read_b64_tr_b16 a[216:217], v12 offset:4096
v_mfma_f32_16x16x32_bf16 v[92:95], a[224:227], a[124:127], v[92:95]
ds_read_b64_tr_b16 a[218:219], v12 offset:4608
v_mfma_f32_16x16x32_bf16 v[96:99], a[224:227], a[128:131], v[96:99]
v_mfma_f32_16x16x32_bf16 v[100:103], a[228:231], a[120:123], v[100:103]
ds_read_b64_tr_b16 a[220:221], v13 offset:4096
v_mfma_f32_16x16x32_bf16 v[104:107], a[228:231], a[124:127], v[104:107]
ds_read_b64_tr_b16 a[222:223], v13 offset:4608
v_mfma_f32_16x16x32_bf16 v[108:111], a[228:231], a[128:131], v[108:111]
v_mfma_f32_16x16x32_bf16 v[112:115], a[232:235], a[120:123], v[112:115]
ds_read_b64_tr_b16 a[224:225], v14 offset:4096
v_mfma_f32_16x16x32_bf16 v[116:119], a[232:235], a[124:127], v[116:119]
ds_read_b64_tr_b16 a[226:227], v14 offset:4608
v_mfma_f32_16x16x32_bf16 v[120:123], a[232:235], a[128:131], v[120:123]
s_waitcnt lgkmcnt(8)
v_mfma_f32_16x16x32_bf16 v[76:79], a[236:239], a[132:135], v[76:79]
ds_read_b64_tr_b16 a[228:229], v11 offset:5120
v_mfma_f32_16x16x32_bf16 v[80:83], a[236:239], a[136:139], v[80:83]
ds_read_b64_tr_b16 a[230:231], v11 offset:5632
v_mfma_f32_16x16x32_bf16 v[84:87], a[236:239], a[140:143], v[84:87]
v_mfma_f32_16x16x32_bf16 v[88:91], a[240:243], a[132:135], v[88:91]
ds_read_b64_tr_b16 a[232:233], v12 offset:5120
v_mfma_f32_16x16x32_bf16 v[92:95], a[240:243], a[136:139], v[92:95]
ds_read_b64_tr_b16 a[234:235], v12 offset:5632
v_mfma_f32_16x16x32_bf16 v[96:99], a[240:243], a[140:143], v[96:99]
v_mfma_f32_16x16x32_bf16 v[100:103], a[204:207], a[132:135], v[100:103]
ds_read_b64_tr_b16 a[236:237], v13 offset:5120
v_mfma_f32_16x16x32_bf16 v[104:107], a[204:207], a[136:139], v[104:107]
ds_read_b64_tr_b16 a[238:239], v13 offset:5632
v_mfma_f32_16x16x32_bf16 v[108:111], a[204:207], a[140:143], v[108:111]
v_mfma_f32_16x16x32_bf16 v[112:115], a[208:211], a[132:135], v[112:115]
ds_read_b64_tr_b16 a[240:241], v14 offset:5120
v_mfma_f32_16x16x32_bf16 v[116:119], a[208:211], a[136:139], v[116:119]
ds_read_b64_tr_b16 a[242:243], v14 offset:5632
v_mfma_f32_16x16x32_bf16 v[120:123], a[208:211], a[140:143], v[120:123]
s_waitcnt lgkmcnt(8)
v_mfma_f32_16x16x32_bf16 v[76:79], a[212:215], a[144:147], v[76:79]
ds_read_b64_tr_b16 a[204:205], v11 offset:6144
v_mfma_f32_16x16x32_bf16 v[80:83], a[212:215], a[148:151], v[80:83]
ds_read_b64_tr_b16 a[206:207], v11 offset:6656
v_mfma_f32_16x16x32_bf16 v[84:87], a[212:215], a[152:155], v[84:87]
v_mfma_f32_16x16x32_bf16 v[88:91], a[216:219], a[144:147], v[88:91]
ds_read_b64_tr_b16 a[208:209], v12 offset:6144
v_mfma_f32_16x16x32_bf16 v[92:95], a[216:219], a[148:151], v[92:95]
ds_read_b64_tr_b16 a[210:211], v12 offset:6656
v_mfma_f32_16x16x32_bf16 v[96:99], a[216:219], a[152:155], v[96:99]
v_mfma_f32_16x16x32_bf16 v[100:103], a[220:223], a[144:147], v[100:103]
ds_read_b64_tr_b16 a[212:213], v13 offset:6144
v_mfma_f32_16x16x32_bf16 v[104:107], a[220:223], a[148:151], v[104:107]
ds_read_b64_tr_b16 a[214:215], v13 offset:6656
v_mfma_f32_16x16x32_bf16 v[108:111], a[220:223], a[152:155], v[108:111]
v_mfma_f32_16x16x32_bf16 v[112:115], a[224:227], a[144:147], v[112:115]
ds_read_b64_tr_b16 a[216:217], v14 offset:6144
v_mfma_f32_16x16x32_bf16 v[116:119], a[224:227], a[148:151], v[116:119]
ds_read_b64_tr_b16 a[218:219], v14 offset:6656
v_mfma_f32_16x16x32_bf16 v[120:123], a[224:227], a[152:155], v[120:123]
s_waitcnt lgkmcnt(8)
v_mfma_f32_16x16x32_bf16 v[76:79], a[228:231], a[156:159], v[76:79]
ds_read_b64_tr_b16 a[220:221], v11 offset:7168
v_mfma_f32_16x16x32_bf16 v[80:83], a[228:231], a[160:163], v[80:83]
ds_read_b64_tr_b16 a[222:223], v11 offset:7680
v_mfma_f32_16x16x32_bf16 v[84:87], a[228:231], a[164:167], v[84:87]
v_mfma_f32_16x16x32_bf16 v[88:91], a[232:235], a[156:159], v[88:91]
ds_read_b64_tr_b16 a[224:225], v12 offset:7168
v_mfma_f32_16x16x32_bf16 v[92:95], a[232:235], a[160:163], v[92:95]
ds_read_b64_tr_b16 a[226:227], v12 offset:7680
v_mfma_f32_16x16x32_bf16 v[96:99], a[232:235], a[164:167], v[96:99]
v_mfma_f32_16x16x32_bf16 v[100:103], a[236:239], a[156:159], v[100:103]
ds_read_b64_tr_b16 a[228:229], v13 offset:7168
v_mfma_f32_16x16x32_bf16 v[104:107], a[236:239], a[160:163], v[104:107]
ds_read_b64_tr_b16 a[230:231], v13 offset:7680
v_mfma_f32_16x16x32_bf16 v[108:111], a[236:239], a[164:167], v[108:111]
v_mfma_f32_16x16x32_bf16 v[112:115], a[240:243], a[156:159], v[112:115]
ds_read_b64_tr_b16 a[232:233], v14 offset:7168
v_mfma_f32_16x16x32_bf16 v[116:119], a[240:243], a[160:163], v[116:119]
ds_read_b64_tr_b16 a[234:235], v14 offset:7680
v_mfma_f32_16x16x32_bf16 v[120:123], a[240:243], a[164:167], v[120:123]
s_waitcnt lgkmcnt(8)
v_mfma_f32_16x16x32_bf16 v[76:79], a[204:207], a[168:171], v[76:79]
s_waitcnt vmcnt(18)
s_barrier
ds_read_b64_tr_b16 a[236:237], v11 offset:8192
v_mfma_f32_16x16x32_bf16 v[80:83], a[204:207], a[172:175], v[80:83]
ds_read_b64_tr_b16 a[238:239], v11 offset:8704
s_add_u32 m0, s64, 36864
v_mfma_f32_16x16x32_bf16 v[84:87], a[204:207], a[176:179], v[84:87]
s_add_u32 s67, s66, 294912
buffer_load_dwordx4 v15, s[44:47], s67 offen lds
v_mfma_f32_16x16x32_bf16 v[88:91], a[208:211], a[168:171], v[88:91]
ds_read_b64_tr_b16 a[240:241], v12 offset:8192
v_mfma_f32_16x16x32_bf16 v[92:95], a[208:211], a[172:175], v[92:95]
ds_read_b64_tr_b16 a[242:243], v12 offset:8704
v_mfma_f32_16x16x32_bf16 v[96:99], a[208:211], a[176:179], v[96:99]
buffer_load_dwordx4 v15, s[48:51], s67 offen offset:1024 lds
v_mfma_f32_16x16x32_bf16 v[100:103], a[212:215], a[168:171], v[100:103]
ds_read_b64_tr_b16 a[204:205], v13 offset:8192
s_add_u32 m0, s64, 38912
v_mfma_f32_16x16x32_bf16 v[104:107], a[212:215], a[172:175], v[104:107]
ds_read_b64_tr_b16 a[206:207], v13 offset:8704
s_add_u32 s67, s66, 128
v_mfma_f32_16x16x32_bf16 v[108:111], a[212:215], a[176:179], v[108:111]
buffer_load_dwordx4 v15, s[44:47], s67 offen lds
v_mfma_f32_16x16x32_bf16 v[112:115], a[216:219], a[168:171], v[112:115]
ds_read_b64_tr_b16 a[208:209], v14 offset:8192
v_mfma_f32_16x16x32_bf16 v[116:119], a[216:219], a[172:175], v[116:119]
ds_read_b64_tr_b16 a[210:211], v14 offset:8704
v_mfma_f32_16x16x32_bf16 v[120:123], a[216:219], a[176:179], v[120:123]
buffer_load_dwordx4 v15, s[48:51], s67 offen offset:1024 lds
s_waitcnt lgkmcnt(8)
v_mfma_f32_16x16x32_bf16 v[76:79], a[220:223], a[180:183], v[76:79]
ds_read_b64_tr_b16 a[212:213], v11 offset:10240
v_mfma_f32_16x16x32_bf16 v[80:83], a[220:223], a[184:187], v[80:83]
ds_read_b64_tr_b16 a[214:215], v11 offset:10752
v_mfma_f32_16x16x32_bf16 v[84:87], a[220:223], a[188:191], v[84:87]
v_mfma_f32_16x16x32_bf16 v[88:91], a[224:227], a[180:183], v[88:91]
ds_read_b64_tr_b16 a[216:217], v12 offset:10240
v_mfma_f32_16x16x32_bf16 v[92:95], a[224:227], a[184:187], v[92:95]
ds_read_b64_tr_b16 a[218:219], v12 offset:10752
v_mfma_f32_16x16x32_bf16 v[96:99], a[224:227], a[188:191], v[96:99]
v_mfma_f32_16x16x32_bf16 v[100:103], a[228:231], a[180:183], v[100:103]
ds_read_b64_tr_b16 a[220:221], v13 offset:10240
v_mfma_f32_16x16x32_bf16 v[104:107], a[228:231], a[184:187], v[104:107]
ds_read_b64_tr_b16 a[222:223], v13 offset:10752
v_mfma_f32_16x16x32_bf16 v[108:111], a[228:231], a[188:191], v[108:111]
v_mfma_f32_16x16x32_bf16 v[112:115], a[232:235], a[180:183], v[112:115]
ds_read_b64_tr_b16 a[224:225], v11 offset:11264
v_mfma_f32_16x16x32_bf16 v[116:119], a[232:235], a[184:187], v[116:119]
ds_read_b64_tr_b16 a[226:227], v11 offset:11776
v_mfma_f32_16x16x32_bf16 v[120:123], a[232:235], a[188:191], v[120:123]
s_waitcnt lgkmcnt(8)
v_mfma_f32_16x16x32_bf16 v[76:79], a[236:239], a[192:195], v[76:79]
ds_read_b64_tr_b16 a[228:229], v12 offset:11264
s_add_u32 m0, s64, 0
v_mfma_f32_16x16x32_bf16 v[80:83], a[236:239], a[196:199], v[80:83]
ds_read_b64_tr_b16 a[230:231], v12 offset:11776
s_add_u32 s67, s66, 73856
v_mfma_f32_16x16x32_bf16 v[84:87], a[236:239], a[200:203], v[84:87]
buffer_load_dwordx4 v15, s[44:47], s67 offen lds
v_mfma_f32_16x16x32_bf16 v[88:91], a[240:243], a[192:195], v[88:91]
ds_read_b64_tr_b16 a[232:233], v13 offset:11264
v_mfma_f32_16x16x32_bf16 v[92:95], a[240:243], a[196:199], v[92:95]
ds_read_b64_tr_b16 a[234:235], v13 offset:11776
v_mfma_f32_16x16x32_bf16 v[96:99], a[240:243], a[200:203], v[96:99]
buffer_load_dwordx4 v15, s[48:51], s67 offen offset:1024 lds
v_mfma_f32_16x16x32_bf16 v[100:103], a[204:207], a[192:195], v[100:103]
ds_read_b64_tr_b16 a[236:237], v11 offset:12288
s_add_u32 m0, s64, 2048
v_mfma_f32_16x16x32_bf16 v[104:107], a[204:207], a[196:199], v[104:107]
ds_read_b64_tr_b16 a[238:239], v11 offset:12800
s_add_u32 s67, s66, 147584
v_mfma_f32_16x16x32_bf16 v[108:111], a[204:207], a[200:203], v[108:111]
buffer_load_dwordx4 v15, s[44:47], s67 offen lds
v_mfma_f32_16x16x32_bf16 v[112:115], a[208:211], a[192:195], v[112:115]
ds_read_b64_tr_b16 a[240:241], v12 offset:12288
v_mfma_f32_16x16x32_bf16 v[116:119], a[208:211], a[196:199], v[116:119]
ds_read_b64_tr_b16 a[242:243], v12 offset:12800
v_mfma_f32_16x16x32_bf16 v[120:123], a[208:211], a[200:203], v[120:123]
buffer_load_dwordx4 v15, s[48:51], s67 offen offset:1024 lds
s_waitcnt lgkmcnt(8)
v_mfma_f32_16x16x32_bf16 v[28:31], a[212:215], a[0:3], 0
ds_read_b64_tr_b16 a[204:205], v13 offset:12288
s_add_u32 m0, s64, 4096
v_mfma_f32_16x16x32_bf16 v[32:35], a[212:215], a[4:7], 0
ds_read_b64_tr_b16 a[206:207], v13 offset:12800
s_add_u32 s67, s66, 221312
v_mfma_f32_16x16x32_bf16 v[36:39], a[212:215], a[8:11], 0
buffer_load_dwordx4 v15, s[44:47], s67 offen lds
v_cvt_pk_bf16_f32 v196, v76, v77
v_mfma_f32_16x16x32_bf16 v[40:43], a[216:219], a[0:3], 0
ds_read_b64_tr_b16 a[208:209], v11 offset:13312
v_cvt_pk_bf16_f32 v197, v78, v79
v_mfma_f32_16x16x32_bf16 v[44:47], a[216:219], a[4:7], 0
ds_read_b64_tr_b16 a[210:211], v11 offset:13824
v_cvt_pk_bf16_f32 v200, v80, v81
v_mfma_f32_16x16x32_bf16 v[48:51], a[216:219], a[8:11], 0
buffer_load_dwordx4 v15, s[48:51], s67 offen offset:1024 lds
v_cvt_pk_bf16_f32 v201, v82, v83
v_mfma_f32_16x16x32_bf16 v[52:55], a[220:223], a[0:3], 0
ds_read_b64_tr_b16 a[212:213], v12 offset:13312
v_cvt_pk_bf16_f32 v204, v84, v85
v_mfma_f32_16x16x32_bf16 v[56:59], a[220:223], a[4:7], 0
ds_read_b64_tr_b16 a[214:215], v12 offset:13824
v_cvt_pk_bf16_f32 v205, v86, v87
v_mfma_f32_16x16x32_bf16 v[60:63], a[220:223], a[8:11], 0
v_cvt_pk_bf16_f32 v198, v88, v89
v_cvt_pk_bf16_f32 v199, v90, v91
v_mfma_f32_16x16x32_bf16 v[28:31], a[224:227], a[12:15], v[28:31]
ds_read_b64_tr_b16 a[216:217], v13 offset:13312
v_mfma_f32_16x16x32_bf16 v[32:35], a[224:227], a[16:19], v[32:35]
ds_read_b64_tr_b16 a[218:219], v13 offset:13824
v_mfma_f32_16x16x32_bf16 v[36:39], a[224:227], a[20:23], v[36:39]
s_waitcnt lgkmcnt(8)
v_mfma_f32_16x16x32_bf16 v[40:43], a[228:231], a[12:15], v[40:43]
ds_read_b64_tr_b16 a[220:221], v11 offset:14336
v_mfma_f32_16x16x32_bf16 v[44:47], a[228:231], a[16:19], v[44:47]
ds_read_b64_tr_b16 a[222:223], v11 offset:14848
v_mfma_f32_16x16x32_bf16 v[48:51], a[228:231], a[20:23], v[48:51]
v_mfma_f32_16x16x32_bf16 v[52:55], a[232:235], a[12:15], v[52:55]
ds_read_b64_tr_b16 a[224:225], v12 offset:14336
v_mfma_f32_16x16x32_bf16 v[56:59], a[232:235], a[16:19], v[56:59]
ds_read_b64_tr_b16 a[226:227], v12 offset:14848
v_mfma_f32_16x16x32_bf16 v[60:63], a[232:235], a[20:23], v[60:63]
v_mfma_f32_16x16x32_bf16 v[28:31], a[236:239], a[24:27], v[28:31]
ds_read_b64_tr_b16 a[228:229], v13 offset:14336
v_mfma_f32_16x16x32_bf16 v[32:35], a[236:239], a[28:31], v[32:35]
ds_read_b64_tr_b16 a[230:231], v13 offset:14848
v_mfma_f32_16x16x32_bf16 v[36:39], a[236:239], a[32:35], v[36:39]
v_cvt_pk_bf16_f32 v202, v92, v93
v_cvt_pk_bf16_f32 v203, v94, v95
v_mfma_f32_16x16x32_bf16 v[40:43], a[240:243], a[24:27], v[40:43]
ds_read_b64_tr_b16 a[232:233], v11 offset:15360
v_cvt_pk_bf16_f32 v206, v96, v97
v_mfma_f32_16x16x32_bf16 v[44:47], a[240:243], a[28:31], v[44:47]
ds_read_b64_tr_b16 a[234:235], v11 offset:15872
v_cvt_pk_bf16_f32 v207, v98, v99
v_mfma_f32_16x16x32_bf16 v[48:51], a[240:243], a[32:35], v[48:51]
v_cvt_pk_bf16_f32 v208, v100, v101
s_waitcnt lgkmcnt(8)
v_mfma_f32_16x16x32_bf16 v[52:55], a[204:207], a[24:27], v[52:55]
ds_read_b64_tr_b16 a[236:237], v12 offset:15360
v_cvt_pk_bf16_f32 v209, v102, v103
v_mfma_f32_16x16x32_bf16 v[56:59], a[204:207], a[28:31], v[56:59]
ds_read_b64_tr_b16 a[238:239], v12 offset:15872
v_cvt_pk_bf16_f32 v212, v104, v105
v_mfma_f32_16x16x32_bf16 v[60:63], a[204:207], a[32:35], v[60:63]
v_cvt_pk_bf16_f32 v213, v106, v107
v_mfma_f32_16x16x32_bf16 v[28:31], a[208:211], a[36:39], v[28:31]
ds_read_b64_tr_b16 a[240:241], v13 offset:15360
v_mfma_f32_16x16x32_bf16 v[32:35], a[208:211], a[40:43], v[32:35]
ds_read_b64_tr_b16 a[242:243], v13 offset:15872
v_mfma_f32_16x16x32_bf16 v[36:39], a[208:211], a[44:47], v[36:39]
v_mfma_f32_16x16x32_bf16 v[40:43], a[212:215], a[36:39], v[40:43]
ds_read_b64_tr_b16 a[204:205], v11 offset:16384
v_mfma_f32_16x16x32_bf16 v[44:47], a[212:215], a[40:43], v[44:47]
ds_read_b64_tr_b16 a[206:207], v11 offset:16896
v_mfma_f32_16x16x32_bf16 v[48:51], a[212:215], a[44:47], v[48:51]
v_mfma_f32_16x16x32_bf16 v[52:55], a[216:219], a[36:39], v[52:55]
ds_read_b64_tr_b16 a[208:209], v12 offset:16384
v_mfma_f32_16x16x32_bf16 v[56:59], a[216:219], a[40:43], v[56:59]
ds_read_b64_tr_b16 a[210:211], v12 offset:16896
v_mfma_f32_16x16x32_bf16 v[60:63], a[216:219], a[44:47], v[60:63]
s_waitcnt lgkmcnt(8)
v_mfma_f32_16x16x32_bf16 v[28:31], a[220:223], a[48:51], v[28:31]
ds_read_b64_tr_b16 a[212:213], v13 offset:16384
v_mfma_f32_16x16x32_bf16 v[32:35], a[220:223], a[52:55], v[32:35]
ds_read_b64_tr_b16 a[214:215], v13 offset:16896
v_mfma_f32_16x16x32_bf16 v[36:39], a[220:223], a[56:59], v[36:39]
v_cvt_pk_bf16_f32 v216, v108, v109
v_cvt_pk_bf16_f32 v217, v110, v111
v_mfma_f32_16x16x32_bf16 v[40:43], a[224:227], a[48:51], v[40:43]
ds_read_b64_tr_b16 a[216:217], v11 offset:17408
v_cvt_pk_bf16_f32 v210, v112, v113
v_mfma_f32_16x16x32_bf16 v[44:47], a[224:227], a[52:55], v[44:47]
ds_read_b64_tr_b16 a[218:219], v11 offset:17920
v_cvt_pk_bf16_f32 v211, v114, v115
v_mfma_f32_16x16x32_bf16 v[48:51], a[224:227], a[56:59], v[48:51]
v_cvt_pk_bf16_f32 v214, v116, v117
v_cvt_pk_bf16_f32 v215, v118, v119
v_mfma_f32_16x16x32_bf16 v[52:55], a[228:231], a[48:51], v[52:55]
ds_read_b64_tr_b16 a[220:221], v12 offset:17408
v_cvt_pk_bf16_f32 v218, v120, v121
v_mfma_f32_16x16x32_bf16 v[56:59], a[228:231], a[52:55], v[56:59]
ds_read_b64_tr_b16 a[222:223], v12 offset:17920
v_cvt_pk_bf16_f32 v219, v122, v123
v_mfma_f32_16x16x32_bf16 v[60:63], a[228:231], a[56:59], v[60:63]
v_mfma_f32_16x16x32_bf16 v[28:31], a[232:235], a[60:63], v[28:31]
ds_read_b64_tr_b16 a[224:225], v13 offset:17408
v_mfma_f32_16x16x32_bf16 v[32:35], a[232:235], a[64:67], v[32:35]
ds_read_b64_tr_b16 a[226:227], v13 offset:17920
v_mfma_f32_16x16x32_bf16 v[36:39], a[232:235], a[68:71], v[36:39]
s_waitcnt lgkmcnt(8)
v_mfma_f32_16x16x32_bf16 v[40:43], a[236:239], a[60:63], v[40:43]
s_waitcnt vmcnt(19)
s_barrier
ds_read_b64_tr_b16 a[228:229], v11 offset:18432
v_mfma_f32_16x16x32_bf16 v[44:47], a[236:239], a[64:67], v[44:47]
ds_read_b64_tr_b16 a[230:231], v11 offset:18944
s_add_u32 m0, s64, 6144
v_mfma_f32_16x16x32_bf16 v[48:51], a[236:239], a[68:71], v[48:51]
s_add_u32 s67, s66, 295040
buffer_load_dwordx4 v15, s[44:47], s67 offen lds
v_mfma_f32_16x16x32_bf16 v[52:55], a[240:243], a[60:63], v[52:55]
ds_read_b64_tr_b16 a[232:233], v12 offset:18432
v_mfma_f32_16x16x32_bf16 v[56:59], a[240:243], a[64:67], v[56:59]
ds_read_b64_tr_b16 a[234:235], v12 offset:18944
v_mfma_f32_16x16x32_bf16 v[60:63], a[240:243], a[68:71], v[60:63]
buffer_load_dwordx4 v15, s[48:51], s67 offen offset:1024 lds
v_mfma_f32_16x16x32_bf16 v[28:31], a[204:207], a[72:75], v[28:31]
ds_read_b64_tr_b16 a[236:237], v13 offset:18432
s_add_u32 m0, s64, 8192
v_mfma_f32_16x16x32_bf16 v[32:35], a[204:207], a[76:79], v[32:35]
ds_read_b64_tr_b16 a[238:239], v13 offset:18944
s_add_u32 s67, s66, 256
v_mfma_f32_16x16x32_bf16 v[36:39], a[204:207], a[80:83], v[36:39]
buffer_load_dwordx4 v15, s[44:47], s67 offen lds
v_mfma_f32_16x16x32_bf16 v[40:43], a[208:211], a[72:75], v[40:43]
ds_read_b64_tr_b16 a[240:241], v11 offset:19456
v_mfma_f32_16x16x32_bf16 v[44:47], a[208:211], a[76:79], v[44:47]
ds_read_b64_tr_b16 a[242:243], v11 offset:19968
v_mfma_f32_16x16x32_bf16 v[48:51], a[208:211], a[80:83], v[48:51]
buffer_load_dwordx4 v15, s[48:51], s67 offen offset:1024 lds
s_waitcnt lgkmcnt(8)
v_mfma_f32_16x16x32_bf16 v[52:55], a[212:215], a[72:75], v[52:55]
ds_read_b64_tr_b16 a[204:205], v12 offset:19456
s_add_u32 m0, s64, 10240
v_mfma_f32_16x16x32_bf16 v[56:59], a[212:215], a[76:79], v[56:59]
ds_read_b64_tr_b16 a[206:207], v12 offset:19968
s_add_u32 s67, s66, 73984
v_mfma_f32_16x16x32_bf16 v[60:63], a[212:215], a[80:83], v[60:63]
buffer_load_dwordx4 v15, s[44:47], s67 offen lds
v_mfma_f32_16x16x32_bf16 v[28:31], a[216:219], a[84:87], v[28:31]
ds_read_b64_tr_b16 a[208:209], v13 offset:19456
v_mfma_f32_16x16x32_bf16 v[32:35], a[216:219], a[88:91], v[32:35]
ds_read_b64_tr_b16 a[210:211], v13 offset:19968
v_mfma_f32_16x16x32_bf16 v[36:39], a[216:219], a[92:95], v[36:39]
buffer_load_dwordx4 v15, s[48:51], s67 offen offset:1024 lds
v_mfma_f32_16x16x32_bf16 v[40:43], a[220:223], a[84:87], v[40:43]
ds_read_b64_tr_b16 a[212:213], v11 offset:20480
v_mfma_f32_16x16x32_bf16 v[44:47], a[220:223], a[88:91], v[44:47]
ds_read_b64_tr_b16 a[214:215], v11 offset:20992
v_mfma_f32_16x16x32_bf16 v[48:51], a[220:223], a[92:95], v[48:51]
v_mfma_f32_16x16x32_bf16 v[52:55], a[224:227], a[84:87], v[52:55]
ds_read_b64_tr_b16 a[216:217], v12 offset:20480
v_mfma_f32_16x16x32_bf16 v[56:59], a[224:227], a[88:91], v[56:59]
ds_read_b64_tr_b16 a[218:219], v12 offset:20992
v_mfma_f32_16x16x32_bf16 v[60:63], a[224:227], a[92:95], v[60:63]
s_waitcnt lgkmcnt(8)
v_mfma_f32_16x16x32_bf16 v[28:31], a[228:231], a[96:99], v[28:31]
ds_read_b64_tr_b16 a[220:221], v13 offset:20480
s_add_u32 m0, s64, 12288
v_mfma_f32_16x16x32_bf16 v[32:35], a[228:231], a[100:103], v[32:35]
ds_read_b64_tr_b16 a[222:223], v13 offset:20992
s_add_u32 s67, s66, 147712
v_mfma_f32_16x16x32_bf16 v[36:39], a[228:231], a[104:107], v[36:39]
buffer_load_dwordx4 v15, s[44:47], s67 offen lds
v_mfma_f32_16x16x32_bf16 v[40:43], a[232:235], a[96:99], v[40:43]
ds_read_b64_tr_b16 a[224:225], v11 offset:21504
v_mfma_f32_16x16x32_bf16 v[44:47], a[232:235], a[100:103], v[44:47]
ds_read_b64_tr_b16 a[226:227], v11 offset:22016
v_mfma_f32_16x16x32_bf16 v[48:51], a[232:235], a[104:107], v[48:51]
buffer_load_dwordx4 v15, s[48:51], s67 offen offset:1024 lds
v_mfma_f32_16x16x32_bf16 v[52:55], a[236:239], a[96:99], v[52:55]
ds_read_b64_tr_b16 a[228:229], v12 offset:21504
s_add_u32 m0, s64, 14336
v_mfma_f32_16x16x32_bf16 v[56:59], a[236:239], a[100:103], v[56:59]
ds_read_b64_tr_b16 a[230:231], v12 offset:22016
s_add_u32 s67, s66, 221440
v_mfma_f32_16x16x32_bf16 v[60:63], a[236:239], a[104:107], v[60:63]
buffer_load_dwordx4 v15, s[44:47], s67 offen lds
v_mfma_f32_16x16x32_bf16 v[28:31], a[240:243], a[108:111], v[28:31]
ds_read_b64_tr_b16 a[232:233], v13 offset:21504
v_mfma_f32_16x16x32_bf16 v[32:35], a[240:243], a[112:115], v[32:35]
ds_read_b64_tr_b16 a[234:235], v13 offset:22016
v_mfma_f32_16x16x32_bf16 v[36:39], a[240:243], a[116:119], v[36:39]
buffer_load_dwordx4 v15, s[48:51], s67 offen offset:1024 lds
s_waitcnt lgkmcnt(8)
v_mfma_f32_16x16x32_bf16 v[40:43], a[204:207], a[108:111], v[40:43]
ds_read_b64_tr_b16 a[236:237], v11 offset:22528
v_mfma_f32_16x16x32_bf16 v[44:47], a[204:207], a[112:115], v[44:47]
ds_read_b64_tr_b16 a[238:239], v11 offset:23040
v_mfma_f32_16x16x32_bf16 v[48:51], a[204:207], a[116:119], v[48:51]
v_mfma_f32_16x16x32_bf16 v[52:55], a[208:211], a[108:111], v[52:55]
ds_read_b64_tr_b16 a[240:241], v12 offset:22528
v_mfma_f32_16x16x32_bf16 v[56:59], a[208:211], a[112:115], v[56:59]
ds_read_b64_tr_b16 a[242:243], v12 offset:23040
v_mfma_f32_16x16x32_bf16 v[60:63], a[208:211], a[116:119], v[60:63]
v_mfma_f32_16x16x32_bf16 v[28:31], a[212:215], a[120:123], v[28:31]
ds_read_b64_tr_b16 a[204:205], v13 offset:22528
v_mfma_f32_16x16x32_bf16 v[32:35], a[212:215], a[124:127], v[32:35]
ds_read_b64_tr_b16 a[206:207], v13 offset:23040
v_mfma_f32_16x16x32_bf16 v[36:39], a[212:215], a[128:131], v[36:39]
v_mfma_f32_16x16x32_bf16 v[40:43], a[216:219], a[120:123], v[40:43]
ds_read_b64_tr_b16 a[208:209], v11 offset:23552
v_mfma_f32_16x16x32_bf16 v[44:47], a[216:219], a[124:127], v[44:47]
ds_read_b64_tr_b16 a[210:211], v11 offset:24064
v_mfma_f32_16x16x32_bf16 v[48:51], a[216:219], a[128:131], v[48:51]
s_waitcnt lgkmcnt(8)
v_mfma_f32_16x16x32_bf16 v[52:55], a[220:223], a[120:123], v[52:55]
ds_read_b64_tr_b16 a[212:213], v12 offset:23552
v_mfma_f32_16x16x32_bf16 v[56:59], a[220:223], a[124:127], v[56:59]
ds_read_b64_tr_b16 a[214:215], v12 offset:24064
v_mfma_f32_16x16x32_bf16 v[60:63], a[220:223], a[128:131], v[60:63]
v_mfma_f32_16x16x32_bf16 v[28:31], a[224:227], a[132:135], v[28:31]
ds_read_b64_tr_b16 a[216:217], v13 offset:23552
v_mfma_f32_16x16x32_bf16 v[32:35], a[224:227], a[136:139], v[32:35]
ds_read_b64_tr_b16 a[218:219], v13 offset:24064
v_mfma_f32_16x16x32_bf16 v[36:39], a[224:227], a[140:143], v[36:39]
v_mfma_f32_16x16x32_bf16 v[40:43], a[228:231], a[132:135], v[40:43]
ds_read_b64_tr_b16 a[220:221], v11 offset:24576
v_mfma_f32_16x16x32_bf16 v[44:47], a[228:231], a[136:139], v[44:47]
ds_read_b64_tr_b16 a[222:223], v11 offset:25088
v_mfma_f32_16x16x32_bf16 v[48:51], a[228:231], a[140:143], v[48:51]
v_mfma_f32_16x16x32_bf16 v[52:55], a[232:235], a[132:135], v[52:55]
ds_read_b64_tr_b16 a[224:225], v12 offset:24576
v_mfma_f32_16x16x32_bf16 v[56:59], a[232:235], a[136:139], v[56:59]
ds_read_b64_tr_b16 a[226:227], v12 offset:25088
v_mfma_f32_16x16x32_bf16 v[60:63], a[232:235], a[140:143], v[60:63]
s_waitcnt lgkmcnt(8)
v_mfma_f32_16x16x32_bf16 v[28:31], a[236:239], a[144:147], v[28:31]
ds_read_b64_tr_b16 a[228:229], v13 offset:24576
v_mfma_f32_16x16x32_bf16 v[32:35], a[236:239], a[148:151], v[32:35]
ds_read_b64_tr_b16 a[230:231], v13 offset:25088
v_mfma_f32_16x16x32_bf16 v[36:39], a[236:239], a[152:155], v[36:39]
v_mfma_f32_16x16x32_bf16 v[40:43], a[240:243], a[144:147], v[40:43]
ds_read_b64_tr_b16 a[232:233], v11 offset:25600
v_mfma_f32_16x16x32_bf16 v[44:47], a[240:243], a[148:151], v[44:47]
ds_read_b64_tr_b16 a[234:235], v11 offset:26112
v_mfma_f32_16x16x32_bf16 v[48:51], a[240:243], a[152:155], v[48:51]
v_mfma_f32_16x16x32_bf16 v[52:55], a[204:207], a[144:147], v[52:55]
ds_read_b64_tr_b16 a[236:237], v12 offset:25600
v_mfma_f32_16x16x32_bf16 v[56:59], a[204:207], a[148:151], v[56:59]
ds_read_b64_tr_b16 a[238:239], v12 offset:26112
v_mfma_f32_16x16x32_bf16 v[60:63], a[204:207], a[152:155], v[60:63]
v_mfma_f32_16x16x32_bf16 v[28:31], a[208:211], a[156:159], v[28:31]
ds_read_b64_tr_b16 a[240:241], v13 offset:25600
v_mfma_f32_16x16x32_bf16 v[32:35], a[208:211], a[160:163], v[32:35]
ds_read_b64_tr_b16 a[242:243], v13 offset:26112
v_mfma_f32_16x16x32_bf16 v[36:39], a[208:211], a[164:167], v[36:39]
s_waitcnt lgkmcnt(8)
v_mfma_f32_16x16x32_bf16 v[40:43], a[212:215], a[156:159], v[40:43]
ds_read_b64_tr_b16 a[204:205], v11 offset:26624
v_mfma_f32_16x16x32_bf16 v[44:47], a[212:215], a[160:163], v[44:47]
ds_read_b64_tr_b16 a[206:207], v11 offset:27136
v_mfma_f32_16x16x32_bf16 v[48:51], a[212:215], a[164:167], v[48:51]
v_mfma_f32_16x16x32_bf16 v[52:55], a[216:219], a[156:159], v[52:55]
ds_read_b64_tr_b16 a[208:209], v12 offset:26624
v_mfma_f32_16x16x32_bf16 v[56:59], a[216:219], a[160:163], v[56:59]
ds_read_b64_tr_b16 a[210:211], v12 offset:27136
v_mfma_f32_16x16x32_bf16 v[60:63], a[216:219], a[164:167], v[60:63]
v_mfma_f32_16x16x32_bf16 v[28:31], a[220:223], a[168:171], v[28:31]
ds_read_b64_tr_b16 a[212:213], v13 offset:26624
v_mfma_f32_16x16x32_bf16 v[32:35], a[220:223], a[172:175], v[32:35]
ds_read_b64_tr_b16 a[214:215], v13 offset:27136
v_mfma_f32_16x16x32_bf16 v[36:39], a[220:223], a[176:179], v[36:39]
v_mfma_f32_16x16x32_bf16 v[40:43], a[224:227], a[168:171], v[40:43]
s_waitcnt vmcnt(18)
s_barrier
ds_read_b64_tr_b16 a[216:217], v11 offset:28672
v_mfma_f32_16x16x32_bf16 v[44:47], a[224:227], a[172:175], v[44:47]
ds_read_b64_tr_b16 a[218:219], v11 offset:29184
s_add_u32 m0, s64, 16384
v_mfma_f32_16x16x32_bf16 v[48:51], a[224:227], a[176:179], v[48:51]
s_add_u32 s67, s66, 295168
s_waitcnt lgkmcnt(8)
v_mfma_f32_16x16x32_bf16 v[52:55], a[228:231], a[168:171], v[52:55]
ds_read_b64_tr_b16 a[220:221], v12 offset:28672
buffer_load_dwordx4 v15, s[44:47], s67 offen lds
v_mfma_f32_16x16x32_bf16 v[56:59], a[228:231], a[172:175], v[56:59]
ds_read_b64_tr_b16 a[222:223], v12 offset:29184
v_mfma_f32_16x16x32_bf16 v[60:63], a[228:231], a[176:179], v[60:63]
v_mfma_f32_16x16x32_bf16 v[28:31], a[232:235], a[180:183], v[28:31]
ds_read_b64_tr_b16 a[224:225], v13 offset:28672
buffer_load_dwordx4 v15, s[48:51], s67 offen offset:1024 lds
v_mfma_f32_16x16x32_bf16 v[32:35], a[232:235], a[184:187], v[32:35]
ds_read_b64_tr_b16 a[226:227], v13 offset:29184
s_add_u32 m0, s64, 18432
v_mfma_f32_16x16x32_bf16 v[36:39], a[232:235], a[188:191], v[36:39]
s_add_u32 s67, s66, 384
v_mfma_f32_16x16x32_bf16 v[40:43], a[236:239], a[180:183], v[40:43]
ds_read_b64_tr_b16 a[228:229], v14 offset:28672
buffer_load_dwordx4 v15, s[44:47], s67 offen lds
v_mfma_f32_16x16x32_bf16 v[44:47], a[236:239], a[184:187], v[44:47]
ds_read_b64_tr_b16 a[230:231], v14 offset:29184
v_mfma_f32_16x16x32_bf16 v[48:51], a[236:239], a[188:191], v[48:51]
v_mfma_f32_16x16x32_bf16 v[52:55], a[240:243], a[180:183], v[52:55]
ds_read_b64_tr_b16 a[232:233], v11 offset:29696
buffer_load_dwordx4 v15, s[48:51], s67 offen offset:1024 lds
v_mfma_f32_16x16x32_bf16 v[56:59], a[240:243], a[184:187], v[56:59]
ds_read_b64_tr_b16 a[234:235], v11 offset:30208
v_mfma_f32_16x16x32_bf16 v[60:63], a[240:243], a[188:191], v[60:63]
s_waitcnt lgkmcnt(8)
v_mfma_f32_16x16x32_bf16 v[28:31], a[204:207], a[192:195], v[28:31]
ds_read_b64_tr_b16 a[236:237], v12 offset:29696
s_add_u32 m0, s64, 20480
v_mfma_f32_16x16x32_bf16 v[32:35], a[204:207], a[196:199], v[32:35]
ds_read_b64_tr_b16 a[238:239], v12 offset:30208
s_add_u32 s67, s66, 74112
v_mfma_f32_16x16x32_bf16 v[36:39], a[204:207], a[200:203], v[36:39]
buffer_load_dwordx4 v15, s[44:47], s67 offen lds
buffer_load_dwordx4 a[252:255], v255, s[56:59], s3 offen
v_mfma_f32_16x16x32_bf16 v[40:43], a[208:211], a[192:195], v[40:43]
ds_read_b64_tr_b16 a[240:241], v13 offset:29696
v_mfma_f32_16x16x32_bf16 v[44:47], a[208:211], a[196:199], v[44:47]
ds_read_b64_tr_b16 a[242:243], v13 offset:30208
v_mfma_f32_16x16x32_bf16 v[48:51], a[208:211], a[200:203], v[48:51]
buffer_load_dwordx4 v15, s[48:51], s67 offen offset:1024 lds
v_mfma_f32_16x16x32_bf16 v[52:55], a[212:215], a[192:195], v[52:55]
ds_read_b64_tr_b16 a[204:205], v14 offset:29696
s_add_u32 m0, s64, 22528
v_mfma_f32_16x16x32_bf16 v[56:59], a[212:215], a[196:199], v[56:59]
ds_read_b64_tr_b16 a[206:207], v14 offset:30208
s_add_u32 s67, s66, 147840
v_mfma_f32_16x16x32_bf16 v[60:63], a[212:215], a[200:203], v[60:63]
buffer_load_dwordx4 v15, s[44:47], s67 offen lds
buffer_load_dwordx4 v15, s[48:51], s67 offen offset:1024 lds
v_mfma_f32_16x16x32_bf16 v[76:79], a[216:219], v[124:127], 0
ds_read_b64_tr_b16 a[208:209], v11 offset:30720
v_mfma_f32_16x16x32_bf16 v[80:83], a[216:219], v[128:131], 0
ds_read_b64_tr_b16 a[210:211], v11 offset:31232
v_mfma_f32_16x16x32_bf16 v[84:87], a[216:219], v[132:135], 0
v_cvt_pk_bf16_f32 v220, v28, v29
s_waitcnt lgkmcnt(8)
v_mfma_f32_16x16x32_bf16 v[88:91], a[220:223], v[124:127], 0
ds_read_b64_tr_b16 a[212:213], v12 offset:30720
v_cvt_pk_bf16_f32 v221, v30, v31
v_mfma_f32_16x16x32_bf16 v[92:95], a[220:223], v[128:131], 0
ds_read_b64_tr_b16 a[214:215], v12 offset:31232
v_cvt_pk_bf16_f32 v224, v32, v33
v_mfma_f32_16x16x32_bf16 v[96:99], a[220:223], v[132:135], 0
v_cvt_pk_bf16_f32 v225, v34, v35
v_cvt_pk_bf16_f32 v228, v36, v37
v_mfma_f32_16x16x32_bf16 v[100:103], a[224:227], v[124:127], 0
ds_read_b64_tr_b16 a[216:217], v13 offset:30720
v_cvt_pk_bf16_f32 v229, v38, v39
v_mfma_f32_16x16x32_bf16 v[104:107], a[224:227], v[128:131], 0
ds_read_b64_tr_b16 a[218:219], v13 offset:31232
v_mfma_f32_16x16x32_bf16 v[108:111], a[224:227], v[132:135], 0
v_mfma_f32_16x16x32_bf16 v[112:115], a[228:231], v[124:127], 0
ds_read_b64_tr_b16 a[220:221], v14 offset:30720
v_mfma_f32_16x16x32_bf16 v[116:119], a[228:231], v[128:131], 0
ds_read_b64_tr_b16 a[222:223], v14 offset:31232
v_mfma_f32_16x16x32_bf16 v[120:123], a[228:231], v[132:135], 0
v_mfma_f32_16x16x32_bf16 v[76:79], a[232:235], v[136:139], v[76:79]
ds_read_b64_tr_b16 a[224:225], v11 offset:31744
v_mfma_f32_16x16x32_bf16 v[80:83], a[232:235], v[140:143], v[80:83]
ds_read_b64_tr_b16 a[226:227], v11 offset:32256
v_mfma_f32_16x16x32_bf16 v[84:87], a[232:235], v[144:147], v[84:87]
s_waitcnt lgkmcnt(8)
v_mfma_f32_16x16x32_bf16 v[88:91], a[236:239], v[136:139], v[88:91]
ds_read_b64_tr_b16 a[228:229], v12 offset:31744
v_mfma_f32_16x16x32_bf16 v[92:95], a[236:239], v[140:143], v[92:95]
ds_read_b64_tr_b16 a[230:231], v12 offset:32256
v_mfma_f32_16x16x32_bf16 v[96:99], a[236:239], v[144:147], v[96:99]
v_mfma_f32_16x16x32_bf16 v[100:103], a[240:243], v[136:139], v[100:103]
ds_read_b64_tr_b16 a[232:233], v13 offset:31744
v_mfma_f32_16x16x32_bf16 v[104:107], a[240:243], v[140:143], v[104:107]
ds_read_b64_tr_b16 a[234:235], v13 offset:32256
v_mfma_f32_16x16x32_bf16 v[108:111], a[240:243], v[144:147], v[108:111]
v_mfma_f32_16x16x32_bf16 v[112:115], a[204:207], v[136:139], v[112:115]
ds_read_b64_tr_b16 a[236:237], v14 offset:31744
v_mfma_f32_16x16x32_bf16 v[116:119], a[204:207], v[140:143], v[116:119]
ds_read_b64_tr_b16 a[238:239], v14 offset:32256
v_mfma_f32_16x16x32_bf16 v[120:123], a[204:207], v[144:147], v[120:123]
v_mfma_f32_16x16x32_bf16 v[76:79], a[208:211], v[148:151], v[76:79]
ds_read_b64_tr_b16 a[240:241], v11 offset:32768
v_mfma_f32_16x16x32_bf16 v[80:83], a[208:211], v[152:155], v[80:83]
ds_read_b64_tr_b16 a[242:243], v11 offset:33280
v_mfma_f32_16x16x32_bf16 v[84:87], a[208:211], v[156:159], v[84:87]
v_cvt_pk_bf16_f32 v222, v40, v41
s_waitcnt lgkmcnt(8)
v_mfma_f32_16x16x32_bf16 v[88:91], a[212:215], v[148:151], v[88:91]
ds_read_b64_tr_b16 a[204:205], v12 offset:32768
v_cvt_pk_bf16_f32 v223, v42, v43
v_mfma_f32_16x16x32_bf16 v[92:95], a[212:215], v[152:155], v[92:95]
ds_read_b64_tr_b16 a[206:207], v12 offset:33280
v_cvt_pk_bf16_f32 v226, v44, v45
v_mfma_f32_16x16x32_bf16 v[96:99], a[212:215], v[156:159], v[96:99]
v_cvt_pk_bf16_f32 v227, v46, v47
v_cvt_pk_bf16_f32 v230, v48, v49
v_mfma_f32_16x16x32_bf16 v[100:103], a[216:219], v[148:151], v[100:103]
ds_read_b64_tr_b16 a[208:209], v13 offset:32768
v_cvt_pk_bf16_f32 v231, v50, v51
v_mfma_f32_16x16x32_bf16 v[104:107], a[216:219], v[152:155], v[104:107]
ds_read_b64_tr_b16 a[210:211], v13 offset:33280
v_mfma_f32_16x16x32_bf16 v[108:111], a[216:219], v[156:159], v[108:111]
v_mfma_f32_16x16x32_bf16 v[112:115], a[220:223], v[148:151], v[112:115]
ds_read_b64_tr_b16 a[212:213], v14 offset:32768
v_mfma_f32_16x16x32_bf16 v[116:119], a[220:223], v[152:155], v[116:119]
ds_read_b64_tr_b16 a[214:215], v14 offset:33280
v_mfma_f32_16x16x32_bf16 v[120:123], a[220:223], v[156:159], v[120:123]
v_mfma_f32_16x16x32_bf16 v[76:79], a[224:227], v[160:163], v[76:79]
ds_read_b64_tr_b16 a[216:217], v11 offset:33792
v_mfma_f32_16x16x32_bf16 v[80:83], a[224:227], v[164:167], v[80:83]
ds_read_b64_tr_b16 a[218:219], v11 offset:34304
v_mfma_f32_16x16x32_bf16 v[84:87], a[224:227], v[168:171], v[84:87]
s_waitcnt lgkmcnt(8)
v_mfma_f32_16x16x32_bf16 v[88:91], a[228:231], v[160:163], v[88:91]
ds_read_b64_tr_b16 a[220:221], v12 offset:33792
v_mfma_f32_16x16x32_bf16 v[92:95], a[228:231], v[164:167], v[92:95]
ds_read_b64_tr_b16 a[222:223], v12 offset:34304
v_mfma_f32_16x16x32_bf16 v[96:99], a[228:231], v[168:171], v[96:99]
v_mfma_f32_16x16x32_bf16 v[100:103], a[232:235], v[160:163], v[100:103]
ds_read_b64_tr_b16 a[224:225], v13 offset:33792
v_mfma_f32_16x16x32_bf16 v[104:107], a[232:235], v[164:167], v[104:107]
ds_read_b64_tr_b16 a[226:227], v13 offset:34304
v_mfma_f32_16x16x32_bf16 v[108:111], a[232:235], v[168:171], v[108:111]
v_mfma_f32_16x16x32_bf16 v[112:115], a[236:239], v[160:163], v[112:115]
ds_read_b64_tr_b16 a[228:229], v14 offset:33792
v_mfma_f32_16x16x32_bf16 v[116:119], a[236:239], v[164:167], v[116:119]
ds_read_b64_tr_b16 a[230:231], v14 offset:34304
v_mfma_f32_16x16x32_bf16 v[120:123], a[236:239], v[168:171], v[120:123]
v_mfma_f32_16x16x32_bf16 v[76:79], a[240:243], v[172:175], v[76:79]
ds_read_b64_tr_b16 a[232:233], v11 offset:34816
v_mfma_f32_16x16x32_bf16 v[80:83], a[240:243], v[176:179], v[80:83]
ds_read_b64_tr_b16 a[234:235], v11 offset:35328
v_mfma_f32_16x16x32_bf16 v[84:87], a[240:243], v[180:183], v[84:87]
v_cvt_pk_bf16_f32 v232, v52, v53
s_waitcnt lgkmcnt(8)
v_mfma_f32_16x16x32_bf16 v[88:91], a[204:207], v[172:175], v[88:91]
ds_read_b64_tr_b16 a[236:237], v12 offset:34816
v_cvt_pk_bf16_f32 v233, v54, v55
v_mfma_f32_16x16x32_bf16 v[92:95], a[204:207], v[176:179], v[92:95]
ds_read_b64_tr_b16 a[238:239], v12 offset:35328
v_cvt_pk_bf16_f32 v236, v56, v57
v_mfma_f32_16x16x32_bf16 v[96:99], a[204:207], v[180:183], v[96:99]
v_cvt_pk_bf16_f32 v237, v58, v59
v_cvt_pk_bf16_f32 v240, v60, v61
v_mfma_f32_16x16x32_bf16 v[100:103], a[208:211], v[172:175], v[100:103]
ds_read_b64_tr_b16 a[240:241], v13 offset:34816
v_cvt_pk_bf16_f32 v241, v62, v63
v_mfma_f32_16x16x32_bf16 v[104:107], a[208:211], v[176:179], v[104:107]
ds_read_b64_tr_b16 a[242:243], v13 offset:35328
v_mfma_f32_16x16x32_bf16 v[108:111], a[208:211], v[180:183], v[108:111]
v_mfma_f32_16x16x32_bf16 v[112:115], a[212:215], v[172:175], v[112:115]
ds_read_b64_tr_b16 a[204:205], v14 offset:34816
v_mfma_f32_16x16x32_bf16 v[116:119], a[212:215], v[176:179], v[116:119]
ds_read_b64_tr_b16 a[206:207], v14 offset:35328
v_mfma_f32_16x16x32_bf16 v[120:123], a[212:215], v[180:183], v[120:123]
v_mfma_f32_16x16x32_bf16 v[76:79], a[216:219], v[184:187], v[76:79]
ds_read_b64_tr_b16 a[208:209], v11 offset:35840
v_mfma_f32_16x16x32_bf16 v[80:83], a[216:219], v[188:191], v[80:83]
ds_read_b64_tr_b16 a[210:211], v11 offset:36352
v_mfma_f32_16x16x32_bf16 v[84:87], a[216:219], v[192:195], v[84:87]
s_waitcnt lgkmcnt(8)
v_mfma_f32_16x16x32_bf16 v[88:91], a[220:223], v[184:187], v[88:91]
ds_read_b64_tr_b16 a[212:213], v12 offset:35840
v_mfma_f32_16x16x32_bf16 v[92:95], a[220:223], v[188:191], v[92:95]
ds_read_b64_tr_b16 a[214:215], v12 offset:36352
v_mfma_f32_16x16x32_bf16 v[96:99], a[220:223], v[192:195], v[96:99]
v_mfma_f32_16x16x32_bf16 v[100:103], a[224:227], v[184:187], v[100:103]
ds_read_b64_tr_b16 a[216:217], v13 offset:35840
v_mfma_f32_16x16x32_bf16 v[104:107], a[224:227], v[188:191], v[104:107]
ds_read_b64_tr_b16 a[218:219], v13 offset:36352
v_mfma_f32_16x16x32_bf16 v[108:111], a[224:227], v[192:195], v[108:111]
v_mfma_f32_16x16x32_bf16 v[112:115], a[228:231], v[184:187], v[112:115]
ds_read_b64_tr_b16 a[220:221], v14 offset:35840
v_mfma_f32_16x16x32_bf16 v[116:119], a[228:231], v[188:191], v[116:119]
ds_read_b64_tr_b16 a[222:223], v14 offset:36352
v_mfma_f32_16x16x32_bf16 v[120:123], a[228:231], v[192:195], v[120:123]
v_mfma_f32_16x16x32_bf16 v[76:79], a[232:235], v[196:199], v[76:79]
ds_read_b64_tr_b16 a[224:225], v11 offset:36864
v_mfma_f32_16x16x32_bf16 v[80:83], a[232:235], v[200:203], v[80:83]
ds_read_b64_tr_b16 a[226:227], v11 offset:37376
v_mfma_f32_16x16x32_bf16 v[84:87], a[232:235], v[204:207], v[84:87]
s_waitcnt lgkmcnt(8)
v_mfma_f32_16x16x32_bf16 v[88:91], a[236:239], v[196:199], v[88:91]
ds_read_b64_tr_b16 a[228:229], v12 offset:36864
v_mfma_f32_16x16x32_bf16 v[92:95], a[236:239], v[200:203], v[92:95]
ds_read_b64_tr_b16 a[230:231], v12 offset:37376
v_mfma_f32_16x16x32_bf16 v[96:99], a[236:239], v[204:207], v[96:99]
v_mfma_f32_16x16x32_bf16 v[100:103], a[240:243], v[196:199], v[100:103]
ds_read_b64_tr_b16 a[232:233], v13 offset:36864
v_mfma_f32_16x16x32_bf16 v[104:107], a[240:243], v[200:203], v[104:107]
ds_read_b64_tr_b16 a[234:235], v13 offset:37376
v_mfma_f32_16x16x32_bf16 v[108:111], a[240:243], v[204:207], v[108:111]
v_mfma_f32_16x16x32_bf16 v[112:115], a[204:207], v[196:199], v[112:115]
ds_read_b64_tr_b16 a[236:237], v14 offset:36864
v_mfma_f32_16x16x32_bf16 v[116:119], a[204:207], v[200:203], v[116:119]
ds_read_b64_tr_b16 a[238:239], v14 offset:37376
v_mfma_f32_16x16x32_bf16 v[120:123], a[204:207], v[204:207], v[120:123]
v_mfma_f32_16x16x32_bf16 v[76:79], a[208:211], v[208:211], v[76:79]
ds_read_b64_tr_b16 a[240:241], v11 offset:37888
v_mfma_f32_16x16x32_bf16 v[80:83], a[208:211], v[212:215], v[80:83]
ds_read_b64_tr_b16 a[242:243], v11 offset:38400
v_mfma_f32_16x16x32_bf16 v[84:87], a[208:211], v[216:219], v[84:87]
s_waitcnt lgkmcnt(8)
v_mfma_f32_16x16x32_bf16 v[88:91], a[212:215], v[208:211], v[88:91]
ds_read_b64_tr_b16 a[204:205], v12 offset:37888
v_mfma_f32_16x16x32_bf16 v[92:95], a[212:215], v[212:215], v[92:95]
ds_read_b64_tr_b16 a[206:207], v12 offset:38400
v_mfma_f32_16x16x32_bf16 v[96:99], a[212:215], v[216:219], v[96:99]
v_mfma_f32_16x16x32_bf16 v[100:103], a[216:219], v[208:211], v[100:103]
ds_read_b64_tr_b16 a[208:209], v13 offset:37888
v_mfma_f32_16x16x32_bf16 v[104:107], a[216:219], v[212:215], v[104:107]
ds_read_b64_tr_b16 a[210:211], v13 offset:38400
v_mfma_f32_16x16x32_bf16 v[108:111], a[216:219], v[216:219], v[108:111]
v_mfma_f32_16x16x32_bf16 v[112:115], a[220:223], v[208:211], v[112:115]
ds_read_b64_tr_b16 a[212:213], v14 offset:37888
v_mfma_f32_16x16x32_bf16 v[116:119], a[220:223], v[212:215], v[116:119]
ds_read_b64_tr_b16 a[214:215], v14 offset:38400
v_mfma_f32_16x16x32_bf16 v[120:123], a[220:223], v[216:219], v[120:123]
v_mfma_f32_16x16x32_bf16 v[76:79], a[224:227], v[220:223], v[76:79]
s_waitcnt vmcnt(17)
s_barrier
ds_read_b64_tr_b16 a[216:217], v11 offset:38912
v_mfma_f32_16x16x32_bf16 v[80:83], a[224:227], v[224:227], v[80:83]
ds_read_b64_tr_b16 a[218:219], v11 offset:39424
s_add_u32 m0, s64, 24576
v_mfma_f32_16x16x32_bf16 v[84:87], a[224:227], v[228:231], v[84:87]
s_add_u32 s67, s66, 221568
s_waitcnt lgkmcnt(8)
v_mfma_f32_16x16x32_bf16 v[88:91], a[228:231], v[220:223], v[88:91]
ds_read_b64_tr_b16 a[220:221], v12 offset:38912
buffer_load_dwordx4 v15, s[44:47], s67 offen lds
v_mfma_f32_16x16x32_bf16 v[92:95], a[228:231], v[224:227], v[92:95]
ds_read_b64_tr_b16 a[222:223], v12 offset:39424
v_mfma_f32_16x16x32_bf16 v[96:99], a[228:231], v[228:231], v[96:99]
v_mfma_f32_16x16x32_bf16 v[100:103], a[232:235], v[220:223], v[100:103]
ds_read_b64_tr_b16 a[224:225], v13 offset:38912
buffer_load_dwordx4 v15, s[48:51], s67 offen offset:1024 lds
v_mfma_f32_16x16x32_bf16 v[104:107], a[232:235], v[224:227], v[104:107]
ds_read_b64_tr_b16 a[226:227], v13 offset:39424
s_add_u32 m0, s64, 26624
v_mfma_f32_16x16x32_bf16 v[108:111], a[232:235], v[228:231], v[108:111]
s_add_u32 s67, s66, 295296
v_mfma_f32_16x16x32_bf16 v[112:115], a[236:239], v[220:223], v[112:115]
ds_read_b64_tr_b16 a[228:229], v14 offset:38912
buffer_load_dwordx4 v15, s[44:47], s67 offen lds
v_mfma_f32_16x16x32_bf16 v[116:119], a[236:239], v[224:227], v[116:119]
ds_read_b64_tr_b16 a[230:231], v14 offset:39424
v_mfma_f32_16x16x32_bf16 v[120:123], a[236:239], v[228:231], v[120:123]
v_mfma_f32_16x16x32_bf16 v[76:79], a[240:243], v[232:235], v[76:79]
ds_read_b64_tr_b16 a[232:233], v11 offset:39936
buffer_load_dwordx4 v15, s[48:51], s67 offen offset:1024 lds
v_mfma_f32_16x16x32_bf16 v[80:83], a[240:243], v[236:239], v[80:83]
ds_read_b64_tr_b16 a[234:235], v11 offset:40448
v_mfma_f32_16x16x32_bf16 v[84:87], a[240:243], v[240:243], v[84:87]
s_waitcnt lgkmcnt(8)
v_mfma_f32_16x16x32_bf16 v[88:91], a[204:207], v[232:235], v[88:91]
ds_read_b64_tr_b16 a[236:237], v12 offset:39936
v_mfma_f32_16x16x32_bf16 v[92:95], a[204:207], v[236:239], v[92:95]
ds_read_b64_tr_b16 a[238:239], v12 offset:40448
v_mfma_f32_16x16x32_bf16 v[96:99], a[204:207], v[240:243], v[96:99]
v_mfma_f32_16x16x32_bf16 v[100:103], a[208:211], v[232:235], v[100:103]
ds_read_b64_tr_b16 a[240:241], v13 offset:39936
v_mfma_f32_16x16x32_bf16 v[104:107], a[208:211], v[236:239], v[104:107]
ds_read_b64_tr_b16 a[242:243], v13 offset:40448
v_mfma_f32_16x16x32_bf16 v[108:111], a[208:211], v[240:243], v[108:111]
v_mfma_f32_16x16x32_bf16 v[112:115], a[212:215], v[232:235], v[112:115]
ds_read_b64_tr_b16 a[204:205], v14 offset:39936
v_mfma_f32_16x16x32_bf16 v[116:119], a[212:215], v[236:239], v[116:119]
ds_read_b64_tr_b16 a[206:207], v14 offset:40448
v_mfma_f32_16x16x32_bf16 v[120:123], a[212:215], v[240:243], v[120:123]
v_mfma_f32_16x16x32_bf16 v[28:31], a[216:219], v[124:127], 0
ds_read_b64_tr_b16 a[208:209], v11 offset:0
s_add_u32 m0, s64, 28672
v_mfma_f32_16x16x32_bf16 v[32:35], a[216:219], v[128:131], 0
ds_read_b64_tr_b16 a[210:211], v11 offset:512
s_add_u32 s67, s66, 512
v_mfma_f32_16x16x32_bf16 v[36:39], a[216:219], v[132:135], 0
buffer_load_dwordx4 v15, s[44:47], s67 offen lds
s_waitcnt lgkmcnt(8)
v_mfma_f32_16x16x32_bf16 v[40:43], a[220:223], v[124:127], 0
ds_read_b64_tr_b16 a[212:213], v12 offset:0
s_add_u32 s73, s14, 0
v_mfma_f32_16x16x32_bf16 v[44:47], a[220:223], v[128:131], 0
ds_read_b64_tr_b16 a[214:215], v12 offset:512
v_cvt_pk_bf16_f32 v76, v76, v77
v_mfma_f32_16x16x32_bf16 v[48:51], a[220:223], v[132:135], 0
buffer_load_dwordx4 v15, s[48:51], s67 offen offset:1024 lds
v_cvt_pk_bf16_f32 v77, v78, v79
v_mfma_f32_16x16x32_bf16 v[52:55], a[224:227], v[124:127], 0
ds_read_b64_tr_b16 a[216:217], v13 offset:0
s_add_u32 m0, s64, 30720
v_mfma_f32_16x16x32_bf16 v[56:59], a[224:227], v[128:131], 0
ds_read_b64_tr_b16 a[218:219], v13 offset:512
s_add_u32 s67, s66, 74240
v_mfma_f32_16x16x32_bf16 v[60:63], a[224:227], v[132:135], 0
buffer_load_dwordx4 v15, s[44:47], s67 offen lds
v_cvt_pk_bf16_f32 v78, v88, v89
v_mfma_f32_16x16x32_bf16 v[64:67], a[228:231], v[124:127], 0
ds_read_b64_tr_b16 a[220:221], v14 offset:0
v_cvt_pk_bf16_f32 v79, v90, v91
v_mfma_f32_16x16x32_bf16 v[68:71], a[228:231], v[128:131], 0
ds_read_b64_tr_b16 a[222:223], v14 offset:512
buffer_store_dwordx4 v[76:79], v16, s[32:35], s73 offen offset:0 sc1
v_mfma_f32_16x16x32_bf16 v[72:75], a[228:231], v[132:135], 0
buffer_load_dwordx4 v15, s[48:51], s67 offen offset:1024 lds
v_cvt_pk_bf16_f32 v80, v80, v81
v_mfma_f32_16x16x32_bf16 v[28:31], a[232:235], v[136:139], v[28:31]
ds_read_b64_tr_b16 a[224:225], v11 offset:1024
v_cvt_pk_bf16_f32 v81, v82, v83
v_mfma_f32_16x16x32_bf16 v[32:35], a[232:235], v[140:143], v[32:35]
ds_read_b64_tr_b16 a[226:227], v11 offset:1536
v_mfma_f32_16x16x32_bf16 v[36:39], a[232:235], v[144:147], v[36:39]
s_waitcnt lgkmcnt(8)
v_mfma_f32_16x16x32_bf16 v[40:43], a[236:239], v[136:139], v[40:43]
ds_read_b64_tr_b16 a[228:229], v12 offset:1024
v_mfma_f32_16x16x32_bf16 v[44:47], a[236:239], v[140:143], v[44:47]
ds_read_b64_tr_b16 a[230:231], v12 offset:1536
v_mfma_f32_16x16x32_bf16 v[48:51], a[236:239], v[144:147], v[48:51]
v_mfma_f32_16x16x32_bf16 v[52:55], a[240:243], v[136:139], v[52:55]
ds_read_b64_tr_b16 a[232:233], v13 offset:1024
v_mfma_f32_16x16x32_bf16 v[56:59], a[240:243], v[140:143], v[56:59]
ds_read_b64_tr_b16 a[234:235], v13 offset:1536
v_mfma_f32_16x16x32_bf16 v[60:63], a[240:243], v[144:147], v[60:63]
v_mfma_f32_16x16x32_bf16 v[64:67], a[204:207], v[136:139], v[64:67]
ds_read_b64_tr_b16 a[236:237], v14 offset:1024
v_mfma_f32_16x16x32_bf16 v[68:71], a[204:207], v[140:143], v[68:71]
ds_read_b64_tr_b16 a[238:239], v14 offset:1536
v_mfma_f32_16x16x32_bf16 v[72:75], a[204:207], v[144:147], v[72:75]
v_mfma_f32_16x16x32_bf16 v[28:31], a[208:211], v[148:151], v[28:31]
ds_read_b64_tr_b16 a[240:241], v11 offset:2048
s_add_u32 m0, s64, 32768
v_mfma_f32_16x16x32_bf16 v[32:35], a[208:211], v[152:155], v[32:35]
ds_read_b64_tr_b16 a[242:243], v11 offset:2560
s_add_u32 s67, s66, 147968
v_mfma_f32_16x16x32_bf16 v[36:39], a[208:211], v[156:159], v[36:39]
buffer_load_dwordx4 v15, s[44:47], s67 offen lds
s_waitcnt lgkmcnt(8)
v_mfma_f32_16x16x32_bf16 v[40:43], a[212:215], v[148:151], v[40:43]
ds_read_b64_tr_b16 a[204:205], v12 offset:2048
v_cvt_pk_bf16_f32 v82, v92, v93
v_mfma_f32_16x16x32_bf16 v[44:47], a[212:215], v[152:155], v[44:47]
ds_read_b64_tr_b16 a[206:207], v12 offset:2560
v_cvt_pk_bf16_f32 v83, v94, v95
v_mfma_f32_16x16x32_bf16 v[48:51], a[212:215], v[156:159], v[48:51]
buffer_load_dwordx4 v15, s[48:51], s67 offen offset:1024 lds
buffer_store_dwordx4 v[80:83], v16, s[32:35], s73 offen offset:256 sc1
v_mfma_f32_16x16x32_bf16 v[52:55], a[216:219], v[148:151], v[52:55]
ds_read_b64_tr_b16 a[208:209], v13 offset:2048
s_add_u32 m0, s64, 34816
v_mfma_f32_16x16x32_bf16 v[56:59], a[216:219], v[152:155], v[56:59]
ds_read_b64_tr_b16 a[210:211], v13 offset:2560
s_add_u32 s67, s66, 221696
v_mfma_f32_16x16x32_bf16 v[60:63], a[216:219], v[156:159], v[60:63]
buffer_load_dwordx4 v15, s[44:47], s67 offen lds
v_cvt_pk_bf16_f32 v84, v84, v85
v_mfma_f32_16x16x32_bf16 v[64:67], a[220:223], v[148:151], v[64:67]
ds_read_b64_tr_b16 a[212:213], v14 offset:2048
v_cvt_pk_bf16_f32 v85, v86, v87
v_mfma_f32_16x16x32_bf16 v[68:71], a[220:223], v[152:155], v[68:71]
ds_read_b64_tr_b16 a[214:215], v14 offset:2560
v_cvt_pk_bf16_f32 v86, v96, v97
v_mfma_f32_16x16x32_bf16 v[72:75], a[220:223], v[156:159], v[72:75]
buffer_load_dwordx4 v15, s[48:51], s67 offen offset:1024 lds
v_cvt_pk_bf16_f32 v87, v98, v99
v_mfma_f32_16x16x32_bf16 v[28:31], a[224:227], v[160:163], v[28:31]
ds_read_b64_tr_b16 a[216:217], v11 offset:3072
buffer_store_dwordx4 v[84:87], v16, s[32:35], s73 offen offset:512 sc1
v_mfma_f32_16x16x32_bf16 v[32:35], a[224:227], v[164:167], v[32:35]
ds_read_b64_tr_b16 a[218:219], v11 offset:3584
v_mfma_f32_16x16x32_bf16 v[36:39], a[224:227], v[168:171], v[36:39]
s_waitcnt lgkmcnt(8)
v_mfma_f32_16x16x32_bf16 v[40:43], a[228:231], v[160:163], v[40:43]
ds_read_b64_tr_b16 a[220:221], v12 offset:3072
v_mfma_f32_16x16x32_bf16 v[44:47], a[228:231], v[164:167], v[44:47]
ds_read_b64_tr_b16 a[222:223], v12 offset:3584
v_mfma_f32_16x16x32_bf16 v[48:51], a[228:231], v[168:171], v[48:51]
v_mfma_f32_16x16x32_bf16 v[52:55], a[232:235], v[160:163], v[52:55]
ds_read_b64_tr_b16 a[224:225], v13 offset:3072
v_mfma_f32_16x16x32_bf16 v[56:59], a[232:235], v[164:167], v[56:59]
ds_read_b64_tr_b16 a[226:227], v13 offset:3584
v_mfma_f32_16x16x32_bf16 v[60:63], a[232:235], v[168:171], v[60:63]
v_mfma_f32_16x16x32_bf16 v[64:67], a[236:239], v[160:163], v[64:67]
ds_read_b64_tr_b16 a[228:229], v14 offset:3072
v_mfma_f32_16x16x32_bf16 v[68:71], a[236:239], v[164:167], v[68:71]
ds_read_b64_tr_b16 a[230:231], v14 offset:3584
v_mfma_f32_16x16x32_bf16 v[72:75], a[236:239], v[168:171], v[72:75]
v_mfma_f32_16x16x32_bf16 v[28:31], a[240:243], v[172:175], v[28:31]
ds_read_b64_tr_b16 a[232:233], v11 offset:4096
v_mfma_f32_16x16x32_bf16 v[32:35], a[240:243], v[176:179], v[32:35]
ds_read_b64_tr_b16 a[234:235], v11 offset:4608
v_mfma_f32_16x16x32_bf16 v[36:39], a[240:243], v[180:183], v[36:39]
s_add_u32 s73, s14, 36864
s_waitcnt lgkmcnt(8)
v_mfma_f32_16x16x32_bf16 v[40:43], a[204:207], v[172:175], v[40:43]
ds_read_b64_tr_b16 a[236:237], v12 offset:4096
v_cvt_pk_bf16_f32 v100, v100, v101
v_mfma_f32_16x16x32_bf16 v[44:47], a[204:207], v[176:179], v[44:47]
ds_read_b64_tr_b16 a[238:239], v12 offset:4608
v_cvt_pk_bf16_f32 v101, v102, v103
v_mfma_f32_16x16x32_bf16 v[48:51], a[204:207], v[180:183], v[48:51]
v_cvt_pk_bf16_f32 v102, v112, v113
v_cvt_pk_bf16_f32 v103, v114, v115
v_mfma_f32_16x16x32_bf16 v[52:55], a[208:211], v[172:175], v[52:55]
ds_read_b64_tr_b16 a[240:241], v13 offset:4096
buffer_store_dwordx4 v[100:103], v16, s[32:35], s73 offen offset:0 sc1
v_mfma_f32_16x16x32_bf16 v[56:59], a[208:211], v[176:179], v[56:59]
ds_read_b64_tr_b16 a[242:243], v13 offset:4608
v_cvt_pk_bf16_f32 v104, v104, v105
v_mfma_f32_16x16x32_bf16 v[60:63], a[208:211], v[180:183], v[60:63]
v_cvt_pk_bf16_f32 v105, v106, v107
v_mfma_f32_16x16x32_bf16 v[64:67], a[212:215], v[172:175], v[64:67]
ds_read_b64_tr_b16 a[204:205], v14 offset:4096
v_mfma_f32_16x16x32_bf16 v[68:71], a[212:215], v[176:179], v[68:71]
ds_read_b64_tr_b16 a[206:207], v14 offset:4608
v_mfma_f32_16x16x32_bf16 v[72:75], a[212:215], v[180:183], v[72:75]
v_mfma_f32_16x16x32_bf16 v[28:31], a[216:219], v[184:187], v[28:31]
ds_read_b64_tr_b16 a[208:209], v11 offset:5120
v_mfma_f32_16x16x32_bf16 v[32:35], a[216:219], v[188:191], v[32:35]
ds_read_b64_tr_b16 a[210:211], v11 offset:5632
v_mfma_f32_16x16x32_bf16 v[36:39], a[216:219], v[192:195], v[36:39]
s_waitcnt lgkmcnt(8)
v_mfma_f32_16x16x32_bf16 v[40:43], a[220:223], v[184:187], v[40:43]
ds_read_b64_tr_b16 a[212:213], v12 offset:5120
v_mfma_f32_16x16x32_bf16 v[44:47], a[220:223], v[188:191], v[44:47]
ds_read_b64_tr_b16 a[214:215], v12 offset:5632
v_mfma_f32_16x16x32_bf16 v[48:51], a[220:223], v[192:195], v[48:51]
v_mfma_f32_16x16x32_bf16 v[52:55], a[224:227], v[184:187], v[52:55]
ds_read_b64_tr_b16 a[216:217], v13 offset:5120
v_mfma_f32_16x16x32_bf16 v[56:59], a[224:227], v[188:191], v[56:59]
ds_read_b64_tr_b16 a[218:219], v13 offset:5632
v_mfma_f32_16x16x32_bf16 v[60:63], a[224:227], v[192:195], v[60:63]
v_mfma_f32_16x16x32_bf16 v[64:67], a[228:231], v[184:187], v[64:67]
ds_read_b64_tr_b16 a[220:221], v14 offset:5120
v_mfma_f32_16x16x32_bf16 v[68:71], a[228:231], v[188:191], v[68:71]
ds_read_b64_tr_b16 a[222:223], v14 offset:5632
v_mfma_f32_16x16x32_bf16 v[72:75], a[228:231], v[192:195], v[72:75]
v_mfma_f32_16x16x32_bf16 v[28:31], a[232:235], v[196:199], v[28:31]
ds_read_b64_tr_b16 a[224:225], v11 offset:6144
v_mfma_f32_16x16x32_bf16 v[32:35], a[232:235], v[200:203], v[32:35]
ds_read_b64_tr_b16 a[226:227], v11 offset:6656
v_mfma_f32_16x16x32_bf16 v[36:39], a[232:235], v[204:207], v[36:39]
v_cvt_pk_bf16_f32 v106, v116, v117
s_waitcnt lgkmcnt(8)
v_mfma_f32_16x16x32_bf16 v[40:43], a[236:239], v[196:199], v[40:43]
ds_read_b64_tr_b16 a[228:229], v12 offset:6144
v_cvt_pk_bf16_f32 v107, v118, v119
v_mfma_f32_16x16x32_bf16 v[44:47], a[236:239], v[200:203], v[44:47]
ds_read_b64_tr_b16 a[230:231], v12 offset:6656
buffer_store_dwordx4 v[104:107], v16, s[32:35], s73 offen offset:256 sc1
v_mfma_f32_16x16x32_bf16 v[48:51], a[236:239], v[204:207], v[48:51]
v_cvt_pk_bf16_f32 v108, v108, v109
v_cvt_pk_bf16_f32 v109, v110, v111
v_mfma_f32_16x16x32_bf16 v[52:55], a[240:243], v[196:199], v[52:55]
ds_read_b64_tr_b16 a[232:233], v13 offset:6144
v_cvt_pk_bf16_f32 v110, v120, v121
v_mfma_f32_16x16x32_bf16 v[56:59], a[240:243], v[200:203], v[56:59]
ds_read_b64_tr_b16 a[234:235], v13 offset:6656
v_cvt_pk_bf16_f32 v111, v122, v123
v_mfma_f32_16x16x32_bf16 v[60:63], a[240:243], v[204:207], v[60:63]
buffer_store_dwordx4 v[108:111], v16, s[32:35], s73 offen offset:512 sc1
v_mfma_f32_16x16x32_bf16 v[64:67], a[204:207], v[196:199], v[64:67]
ds_read_b64_tr_b16 a[236:237], v14 offset:6144
v_mfma_f32_16x16x32_bf16 v[68:71], a[204:207], v[200:203], v[68:71]
ds_read_b64_tr_b16 a[238:239], v14 offset:6656
v_mfma_f32_16x16x32_bf16 v[72:75], a[204:207], v[204:207], v[72:75]
v_mfma_f32_16x16x32_bf16 v[28:31], a[208:211], v[208:211], v[28:31]
ds_read_b64_tr_b16 a[240:241], v11 offset:7168
v_mfma_f32_16x16x32_bf16 v[32:35], a[208:211], v[212:215], v[32:35]
ds_read_b64_tr_b16 a[242:243], v11 offset:7680
v_mfma_f32_16x16x32_bf16 v[36:39], a[208:211], v[216:219], v[36:39]
s_waitcnt lgkmcnt(8)
v_mfma_f32_16x16x32_bf16 v[40:43], a[212:215], v[208:211], v[40:43]
ds_read_b64_tr_b16 a[204:205], v12 offset:7168
v_mfma_f32_16x16x32_bf16 v[44:47], a[212:215], v[212:215], v[44:47]
ds_read_b64_tr_b16 a[206:207], v12 offset:7680
v_mfma_f32_16x16x32_bf16 v[48:51], a[212:215], v[216:219], v[48:51]
v_mfma_f32_16x16x32_bf16 v[52:55], a[216:219], v[208:211], v[52:55]
ds_read_b64_tr_b16 a[208:209], v13 offset:7168
v_mfma_f32_16x16x32_bf16 v[56:59], a[216:219], v[212:215], v[56:59]
ds_read_b64_tr_b16 a[210:211], v13 offset:7680
v_mfma_f32_16x16x32_bf16 v[60:63], a[216:219], v[216:219], v[60:63]
v_mfma_f32_16x16x32_bf16 v[64:67], a[220:223], v[208:211], v[64:67]
ds_read_b64_tr_b16 a[212:213], v14 offset:7168
v_mfma_f32_16x16x32_bf16 v[68:71], a[220:223], v[212:215], v[68:71]
ds_read_b64_tr_b16 a[214:215], v14 offset:7680
v_mfma_f32_16x16x32_bf16 v[72:75], a[220:223], v[216:219], v[72:75]
v_mfma_f32_16x16x32_bf16 v[28:31], a[224:227], v[220:223], v[28:31]
s_waitcnt vmcnt(25)
s_barrier
ds_read_b64_tr_b16 a[216:217], v11 offset:8192
v_mfma_f32_16x16x32_bf16 v[32:35], a[224:227], v[224:227], v[32:35]
ds_read_b64_tr_b16 a[218:219], v11 offset:8704
s_add_u32 m0, s64, 36864
v_mfma_f32_16x16x32_bf16 v[36:39], a[224:227], v[228:231], v[36:39]
s_add_u32 s67, s66, 295424
s_waitcnt lgkmcnt(8)
v_mfma_f32_16x16x32_bf16 v[40:43], a[228:231], v[220:223], v[40:43]
ds_read_b64_tr_b16 a[220:221], v12 offset:8192
buffer_load_dwordx4 v15, s[44:47], s67 offen lds
v_mfma_f32_16x16x32_bf16 v[44:47], a[228:231], v[224:227], v[44:47]
ds_read_b64_tr_b16 a[222:223], v12 offset:8704
v_mfma_f32_16x16x32_bf16 v[48:51], a[228:231], v[228:231], v[48:51]
v_mfma_f32_16x16x32_bf16 v[52:55], a[232:235], v[220:223], v[52:55]
ds_read_b64_tr_b16 a[224:225], v13 offset:8192
buffer_load_dwordx4 v15, s[48:51], s67 offen offset:1024 lds
v_mfma_f32_16x16x32_bf16 v[56:59], a[232:235], v[224:227], v[56:59]
ds_read_b64_tr_b16 a[226:227], v13 offset:8704
v_mfma_f32_16x16x32_bf16 v[60:63], a[232:235], v[228:231], v[60:63]
v_mfma_f32_16x16x32_bf16 v[64:67], a[236:239], v[220:223], v[64:67]
ds_read_b64_tr_b16 a[228:229], v14 offset:8192
v_mfma_f32_16x16x32_bf16 v[68:71], a[236:239], v[224:227], v[68:71]
ds_read_b64_tr_b16 a[230:231], v14 offset:8704
v_mfma_f32_16x16x32_bf16 v[72:75], a[236:239], v[228:231], v[72:75]
v_mfma_f32_16x16x32_bf16 v[28:31], a[240:243], v[232:235], v[28:31]
ds_read_b64_tr_b16 a[232:233], v11 offset:9216
v_mfma_f32_16x16x32_bf16 v[32:35], a[240:243], v[236:239], v[32:35]
ds_read_b64_tr_b16 a[234:235], v11 offset:9728
v_mfma_f32_16x16x32_bf16 v[36:39], a[240:243], v[240:243], v[36:39]
s_waitcnt lgkmcnt(8)
v_mfma_f32_16x16x32_bf16 v[40:43], a[204:207], v[232:235], v[40:43]
ds_read_b64_tr_b16 a[236:237], v12 offset:9216
v_mfma_f32_16x16x32_bf16 v[44:47], a[204:207], v[236:239], v[44:47]
ds_read_b64_tr_b16 a[238:239], v12 offset:9728
v_mfma_f32_16x16x32_bf16 v[48:51], a[204:207], v[240:243], v[48:51]
v_mfma_f32_16x16x32_bf16 v[52:55], a[208:211], v[232:235], v[52:55]
ds_read_b64_tr_b16 a[240:241], v13 offset:9216
v_mfma_f32_16x16x32_bf16 v[56:59], a[208:211], v[236:239], v[56:59]
ds_read_b64_tr_b16 a[242:243], v13 offset:9728
v_mfma_f32_16x16x32_bf16 v[60:63], a[208:211], v[240:243], v[60:63]
v_mfma_f32_16x16x32_bf16 v[64:67], a[212:215], v[232:235], v[64:67]
ds_read_b64_tr_b16 a[204:205], v14 offset:9216
v_mfma_f32_16x16x32_bf16 v[68:71], a[212:215], v[236:239], v[68:71]
ds_read_b64_tr_b16 a[206:207], v14 offset:9728
v_mfma_f32_16x16x32_bf16 v[72:75], a[212:215], v[240:243], v[72:75]
v_mfma_f32_16x16x32_bf16 v[76:79], a[216:219], v[124:127], 0
ds_read_b64_tr_b16 a[208:209], v11 offset:10240
v_mfma_f32_16x16x32_bf16 v[80:83], a[216:219], v[128:131], 0
ds_read_b64_tr_b16 a[210:211], v11 offset:10752
v_mfma_f32_16x16x32_bf16 v[84:87], a[216:219], v[132:135], 0
s_add_u32 s73, s14, 73728
s_waitcnt lgkmcnt(8)
v_mfma_f32_16x16x32_bf16 v[88:91], a[220:223], v[124:127], 0
ds_read_b64_tr_b16 a[212:213], v12 offset:10240
v_cvt_pk_bf16_f32 v28, v28, v29
v_mfma_f32_16x16x32_bf16 v[92:95], a[220:223], v[128:131], 0
ds_read_b64_tr_b16 a[214:215], v12 offset:10752
v_cvt_pk_bf16_f32 v29, v30, v31
v_mfma_f32_16x16x32_bf16 v[96:99], a[220:223], v[132:135], 0
v_cvt_pk_bf16_f32 v30, v40, v41
v_cvt_pk_bf16_f32 v31, v42, v43
v_mfma_f32_16x16x32_bf16 v[100:103], a[224:227], v[124:127], 0
ds_read_b64_tr_b16 a[216:217], v13 offset:10240
buffer_store_dwordx4 v[28:31], v16, s[32:35], s73 offen offset:0 sc1
v_mfma_f32_16x16x32_bf16 v[104:107], a[224:227], v[128:131], 0
ds_read_b64_tr_b16 a[218:219], v13 offset:10752
v_cvt_pk_bf16_f32 v32, v32, v33
v_mfma_f32_16x16x32_bf16 v[108:111], a[224:227], v[132:135], 0
v_cvt_pk_bf16_f32 v33, v34, v35
v_mfma_f32_16x16x32_bf16 v[112:115], a[228:231], v[124:127], 0
ds_read_b64_tr_b16 a[220:221], v14 offset:10240
v_mfma_f32_16x16x32_bf16 v[116:119], a[228:231], v[128:131], 0
ds_read_b64_tr_b16 a[222:223], v14 offset:10752
v_mfma_f32_16x16x32_bf16 v[120:123], a[228:231], v[132:135], 0
v_mfma_f32_16x16x32_bf16 v[76:79], a[232:235], v[136:139], v[76:79]
ds_read_b64_tr_b16 a[224:225], v11 offset:11264
v_mfma_f32_16x16x32_bf16 v[80:83], a[232:235], v[140:143], v[80:83]
ds_read_b64_tr_b16 a[226:227], v11 offset:11776
v_mfma_f32_16x16x32_bf16 v[84:87], a[232:235], v[144:147], v[84:87]
s_waitcnt lgkmcnt(8)
v_mfma_f32_16x16x32_bf16 v[88:91], a[236:239], v[136:139], v[88:91]
ds_read_b64_tr_b16 a[228:229], v12 offset:11264
v_mfma_f32_16x16x32_bf16 v[92:95], a[236:239], v[140:143], v[92:95]
ds_read_b64_tr_b16 a[230:231], v12 offset:11776
v_mfma_f32_16x16x32_bf16 v[96:99], a[236:239], v[144:147], v[96:99]
v_mfma_f32_16x16x32_bf16 v[100:103], a[240:243], v[136:139], v[100:103]
ds_read_b64_tr_b16 a[232:233], v13 offset:11264
v_mfma_f32_16x16x32_bf16 v[104:107], a[240:243], v[140:143], v[104:107]
ds_read_b64_tr_b16 a[234:235], v13 offset:11776
v_mfma_f32_16x16x32_bf16 v[108:111], a[240:243], v[144:147], v[108:111]
v_mfma_f32_16x16x32_bf16 v[112:115], a[204:207], v[136:139], v[112:115]
ds_read_b64_tr_b16 a[236:237], v14 offset:11264
v_mfma_f32_16x16x32_bf16 v[116:119], a[204:207], v[140:143], v[116:119]
ds_read_b64_tr_b16 a[238:239], v14 offset:11776
v_mfma_f32_16x16x32_bf16 v[120:123], a[204:207], v[144:147], v[120:123]
v_mfma_f32_16x16x32_bf16 v[76:79], a[208:211], v[148:151], v[76:79]
ds_read_b64_tr_b16 a[240:241], v11 offset:12288
v_mfma_f32_16x16x32_bf16 v[80:83], a[208:211], v[152:155], v[80:83]
ds_read_b64_tr_b16 a[242:243], v11 offset:12800
v_mfma_f32_16x16x32_bf16 v[84:87], a[208:211], v[156:159], v[84:87]
v_cvt_pk_bf16_f32 v34, v44, v45
s_waitcnt lgkmcnt(8)
v_mfma_f32_16x16x32_bf16 v[88:91], a[212:215], v[148:151], v[88:91]
ds_read_b64_tr_b16 a[204:205], v12 offset:12288
v_cvt_pk_bf16_f32 v35, v46, v47
v_mfma_f32_16x16x32_bf16 v[92:95], a[212:215], v[152:155], v[92:95]
ds_read_b64_tr_b16 a[206:207], v12 offset:12800
buffer_store_dwordx4 v[32:35], v16, s[32:35], s73 offen offset:256 sc1
v_mfma_f32_16x16x32_bf16 v[96:99], a[212:215], v[156:159], v[96:99]
v_cvt_pk_bf16_f32 v36, v36, v37
v_cvt_pk_bf16_f32 v37, v38, v39
v_mfma_f32_16x16x32_bf16 v[100:103], a[216:219], v[148:151], v[100:103]
ds_read_b64_tr_b16 a[208:209], v13 offset:12288
v_cvt_pk_bf16_f32 v38, v48, v49
v_mfma_f32_16x16x32_bf16 v[104:107], a[216:219], v[152:155], v[104:107]
ds_read_b64_tr_b16 a[210:211], v13 offset:12800
v_cvt_pk_bf16_f32 v39, v50, v51
v_mfma_f32_16x16x32_bf16 v[108:111], a[216:219], v[156:159], v[108:111]
buffer_store_dwordx4 v[36:39], v16, s[32:35], s73 offen offset:512 sc1
v_mfma_f32_16x16x32_bf16 v[112:115], a[220:223], v[148:151], v[112:115]
ds_read_b64_tr_b16 a[212:213], v14 offset:12288
v_mfma_f32_16x16x32_bf16 v[116:119], a[220:223], v[152:155], v[116:119]
ds_read_b64_tr_b16 a[214:215], v14 offset:12800
v_mfma_f32_16x16x32_bf16 v[120:123], a[220:223], v[156:159], v[120:123]
v_mfma_f32_16x16x32_bf16 v[76:79], a[224:227], v[160:163], v[76:79]
ds_read_b64_tr_b16 a[216:217], v11 offset:13312
v_mfma_f32_16x16x32_bf16 v[80:83], a[224:227], v[164:167], v[80:83]
ds_read_b64_tr_b16 a[218:219], v11 offset:13824
v_mfma_f32_16x16x32_bf16 v[84:87], a[224:227], v[168:171], v[84:87]
s_waitcnt lgkmcnt(8)
v_mfma_f32_16x16x32_bf16 v[88:91], a[228:231], v[160:163], v[88:91]
ds_read_b64_tr_b16 a[220:221], v12 offset:13312
v_mfma_f32_16x16x32_bf16 v[92:95], a[228:231], v[164:167], v[92:95]
ds_read_b64_tr_b16 a[222:223], v12 offset:13824
v_mfma_f32_16x16x32_bf16 v[96:99], a[228:231], v[168:171], v[96:99]
v_mfma_f32_16x16x32_bf16 v[100:103], a[232:235], v[160:163], v[100:103]
ds_read_b64_tr_b16 a[224:225], v13 offset:13312
v_mfma_f32_16x16x32_bf16 v[104:107], a[232:235], v[164:167], v[104:107]
ds_read_b64_tr_b16 a[226:227], v13 offset:13824
v_mfma_f32_16x16x32_bf16 v[108:111], a[232:235], v[168:171], v[108:111]
v_mfma_f32_16x16x32_bf16 v[112:115], a[236:239], v[160:163], v[112:115]
ds_read_b64_tr_b16 a[228:229], v14 offset:13312
v_mfma_f32_16x16x32_bf16 v[116:119], a[236:239], v[164:167], v[116:119]
ds_read_b64_tr_b16 a[230:231], v14 offset:13824
v_mfma_f32_16x16x32_bf16 v[120:123], a[236:239], v[168:171], v[120:123]
v_mfma_f32_16x16x32_bf16 v[76:79], a[240:243], v[172:175], v[76:79]
ds_read_b64_tr_b16 a[232:233], v11 offset:14336
v_mfma_f32_16x16x32_bf16 v[80:83], a[240:243], v[176:179], v[80:83]
ds_read_b64_tr_b16 a[234:235], v11 offset:14848
v_mfma_f32_16x16x32_bf16 v[84:87], a[240:243], v[180:183], v[84:87]
s_add_u32 s73, s14, 110592
s_waitcnt lgkmcnt(8)
v_mfma_f32_16x16x32_bf16 v[88:91], a[204:207], v[172:175], v[88:91]
ds_read_b64_tr_b16 a[236:237], v12 offset:14336
v_cvt_pk_bf16_f32 v52, v52, v53
v_mfma_f32_16x16x32_bf16 v[92:95], a[204:207], v[176:179], v[92:95]
ds_read_b64_tr_b16 a[238:239], v12 offset:14848
v_cvt_pk_bf16_f32 v53, v54, v55
v_mfma_f32_16x16x32_bf16 v[96:99], a[204:207], v[180:183], v[96:99]
v_cvt_pk_bf16_f32 v54, v64, v65
v_cvt_pk_bf16_f32 v55, v66, v67
v_mfma_f32_16x16x32_bf16 v[100:103], a[208:211], v[172:175], v[100:103]
ds_read_b64_tr_b16 a[240:241], v13 offset:14336
buffer_store_dwordx4 v[52:55], v16, s[32:35], s73 offen offset:0 sc1
v_mfma_f32_16x16x32_bf16 v[104:107], a[208:211], v[176:179], v[104:107]
ds_read_b64_tr_b16 a[242:243], v13 offset:14848
v_cvt_pk_bf16_f32 v56, v56, v57
v_mfma_f32_16x16x32_bf16 v[108:111], a[208:211], v[180:183], v[108:111]
v_cvt_pk_bf16_f32 v57, v58, v59
v_mfma_f32_16x16x32_bf16 v[112:115], a[212:215], v[172:175], v[112:115]
ds_read_b64_tr_b16 a[204:205], v14 offset:14336
v_mfma_f32_16x16x32_bf16 v[116:119], a[212:215], v[176:179], v[116:119]
ds_read_b64_tr_b16 a[206:207], v14 offset:14848
v_mfma_f32_16x16x32_bf16 v[120:123], a[212:215], v[180:183], v[120:123]
v_mfma_f32_16x16x32_bf16 v[76:79], a[216:219], v[184:187], v[76:79]
ds_read_b64_tr_b16 a[208:209], v11 offset:15360
v_mfma_f32_16x16x32_bf16 v[80:83], a[216:219], v[188:191], v[80:83]
ds_read_b64_tr_b16 a[210:211], v11 offset:15872
v_mfma_f32_16x16x32_bf16 v[84:87], a[216:219], v[192:195], v[84:87]
s_waitcnt lgkmcnt(8)
v_mfma_f32_16x16x32_bf16 v[88:91], a[220:223], v[184:187], v[88:91]
ds_read_b64_tr_b16 a[212:213], v12 offset:15360
v_mfma_f32_16x16x32_bf16 v[92:95], a[220:223], v[188:191], v[92:95]
ds_read_b64_tr_b16 a[214:215], v12 offset:15872
v_mfma_f32_16x16x32_bf16 v[96:99], a[220:223], v[192:195], v[96:99]
v_mfma_f32_16x16x32_bf16 v[100:103], a[224:227], v[184:187], v[100:103]
ds_read_b64_tr_b16 a[216:217], v13 offset:15360
v_mfma_f32_16x16x32_bf16 v[104:107], a[224:227], v[188:191], v[104:107]
ds_read_b64_tr_b16 a[218:219], v13 offset:15872
v_mfma_f32_16x16x32_bf16 v[108:111], a[224:227], v[192:195], v[108:111]
v_mfma_f32_16x16x32_bf16 v[112:115], a[228:231], v[184:187], v[112:115]
ds_read_b64_tr_b16 a[220:221], v14 offset:15360
v_mfma_f32_16x16x32_bf16 v[116:119], a[228:231], v[188:191], v[116:119]
ds_read_b64_tr_b16 a[222:223], v14 offset:15872
v_mfma_f32_16x16x32_bf16 v[120:123], a[228:231], v[192:195], v[120:123]
v_mfma_f32_16x16x32_bf16 v[76:79], a[232:235], v[196:199], v[76:79]
ds_read_b64_tr_b16 a[224:225], v11 offset:16384
v_mfma_f32_16x16x32_bf16 v[80:83], a[232:235], v[200:203], v[80:83]
ds_read_b64_tr_b16 a[226:227], v11 offset:16896
v_mfma_f32_16x16x32_bf16 v[84:87], a[232:235], v[204:207], v[84:87]
v_cvt_pk_bf16_f32 v58, v68, v69
s_waitcnt lgkmcnt(8)
v_mfma_f32_16x16x32_bf16 v[88:91], a[236:239], v[196:199], v[88:91]
ds_read_b64_tr_b16 a[228:229], v12 offset:16384
v_cvt_pk_bf16_f32 v59, v70, v71
v_mfma_f32_16x16x32_bf16 v[92:95], a[236:239], v[200:203], v[92:95]
ds_read_b64_tr_b16 a[230:231], v12 offset:16896
buffer_store_dwordx4 v[56:59], v16, s[32:35], s73 offen offset:256 sc1
v_mfma_f32_16x16x32_bf16 v[96:99], a[236:239], v[204:207], v[96:99]
v_cvt_pk_bf16_f32 v60, v60, v61
v_cvt_pk_bf16_f32 v61, v62, v63
v_mfma_f32_16x16x32_bf16 v[100:103], a[240:243], v[196:199], v[100:103]
ds_read_b64_tr_b16 a[232:233], v13 offset:16384
v_cvt_pk_bf16_f32 v62, v72, v73
v_mfma_f32_16x16x32_bf16 v[104:107], a[240:243], v[200:203], v[104:107]
ds_read_b64_tr_b16 a[234:235], v13 offset:16896
v_cvt_pk_bf16_f32 v63, v74, v75
v_mfma_f32_16x16x32_bf16 v[108:111], a[240:243], v[204:207], v[108:111]
buffer_store_dwordx4 v[60:63], v16, s[32:35], s73 offen offset:512 sc1
v_mfma_f32_16x16x32_bf16 v[112:115], a[204:207], v[196:199], v[112:115]
ds_read_b64_tr_b16 a[236:237], v14 offset:16384
v_mfma_f32_16x16x32_bf16 v[116:119], a[204:207], v[200:203], v[116:119]
ds_read_b64_tr_b16 a[238:239], v14 offset:16896
v_mfma_f32_16x16x32_bf16 v[120:123], a[204:207], v[204:207], v[120:123]
v_mfma_f32_16x16x32_bf16 v[76:79], a[208:211], v[208:211], v[76:79]
ds_read_b64_tr_b16 a[240:241], v11 offset:17408
v_mfma_f32_16x16x32_bf16 v[80:83], a[208:211], v[212:215], v[80:83]
ds_read_b64_tr_b16 a[242:243], v11 offset:17920
v_mfma_f32_16x16x32_bf16 v[84:87], a[208:211], v[216:219], v[84:87]
s_waitcnt lgkmcnt(8)
v_mfma_f32_16x16x32_bf16 v[88:91], a[212:215], v[208:211], v[88:91]
ds_read_b64_tr_b16 a[204:205], v12 offset:17408
v_mfma_f32_16x16x32_bf16 v[92:95], a[212:215], v[212:215], v[92:95]
ds_read_b64_tr_b16 a[206:207], v12 offset:17920
v_mfma_f32_16x16x32_bf16 v[96:99], a[212:215], v[216:219], v[96:99]
v_mfma_f32_16x16x32_bf16 v[100:103], a[216:219], v[208:211], v[100:103]
ds_read_b64_tr_b16 a[208:209], v13 offset:17408
v_mfma_f32_16x16x32_bf16 v[104:107], a[216:219], v[212:215], v[104:107]
ds_read_b64_tr_b16 a[210:211], v13 offset:17920
v_mfma_f32_16x16x32_bf16 v[108:111], a[216:219], v[216:219], v[108:111]
v_mfma_f32_16x16x32_bf16 v[112:115], a[220:223], v[208:211], v[112:115]
ds_read_b64_tr_b16 a[212:213], v14 offset:17408
v_mfma_f32_16x16x32_bf16 v[116:119], a[220:223], v[212:215], v[116:119]
ds_read_b64_tr_b16 a[214:215], v14 offset:17920
v_mfma_f32_16x16x32_bf16 v[120:123], a[220:223], v[216:219], v[120:123]
v_mfma_f32_16x16x32_bf16 v[76:79], a[224:227], v[220:223], v[76:79]
s_waitcnt vmcnt(22)
s_barrier
ds_read_b64_tr_b16 a[216:217], v11 offset:18432
v_mfma_f32_16x16x32_bf16 v[80:83], a[224:227], v[224:227], v[80:83]
ds_read_b64_tr_b16 a[218:219], v11 offset:18944
v_mfma_f32_16x16x32_bf16 v[84:87], a[224:227], v[228:231], v[84:87]
s_waitcnt lgkmcnt(8)
v_mfma_f32_16x16x32_bf16 v[88:91], a[228:231], v[220:223], v[88:91]
ds_read_b64_tr_b16 a[220:221], v12 offset:18432
v_mfma_f32_16x16x32_bf16 v[92:95], a[228:231], v[224:227], v[92:95]
ds_read_b64_tr_b16 a[222:223], v12 offset:18944
v_mfma_f32_16x16x32_bf16 v[96:99], a[228:231], v[228:231], v[96:99]
v_mfma_f32_16x16x32_bf16 v[100:103], a[232:235], v[220:223], v[100:103]
ds_read_b64_tr_b16 a[224:225], v13 offset:18432
v_mfma_f32_16x16x32_bf16 v[104:107], a[232:235], v[224:227], v[104:107]
ds_read_b64_tr_b16 a[226:227], v13 offset:18944
v_mfma_f32_16x16x32_bf16 v[108:111], a[232:235], v[228:231], v[108:111]
v_mfma_f32_16x16x32_bf16 v[112:115], a[236:239], v[220:223], v[112:115]
ds_read_b64_tr_b16 a[228:229], v14 offset:18432
v_mfma_f32_16x16x32_bf16 v[116:119], a[236:239], v[224:227], v[116:119]
ds_read_b64_tr_b16 a[230:231], v14 offset:18944
v_mfma_f32_16x16x32_bf16 v[120:123], a[236:239], v[228:231], v[120:123]
v_mfma_f32_16x16x32_bf16 v[76:79], a[240:243], v[232:235], v[76:79]
ds_read_b64_tr_b16 a[232:233], v11 offset:19456
v_mfma_f32_16x16x32_bf16 v[80:83], a[240:243], v[236:239], v[80:83]
ds_read_b64_tr_b16 a[234:235], v11 offset:19968
v_mfma_f32_16x16x32_bf16 v[84:87], a[240:243], v[240:243], v[84:87]
s_waitcnt lgkmcnt(8)
v_mfma_f32_16x16x32_bf16 v[88:91], a[204:207], v[232:235], v[88:91]
ds_read_b64_tr_b16 a[236:237], v12 offset:19456
v_mfma_f32_16x16x32_bf16 v[92:95], a[204:207], v[236:239], v[92:95]
ds_read_b64_tr_b16 a[238:239], v12 offset:19968
v_mfma_f32_16x16x32_bf16 v[96:99], a[204:207], v[240:243], v[96:99]
v_mfma_f32_16x16x32_bf16 v[100:103], a[208:211], v[232:235], v[100:103]
ds_read_b64_tr_b16 a[240:241], v13 offset:19456
v_mfma_f32_16x16x32_bf16 v[104:107], a[208:211], v[236:239], v[104:107]
ds_read_b64_tr_b16 a[242:243], v13 offset:19968
v_mfma_f32_16x16x32_bf16 v[108:111], a[208:211], v[240:243], v[108:111]
v_mfma_f32_16x16x32_bf16 v[112:115], a[212:215], v[232:235], v[112:115]
ds_read_b64_tr_b16 a[204:205], v14 offset:19456
v_mfma_f32_16x16x32_bf16 v[116:119], a[212:215], v[236:239], v[116:119]
ds_read_b64_tr_b16 a[206:207], v14 offset:19968
v_mfma_f32_16x16x32_bf16 v[120:123], a[212:215], v[240:243], v[120:123]
v_mfma_f32_16x16x32_bf16 v[28:31], a[216:219], v[124:127], 0
ds_read_b64_tr_b16 a[208:209], v11 offset:20480
v_mfma_f32_16x16x32_bf16 v[32:35], a[216:219], v[128:131], 0
ds_read_b64_tr_b16 a[210:211], v11 offset:20992
v_mfma_f32_16x16x32_bf16 v[36:39], a[216:219], v[132:135], 0
s_add_u32 s73, s14, 147456
s_waitcnt lgkmcnt(8)
v_mfma_f32_16x16x32_bf16 v[40:43], a[220:223], v[124:127], 0
ds_read_b64_tr_b16 a[212:213], v12 offset:20480
v_cvt_pk_bf16_f32 v76, v76, v77
v_mfma_f32_16x16x32_bf16 v[44:47], a[220:223], v[128:131], 0
ds_read_b64_tr_b16 a[214:215], v12 offset:20992
v_cvt_pk_bf16_f32 v77, v78, v79
v_mfma_f32_16x16x32_bf16 v[48:51], a[220:223], v[132:135], 0
v_cvt_pk_bf16_f32 v78, v88, v89
v_cvt_pk_bf16_f32 v79, v90, v91
v_mfma_f32_16x16x32_bf16 v[52:55], a[224:227], v[124:127], 0
ds_read_b64_tr_b16 a[216:217], v13 offset:20480
buffer_store_dwordx4 v[76:79], v16, s[32:35], s73 offen offset:0 sc1
v_mfma_f32_16x16x32_bf16 v[56:59], a[224:227], v[128:131], 0
ds_read_b64_tr_b16 a[218:219], v13 offset:20992
v_cvt_pk_bf16_f32 v80, v80, v81
v_mfma_f32_16x16x32_bf16 v[60:63], a[224:227], v[132:135], 0
v_cvt_pk_bf16_f32 v81, v82, v83
buffer_load_dwordx4 a[252:255], v255, s[56:59], s3 offen
v_mfma_f32_16x16x32_bf16 v[64:67], a[228:231], v[124:127], 0
ds_read_b64_tr_b16 a[220:221], v14 offset:20480
v_mfma_f32_16x16x32_bf16 v[68:71], a[228:231], v[128:131], 0
ds_read_b64_tr_b16 a[222:223], v14 offset:20992
v_mfma_f32_16x16x32_bf16 v[72:75], a[228:231], v[132:135], 0
v_mfma_f32_16x16x32_bf16 v[28:31], a[232:235], v[136:139], v[28:31]
ds_read_b64_tr_b16 a[224:225], v11 offset:21504
v_mfma_f32_16x16x32_bf16 v[32:35], a[232:235], v[140:143], v[32:35]
ds_read_b64_tr_b16 a[226:227], v11 offset:22016
v_mfma_f32_16x16x32_bf16 v[36:39], a[232:235], v[144:147], v[36:39]
s_waitcnt lgkmcnt(8)
v_mfma_f32_16x16x32_bf16 v[40:43], a[236:239], v[136:139], v[40:43]
ds_read_b64_tr_b16 a[228:229], v12 offset:21504
v_mfma_f32_16x16x32_bf16 v[44:47], a[236:239], v[140:143], v[44:47]
ds_read_b64_tr_b16 a[230:231], v12 offset:22016
v_mfma_f32_16x16x32_bf16 v[48:51], a[236:239], v[144:147], v[48:51]
v_mfma_f32_16x16x32_bf16 v[52:55], a[240:243], v[136:139], v[52:55]
ds_read_b64_tr_b16 a[232:233], v13 offset:21504
v_mfma_f32_16x16x32_bf16 v[56:59], a[240:243], v[140:143], v[56:59]
ds_read_b64_tr_b16 a[234:235], v13 offset:22016
v_mfma_f32_16x16x32_bf16 v[60:63], a[240:243], v[144:147], v[60:63]
v_mfma_f32_16x16x32_bf16 v[64:67], a[204:207], v[136:139], v[64:67]
ds_read_b64_tr_b16 a[236:237], v14 offset:21504
v_mfma_f32_16x16x32_bf16 v[68:71], a[204:207], v[140:143], v[68:71]
ds_read_b64_tr_b16 a[238:239], v14 offset:22016
v_mfma_f32_16x16x32_bf16 v[72:75], a[204:207], v[144:147], v[72:75]
v_mfma_f32_16x16x32_bf16 v[28:31], a[208:211], v[148:151], v[28:31]
ds_read_b64_tr_b16 a[240:241], v11 offset:22528
v_mfma_f32_16x16x32_bf16 v[32:35], a[208:211], v[152:155], v[32:35]
ds_read_b64_tr_b16 a[242:243], v11 offset:23040
v_mfma_f32_16x16x32_bf16 v[36:39], a[208:211], v[156:159], v[36:39]
v_cvt_pk_bf16_f32 v82, v92, v93
s_waitcnt lgkmcnt(8)
v_mfma_f32_16x16x32_bf16 v[40:43], a[212:215], v[148:151], v[40:43]
ds_read_b64_tr_b16 a[204:205], v12 offset:22528
v_cvt_pk_bf16_f32 v83, v94, v95
v_mfma_f32_16x16x32_bf16 v[44:47], a[212:215], v[152:155], v[44:47]
ds_read_b64_tr_b16 a[206:207], v12 offset:23040
buffer_store_dwordx4 v[80:83], v16, s[32:35], s73 offen offset:256 sc1
v_mfma_f32_16x16x32_bf16 v[48:51], a[212:215], v[156:159], v[48:51]
v_cvt_pk_bf16_f32 v84, v84, v85
v_cvt_pk_bf16_f32 v85, v86, v87
v_mfma_f32_16x16x32_bf16 v[52:55], a[216:219], v[148:151], v[52:55]
ds_read_b64_tr_b16 a[208:209], v13 offset:22528
v_cvt_pk_bf16_f32 v86, v96, v97
v_mfma_f32_16x16x32_bf16 v[56:59], a[216:219], v[152:155], v[56:59]
ds_read_b64_tr_b16 a[210:211], v13 offset:23040
v_cvt_pk_bf16_f32 v87, v98, v99
v_mfma_f32_16x16x32_bf16 v[60:63], a[216:219], v[156:159], v[60:63]
buffer_store_dwordx4 v[84:87], v16, s[32:35], s73 offen offset:512 sc1
v_mfma_f32_16x16x32_bf16 v[64:67], a[220:223], v[148:151], v[64:67]
ds_read_b64_tr_b16 a[212:213], v14 offset:22528
v_mfma_f32_16x16x32_bf16 v[68:71], a[220:223], v[152:155], v[68:71]
ds_read_b64_tr_b16 a[214:215], v14 offset:23040
v_mfma_f32_16x16x32_bf16 v[72:75], a[220:223], v[156:159], v[72:75]
v_mfma_f32_16x16x32_bf16 v[28:31], a[224:227], v[160:163], v[28:31]
ds_read_b64_tr_b16 a[216:217], v11 offset:23552
v_mfma_f32_16x16x32_bf16 v[32:35], a[224:227], v[164:167], v[32:35]
ds_read_b64_tr_b16 a[218:219], v11 offset:24064
v_mfma_f32_16x16x32_bf16 v[36:39], a[224:227], v[168:171], v[36:39]
s_waitcnt lgkmcnt(8)
v_mfma_f32_16x16x32_bf16 v[40:43], a[228:231], v[160:163], v[40:43]
ds_read_b64_tr_b16 a[220:221], v12 offset:23552
v_mfma_f32_16x16x32_bf16 v[44:47], a[228:231], v[164:167], v[44:47]
ds_read_b64_tr_b16 a[222:223], v12 offset:24064
v_mfma_f32_16x16x32_bf16 v[48:51], a[228:231], v[168:171], v[48:51]
v_mfma_f32_16x16x32_bf16 v[52:55], a[232:235], v[160:163], v[52:55]
ds_read_b64_tr_b16 a[224:225], v13 offset:23552
v_mfma_f32_16x16x32_bf16 v[56:59], a[232:235], v[164:167], v[56:59]
ds_read_b64_tr_b16 a[226:227], v13 offset:24064
v_mfma_f32_16x16x32_bf16 v[60:63], a[232:235], v[168:171], v[60:63]
v_mfma_f32_16x16x32_bf16 v[64:67], a[236:239], v[160:163], v[64:67]
ds_read_b64_tr_b16 a[228:229], v14 offset:23552
v_mfma_f32_16x16x32_bf16 v[68:71], a[236:239], v[164:167], v[68:71]
ds_read_b64_tr_b16 a[230:231], v14 offset:24064
v_mfma_f32_16x16x32_bf16 v[72:75], a[236:239], v[168:171], v[72:75]
v_mfma_f32_16x16x32_bf16 v[28:31], a[240:243], v[172:175], v[28:31]
ds_read_b64_tr_b16 a[232:233], v11 offset:24576
v_mfma_f32_16x16x32_bf16 v[32:35], a[240:243], v[176:179], v[32:35]
ds_read_b64_tr_b16 a[234:235], v11 offset:25088
v_mfma_f32_16x16x32_bf16 v[36:39], a[240:243], v[180:183], v[36:39]
s_add_u32 s73, s14, 184320
s_waitcnt lgkmcnt(8)
v_mfma_f32_16x16x32_bf16 v[40:43], a[204:207], v[172:175], v[40:43]
ds_read_b64_tr_b16 a[236:237], v12 offset:24576
v_cvt_pk_bf16_f32 v100, v100, v101
v_mfma_f32_16x16x32_bf16 v[44:47], a[204:207], v[176:179], v[44:47]
ds_read_b64_tr_b16 a[238:239], v12 offset:25088
v_cvt_pk_bf16_f32 v101, v102, v103
v_mfma_f32_16x16x32_bf16 v[48:51], a[204:207], v[180:183], v[48:51]
v_cvt_pk_bf16_f32 v102, v112, v113
v_cvt_pk_bf16_f32 v103, v114, v115
v_mfma_f32_16x16x32_bf16 v[52:55], a[208:211], v[172:175], v[52:55]
ds_read_b64_tr_b16 a[240:241], v13 offset:24576
buffer_store_dwordx4 v[100:103], v16, s[32:35], s73 offen offset:0 sc1
v_mfma_f32_16x16x32_bf16 v[56:59], a[208:211], v[176:179], v[56:59]
ds_read_b64_tr_b16 a[242:243], v13 offset:25088
v_cvt_pk_bf16_f32 v104, v104, v105
v_mfma_f32_16x16x32_bf16 v[60:63], a[208:211], v[180:183], v[60:63]
v_cvt_pk_bf16_f32 v105, v106, v107
v_mfma_f32_16x16x32_bf16 v[64:67], a[212:215], v[172:175], v[64:67]
ds_read_b64_tr_b16 a[204:205], v14 offset:24576
v_mfma_f32_16x16x32_bf16 v[68:71], a[212:215], v[176:179], v[68:71]
ds_read_b64_tr_b16 a[206:207], v14 offset:25088
v_mfma_f32_16x16x32_bf16 v[72:75], a[212:215], v[180:183], v[72:75]
v_mfma_f32_16x16x32_bf16 v[28:31], a[216:219], v[184:187], v[28:31]
ds_read_b64_tr_b16 a[208:209], v11 offset:25600
v_mfma_f32_16x16x32_bf16 v[32:35], a[216:219], v[188:191], v[32:35]
ds_read_b64_tr_b16 a[210:211], v11 offset:26112
v_mfma_f32_16x16x32_bf16 v[36:39], a[216:219], v[192:195], v[36:39]
s_waitcnt lgkmcnt(8)
v_mfma_f32_16x16x32_bf16 v[40:43], a[220:223], v[184:187], v[40:43]
ds_read_b64_tr_b16 a[212:213], v12 offset:25600
v_mfma_f32_16x16x32_bf16 v[44:47], a[220:223], v[188:191], v[44:47]
ds_read_b64_tr_b16 a[214:215], v12 offset:26112
v_mfma_f32_16x16x32_bf16 v[48:51], a[220:223], v[192:195], v[48:51]
v_mfma_f32_16x16x32_bf16 v[52:55], a[224:227], v[184:187], v[52:55]
ds_read_b64_tr_b16 a[216:217], v13 offset:25600
v_mfma_f32_16x16x32_bf16 v[56:59], a[224:227], v[188:191], v[56:59]
ds_read_b64_tr_b16 a[218:219], v13 offset:26112
v_mfma_f32_16x16x32_bf16 v[60:63], a[224:227], v[192:195], v[60:63]
v_mfma_f32_16x16x32_bf16 v[64:67], a[228:231], v[184:187], v[64:67]
ds_read_b64_tr_b16 a[220:221], v14 offset:25600
v_mfma_f32_16x16x32_bf16 v[68:71], a[228:231], v[188:191], v[68:71]
ds_read_b64_tr_b16 a[222:223], v14 offset:26112
v_mfma_f32_16x16x32_bf16 v[72:75], a[228:231], v[192:195], v[72:75]
v_mfma_f32_16x16x32_bf16 v[28:31], a[232:235], v[196:199], v[28:31]
ds_read_b64_tr_b16 a[224:225], v11 offset:26624
v_mfma_f32_16x16x32_bf16 v[32:35], a[232:235], v[200:203], v[32:35]
ds_read_b64_tr_b16 a[226:227], v11 offset:27136
v_mfma_f32_16x16x32_bf16 v[36:39], a[232:235], v[204:207], v[36:39]
v_cvt_pk_bf16_f32 v106, v116, v117
s_waitcnt lgkmcnt(8)
v_mfma_f32_16x16x32_bf16 v[40:43], a[236:239], v[196:199], v[40:43]
ds_read_b64_tr_b16 a[228:229], v12 offset:26624
v_cvt_pk_bf16_f32 v107, v118, v119
v_mfma_f32_16x16x32_bf16 v[44:47], a[236:239], v[200:203], v[44:47]
ds_read_b64_tr_b16 a[230:231], v12 offset:27136
buffer_store_dwordx4 v[104:107], v16, s[32:35], s73 offen offset:256 sc1
v_mfma_f32_16x16x32_bf16 v[48:51], a[236:239], v[204:207], v[48:51]
v_cvt_pk_bf16_f32 v108, v108, v109
v_cvt_pk_bf16_f32 v109, v110, v111
v_mfma_f32_16x16x32_bf16 v[52:55], a[240:243], v[196:199], v[52:55]
ds_read_b64_tr_b16 a[232:233], v13 offset:26624
v_cvt_pk_bf16_f32 v110, v120, v121
v_mfma_f32_16x16x32_bf16 v[56:59], a[240:243], v[200:203], v[56:59]
ds_read_b64_tr_b16 a[234:235], v13 offset:27136
v_cvt_pk_bf16_f32 v111, v122, v123
v_mfma_f32_16x16x32_bf16 v[60:63], a[240:243], v[204:207], v[60:63]
buffer_store_dwordx4 v[108:111], v16, s[32:35], s73 offen offset:512 sc1
v_mfma_f32_16x16x32_bf16 v[64:67], a[204:207], v[196:199], v[64:67]
ds_read_b64_tr_b16 a[236:237], v14 offset:26624
v_mfma_f32_16x16x32_bf16 v[68:71], a[204:207], v[200:203], v[68:71]
ds_read_b64_tr_b16 a[238:239], v14 offset:27136
v_mfma_f32_16x16x32_bf16 v[72:75], a[204:207], v[204:207], v[72:75]
v_mfma_f32_16x16x32_bf16 v[28:31], a[208:211], v[208:211], v[28:31]
ds_read_b64_tr_b16 a[240:241], v11 offset:27648
v_mfma_f32_16x16x32_bf16 v[32:35], a[208:211], v[212:215], v[32:35]
ds_read_b64_tr_b16 a[242:243], v11 offset:28160
v_mfma_f32_16x16x32_bf16 v[36:39], a[208:211], v[216:219], v[36:39]
s_waitcnt lgkmcnt(8)
v_mfma_f32_16x16x32_bf16 v[40:43], a[212:215], v[208:211], v[40:43]
ds_read_b64_tr_b16 a[204:205], v12 offset:27648
v_mfma_f32_16x16x32_bf16 v[44:47], a[212:215], v[212:215], v[44:47]
ds_read_b64_tr_b16 a[206:207], v12 offset:28160
v_mfma_f32_16x16x32_bf16 v[48:51], a[212:215], v[216:219], v[48:51]
v_mfma_f32_16x16x32_bf16 v[52:55], a[216:219], v[208:211], v[52:55]
ds_read_b64_tr_b16 a[208:209], v13 offset:27648
v_mfma_f32_16x16x32_bf16 v[56:59], a[216:219], v[212:215], v[56:59]
ds_read_b64_tr_b16 a[210:211], v13 offset:28160
v_mfma_f32_16x16x32_bf16 v[60:63], a[216:219], v[216:219], v[60:63]
v_mfma_f32_16x16x32_bf16 v[64:67], a[220:223], v[208:211], v[64:67]
ds_read_b64_tr_b16 a[212:213], v14 offset:27648
v_mfma_f32_16x16x32_bf16 v[68:71], a[220:223], v[212:215], v[68:71]
ds_read_b64_tr_b16 a[214:215], v14 offset:28160
v_mfma_f32_16x16x32_bf16 v[72:75], a[220:223], v[216:219], v[72:75]
v_mfma_f32_16x16x32_bf16 v[28:31], a[224:227], v[220:223], v[28:31]
s_waitcnt vmcnt(13)
s_barrier
ds_read_b64_tr_b16 a[216:217], v11 offset:28672
v_mfma_f32_16x16x32_bf16 v[32:35], a[224:227], v[224:227], v[32:35]
ds_read_b64_tr_b16 a[218:219], v11 offset:29184
v_mfma_f32_16x16x32_bf16 v[36:39], a[224:227], v[228:231], v[36:39]
s_waitcnt lgkmcnt(8)
v_mfma_f32_16x16x32_bf16 v[40:43], a[228:231], v[220:223], v[40:43]
ds_read_b64_tr_b16 a[220:221], v12 offset:28672
v_mfma_f32_16x16x32_bf16 v[44:47], a[228:231], v[224:227], v[44:47]
ds_read_b64_tr_b16 a[222:223], v12 offset:29184
v_mfma_f32_16x16x32_bf16 v[48:51], a[228:231], v[228:231], v[48:51]
v_mfma_f32_16x16x32_bf16 v[52:55], a[232:235], v[220:223], v[52:55]
ds_read_b64_tr_b16 a[224:225], v13 offset:28672
v_mfma_f32_16x16x32_bf16 v[56:59], a[232:235], v[224:227], v[56:59]
ds_read_b64_tr_b16 a[226:227], v13 offset:29184
v_mfma_f32_16x16x32_bf16 v[60:63], a[232:235], v[228:231], v[60:63]
v_mfma_f32_16x16x32_bf16 v[64:67], a[236:239], v[220:223], v[64:67]
ds_read_b64_tr_b16 a[228:229], v11 offset:29696
v_mfma_f32_16x16x32_bf16 v[68:71], a[236:239], v[224:227], v[68:71]
ds_read_b64_tr_b16 a[230:231], v11 offset:30208
v_mfma_f32_16x16x32_bf16 v[72:75], a[236:239], v[228:231], v[72:75]
v_mfma_f32_16x16x32_bf16 v[28:31], a[240:243], v[232:235], v[28:31]
ds_read_b64_tr_b16 a[232:233], v12 offset:29696
v_mfma_f32_16x16x32_bf16 v[32:35], a[240:243], v[236:239], v[32:35]
ds_read_b64_tr_b16 a[234:235], v12 offset:30208
v_mfma_f32_16x16x32_bf16 v[36:39], a[240:243], v[240:243], v[36:39]
s_waitcnt lgkmcnt(8)
v_mfma_f32_16x16x32_bf16 v[40:43], a[204:207], v[232:235], v[40:43]
ds_read_b64_tr_b16 a[236:237], v13 offset:29696
v_mfma_f32_16x16x32_bf16 v[44:47], a[204:207], v[236:239], v[44:47]
ds_read_b64_tr_b16 a[238:239], v13 offset:30208
v_mfma_f32_16x16x32_bf16 v[48:51], a[204:207], v[240:243], v[48:51]
v_mfma_f32_16x16x32_bf16 v[52:55], a[208:211], v[232:235], v[52:55]
ds_read_b64_tr_b16 a[240:241], v11 offset:30720
v_mfma_f32_16x16x32_bf16 v[56:59], a[208:211], v[236:239], v[56:59]
ds_read_b64_tr_b16 a[242:243], v11 offset:31232
v_mfma_f32_16x16x32_bf16 v[60:63], a[208:211], v[240:243], v[60:63]
v_mfma_f32_16x16x32_bf16 v[64:67], a[212:215], v[232:235], v[64:67]
ds_read_b64_tr_b16 a[204:205], v12 offset:30720
v_mfma_f32_16x16x32_bf16 v[68:71], a[212:215], v[236:239], v[68:71]
ds_read_b64_tr_b16 a[206:207], v12 offset:31232
v_mfma_f32_16x16x32_bf16 v[72:75], a[212:215], v[240:243], v[72:75]
v_mfma_f32_16x16x32_bf16 v[76:79], a[216:219], v[124:127], 0
ds_read_b64_tr_b16 a[208:209], v13 offset:30720
v_mfma_f32_16x16x32_bf16 v[80:83], a[216:219], v[128:131], 0
ds_read_b64_tr_b16 a[210:211], v13 offset:31232
v_mfma_f32_16x16x32_bf16 v[84:87], a[216:219], v[132:135], 0
s_add_u32 s73, s14, 221184
s_waitcnt lgkmcnt(8)
v_mfma_f32_16x16x32_bf16 v[88:91], a[220:223], v[124:127], 0
ds_read_b64_tr_b16 a[212:213], v11 offset:31744
v_cvt_pk_bf16_f32 v28, v28, v29
v_mfma_f32_16x16x32_bf16 v[92:95], a[220:223], v[128:131], 0
ds_read_b64_tr_b16 a[214:215], v11 offset:32256
v_cvt_pk_bf16_f32 v29, v30, v31
v_mfma_f32_16x16x32_bf16 v[96:99], a[220:223], v[132:135], 0
v_cvt_pk_bf16_f32 v30, v40, v41
v_cvt_pk_bf16_f32 v31, v42, v43
v_mfma_f32_16x16x32_bf16 v[100:103], a[224:227], v[124:127], 0
ds_read_b64_tr_b16 a[216:217], v12 offset:31744
buffer_store_dwordx4 v[28:31], v16, s[32:35], s73 offen offset:0 sc1
v_mfma_f32_16x16x32_bf16 v[104:107], a[224:227], v[128:131], 0
ds_read_b64_tr_b16 a[218:219], v12 offset:32256
v_cvt_pk_bf16_f32 v32, v32, v33
v_mfma_f32_16x16x32_bf16 v[108:111], a[224:227], v[132:135], 0
v_cvt_pk_bf16_f32 v33, v34, v35
v_mfma_f32_16x16x32_bf16 v[76:79], a[228:231], v[136:139], v[76:79]
ds_read_b64_tr_b16 a[220:221], v13 offset:31744
v_mfma_f32_16x16x32_bf16 v[80:83], a[228:231], v[140:143], v[80:83]
ds_read_b64_tr_b16 a[222:223], v13 offset:32256
v_mfma_f32_16x16x32_bf16 v[84:87], a[228:231], v[144:147], v[84:87]
v_mfma_f32_16x16x32_bf16 v[88:91], a[232:235], v[136:139], v[88:91]
ds_read_b64_tr_b16 a[224:225], v11 offset:32768
v_mfma_f32_16x16x32_bf16 v[92:95], a[232:235], v[140:143], v[92:95]
ds_read_b64_tr_b16 a[226:227], v11 offset:33280
v_mfma_f32_16x16x32_bf16 v[96:99], a[232:235], v[144:147], v[96:99]
s_waitcnt lgkmcnt(8)
v_mfma_f32_16x16x32_bf16 v[100:103], a[236:239], v[136:139], v[100:103]
ds_read_b64_tr_b16 a[228:229], v12 offset:32768
v_mfma_f32_16x16x32_bf16 v[104:107], a[236:239], v[140:143], v[104:107]
ds_read_b64_tr_b16 a[230:231], v12 offset:33280
v_mfma_f32_16x16x32_bf16 v[108:111], a[236:239], v[144:147], v[108:111]
v_mfma_f32_16x16x32_bf16 v[76:79], a[240:243], v[148:151], v[76:79]
ds_read_b64_tr_b16 a[232:233], v13 offset:32768
v_mfma_f32_16x16x32_bf16 v[80:83], a[240:243], v[152:155], v[80:83]
ds_read_b64_tr_b16 a[234:235], v13 offset:33280
v_mfma_f32_16x16x32_bf16 v[84:87], a[240:243], v[156:159], v[84:87]
v_cvt_pk_bf16_f32 v34, v44, v45
v_cvt_pk_bf16_f32 v35, v46, v47
v_mfma_f32_16x16x32_bf16 v[88:91], a[204:207], v[148:151], v[88:91]
ds_read_b64_tr_b16 a[236:237], v11 offset:33792
buffer_store_dwordx4 v[32:35], v16, s[32:35], s73 offen offset:256 sc1
v_mfma_f32_16x16x32_bf16 v[92:95], a[204:207], v[152:155], v[92:95]
ds_read_b64_tr_b16 a[238:239], v11 offset:34304
v_cvt_pk_bf16_f32 v36, v36, v37
v_mfma_f32_16x16x32_bf16 v[96:99], a[204:207], v[156:159], v[96:99]
v_cvt_pk_bf16_f32 v37, v38, v39
v_cvt_pk_bf16_f32 v38, v48, v49
v_mfma_f32_16x16x32_bf16 v[100:103], a[208:211], v[148:151], v[100:103]
ds_read_b64_tr_b16 a[240:241], v12 offset:33792
v_cvt_pk_bf16_f32 v39, v50, v51
v_mfma_f32_16x16x32_bf16 v[104:107], a[208:211], v[152:155], v[104:107]
ds_read_b64_tr_b16 a[242:243], v12 offset:34304
buffer_store_dwordx4 v[36:39], v16, s[32:35], s73 offen offset:512 sc1
v_mfma_f32_16x16x32_bf16 v[108:111], a[208:211], v[156:159], v[108:111]
s_waitcnt lgkmcnt(8)
v_mfma_f32_16x16x32_bf16 v[76:79], a[212:215], v[160:163], v[76:79]
ds_read_b64_tr_b16 a[204:205], v13 offset:33792
v_mfma_f32_16x16x32_bf16 v[80:83], a[212:215], v[164:167], v[80:83]
ds_read_b64_tr_b16 a[206:207], v13 offset:34304
v_mfma_f32_16x16x32_bf16 v[84:87], a[212:215], v[168:171], v[84:87]
v_mfma_f32_16x16x32_bf16 v[88:91], a[216:219], v[160:163], v[88:91]
ds_read_b64_tr_b16 a[208:209], v11 offset:34816
v_mfma_f32_16x16x32_bf16 v[92:95], a[216:219], v[164:167], v[92:95]
ds_read_b64_tr_b16 a[210:211], v11 offset:35328
v_mfma_f32_16x16x32_bf16 v[96:99], a[216:219], v[168:171], v[96:99]
v_mfma_f32_16x16x32_bf16 v[100:103], a[220:223], v[160:163], v[100:103]
ds_read_b64_tr_b16 a[212:213], v12 offset:34816
v_mfma_f32_16x16x32_bf16 v[104:107], a[220:223], v[164:167], v[104:107]
ds_read_b64_tr_b16 a[214:215], v12 offset:35328
v_mfma_f32_16x16x32_bf16 v[108:111], a[220:223], v[168:171], v[108:111]
v_mfma_f32_16x16x32_bf16 v[76:79], a[224:227], v[172:175], v[76:79]
ds_read_b64_tr_b16 a[216:217], v13 offset:34816
v_mfma_f32_16x16x32_bf16 v[80:83], a[224:227], v[176:179], v[80:83]
ds_read_b64_tr_b16 a[218:219], v13 offset:35328
v_mfma_f32_16x16x32_bf16 v[84:87], a[224:227], v[180:183], v[84:87]
s_add_u32 s73, s14, 258048
s_waitcnt lgkmcnt(8)
v_mfma_f32_16x16x32_bf16 v[88:91], a[228:231], v[172:175], v[88:91]
ds_read_b64_tr_b16 a[220:221], v11 offset:35840
v_cvt_pk_bf16_f32 v52, v52, v53
v_mfma_f32_16x16x32_bf16 v[92:95], a[228:231], v[176:179], v[92:95]
ds_read_b64_tr_b16 a[222:223], v11 offset:36352
v_cvt_pk_bf16_f32 v53, v54, v55
v_mfma_f32_16x16x32_bf16 v[96:99], a[228:231], v[180:183], v[96:99]
v_cvt_pk_bf16_f32 v54, v64, v65
v_cvt_pk_bf16_f32 v55, v66, v67
v_mfma_f32_16x16x32_bf16 v[100:103], a[232:235], v[172:175], v[100:103]
ds_read_b64_tr_b16 a[224:225], v12 offset:35840
buffer_store_dwordx4 v[52:55], v16, s[32:35], s73 offen offset:0 sc1
v_mfma_f32_16x16x32_bf16 v[104:107], a[232:235], v[176:179], v[104:107]
ds_read_b64_tr_b16 a[226:227], v12 offset:36352
v_cvt_pk_bf16_f32 v56, v56, v57
v_mfma_f32_16x16x32_bf16 v[108:111], a[232:235], v[180:183], v[108:111]
v_cvt_pk_bf16_f32 v57, v58, v59
v_mfma_f32_16x16x32_bf16 v[76:79], a[236:239], v[184:187], v[76:79]
ds_read_b64_tr_b16 a[228:229], v13 offset:35840
v_mfma_f32_16x16x32_bf16 v[80:83], a[236:239], v[188:191], v[80:83]
ds_read_b64_tr_b16 a[230:231], v13 offset:36352
v_mfma_f32_16x16x32_bf16 v[84:87], a[236:239], v[192:195], v[84:87]
v_mfma_f32_16x16x32_bf16 v[88:91], a[240:243], v[184:187], v[88:91]
ds_read_b64_tr_b16 a[232:233], v11 offset:36864
v_mfma_f32_16x16x32_bf16 v[92:95], a[240:243], v[188:191], v[92:95]
ds_read_b64_tr_b16 a[234:235], v11 offset:37376
v_mfma_f32_16x16x32_bf16 v[96:99], a[240:243], v[192:195], v[96:99]
s_waitcnt lgkmcnt(8)
v_mfma_f32_16x16x32_bf16 v[100:103], a[204:207], v[184:187], v[100:103]
ds_read_b64_tr_b16 a[236:237], v12 offset:36864
v_mfma_f32_16x16x32_bf16 v[104:107], a[204:207], v[188:191], v[104:107]
ds_read_b64_tr_b16 a[238:239], v12 offset:37376
v_mfma_f32_16x16x32_bf16 v[108:111], a[204:207], v[192:195], v[108:111]
v_mfma_f32_16x16x32_bf16 v[76:79], a[208:211], v[196:199], v[76:79]
ds_read_b64_tr_b16 a[240:241], v13 offset:36864
v_mfma_f32_16x16x32_bf16 v[80:83], a[208:211], v[200:203], v[80:83]
ds_read_b64_tr_b16 a[242:243], v13 offset:37376
v_mfma_f32_16x16x32_bf16 v[84:87], a[208:211], v[204:207], v[84:87]
v_cvt_pk_bf16_f32 v58, v68, v69
v_cvt_pk_bf16_f32 v59, v70, v71
v_mfma_f32_16x16x32_bf16 v[88:91], a[212:215], v[196:199], v[88:91]
ds_read_b64_tr_b16 a[204:205], v11 offset:37888
buffer_store_dwordx4 v[56:59], v16, s[32:35], s73 offen offset:256 sc1
v_mfma_f32_16x16x32_bf16 v[92:95], a[212:215], v[200:203], v[92:95]
ds_read_b64_tr_b16 a[206:207], v11 offset:38400
v_cvt_pk_bf16_f32 v60, v60, v61
v_mfma_f32_16x16x32_bf16 v[96:99], a[212:215], v[204:207], v[96:99]
v_cvt_pk_bf16_f32 v61, v62, v63
v_cvt_pk_bf16_f32 v62, v72, v73
v_mfma_f32_16x16x32_bf16 v[100:103], a[216:219], v[196:199], v[100:103]
ds_read_b64_tr_b16 a[208:209], v12 offset:37888
v_cvt_pk_bf16_f32 v63, v74, v75
v_mfma_f32_16x16x32_bf16 v[104:107], a[216:219], v[200:203], v[104:107]
ds_read_b64_tr_b16 a[210:211], v12 offset:38400
buffer_store_dwordx4 v[60:63], v16, s[32:35], s73 offen offset:512 sc1
v_mfma_f32_16x16x32_bf16 v[108:111], a[216:219], v[204:207], v[108:111]
s_waitcnt lgkmcnt(8)
v_mfma_f32_16x16x32_bf16 v[76:79], a[220:223], v[208:211], v[76:79]
ds_read_b64_tr_b16 a[212:213], v13 offset:37888
v_mfma_f32_16x16x32_bf16 v[80:83], a[220:223], v[212:215], v[80:83]
ds_read_b64_tr_b16 a[214:215], v13 offset:38400
v_mfma_f32_16x16x32_bf16 v[84:87], a[220:223], v[216:219], v[84:87]
v_mfma_f32_16x16x32_bf16 v[88:91], a[224:227], v[208:211], v[88:91]
v_mfma_f32_16x16x32_bf16 v[92:95], a[224:227], v[212:215], v[92:95]
v_mfma_f32_16x16x32_bf16 v[96:99], a[224:227], v[216:219], v[96:99]
v_mfma_f32_16x16x32_bf16 v[100:103], a[228:231], v[208:211], v[100:103]
v_mfma_f32_16x16x32_bf16 v[104:107], a[228:231], v[212:215], v[104:107]
v_mfma_f32_16x16x32_bf16 v[108:111], a[228:231], v[216:219], v[108:111]
v_mfma_f32_16x16x32_bf16 v[76:79], a[232:235], v[220:223], v[76:79]
v_mfma_f32_16x16x32_bf16 v[80:83], a[232:235], v[224:227], v[80:83]
v_mfma_f32_16x16x32_bf16 v[84:87], a[232:235], v[228:231], v[84:87]
s_waitcnt lgkmcnt(2)
v_mfma_f32_16x16x32_bf16 v[88:91], a[236:239], v[220:223], v[88:91]
v_mfma_f32_16x16x32_bf16 v[92:95], a[236:239], v[224:227], v[92:95]
v_mfma_f32_16x16x32_bf16 v[96:99], a[236:239], v[228:231], v[96:99]
v_mfma_f32_16x16x32_bf16 v[100:103], a[240:243], v[220:223], v[100:103]
v_mfma_f32_16x16x32_bf16 v[104:107], a[240:243], v[224:227], v[104:107]
v_mfma_f32_16x16x32_bf16 v[108:111], a[240:243], v[228:231], v[108:111]
v_mfma_f32_16x16x32_bf16 v[76:79], a[204:207], v[232:235], v[76:79]
v_mfma_f32_16x16x32_bf16 v[80:83], a[204:207], v[236:239], v[80:83]
v_mfma_f32_16x16x32_bf16 v[84:87], a[204:207], v[240:243], v[84:87]
v_mfma_f32_16x16x32_bf16 v[88:91], a[208:211], v[232:235], v[88:91]
v_mfma_f32_16x16x32_bf16 v[92:95], a[208:211], v[236:239], v[92:95]
v_mfma_f32_16x16x32_bf16 v[96:99], a[208:211], v[240:243], v[96:99]
s_waitcnt lgkmcnt(0)
v_mfma_f32_16x16x32_bf16 v[100:103], a[212:215], v[232:235], v[100:103]
v_mfma_f32_16x16x32_bf16 v[104:107], a[212:215], v[236:239], v[104:107]
v_mfma_f32_16x16x32_bf16 v[108:111], a[212:215], v[240:243], v[108:111]
s_add_u32 s73, s14, 294912
v_cvt_pk_bf16_f32 v76, v76, v77
v_cvt_pk_bf16_f32 v77, v78, v79
v_cvt_pk_bf16_f32 v78, v88, v89
v_cvt_pk_bf16_f32 v79, v90, v91
buffer_store_dwordx4 v[76:79], v16, s[32:35], s73 offen offset:0 sc1
v_cvt_pk_bf16_f32 v80, v80, v81
v_cvt_pk_bf16_f32 v81, v82, v83
v_cvt_pk_bf16_f32 v82, v92, v93
v_cvt_pk_bf16_f32 v83, v94, v95
buffer_store_dwordx4 v[80:83], v16, s[32:35], s73 offen offset:256 sc1
v_cvt_pk_bf16_f32 v84, v84, v85
v_cvt_pk_bf16_f32 v85, v86, v87
v_cvt_pk_bf16_f32 v86, v96, v97
v_cvt_pk_bf16_f32 v87, v98, v99
buffer_store_dwordx4 v[84:87], v16, s[32:35], s73 offen offset:512 sc1
s_add_u32 s73, s14, 331776
v_cvt_pk_bf16_f32 v100, v100, v101
v_cvt_pk_bf16_f32 v101, v102, v103
buffer_store_dwordx4 v[100:103], v16, s[32:35], s73 offen offset:0 sc1
v_cvt_pk_bf16_f32 v104, v104, v105
v_cvt_pk_bf16_f32 v105, v106, v107
buffer_store_dwordx4 v[104:107], v16, s[32:35], s73 offen offset:256 sc1
v_cvt_pk_bf16_f32 v108, v108, v109
v_cvt_pk_bf16_f32 v109, v110, v111
buffer_store_dwordx4 v[108:111], v16, s[32:35], s73 offen offset:512 sc1
s_waitcnt vmcnt(0)
s_barrier
buffer_store_dword v25, v21, s[32:35], 0 offen sc1
s_branch L_aux_fin
L_aux_help:
s_mov_b32 s36, s10
s_mov_b32 s37, s11
s_mov_b32 s38, 663552
s_mov_b32 s39, 0x20000
s_sub_u32 s73, s61, 12
s_lshl_b32 s73, s73, 2
s_add_u32 s73, s73, s60
s_mul_i32 s73, s73, 23552
buffer_load_dwordx4 a[252:255], v20, s[36:39], s73 offen offset:0
buffer_load_dwordx4 a[252:255], v20, s[36:39], s73 offen offset:1024
buffer_load_dwordx4 a[252:255], v20, s[36:39], s73 offen offset:2048
buffer_load_dwordx4 a[252:255], v20, s[36:39], s73 offen offset:3072
s_add_u32 s73, s73, 4096
buffer_load_dwordx4 a[252:255], v20, s[36:39], s73 offen offset:0
buffer_load_dwordx4 a[252:255], v20, s[36:39], s73 offen offset:1024
buffer_load_dwordx4 a[252:255], v20, s[36:39], s73 offen offset:2048
buffer_load_dwordx4 a[252:255], v20, s[36:39], s73 offen offset:3072
s_add_u32 s73, s73, 4096
buffer_load_dwordx4 a[252:255], v20, s[36:39], s73 offen offset:0
buffer_load_dwordx4 a[252:255], v20, s[36:39], s73 offen offset:1024
buffer_load_dwordx4 a[252:255], v20, s[36:39], s73 offen offset:2048
buffer_load_dwordx4 a[252:255], v20, s[36:39], s73 offen offset:3072
s_add_u32 s73, s73, 4096
buffer_load_dwordx4 a[252:255], v20, s[36:39], s73 offen offset:0
buffer_load_dwordx4 a[252:255], v20, s[36:39], s73 offen offset:1024
buffer_load_dwordx4 a[252:255], v20, s[36:39], s73 offen offset:2048
buffer_load_dwordx4 a[252:255], v20, s[36:39], s73 offen offset:3072
s_add_u32 s73, s73, 4096
buffer_load_dwordx4 a[252:255], v20, s[36:39], s73 offen offset:0
buffer_load_dwordx4 a[252:255], v20, s[36:39], s73 offen offset:1024
buffer_load_dwordx4 a[252:255], v20, s[36:39], s73 offen offset:2048
buffer_load_dwordx4 a[252:255], v20, s[36:39], s73 offen offset:3072
s_add_u32 s73, s73, 4096
buffer_load_dwordx4 a[252:255], v20, s[36:39], s73 offen offset:0
buffer_load_dwordx4 a[252:255], v20, s[36:39], s73 offen offset:1024
buffer_load_dwordx4 a[252:255], v20, s[36:39], s73 offen offset:2048
s_mov_b32 s36, s12
s_mov_b32 s37, s13
s_mov_b32 s38, 663552
s_mov_b32 s39, 0x20000
s_sub_u32 s73, s61, 12
s_lshl_b32 s73, s73, 2
s_add_u32 s73, s73, s60
s_mul_i32 s73, s73, 23552
buffer_load_dwordx4 a[252:255], v20, s[36:39], s73 offen offset:0
buffer_load_dwordx4 a[252:255], v20, s[36:39], s73 offen offset:1024
buffer_load_dwordx4 a[252:255], v20, s[36:39], s73 offen offset:2048
buffer_load_dwordx4 a[252:255], v20, s[36:39], s73 offen offset:3072
s_add_u32 s73, s73, 4096
buffer_load_dwordx4 a[252:255], v20, s[36:39], s73 offen offset:0
buffer_load_dwordx4 a[252:255], v20, s[36:39], s73 offen offset:1024
buffer_load_dwordx4 a[252:255], v20, s[36:39], s73 offen offset:2048
buffer_load_dwordx4 a[252:255], v20, s[36:39], s73 offen offset:3072
s_add_u32 s73, s73, 4096
buffer_load_dwordx4 a[252:255], v20, s[36:39], s73 offen offset:0
buffer_load_dwordx4 a[252:255], v20, s[36:39], s73 offen offset:1024
buffer_load_dwordx4 a[252:255], v20, s[36:39], s73 offen offset:2048
buffer_load_dwordx4 a[252:255], v20, s[36:39], s73 offen offset:3072
s_add_u32 s73, s73, 4096
buffer_load_dwordx4 a[252:255], v20, s[36:39], s73 offen offset:0
buffer_load_dwordx4 a[252:255], v20, s[36:39], s73 offen offset:1024
buffer_load_dwordx4 a[252:255], v20, s[36:39], s73 offen offset:2048
buffer_load_dwordx4 a[252:255], v20, s[36:39], s73 offen offset:3072
s_add_u32 s73, s73, 4096
buffer_load_dwordx4 a[252:255], v20, s[36:39], s73 offen offset:0
buffer_load_dwordx4 a[252:255], v20, s[36:39], s73 offen offset:1024
buffer_load_dwordx4 a[252:255], v20, s[36:39], s73 offen offset:2048
buffer_load_dwordx4 a[252:255], v20, s[36:39], s73 offen offset:3072
s_add_u32 s73, s73, 4096
buffer_load_dwordx4 a[252:255], v20, s[36:39], s73 offen offset:0
buffer_load_dwordx4 a[252:255], v20, s[36:39], s73 offen offset:1024
buffer_load_dwordx4 a[252:255], v20, s[36:39], s73 offen offset:2048
L_aux_fin:
s_cmp_lg_u32 s60, 3
s_cbranch_scc1 L_fin_done
s_add_u32 s73, s15, 8192
v_lshl_add_u32 v2, v1, 7, s73
s_mov_b32 s74, 200000
s_mov_b32 exec_lo, 0xfff
s_mov_b32 exec_hi, 0x0
L_poll_49:
s_sleep 8
buffer_load_dword v4, v2, s[32:35], 0 offen sc1
s_sub_u32 s74, s74, 1
s_waitcnt vmcnt(0)
v_cmp_eq_u32 vcc, s63, v4
s_cmp_eq_u32 s74, 0
s_cbranch_scc1 L_polld_50
s_cmp_eq_u64 vcc, exec
s_cbranch_scc0 L_poll_49
L_polld_50:
s_mov_b64 exec, -1
s_add_u32 s73, s15, 2048
v_lshl_add_u32 v2, v1, 7, s73
s_mov_b32 s74, 200000
s_mov_b32 exec_lo, 0xefff
s_mov_b32 exec_hi, 0x0
L_poll_51:
s_sleep 8
buffer_load_dword v4, v2, s[32:35], 0 offen sc1
s_sub_u32 s74, s74, 1
s_waitcnt vmcnt(0)
v_cmp_eq_u32 vcc, s63, v4
s_cmp_eq_u32 s74, 0
s_cbranch_scc1 L_polld_52
s_cmp_eq_u64 vcc, exec
s_cbranch_scc0 L_poll_51
L_polld_52:
s_mov_b64 exec, -1
s_lshl_b32 s73, s61, 2
v_mov_b32 v2, 2147483392
v_mov_b32 v4, s73
v_cmp_eq_u32 vcc, 0, v1
s_nop 1
v_cndmask_b32 v2, v2, v4, vcc
buffer_store_dword v22, v2, s[32:35], 0 offen sc1
s_branch L_fin_done
L_fin_done:
s_endpgm
L_end:
s_endpgm
.section .rodata,"a"
.p2align 6
.amdhsa_kernel recurrent_scan__spectral_fnet__glu_gated_reglu__prompt_kernel
  .amdhsa_next_free_vgpr 512
  .amdhsa_next_free_sgpr 102
  .amdhsa_accum_offset 256
  .amdhsa_group_segment_fixed_size 0
  .amdhsa_kernarg_size 96
  .amdhsa_user_sgpr_count 2
  .amdhsa_user_sgpr_kernarg_segment_ptr 1
  .amdhsa_system_sgpr_workgroup_id_x 1
.end_amdhsa_kernel
```
